```python
import torch

def _softmax(x, axis=-1):
    return torch.softmax(x, dim=axis)
def _gelu(x):
    return torch.nn.functional.gelu(x, approximate="tanh")
def _silu(x):
    return torch.nn.functional.silu(x)
def _sigmoid(x):
    return torch.sigmoid(x)
def _layernorm(x, axis=-1, eps=1e-5):
    m = x.mean(dim=axis, keepdim=True)
    v = x.var(dim=axis, keepdim=True, unbiased=False)
    return (x - m) / torch.sqrt(v + eps)
def _scatter_add(tgt, idx, src, axis=0):
    return tgt.clone().index_add_(axis, idx, src)
def _segment_sum(src, seg, n):
    out = torch.zeros((n,) + src.shape[1:], dtype=src.dtype)
    return out.index_add_(0, seg, src)
def _pad(x, pw):
    flat = tuple(v for pair in reversed(pw) for v in pair)
    return torch.nn.functional.pad(x, flat)

kernel_name = 'recurrent_scan__sliding_block__glu_gated_bilinear__prompt'

def setup_inputs():

    _w = (lambda a: (lambda t: t.to(torch.bfloat16) if t.is_floating_point() else t)(torch.as_tensor(a)))
    def _A_setup():
        B, S, D = 1, 2048, 1024
        return {
            "x": _w((lambda *s: torch.randn(*s, dtype=torch.bfloat16) * 0.05)(B, S, D)),
            "wqkv": _w((lambda *s: torch.randn(*s, dtype=torch.bfloat16) * 0.2)(D, 3 * D)),
            "wo": _w((lambda *s: torch.randn(*s, dtype=torch.bfloat16) * 0.2)(D, D)),
        }
    _A_in = _A_setup()

    def _B_setup():
        B, S, D, F = 1, 2048, 1024, 3584
        return {
            "x": _w((lambda *s: torch.randn(*s, dtype=torch.bfloat16) * 0.05)(B, S, D)),
            "w_gate": _w((lambda *s: torch.randn(*s, dtype=torch.bfloat16) * 0.1)(D, F) * (D ** -0.5)),
            "w_up": _w((lambda *s: torch.randn(*s, dtype=torch.bfloat16) * 0.1)(D, F) * (D ** -0.5)),
            "w_down": _w((lambda *s: torch.randn(*s, dtype=torch.bfloat16) * 0.1)(F, D) * (F ** -0.5)),
        }
    _B_in = _B_setup()

    return {
        "A_x": _A_in["x"],
        "A_wqkv": _A_in["wqkv"],
        "A_wo": _A_in["wo"],
        "B_x": _B_in["x"],
        "B_w_gate": _B_in["w_gate"],
        "B_w_up": _B_in["w_up"],
        "B_w_down": _B_in["w_down"],
    }

def reference(A_x, A_wqkv, A_wo, B_x, B_w_gate, B_w_up, B_w_down):
    def _A_ref(x, wqkv, wo):
        B, S, D = x.shape
        H = 32; Dh = D // H; W = 256
        qkv = (lambda x, *d: x.permute(*d))((x @ wqkv).reshape(B, S, 3, H, Dh), 2, 0, 3, 1, 4)
        q, k, v = qkv[0], qkv[1], qkv[2]
        scores = torch.einsum("bhqd,bhkd->bhqk", q, k) * (Dh ** -0.5)
        idx = torch.arange(S)
        mask = (idx[:, None] - idx[None, :] >= 0) & (idx[:, None] - idx[None, :] < W)
        scores = torch.where(mask[None, None], scores, -1e9)
        p = _softmax(scores, axis=-1)
        o = torch.einsum("bhqk,bhkd->bhqd", p, v)
        return (lambda x, *d: x.permute(*d))(o, 0, 2, 1, 3).reshape(B, S, D) @ wo

    def _B_ref(x, w_gate, w_up, w_down):
        g = torch.einsum("bsd,df->bsf", x, w_gate)
        u = torch.einsum("bsd,df->bsf", x, w_up)
        h = g * u
        return torch.einsum("bsf,fd->bsd", h, w_down)

    x = A_x
    xn = _layernorm(x, axis=-1)
    s = _A_ref(xn, A_wqkv, A_wo)
    g = _silu(_B_ref(xn, B_w_gate, B_w_up, B_w_down))
    return x + s * g
```

```asm
; @launch grid=(256,1,1) block=(256,1,1) lds=151552
.amdgcn_target "amdgcn-amd-amdhsa--gfx950"
.text
.globl recurrent_scan__sliding_block__glu_gated_bilinear__prompt_kernel
.p2align 8
.type recurrent_scan__sliding_block__glu_gated_bilinear__prompt_kernel,@function
recurrent_scan__sliding_block__glu_gated_bilinear__prompt_kernel:
    s_cmp_ge_u32 s2, 256
    s_cbranch_scc1 L_k2_done
    s_load_dwordx2 s[44:45], s[0:1], 0
    s_load_dwordx2 s[4:5], s[0:1], 72
    s_load_dwordx2 s[6:7], s[0:1], 8
    s_load_dwordx4 s[48:51], s[0:1], 32
    s_load_dwordx2 s[42:43], s[0:1], 64
    v_lshrrev_b32 v1, 6, v0
    v_and_b32 v22, 63, v0
    s_mov_b32 s77, s2
    v_readfirstlane_b32 s3, v1
    s_and_b32 s33, s2, 7
    s_lshr_b32 s34, s2, 3
    s_and_b32 s20, s34, 7
    s_lshr_b32 s34, s34, 3
    s_lshl_b32 s33, s33, 2
    s_lshr_b32 s33, 1982148928, s33
    s_and_b32 s33, s33, 7
    s_lshl_b32 s33, s33, 2
    s_add_u32 s21, s33, s34
    s_lshr_b32 s22, s3, 1
    s_and_b32 s23, s3, 1
    s_lshl_b32 s41, s20, 8
    v_lshrrev_b32 v23, 3, v22
    v_lshlrev_b32 v23, 11, v23
    v_and_b32 v24, 7, v22
    v_lshrrev_b32 v25, 4, v22
    v_xor_b32 v24, v24, v25
    v_lshl_add_u32 v23, v24, 4, v23
    v_xor_b32 v24, 64, v23
    s_lshl_b32 s33, s3, 6
    s_add_u32 s33, s33, s41
    s_lshl_b32 s33, s33, 11
    s_add_u32 s34, s33, 0
    v_add_u32 v1, s34, v23
    s_add_u32 s34, s33, 15360
    v_add_u32 v2, s34, v24
    s_add_u32 s34, s33, 30720
    v_add_u32 v3, s34, v23
    s_add_u32 s34, s33, 46080
    v_add_u32 v4, s34, v24
    s_add_u32 s34, s33, 65536
    v_add_u32 v5, s34, v23
    s_add_u32 s34, s33, 80896
    v_add_u32 v6, s34, v24
    s_add_u32 s34, s33, 96256
    v_add_u32 v7, s34, v23
    s_add_u32 s34, s33, 111616
    v_add_u32 v8, s34, v24
    s_lshl_b32 s31, s3, 13
    s_lshl_b32 s33, s21, 3
    s_add_u32 s33, s33, s41
    s_lshl_b32 s34, s3, 1
    s_add_u32 s40, s33, s34
    s_lshl_b32 s33, s40, 11
    v_lshlrev_b32 v25, 4, v22
    v_add_u32 v25, s33, v25
    s_lshr_b32 s33, s20, 3
    s_lshl_b32 s24, s33, 10
    s_lshl_b32 s35, s33, 4
    s_waitcnt lgkmcnt(0)
    s_mov_b32 s8, s44
    s_mov_b32 s9, s45
    s_mov_b32 s10, 4194304
    s_mov_b32 s11, 0x00020000
    v_mov_b32 v31, v25
    s_mov_b32 s62, s40
    s_add_u32 m0, s31, 81920
    s_nop 0
    buffer_load_dwordx4 v1, s[8:11], s24 offen offset:0 lds
    buffer_load_dwordx4 v2, s[8:11], s24 offen offset:1024 lds
    buffer_load_dwordx4 v3, s[8:11], s24 offen offset:2048 lds
    buffer_load_dwordx4 v4, s[8:11], s24 offen offset:3072 lds
    s_add_u32 m0, s31, 86016
    s_nop 0
    buffer_load_dwordx4 v5, s[8:11], s24 offen offset:0 lds
    buffer_load_dwordx4 v6, s[8:11], s24 offen offset:1024 lds
    buffer_load_dwordx4 v7, s[8:11], s24 offen offset:2048 lds
    buffer_load_dwordx4 v8, s[8:11], s24 offen offset:3072 lds
    s_add_u32 s24, s24, 128
    s_mov_b32 s36, s4
    s_mov_b32 s37, s5
    s_mov_b32 s38, 268435456
    s_mov_b32 s39, 0x00020000
    s_cmp_eq_u32 s22, 0
    s_cselect_b32 s52, s48, s50
    s_cselect_b32 s53, s49, s51
    s_cmp_eq_u32 s23, 0
    s_cselect_b32 s54, s6, s52
    s_cselect_b32 s55, s7, s53
    s_mov_b32 s57, 7340032
    s_cselect_b32 s56, 6291456, s57
    s_mov_b32 s57, 229376
    s_cselect_b32 s27, 196608, s57
    s_mov_b32 s12, s54
    s_mov_b32 s13, s55
    s_mov_b32 s14, s56
    s_mov_b32 s15, 0x00020000
    s_mov_b32 s16, s52
    s_mov_b32 s17, s53
    s_mov_b32 s18, 7340032
    s_mov_b32 s19, 0x00020000
    s_mov_b32 s28, 229376
    s_mov_b32 s63, s35
    s_mul_i32 s25, s35, s27
    s_mul_i32 s26, s35, s28
    s_lshl_b32 s97, s27, 5
    s_lshl_b32 s98, s28, 5
    s_mov_b32 s57, 0x32176540
    s_cmp_lt_u32 s20, 4
    s_cselect_b32 s97, 0x76543210, s57
    s_mov_b32 s98, s97
    s_lshr_b32 s33, s20, 2
    s_mul_i32 s33, s33, 3
    s_sub_u32 s33, s20, s33
    s_add_u32 s99, s33, 1
    s_max_u32 s99, s99, 1
    s_cmp_eq_u32 s22, 0
    s_cselect_b32 s78, s33, 99
    s_cmp_eq_u32 s23, 1
    s_cbranch_scc1 L_k2_wn1
    s_mul_i32 s33, s22, 192
    s_add_u32 s33, s33, 0
    v_add_u32 v23, s33, v22
    v_mul_u32_u24 v24, 5462, v23
    v_lshrrev_b32 v24, 16, v24
    v_mul_u32_u24 v25, 12, v24
    v_sub_u32 v25, v23, v25
    v_and_b32 v26, 19, v24
    v_lshrrev_b32 v27, 2, v24
    v_and_b32 v27, 1, v27
    v_lshl_add_u32 v26, v27, 3, v26
    v_lshrrev_b32 v27, 3, v24
    v_and_b32 v27, 1, v27
    v_lshl_add_u32 v26, v27, 2, v26
    v_lshrrev_b32 v27, 2, v24
    v_and_b32 v27, 1, v27
    v_lshrrev_b32 v28, 1, v25
    v_xor_b32 v28, v28, v27
    v_lshrrev_b32 v27, 1, v28
    v_lshlrev_b32 v27, 11, v27
    v_and_b32 v28, 1, v28
    v_lshl_add_u32 v27, v28, 5, v27
    v_and_b32 v28, 1, v25
    v_lshl_add_u32 v27, v28, 4, v27
    v_mul_u32_u24 v26, 6144, v26
    v_add_u32 v26, v26, v27
    s_lshl_b32 s33, s21, 6
    s_sub_u32 s33, s33, 0
    v_add_u32 v9, s33, v26
    s_mul_i32 s33, s22, 192
    s_add_u32 s33, s33, 64
    v_add_u32 v23, s33, v22
    v_mul_u32_u24 v24, 5462, v23
    v_lshrrev_b32 v24, 16, v24
    v_mul_u32_u24 v25, 12, v24
    v_sub_u32 v25, v23, v25
    v_and_b32 v26, 19, v24
    v_lshrrev_b32 v27, 2, v24
    v_and_b32 v27, 1, v27
    v_lshl_add_u32 v26, v27, 3, v26
    v_lshrrev_b32 v27, 3, v24
    v_and_b32 v27, 1, v27
    v_lshl_add_u32 v26, v27, 2, v26
    v_lshrrev_b32 v27, 2, v24
    v_and_b32 v27, 1, v27
    v_lshrrev_b32 v28, 1, v25
    v_xor_b32 v28, v28, v27
    v_lshrrev_b32 v27, 1, v28
    v_lshlrev_b32 v27, 11, v27
    v_and_b32 v28, 1, v28
    v_lshl_add_u32 v27, v28, 5, v27
    v_and_b32 v28, 1, v25
    v_lshl_add_u32 v27, v28, 4, v27
    v_mul_u32_u24 v26, 6144, v26
    v_add_u32 v26, v26, v27
    s_lshl_b32 s33, s21, 6
    s_sub_u32 s33, s33, 1024
    v_add_u32 v10, s33, v26
    s_mul_i32 s33, s22, 192
    s_add_u32 s33, s33, 128
    v_add_u32 v23, s33, v22
    v_mul_u32_u24 v24, 5462, v23
    v_lshrrev_b32 v24, 16, v24
    v_mul_u32_u24 v25, 12, v24
    v_sub_u32 v25, v23, v25
    v_and_b32 v26, 19, v24
    v_lshrrev_b32 v27, 2, v24
    v_and_b32 v27, 1, v27
    v_lshl_add_u32 v26, v27, 3, v26
    v_lshrrev_b32 v27, 3, v24
    v_and_b32 v27, 1, v27
    v_lshl_add_u32 v26, v27, 2, v26
    v_lshrrev_b32 v27, 2, v24
    v_and_b32 v27, 1, v27
    v_lshrrev_b32 v28, 1, v25
    v_xor_b32 v28, v28, v27
    v_lshrrev_b32 v27, 1, v28
    v_lshlrev_b32 v27, 11, v27
    v_and_b32 v28, 1, v28
    v_lshl_add_u32 v27, v28, 5, v27
    v_and_b32 v28, 1, v25
    v_lshl_add_u32 v27, v28, 4, v27
    v_mul_u32_u24 v26, 6144, v26
    v_add_u32 v26, v26, v27
    s_lshl_b32 s33, s21, 6
    s_sub_u32 s33, s33, 2048
    v_add_u32 v11, s33, v26
    v_add_u32 v23, 0, v22
    v_mul_u32_u24 v24, 4682, v23
    v_lshrrev_b32 v24, 16, v24
    v_mul_u32_u24 v25, 14, v24
    v_sub_u32 v25, v23, v25
    v_and_b32 v26, 19, v24
    v_lshrrev_b32 v27, 2, v24
    v_and_b32 v27, 1, v27
    v_lshl_add_u32 v26, v27, 3, v26
    v_lshrrev_b32 v27, 3, v24
    v_and_b32 v27, 1, v27
    v_lshl_add_u32 v26, v27, 2, v26
    v_mul_u32_u24 v26, 7168, v26
    v_lshl_add_u32 v26, v25, 4, v26
    s_mul_i32 s33, s21, 224
    s_sub_u32 s33, s33, 0
    v_add_u32 v12, s33, v26
    v_add_u32 v23, 64, v22
    v_mul_u32_u24 v24, 4682, v23
    v_lshrrev_b32 v24, 16, v24
    v_mul_u32_u24 v25, 14, v24
    v_sub_u32 v25, v23, v25
    v_and_b32 v26, 19, v24
    v_lshrrev_b32 v27, 2, v24
    v_and_b32 v27, 1, v27
    v_lshl_add_u32 v26, v27, 3, v26
    v_lshrrev_b32 v27, 3, v24
    v_and_b32 v27, 1, v27
    v_lshl_add_u32 v26, v27, 2, v26
    v_mul_u32_u24 v26, 7168, v26
    v_lshl_add_u32 v26, v25, 4, v26
    s_mul_i32 s33, s21, 224
    s_sub_u32 s33, s33, 1024
    v_add_u32 v13, s33, v26
    s_mul_i32 s29, s22, 3072
    s_mul_i32 s30, s22, 7168
    s_add_u32 s30, s30, 6144
    s_add_u32 m0, s29, 0
    s_nop 0
    buffer_load_dwordx4 v9, s[12:15], s25 offen offset:0 lds
    buffer_load_dwordx4 v10, s[12:15], s25 offen offset:1024 lds
    buffer_load_dwordx4 v11, s[12:15], s25 offen offset:2048 lds
    s_add_u32 m0, s30, 0
    s_nop 0
    buffer_load_dwordx4 v12, s[16:19], s26 offen offset:0 lds
    buffer_load_dwordx4 v13, s[16:19], s26 offen offset:1024 lds
    s_add_u32 s25, s25, s27
    s_add_u32 s26, s26, s28
    s_add_u32 m0, s29, 20480
    s_nop 0
    buffer_load_dwordx4 v9, s[12:15], s25 offen offset:0 lds
    buffer_load_dwordx4 v10, s[12:15], s25 offen offset:1024 lds
    buffer_load_dwordx4 v11, s[12:15], s25 offen offset:2048 lds
    s_add_u32 m0, s30, 20480
    s_nop 0
    buffer_load_dwordx4 v12, s[16:19], s26 offen offset:0 lds
    buffer_load_dwordx4 v13, s[16:19], s26 offen offset:1024 lds
    s_add_u32 s25, s25, s27
    s_add_u32 s26, s26, s28
    s_add_u32 m0, s31, 114688
    s_nop 0
    buffer_load_dwordx4 v1, s[8:11], s24 offen offset:0 lds
    buffer_load_dwordx4 v2, s[8:11], s24 offen offset:1024 lds
    buffer_load_dwordx4 v3, s[8:11], s24 offen offset:2048 lds
    buffer_load_dwordx4 v4, s[8:11], s24 offen offset:3072 lds
    s_add_u32 m0, s31, 118784
    s_nop 0
    buffer_load_dwordx4 v5, s[8:11], s24 offen offset:0 lds
    buffer_load_dwordx4 v6, s[8:11], s24 offen offset:1024 lds
    buffer_load_dwordx4 v7, s[8:11], s24 offen offset:2048 lds
    buffer_load_dwordx4 v8, s[8:11], s24 offen offset:3072 lds
    s_lshr_b32 s98, s98, 4
    s_and_b32 s24, s98, 7
    s_lshl_b32 s24, s24, 8
    v_and_b32 v23, 15, v22
    v_lshrrev_b32 v24, 4, v22
    v_lshrrev_b32 v25, 1, v23
    v_xor_b32 v25, v25, v24
    v_lshlrev_b32 v25, 4, v25
    v_lshl_add_u32 v25, v23, 7, v25
    s_lshl_b32 s33, s22, 14
    s_add_u32 s33, s33, 81920
    v_add_u32 v14, s33, v25
    v_xor_b32 v15, 64, v14
    v_lshrrev_b32 v25, 1, v24
    v_lshlrev_b32 v25, 4, v25
    v_and_b32 v26, 1, v24
    v_lshl_add_u32 v25, v26, 2, v25
    v_lshrrev_b32 v27, 2, v23
    v_add_u32 v25, v25, v27
    v_and_b32 v27, 3, v23
    v_lshlrev_b32 v27, 3, v27
    v_mul_u32_u24 v28, 224, v25
    v_add_u32 v16, v28, v27
    v_add_u32 v17, 40960, v16
    v_mul_u32_u24 v28, 192, v25
    v_add_u32 v28, v28, v27
    v_lshlrev_b32 v26, 5, v26
    v_add_u32 v18, v28, v26
    v_add_u32 v19, 40960, v18
    v_sub_u32 v20, v28, v26
    v_add_u32 v21, 40960, v20
    v_mov_b32 v72, 0
    v_mov_b32 v73, 0
    v_mov_b32 v74, 0
    v_mov_b32 v75, 0
    s_nop 1
    v_mfma_f32_32x32x16_bf16 a[80:95], v[72:75], v[72:75], 0
    v_mfma_f32_32x32x16_bf16 a[96:111], v[72:75], v[72:75], 0
    v_mfma_f32_32x32x16_bf16 a[112:127], v[72:75], v[72:75], 0
    v_mfma_f32_32x32x16_bf16 a[128:143], v[72:75], v[72:75], 0
    v_mfma_f32_32x32x16_bf16 a[144:159], v[72:75], v[72:75], 0
    v_mfma_f32_32x32x16_bf16 a[160:175], v[72:75], v[72:75], 0
    v_mfma_f32_32x32x16_bf16 a[176:191], v[72:75], v[72:75], 0
    v_mfma_f32_32x32x16_bf16 a[192:207], v[72:75], v[72:75], 0
    v_mfma_f32_32x32x16_bf16 a[208:223], v[72:75], v[72:75], 0
    v_mfma_f32_32x32x16_bf16 a[224:239], v[72:75], v[72:75], 0
    v_mfma_f32_32x32x16_bf16 a[240:255], v[72:75], v[72:75], 0
    v_mfma_f32_32x32x16_bf16 v[112:127], v[72:75], v[72:75], 0
    v_mfma_f32_32x32x16_bf16 v[128:143], v[72:75], v[72:75], 0
    v_mfma_f32_32x32x16_bf16 v[144:159], v[72:75], v[72:75], 0
    v_mfma_f32_32x32x16_bf16 v[160:175], v[72:75], v[72:75], 0
    v_mfma_f32_32x32x16_bf16 v[176:191], v[72:75], v[72:75], 0
    v_mfma_f32_32x32x16_bf16 v[192:207], v[72:75], v[72:75], 0
    v_mfma_f32_32x32x16_bf16 v[208:223], v[72:75], v[72:75], 0
    v_mfma_f32_32x32x16_bf16 v[224:239], v[72:75], v[72:75], 0
    v_mfma_f32_32x32x16_bf16 v[240:255], v[72:75], v[72:75], 0
    v_mfma_f32_32x32x16_bf16 v[32:47], v[72:75], v[72:75], 0
    v_mfma_f32_32x32x16_bf16 v[48:63], v[72:75], v[72:75], 0
    v_mfma_f32_16x16x32_bf16 v[64:67], v[72:75], v[72:75], 0
    v_mfma_f32_16x16x32_bf16 v[68:71], v[72:75], v[72:75], 0
    v_mov_b32 v72, 0x3f803f80
    v_mov_b32 v73, 0x3f803f80
    v_mov_b32 v74, 0x3f803f80
    v_mov_b32 v75, 0x3f803f80
    s_waitcnt vmcnt(13)
    s_barrier
    ds_read_b128 a[0:3], v14 offset:0
    ds_read_b128 a[4:7], v14 offset:2048
    ds_read_b128 a[8:11], v14 offset:4096
    ds_read_b128 a[12:15], v14 offset:6144
    ds_read_b128 a[16:19], v14 offset:8192
    ds_read_b128 a[20:23], v14 offset:10240
    ds_read_b128 a[24:27], v14 offset:12288
    ds_read_b128 a[28:31], v14 offset:14336
    ds_read_b64_tr_b16 a[64:65], v18 offset:128
    ds_read_b64_tr_b16 a[66:67], v18 offset:1664
    ds_read_b64_tr_b16 a[68:69], v20 offset:160
    ds_read_b64_tr_b16 a[70:71], v20 offset:1696
    s_add_u32 m0, s29, 40960
    s_nop 0
    buffer_load_dwordx4 v9, s[12:15], s25 offen offset:0 lds
    buffer_load_dwordx4 v10, s[12:15], s25 offen offset:1024 lds
    buffer_load_dwordx4 v11, s[12:15], s25 offen offset:2048 lds
    s_add_u32 m0, s30, 40960
    s_nop 0
    buffer_load_dwordx4 v12, s[16:19], s26 offen offset:0 lds
    buffer_load_dwordx4 v13, s[16:19], s26 offen offset:1024 lds
    s_add_u32 s25, s25, s27
    s_add_u32 s26, s26, s28
    s_add_u32 m0, s29, 61440
    s_nop 0
    buffer_load_dwordx4 v9, s[12:15], s25 offen offset:0 lds
    buffer_load_dwordx4 v10, s[12:15], s25 offen offset:1024 lds
    buffer_load_dwordx4 v[76:79], v31, s[8:11], 0 offen offset:0
    buffer_load_dwordx4 v[80:83], v31, s[8:11], 0 offen offset:1024
    buffer_load_dwordx4 v[84:87], v31, s[8:11], 0 offen offset:2048
    buffer_load_dwordx4 v[88:91], v31, s[8:11], 0 offen offset:3072
    v_mov_b32 v23, 0
    s_mov_b32 s33, 41156608
    buffer_load_dword v110, v23, s[36:39], s33 offen sc1
    s_lshl_b32 s33, s77, 9
    s_lshl_b32 s34, s3, 7
    s_add_u32 s33, s33, s34
    s_add_u32 s34, s33, 40632320
    v_mov_b32 v23, s34
    s_add_u32 s34, s33, 40894464
    v_writelane_b32 v23, s34, 1
    s_lshl_b32 s33, s77, 7
    s_add_u32 s34, s33, 41091072
    v_writelane_b32 v23, s34, 2
    s_add_u32 s34, s33, 41123840
    v_writelane_b32 v23, s34, 3
    s_mov_b64 exec, 15
    buffer_load_dword v0, v23, s[36:39], 0 offen
    s_mov_b64 exec, -1
    s_load_dwordx2 s[44:45], s[0:1], 16
    s_load_dwordx2 s[48:49], s[0:1], 48
    v_lshrrev_b32 v23, 4, v22
    v_and_b32 v24, 15, v22
    v_lshrrev_b32 v26, 1, v24
    v_and_b32 v24, 1, v24
    v_xor_b32 v26, v26, v23
    v_lshlrev_b32 v26, 5, v26
    v_lshl_add_u32 v26, v24, 4, v26
    v_lshl_add_u32 v26, v23, 11, v26
    v_lshlrev_b32 v27, 4, v22
    s_lshr_b32 s50, s77, 3
    s_mul_i32 s50, s50, 36
    s_mul_i32 s34, s3, 9
    s_add_u32 s50, s50, s34
    s_and_b32 s35, s77, 7
    s_mul_i32 s51, s35, 1152
    s_add_u32 s51, s51, s50
    s_lshl_b32 s51, s51, 10
    s_add_u32 s51, s51, 41943040
    s_lshl_b32 s35, s35, 8
    s_waitcnt lgkmcnt(0)
    s_add_u32 s48, s48, s35
    s_addc_u32 s49, s49, 0
    s_add_u32 s44, s44, s35
    s_addc_u32 s45, s45, 0
    s_sub_u32 s34, s50, 256
    s_cmp_lt_u32 s50, 256
    s_cselect_b32 s46, s44, s48
    s_cselect_b32 s47, s45, s49
    s_cselect_b32 s34, s50, s34
    s_lshl_b32 s34, s34, 13
    s_add_u32 s46, s46, s34
    s_addc_u32 s47, s47, 0
    s_getpc_b64 s[44:45]
L_pc_p0:
    s_sub_u32 s44, s44, L_pc_p0-recurrent_scan__sliding_block__glu_gated_bilinear__prompt_kernel
    s_subb_u32 s45, s45, 0
    s_lshr_b32 s33, s77, 3
    s_lshl_b32 s33, s33, 2
    s_add_u32 s33, s33, s3
    s_mul_i32 s33, s33, 7
    v_min_u32 v23, 6, v22
    v_add_u32 v23, s33, v23
    v_lshlrev_b32 v23, 7, v23
    v_min_u32 v23, L_text_end-recurrent_scan__sliding_block__glu_gated_bilinear__prompt_kernel-4, v23
    s_mov_b64 exec, 127
    global_load_dword v0, v23, s[44:45]
    s_mov_b64 exec, -1
    s_mov_b32 s32, 0
L_k2_w0_top:
    s_cmp_eq_u32 s32, s78
    s_cbranch_scc1 L_k2_w0_cs
    s_waitcnt lgkmcnt(2)
    v_mfma_f32_16x16x32_bf16 a[80:83], a[64:67], a[0:3], a[80:83]
    ds_read_b64_tr_b16 a[72:73], v16 offset:6144
    v_mfma_f32_16x16x32_bf16 a[84:87], a[64:67], a[4:7], a[84:87]
    ds_read_b64_tr_b16 a[74:75], v16 offset:7936
    v_mfma_f32_16x16x32_bf16 a[88:91], a[64:67], a[8:11], a[88:91]
    ds_read_b128 a[32:35], v15 offset:0
    v_mfma_f32_16x16x32_bf16 a[92:95], a[64:67], a[12:15], a[92:95]
    ds_read_b128 a[36:39], v15 offset:2048
    v_mfma_f32_16x16x32_bf16 a[96:99], a[64:67], a[16:19], a[96:99]
    buffer_load_dwordx4 v11, s[12:15], s25 offen offset:2048 lds
    v_mfma_f32_16x16x32_bf16 a[100:103], a[64:67], a[20:23], a[100:103]
    v_mfma_f32_16x16x32_bf16 a[104:107], a[64:67], a[24:27], a[104:107]
    v_mfma_f32_16x16x32_bf16 a[108:111], a[64:67], a[28:31], a[108:111]
    s_waitcnt lgkmcnt(4)
    v_mfma_f32_16x16x32_bf16 a[112:115], a[68:71], a[0:3], a[112:115]
    ds_read_b64_tr_b16 a[76:77], v16 offset:6176
    v_mfma_f32_16x16x32_bf16 a[116:119], a[68:71], a[4:7], a[116:119]
    ds_read_b64_tr_b16 a[78:79], v16 offset:7968
    v_mfma_f32_16x16x32_bf16 a[120:123], a[68:71], a[8:11], a[120:123]
    ds_read_b128 a[40:43], v15 offset:4096
    v_mfma_f32_16x16x32_bf16 a[124:127], a[68:71], a[12:15], a[124:127]
    s_add_u32 m0, s30, 61440
    ds_read_b128 a[44:47], v15 offset:6144
    v_mfma_f32_16x16x32_bf16 a[128:131], a[68:71], a[16:19], a[128:131]
    buffer_load_dwordx4 v12, s[16:19], s26 offen offset:0 lds
    v_mfma_f32_16x16x32_bf16 a[132:135], a[68:71], a[20:23], a[132:135]
    v_mfma_f32_16x16x32_bf16 a[136:139], a[68:71], a[24:27], a[136:139]
    v_mfma_f32_16x16x32_bf16 a[140:143], a[68:71], a[28:31], a[140:143]
    s_waitcnt lgkmcnt(6)
    v_mfma_f32_16x16x32_bf16 a[144:147], a[72:75], a[0:3], a[144:147]
    ds_read_b64_tr_b16 a[64:65], v16 offset:6208
    v_mfma_f32_16x16x32_bf16 a[148:151], a[72:75], a[4:7], a[148:151]
    ds_read_b64_tr_b16 a[66:67], v16 offset:8000
    v_mfma_f32_16x16x32_bf16 a[152:155], a[72:75], a[8:11], a[152:155]
    ds_read_b128 a[48:51], v15 offset:8192
    v_mfma_f32_16x16x32_bf16 a[156:159], a[72:75], a[12:15], a[156:159]
    buffer_load_dwordx4 v13, s[16:19], s26 offen offset:1024 lds
    v_mfma_f32_16x16x32_bf16 a[160:163], a[72:75], a[16:19], a[160:163]
    s_lshr_b32 s97, s97, 4
    s_and_b32 s33, s97, 7
    s_lshl_b32 s33, s33, 2
    s_mul_i32 s25, s33, s27
    s_mul_i32 s26, s33, s28
    v_mfma_f32_16x16x32_bf16 a[164:167], a[72:75], a[20:23], a[164:167]
    v_mfma_f32_16x16x32_bf16 a[168:171], a[72:75], a[24:27], a[168:171]
    v_mfma_f32_16x16x32_bf16 a[172:175], a[72:75], a[28:31], a[172:175]
    s_waitcnt lgkmcnt(5)
    v_mfma_f32_16x16x32_bf16 a[176:179], a[76:79], a[0:3], a[176:179]
    ds_read_b64_tr_b16 a[68:69], v16 offset:6240
    v_mfma_f32_16x16x32_bf16 a[180:183], a[76:79], a[4:7], a[180:183]
    ds_read_b64_tr_b16 a[70:71], v16 offset:8032
    v_mfma_f32_16x16x32_bf16 a[184:187], a[76:79], a[8:11], a[184:187]
    ds_read_b128 a[52:55], v15 offset:10240
    v_mfma_f32_16x16x32_bf16 a[188:191], a[76:79], a[12:15], a[188:191]
    v_mfma_f32_16x16x32_bf16 a[192:195], a[76:79], a[16:19], a[192:195]
    v_mfma_f32_16x16x32_bf16 a[196:199], a[76:79], a[20:23], a[196:199]
    v_mfma_f32_16x16x32_bf16 a[200:203], a[76:79], a[24:27], a[200:203]
    v_mfma_f32_16x16x32_bf16 a[204:207], a[76:79], a[28:31], a[204:207]
    s_waitcnt lgkmcnt(4)
    v_mfma_f32_16x16x32_bf16 a[208:211], a[64:67], a[0:3], a[208:211]
    ds_read_b64_tr_b16 a[72:73], v16 offset:13312
    v_mfma_f32_16x16x32_bf16 a[212:215], a[64:67], a[4:7], a[212:215]
    ds_read_b64_tr_b16 a[74:75], v16 offset:15104
    v_mfma_f32_16x16x32_bf16 a[216:219], a[64:67], a[8:11], a[216:219]
    ds_read_b128 a[56:59], v15 offset:12288
    v_mfma_f32_16x16x32_bf16 a[220:223], a[64:67], a[12:15], a[220:223]
    v_mfma_f32_16x16x32_bf16 a[224:227], a[64:67], a[16:19], a[224:227]
    v_mfma_f32_16x16x32_bf16 a[228:231], a[64:67], a[20:23], a[228:231]
    v_mfma_f32_16x16x32_bf16 a[232:235], a[64:67], a[24:27], a[232:235]
    v_mfma_f32_16x16x32_bf16 a[236:239], a[64:67], a[28:31], a[236:239]
    s_waitcnt lgkmcnt(4)
    v_mfma_f32_16x16x32_bf16 a[240:243], a[68:71], a[0:3], a[240:243]
    ds_read_b64_tr_b16 a[76:77], v16 offset:13344
    v_mfma_f32_16x16x32_bf16 a[244:247], a[68:71], a[4:7], a[244:247]
    ds_read_b64_tr_b16 a[78:79], v16 offset:15136
    v_mfma_f32_16x16x32_bf16 a[248:251], a[68:71], a[8:11], a[248:251]
    ds_read_b128 a[60:63], v15 offset:14336
    v_mfma_f32_16x16x32_bf16 a[252:255], a[68:71], a[12:15], a[252:255]
    v_mfma_f32_16x16x32_bf16 v[112:115], a[68:71], a[16:19], v[112:115]
    v_mfma_f32_16x16x32_bf16 v[116:119], a[68:71], a[20:23], v[116:119]
    v_mfma_f32_16x16x32_bf16 v[120:123], a[68:71], a[24:27], v[120:123]
    v_mfma_f32_16x16x32_bf16 v[124:127], a[68:71], a[28:31], v[124:127]
    s_waitcnt lgkmcnt(4)
    v_mfma_f32_16x16x32_bf16 v[128:131], a[72:75], a[0:3], v[128:131]
    ds_read_b64_tr_b16 a[64:65], v16 offset:13376
    v_mfma_f32_16x16x32_bf16 v[132:135], a[72:75], a[4:7], v[132:135]
    ds_read_b64_tr_b16 a[66:67], v16 offset:15168
    v_mfma_f32_16x16x32_bf16 v[136:139], a[72:75], a[8:11], v[136:139]
    ds_read_b64_tr_b16 a[68:69], v16 offset:13408
    v_mfma_f32_16x16x32_bf16 v[140:143], a[72:75], a[12:15], v[140:143]
    ds_read_b64_tr_b16 a[70:71], v16 offset:15200
    v_mfma_f32_16x16x32_bf16 v[144:147], a[72:75], a[16:19], v[144:147]
    v_mfma_f32_16x16x32_bf16 v[148:151], a[72:75], a[20:23], v[148:151]
    v_mfma_f32_16x16x32_bf16 v[152:155], a[72:75], a[24:27], v[152:155]
    v_mfma_f32_16x16x32_bf16 v[156:159], a[72:75], a[28:31], v[156:159]
    s_waitcnt lgkmcnt(5)
    v_mfma_f32_16x16x32_bf16 v[160:163], a[76:79], a[0:3], v[160:163]
    v_mfma_f32_16x16x32_bf16 v[164:167], a[76:79], a[4:7], v[164:167]
    v_mfma_f32_16x16x32_bf16 v[168:171], a[76:79], a[8:11], v[168:171]
    v_mfma_f32_16x16x32_bf16 v[172:175], a[76:79], a[12:15], v[172:175]
    v_mfma_f32_16x16x32_bf16 v[176:179], a[76:79], a[16:19], v[176:179]
    v_mfma_f32_16x16x32_bf16 v[180:183], a[76:79], a[20:23], v[180:183]
    v_mfma_f32_16x16x32_bf16 v[184:187], a[76:79], a[24:27], v[184:187]
    v_mfma_f32_16x16x32_bf16 v[188:191], a[76:79], a[28:31], v[188:191]
    s_waitcnt vmcnt(5) lgkmcnt(0)
    s_barrier
    v_mfma_f32_16x16x32_bf16 v[192:195], a[64:67], a[0:3], v[192:195]
    ds_read_b64_tr_b16 a[72:73], v18 offset:20608
    v_mfma_f32_16x16x32_bf16 v[196:199], a[64:67], a[4:7], v[196:199]
    s_add_u32 m0, s29, 0
    ds_read_b64_tr_b16 a[74:75], v18 offset:22144
    v_mfma_f32_16x16x32_bf16 v[200:203], a[64:67], a[8:11], v[200:203]
    buffer_load_dwordx4 v9, s[12:15], s25 offen offset:0 lds
    v_mfma_f32_16x16x32_bf16 v[204:207], a[64:67], a[12:15], v[204:207]
    buffer_load_dwordx4 v10, s[12:15], s25 offen offset:1024 lds
    v_mfma_f32_16x16x32_bf16 v[208:211], a[64:67], a[16:19], v[208:211]
    v_mfma_f32_16x16x32_bf16 v[212:215], a[64:67], a[20:23], v[212:215]
    v_mfma_f32_16x16x32_bf16 v[216:219], a[64:67], a[24:27], v[216:219]
    v_mfma_f32_16x16x32_bf16 v[220:223], a[64:67], a[28:31], v[220:223]
    v_mfma_f32_16x16x32_bf16 v[224:227], a[68:71], a[0:3], v[224:227]
    ds_read_b64_tr_b16 a[76:77], v20 offset:20640
    v_mfma_f32_16x16x32_bf16 v[228:231], a[68:71], a[4:7], v[228:231]
    ds_read_b64_tr_b16 a[78:79], v20 offset:22176
    v_mfma_f32_16x16x32_bf16 v[232:235], a[68:71], a[8:11], v[232:235]
    buffer_load_dwordx4 v11, s[12:15], s25 offen offset:2048 lds
    v_mfma_f32_16x16x32_bf16 v[236:239], a[68:71], a[12:15], v[236:239]
    s_add_u32 m0, s30, 0
    v_mfma_f32_16x16x32_bf16 v[240:243], a[68:71], a[16:19], v[240:243]
    buffer_load_dwordx4 v12, s[16:19], s26 offen offset:0 lds
    v_mfma_f32_16x16x32_bf16 v[244:247], a[68:71], a[20:23], v[244:247]
    v_mfma_f32_16x16x32_bf16 v[248:251], a[68:71], a[24:27], v[248:251]
    v_mfma_f32_16x16x32_bf16 v[252:255], a[68:71], a[28:31], v[252:255]
    s_waitcnt lgkmcnt(2)
    v_mfma_f32_16x16x32_bf16 a[80:83], a[72:75], a[32:35], a[80:83]
    ds_read_b64_tr_b16 a[64:65], v16 offset:26624
    v_mfma_f32_16x16x32_bf16 a[84:87], a[72:75], a[36:39], a[84:87]
    ds_read_b64_tr_b16 a[66:67], v16 offset:28416
    v_mfma_f32_16x16x32_bf16 a[88:91], a[72:75], a[40:43], a[88:91]
    ds_read_b128 a[0:3], v14 offset:32768
    v_mfma_f32_16x16x32_bf16 a[92:95], a[72:75], a[44:47], a[92:95]
    ds_read_b128 a[4:7], v14 offset:34816
    v_mfma_f32_16x16x32_bf16 a[96:99], a[72:75], a[48:51], a[96:99]
    buffer_load_dwordx4 v13, s[16:19], s26 offen offset:1024 lds
    v_mfma_f32_16x16x32_bf16 a[100:103], a[72:75], a[52:55], a[100:103]
    s_add_u32 s25, s25, s27
    s_add_u32 s26, s26, s28
    s_add_u32 m0, s31, 81920
    v_mfma_f32_16x16x32_bf16 a[104:107], a[72:75], a[56:59], a[104:107]
    buffer_load_dwordx4 v1, s[8:11], s24 offen offset:0 lds
    v_mfma_f32_16x16x32_bf16 a[108:111], a[72:75], a[60:63], a[108:111]
    s_waitcnt lgkmcnt(4)
    v_mfma_f32_16x16x32_bf16 a[112:115], a[76:79], a[32:35], a[112:115]
    ds_read_b64_tr_b16 a[68:69], v16 offset:26656
    v_mfma_f32_16x16x32_bf16 a[116:119], a[76:79], a[36:39], a[116:119]
    ds_read_b64_tr_b16 a[70:71], v16 offset:28448
    v_mfma_f32_16x16x32_bf16 a[120:123], a[76:79], a[40:43], a[120:123]
    ds_read_b128 a[8:11], v14 offset:36864
    v_mfma_f32_16x16x32_bf16 a[124:127], a[76:79], a[44:47], a[124:127]
    ds_read_b128 a[12:15], v14 offset:38912
    v_mfma_f32_16x16x32_bf16 a[128:131], a[76:79], a[48:51], a[128:131]
    buffer_load_dwordx4 v2, s[8:11], s24 offen offset:1024 lds
    v_mfma_f32_16x16x32_bf16 a[132:135], a[76:79], a[52:55], a[132:135]
    v_mfma_f32_16x16x32_bf16 a[136:139], a[76:79], a[56:59], a[136:139]
    v_mfma_f32_16x16x32_bf16 a[140:143], a[76:79], a[60:63], a[140:143]
    s_waitcnt lgkmcnt(6)
    v_mfma_f32_16x16x32_bf16 a[144:147], a[64:67], a[32:35], a[144:147]
    ds_read_b64_tr_b16 a[72:73], v16 offset:26688
    v_mfma_f32_16x16x32_bf16 a[148:151], a[64:67], a[36:39], a[148:151]
    ds_read_b64_tr_b16 a[74:75], v16 offset:28480
    v_mfma_f32_16x16x32_bf16 a[152:155], a[64:67], a[40:43], a[152:155]
    ds_read_b128 a[16:19], v14 offset:40960
    v_mfma_f32_16x16x32_bf16 a[156:159], a[64:67], a[44:47], a[156:159]
    buffer_load_dwordx4 v3, s[8:11], s24 offen offset:2048 lds
    v_mfma_f32_16x16x32_bf16 a[160:163], a[64:67], a[48:51], a[160:163]
    v_mfma_f32_16x16x32_bf16 a[164:167], a[64:67], a[52:55], a[164:167]
    v_mfma_f32_16x16x32_bf16 a[168:171], a[64:67], a[56:59], a[168:171]
    v_mfma_f32_16x16x32_bf16 a[172:175], a[64:67], a[60:63], a[172:175]
    s_waitcnt lgkmcnt(5)
    v_mfma_f32_16x16x32_bf16 a[176:179], a[68:71], a[32:35], a[176:179]
    ds_read_b64_tr_b16 a[76:77], v16 offset:26720
    v_mfma_f32_16x16x32_bf16 a[180:183], a[68:71], a[36:39], a[180:183]
    ds_read_b64_tr_b16 a[78:79], v16 offset:28512
    v_mfma_f32_16x16x32_bf16 a[184:187], a[68:71], a[40:43], a[184:187]
    ds_read_b128 a[20:23], v14 offset:43008
    v_mfma_f32_16x16x32_bf16 a[188:191], a[68:71], a[44:47], a[188:191]
    buffer_load_dwordx4 v4, s[8:11], s24 offen offset:3072 lds
    v_mfma_f32_16x16x32_bf16 a[192:195], a[68:71], a[48:51], a[192:195]
    v_mfma_f32_16x16x32_bf16 a[196:199], a[68:71], a[52:55], a[196:199]
    v_mfma_f32_16x16x32_bf16 a[200:203], a[68:71], a[56:59], a[200:203]
    v_mfma_f32_16x16x32_bf16 a[204:207], a[68:71], a[60:63], a[204:207]
    s_waitcnt lgkmcnt(4)
    v_mfma_f32_16x16x32_bf16 a[208:211], a[72:75], a[32:35], a[208:211]
    ds_read_b64_tr_b16 a[64:65], v16 offset:33792
    v_mfma_f32_16x16x32_bf16 a[212:215], a[72:75], a[36:39], a[212:215]
    ds_read_b64_tr_b16 a[66:67], v16 offset:35584
    v_mfma_f32_16x16x32_bf16 a[216:219], a[72:75], a[40:43], a[216:219]
    s_add_u32 m0, s31, 86016
    ds_read_b128 a[24:27], v14 offset:45056
    v_mfma_f32_16x16x32_bf16 a[220:223], a[72:75], a[44:47], a[220:223]
    buffer_load_dwordx4 v5, s[8:11], s24 offen offset:0 lds
    v_mfma_f32_16x16x32_bf16 a[224:227], a[72:75], a[48:51], a[224:227]
    v_mfma_f32_16x16x32_bf16 a[228:231], a[72:75], a[52:55], a[228:231]
    v_mfma_f32_16x16x32_bf16 a[232:235], a[72:75], a[56:59], a[232:235]
    v_mfma_f32_16x16x32_bf16 a[236:239], a[72:75], a[60:63], a[236:239]
    s_waitcnt lgkmcnt(4)
    v_mfma_f32_16x16x32_bf16 a[240:243], a[76:79], a[32:35], a[240:243]
    ds_read_b64_tr_b16 a[68:69], v16 offset:33824
    v_mfma_f32_16x16x32_bf16 a[244:247], a[76:79], a[36:39], a[244:247]
    ds_read_b64_tr_b16 a[70:71], v16 offset:35616
    v_mfma_f32_16x16x32_bf16 a[248:251], a[76:79], a[40:43], a[248:251]
    ds_read_b128 a[28:31], v14 offset:47104
    v_mfma_f32_16x16x32_bf16 a[252:255], a[76:79], a[44:47], a[252:255]
    buffer_load_dwordx4 v6, s[8:11], s24 offen offset:1024 lds
    v_mfma_f32_16x16x32_bf16 v[112:115], a[76:79], a[48:51], v[112:115]
    v_mfma_f32_16x16x32_bf16 v[116:119], a[76:79], a[52:55], v[116:119]
    v_mfma_f32_16x16x32_bf16 v[120:123], a[76:79], a[56:59], v[120:123]
    v_mfma_f32_16x16x32_bf16 v[124:127], a[76:79], a[60:63], v[124:127]
    s_waitcnt lgkmcnt(4)
    v_mfma_f32_16x16x32_bf16 v[128:131], a[64:67], a[32:35], v[128:131]
    ds_read_b64_tr_b16 a[72:73], v16 offset:33856
    v_mfma_f32_16x16x32_bf16 v[132:135], a[64:67], a[36:39], v[132:135]
    ds_read_b64_tr_b16 a[74:75], v16 offset:35648
    v_mfma_f32_16x16x32_bf16 v[136:139], a[64:67], a[40:43], v[136:139]
    ds_read_b64_tr_b16 a[76:77], v16 offset:33888
    v_mfma_f32_16x16x32_bf16 v[140:143], a[64:67], a[44:47], v[140:143]
    ds_read_b64_tr_b16 a[78:79], v16 offset:35680
    v_mfma_f32_16x16x32_bf16 v[144:147], a[64:67], a[48:51], v[144:147]
    buffer_load_dwordx4 v7, s[8:11], s24 offen offset:2048 lds
    v_mfma_f32_16x16x32_bf16 v[148:151], a[64:67], a[52:55], v[148:151]
    v_mfma_f32_16x16x32_bf16 v[152:155], a[64:67], a[56:59], v[152:155]
    v_mfma_f32_16x16x32_bf16 v[156:159], a[64:67], a[60:63], v[156:159]
    s_waitcnt lgkmcnt(5)
    v_mfma_f32_16x16x32_bf16 v[160:163], a[68:71], a[32:35], v[160:163]
    v_mfma_f32_16x16x32_bf16 v[164:167], a[68:71], a[36:39], v[164:167]
    v_mfma_f32_16x16x32_bf16 v[168:171], a[68:71], a[40:43], v[168:171]
    buffer_load_dwordx4 v8, s[8:11], s24 offen offset:3072 lds
    v_mfma_f32_16x16x32_bf16 v[172:175], a[68:71], a[44:47], v[172:175]
    s_add_u32 s24, s24, 128
    v_mfma_f32_16x16x32_bf16 v[176:179], a[68:71], a[48:51], v[176:179]
    v_mfma_f32_16x16x32_bf16 v[180:183], a[68:71], a[52:55], v[180:183]
    v_mfma_f32_16x16x32_bf16 v[184:187], a[68:71], a[56:59], v[184:187]
    v_mfma_f32_16x16x32_bf16 v[188:191], a[68:71], a[60:63], v[188:191]
    s_waitcnt vmcnt(25) lgkmcnt(0)
    s_barrier
    v_mfma_f32_16x16x32_bf16 v[192:195], a[72:75], a[32:35], v[192:195]
    ds_read_b64_tr_b16 a[64:65], v19 offset:128
    v_mfma_f32_16x16x32_bf16 v[196:199], a[72:75], a[36:39], v[196:199]
    s_add_u32 m0, s29, 20480
    ds_read_b64_tr_b16 a[66:67], v19 offset:1664
    v_mfma_f32_16x16x32_bf16 v[200:203], a[72:75], a[40:43], v[200:203]
    buffer_load_dwordx4 v9, s[12:15], s25 offen offset:0 lds
    v_mfma_f32_16x16x32_bf16 v[204:207], a[72:75], a[44:47], v[204:207]
    v_mfma_f32_16x16x32_bf16 v[208:211], a[72:75], a[48:51], v[208:211]
    v_mfma_f32_16x16x32_bf16 v[212:215], a[72:75], a[52:55], v[212:215]
    v_mfma_f32_16x16x32_bf16 v[216:219], a[72:75], a[56:59], v[216:219]
    v_mfma_f32_16x16x32_bf16 v[220:223], a[72:75], a[60:63], v[220:223]
    v_mfma_f32_16x16x32_bf16 v[224:227], a[76:79], a[32:35], v[224:227]
    ds_read_b64_tr_b16 a[68:69], v21 offset:160
    v_mfma_f32_16x16x32_bf16 v[228:231], a[76:79], a[36:39], v[228:231]
    ds_read_b64_tr_b16 a[70:71], v21 offset:1696
    v_mfma_f32_16x16x32_bf16 v[232:235], a[76:79], a[40:43], v[232:235]
    buffer_load_dwordx4 v10, s[12:15], s25 offen offset:1024 lds
    v_mfma_f32_16x16x32_bf16 v[236:239], a[76:79], a[44:47], v[236:239]
    v_mfma_f32_16x16x32_bf16 v[240:243], a[76:79], a[48:51], v[240:243]
    v_mfma_f32_16x16x32_bf16 v[244:247], a[76:79], a[52:55], v[244:247]
    v_mfma_f32_16x16x32_bf16 v[248:251], a[76:79], a[56:59], v[248:251]
    v_mfma_f32_16x16x32_bf16 v[252:255], a[76:79], a[60:63], v[252:255]
    s_waitcnt lgkmcnt(2)
    v_mfma_f32_16x16x32_bf16 a[80:83], a[64:67], a[0:3], a[80:83]
    ds_read_b64_tr_b16 a[72:73], v17 offset:6144
    v_mfma_f32_16x16x32_bf16 a[84:87], a[64:67], a[4:7], a[84:87]
    ds_read_b64_tr_b16 a[74:75], v17 offset:7936
    v_mfma_f32_16x16x32_bf16 a[88:91], a[64:67], a[8:11], a[88:91]
    ds_read_b128 a[32:35], v15 offset:32768
    v_mfma_f32_16x16x32_bf16 a[92:95], a[64:67], a[12:15], a[92:95]
    ds_read_b128 a[36:39], v15 offset:34816
    v_mfma_f32_16x16x32_bf16 a[96:99], a[64:67], a[16:19], a[96:99]
    buffer_load_dwordx4 v11, s[12:15], s25 offen offset:2048 lds
    v_mfma_f32_16x16x32_bf16 a[100:103], a[64:67], a[20:23], a[100:103]
    v_mfma_f32_16x16x32_bf16 a[104:107], a[64:67], a[24:27], a[104:107]
    v_mfma_f32_16x16x32_bf16 a[108:111], a[64:67], a[28:31], a[108:111]
    s_waitcnt lgkmcnt(4)
    v_mfma_f32_16x16x32_bf16 a[112:115], a[68:71], a[0:3], a[112:115]
    ds_read_b64_tr_b16 a[76:77], v17 offset:6176
    v_mfma_f32_16x16x32_bf16 a[116:119], a[68:71], a[4:7], a[116:119]
    ds_read_b64_tr_b16 a[78:79], v17 offset:7968
    v_mfma_f32_16x16x32_bf16 a[120:123], a[68:71], a[8:11], a[120:123]
    ds_read_b128 a[40:43], v15 offset:36864
    v_mfma_f32_16x16x32_bf16 a[124:127], a[68:71], a[12:15], a[124:127]
    s_add_u32 m0, s30, 20480
    ds_read_b128 a[44:47], v15 offset:38912
    v_mfma_f32_16x16x32_bf16 a[128:131], a[68:71], a[16:19], a[128:131]
    buffer_load_dwordx4 v12, s[16:19], s26 offen offset:0 lds
    v_mfma_f32_16x16x32_bf16 a[132:135], a[68:71], a[20:23], a[132:135]
    v_mfma_f32_16x16x32_bf16 a[136:139], a[68:71], a[24:27], a[136:139]
    v_mfma_f32_16x16x32_bf16 a[140:143], a[68:71], a[28:31], a[140:143]
    s_waitcnt lgkmcnt(6)
    v_mfma_f32_16x16x32_bf16 a[144:147], a[72:75], a[0:3], a[144:147]
    ds_read_b64_tr_b16 a[64:65], v17 offset:6208
    v_mfma_f32_16x16x32_bf16 a[148:151], a[72:75], a[4:7], a[148:151]
    ds_read_b64_tr_b16 a[66:67], v17 offset:8000
    v_mfma_f32_16x16x32_bf16 a[152:155], a[72:75], a[8:11], a[152:155]
    ds_read_b128 a[48:51], v15 offset:40960
    v_mfma_f32_16x16x32_bf16 a[156:159], a[72:75], a[12:15], a[156:159]
    buffer_load_dwordx4 v13, s[16:19], s26 offen offset:1024 lds
    v_mfma_f32_16x16x32_bf16 a[160:163], a[72:75], a[16:19], a[160:163]
    s_add_u32 s25, s25, s27
    s_add_u32 s26, s26, s28
    v_mfma_f32_16x16x32_bf16 a[164:167], a[72:75], a[20:23], a[164:167]
    v_mfma_f32_16x16x32_bf16 a[168:171], a[72:75], a[24:27], a[168:171]
    v_mfma_f32_16x16x32_bf16 a[172:175], a[72:75], a[28:31], a[172:175]
    s_waitcnt lgkmcnt(5)
    v_mfma_f32_16x16x32_bf16 a[176:179], a[76:79], a[0:3], a[176:179]
    ds_read_b64_tr_b16 a[68:69], v17 offset:6240
    v_mfma_f32_16x16x32_bf16 a[180:183], a[76:79], a[4:7], a[180:183]
    ds_read_b64_tr_b16 a[70:71], v17 offset:8032
    v_mfma_f32_16x16x32_bf16 a[184:187], a[76:79], a[8:11], a[184:187]
    ds_read_b128 a[52:55], v15 offset:43008
    v_mfma_f32_16x16x32_bf16 a[188:191], a[76:79], a[12:15], a[188:191]
    v_mfma_f32_16x16x32_bf16 a[192:195], a[76:79], a[16:19], a[192:195]
    v_mfma_f32_16x16x32_bf16 a[196:199], a[76:79], a[20:23], a[196:199]
    v_mfma_f32_16x16x32_bf16 a[200:203], a[76:79], a[24:27], a[200:203]
    v_mfma_f32_16x16x32_bf16 a[204:207], a[76:79], a[28:31], a[204:207]
    s_waitcnt lgkmcnt(4)
    v_mfma_f32_16x16x32_bf16 a[208:211], a[64:67], a[0:3], a[208:211]
    ds_read_b64_tr_b16 a[72:73], v17 offset:13312
    v_mfma_f32_16x16x32_bf16 a[212:215], a[64:67], a[4:7], a[212:215]
    ds_read_b64_tr_b16 a[74:75], v17 offset:15104
    v_mfma_f32_16x16x32_bf16 a[216:219], a[64:67], a[8:11], a[216:219]
    ds_read_b128 a[56:59], v15 offset:45056
    v_mfma_f32_16x16x32_bf16 a[220:223], a[64:67], a[12:15], a[220:223]
    v_mfma_f32_16x16x32_bf16 a[224:227], a[64:67], a[16:19], a[224:227]
    v_mfma_f32_16x16x32_bf16 a[228:231], a[64:67], a[20:23], a[228:231]
    v_mfma_f32_16x16x32_bf16 a[232:235], a[64:67], a[24:27], a[232:235]
    v_mfma_f32_16x16x32_bf16 a[236:239], a[64:67], a[28:31], a[236:239]
    s_waitcnt lgkmcnt(4)
    v_mfma_f32_16x16x32_bf16 a[240:243], a[68:71], a[0:3], a[240:243]
    ds_read_b64_tr_b16 a[76:77], v17 offset:13344
    v_mfma_f32_16x16x32_bf16 a[244:247], a[68:71], a[4:7], a[244:247]
    ds_read_b64_tr_b16 a[78:79], v17 offset:15136
    v_mfma_f32_16x16x32_bf16 a[248:251], a[68:71], a[8:11], a[248:251]
    ds_read_b128 a[60:63], v15 offset:47104
    v_mfma_f32_16x16x32_bf16 a[252:255], a[68:71], a[12:15], a[252:255]
    v_mfma_f32_16x16x32_bf16 v[112:115], a[68:71], a[16:19], v[112:115]
    v_mfma_f32_16x16x32_bf16 v[116:119], a[68:71], a[20:23], v[116:119]
    v_mfma_f32_16x16x32_bf16 v[120:123], a[68:71], a[24:27], v[120:123]
    v_mfma_f32_16x16x32_bf16 v[124:127], a[68:71], a[28:31], v[124:127]
    s_waitcnt lgkmcnt(4)
    v_mfma_f32_16x16x32_bf16 v[128:131], a[72:75], a[0:3], v[128:131]
    ds_read_b64_tr_b16 a[64:65], v17 offset:13376
    v_mfma_f32_16x16x32_bf16 v[132:135], a[72:75], a[4:7], v[132:135]
    ds_read_b64_tr_b16 a[66:67], v17 offset:15168
    v_mfma_f32_16x16x32_bf16 v[136:139], a[72:75], a[8:11], v[136:139]
    ds_read_b64_tr_b16 a[68:69], v17 offset:13408
    v_mfma_f32_16x16x32_bf16 v[140:143], a[72:75], a[12:15], v[140:143]
    ds_read_b64_tr_b16 a[70:71], v17 offset:15200
    v_mfma_f32_16x16x32_bf16 v[144:147], a[72:75], a[16:19], v[144:147]
    v_mfma_f32_16x16x32_bf16 v[148:151], a[72:75], a[20:23], v[148:151]
    v_mfma_f32_16x16x32_bf16 v[152:155], a[72:75], a[24:27], v[152:155]
    v_mfma_f32_16x16x32_bf16 v[156:159], a[72:75], a[28:31], v[156:159]
    s_waitcnt lgkmcnt(5)
    v_mfma_f32_16x16x32_bf16 v[160:163], a[76:79], a[0:3], v[160:163]
    v_mfma_f32_16x16x32_bf16 v[164:167], a[76:79], a[4:7], v[164:167]
    v_mfma_f32_16x16x32_bf16 v[168:171], a[76:79], a[8:11], v[168:171]
    v_mfma_f32_16x16x32_bf16 v[172:175], a[76:79], a[12:15], v[172:175]
    v_mfma_f32_16x16x32_bf16 v[176:179], a[76:79], a[16:19], v[176:179]
    v_mfma_f32_16x16x32_bf16 v[180:183], a[76:79], a[20:23], v[180:183]
    v_mfma_f32_16x16x32_bf16 v[184:187], a[76:79], a[24:27], v[184:187]
    v_mfma_f32_16x16x32_bf16 v[188:191], a[76:79], a[28:31], v[188:191]
    s_waitcnt vmcnt(5) lgkmcnt(0)
    s_barrier
    v_mfma_f32_16x16x32_bf16 v[192:195], a[64:67], a[0:3], v[192:195]
    ds_read_b64_tr_b16 a[72:73], v19 offset:20608
    v_mfma_f32_16x16x32_bf16 v[196:199], a[64:67], a[4:7], v[196:199]
    s_add_u32 m0, s29, 40960
    ds_read_b64_tr_b16 a[74:75], v19 offset:22144
    v_mfma_f32_16x16x32_bf16 v[200:203], a[64:67], a[8:11], v[200:203]
    buffer_load_dwordx4 v9, s[12:15], s25 offen offset:0 lds
    v_mfma_f32_16x16x32_bf16 v[204:207], a[64:67], a[12:15], v[204:207]
    buffer_load_dwordx4 v10, s[12:15], s25 offen offset:1024 lds
    v_mfma_f32_16x16x32_bf16 v[208:211], a[64:67], a[16:19], v[208:211]
    v_mfma_f32_16x16x32_bf16 v[212:215], a[64:67], a[20:23], v[212:215]
    v_mfma_f32_16x16x32_bf16 v[216:219], a[64:67], a[24:27], v[216:219]
    v_mfma_f32_16x16x32_bf16 v[220:223], a[64:67], a[28:31], v[220:223]
    v_mfma_f32_16x16x32_bf16 v[224:227], a[68:71], a[0:3], v[224:227]
    ds_read_b64_tr_b16 a[76:77], v21 offset:20640
    v_mfma_f32_16x16x32_bf16 v[228:231], a[68:71], a[4:7], v[228:231]
    ds_read_b64_tr_b16 a[78:79], v21 offset:22176
    v_mfma_f32_16x16x32_bf16 v[232:235], a[68:71], a[8:11], v[232:235]
    buffer_load_dwordx4 v11, s[12:15], s25 offen offset:2048 lds
    v_mfma_f32_16x16x32_bf16 v[236:239], a[68:71], a[12:15], v[236:239]
    s_add_u32 m0, s30, 40960
    v_mfma_f32_16x16x32_bf16 v[240:243], a[68:71], a[16:19], v[240:243]
    buffer_load_dwordx4 v12, s[16:19], s26 offen offset:0 lds
    v_mfma_f32_16x16x32_bf16 v[244:247], a[68:71], a[20:23], v[244:247]
    v_mfma_f32_16x16x32_bf16 v[248:251], a[68:71], a[24:27], v[248:251]
    v_mfma_f32_16x16x32_bf16 v[252:255], a[68:71], a[28:31], v[252:255]
    s_waitcnt lgkmcnt(2)
    v_mfma_f32_16x16x32_bf16 a[80:83], a[72:75], a[32:35], a[80:83]
    ds_read_b64_tr_b16 a[64:65], v17 offset:26624
    v_mfma_f32_16x16x32_bf16 a[84:87], a[72:75], a[36:39], a[84:87]
    ds_read_b64_tr_b16 a[66:67], v17 offset:28416
    v_mfma_f32_16x16x32_bf16 a[88:91], a[72:75], a[40:43], a[88:91]
    ds_read_b128 a[0:3], v14 offset:0
    v_mfma_f32_16x16x32_bf16 a[92:95], a[72:75], a[44:47], a[92:95]
    ds_read_b128 a[4:7], v14 offset:2048
    v_mfma_f32_16x16x32_bf16 a[96:99], a[72:75], a[48:51], a[96:99]
    buffer_load_dwordx4 v13, s[16:19], s26 offen offset:1024 lds
    v_mfma_f32_16x16x32_bf16 a[100:103], a[72:75], a[52:55], a[100:103]
    s_add_u32 s25, s25, s27
    s_add_u32 s26, s26, s28
    s_add_u32 m0, s31, 114688
    v_mfma_f32_16x16x32_bf16 a[104:107], a[72:75], a[56:59], a[104:107]
    buffer_load_dwordx4 v1, s[8:11], s24 offen offset:0 lds
    v_mfma_f32_16x16x32_bf16 a[108:111], a[72:75], a[60:63], a[108:111]
    s_waitcnt lgkmcnt(4)
    v_mfma_f32_16x16x32_bf16 a[112:115], a[76:79], a[32:35], a[112:115]
    ds_read_b64_tr_b16 a[68:69], v17 offset:26656
    v_mfma_f32_16x16x32_bf16 a[116:119], a[76:79], a[36:39], a[116:119]
    ds_read_b64_tr_b16 a[70:71], v17 offset:28448
    v_mfma_f32_16x16x32_bf16 a[120:123], a[76:79], a[40:43], a[120:123]
    ds_read_b128 a[8:11], v14 offset:4096
    v_mfma_f32_16x16x32_bf16 a[124:127], a[76:79], a[44:47], a[124:127]
    ds_read_b128 a[12:15], v14 offset:6144
    v_mfma_f32_16x16x32_bf16 a[128:131], a[76:79], a[48:51], a[128:131]
    buffer_load_dwordx4 v2, s[8:11], s24 offen offset:1024 lds
    v_mfma_f32_16x16x32_bf16 a[132:135], a[76:79], a[52:55], a[132:135]
    v_mfma_f32_16x16x32_bf16 a[136:139], a[76:79], a[56:59], a[136:139]
    v_mfma_f32_16x16x32_bf16 a[140:143], a[76:79], a[60:63], a[140:143]
    s_waitcnt lgkmcnt(6)
    v_mfma_f32_16x16x32_bf16 a[144:147], a[64:67], a[32:35], a[144:147]
    ds_read_b64_tr_b16 a[72:73], v17 offset:26688
    v_mfma_f32_16x16x32_bf16 a[148:151], a[64:67], a[36:39], a[148:151]
    ds_read_b64_tr_b16 a[74:75], v17 offset:28480
    v_mfma_f32_16x16x32_bf16 a[152:155], a[64:67], a[40:43], a[152:155]
    ds_read_b128 a[16:19], v14 offset:8192
    v_mfma_f32_16x16x32_bf16 a[156:159], a[64:67], a[44:47], a[156:159]
    buffer_load_dwordx4 v3, s[8:11], s24 offen offset:2048 lds
    v_mfma_f32_16x16x32_bf16 a[160:163], a[64:67], a[48:51], a[160:163]
    v_mfma_f32_16x16x32_bf16 a[164:167], a[64:67], a[52:55], a[164:167]
    v_mfma_f32_16x16x32_bf16 a[168:171], a[64:67], a[56:59], a[168:171]
    v_mfma_f32_16x16x32_bf16 a[172:175], a[64:67], a[60:63], a[172:175]
    s_waitcnt lgkmcnt(5)
    v_mfma_f32_16x16x32_bf16 a[176:179], a[68:71], a[32:35], a[176:179]
    ds_read_b64_tr_b16 a[76:77], v17 offset:26720
    v_mfma_f32_16x16x32_bf16 a[180:183], a[68:71], a[36:39], a[180:183]
    ds_read_b64_tr_b16 a[78:79], v17 offset:28512
    v_mfma_f32_16x16x32_bf16 a[184:187], a[68:71], a[40:43], a[184:187]
    ds_read_b128 a[20:23], v14 offset:10240
    v_mfma_f32_16x16x32_bf16 a[188:191], a[68:71], a[44:47], a[188:191]
    buffer_load_dwordx4 v4, s[8:11], s24 offen offset:3072 lds
    v_mfma_f32_16x16x32_bf16 a[192:195], a[68:71], a[48:51], a[192:195]
    v_mfma_f32_16x16x32_bf16 a[196:199], a[68:71], a[52:55], a[196:199]
    v_mfma_f32_16x16x32_bf16 a[200:203], a[68:71], a[56:59], a[200:203]
    v_mfma_f32_16x16x32_bf16 a[204:207], a[68:71], a[60:63], a[204:207]
    s_waitcnt lgkmcnt(4)
    v_mfma_f32_16x16x32_bf16 a[208:211], a[72:75], a[32:35], a[208:211]
    ds_read_b64_tr_b16 a[64:65], v17 offset:33792
    v_mfma_f32_16x16x32_bf16 a[212:215], a[72:75], a[36:39], a[212:215]
    ds_read_b64_tr_b16 a[66:67], v17 offset:35584
    v_mfma_f32_16x16x32_bf16 a[216:219], a[72:75], a[40:43], a[216:219]
    s_add_u32 m0, s31, 118784
    ds_read_b128 a[24:27], v14 offset:12288
    v_mfma_f32_16x16x32_bf16 a[220:223], a[72:75], a[44:47], a[220:223]
    buffer_load_dwordx4 v5, s[8:11], s24 offen offset:0 lds
    v_mfma_f32_16x16x32_bf16 a[224:227], a[72:75], a[48:51], a[224:227]
    v_mfma_f32_16x16x32_bf16 a[228:231], a[72:75], a[52:55], a[228:231]
    v_mfma_f32_16x16x32_bf16 a[232:235], a[72:75], a[56:59], a[232:235]
    v_mfma_f32_16x16x32_bf16 a[236:239], a[72:75], a[60:63], a[236:239]
    s_waitcnt lgkmcnt(4)
    v_mfma_f32_16x16x32_bf16 a[240:243], a[76:79], a[32:35], a[240:243]
    ds_read_b64_tr_b16 a[68:69], v17 offset:33824
    v_mfma_f32_16x16x32_bf16 a[244:247], a[76:79], a[36:39], a[244:247]
    ds_read_b64_tr_b16 a[70:71], v17 offset:35616
    v_mfma_f32_16x16x32_bf16 a[248:251], a[76:79], a[40:43], a[248:251]
    ds_read_b128 a[28:31], v14 offset:14336
    v_mfma_f32_16x16x32_bf16 a[252:255], a[76:79], a[44:47], a[252:255]
    buffer_load_dwordx4 v6, s[8:11], s24 offen offset:1024 lds
    v_mfma_f32_16x16x32_bf16 v[112:115], a[76:79], a[48:51], v[112:115]
    v_mfma_f32_16x16x32_bf16 v[116:119], a[76:79], a[52:55], v[116:119]
    v_mfma_f32_16x16x32_bf16 v[120:123], a[76:79], a[56:59], v[120:123]
    v_mfma_f32_16x16x32_bf16 v[124:127], a[76:79], a[60:63], v[124:127]
    s_waitcnt lgkmcnt(4)
    v_mfma_f32_16x16x32_bf16 v[128:131], a[64:67], a[32:35], v[128:131]
    ds_read_b64_tr_b16 a[72:73], v17 offset:33856
    v_mfma_f32_16x16x32_bf16 v[132:135], a[64:67], a[36:39], v[132:135]
    ds_read_b64_tr_b16 a[74:75], v17 offset:35648
    v_mfma_f32_16x16x32_bf16 v[136:139], a[64:67], a[40:43], v[136:139]
    ds_read_b64_tr_b16 a[76:77], v17 offset:33888
    v_mfma_f32_16x16x32_bf16 v[140:143], a[64:67], a[44:47], v[140:143]
    ds_read_b64_tr_b16 a[78:79], v17 offset:35680
    v_mfma_f32_16x16x32_bf16 v[144:147], a[64:67], a[48:51], v[144:147]
    buffer_load_dwordx4 v7, s[8:11], s24 offen offset:2048 lds
    v_mfma_f32_16x16x32_bf16 v[148:151], a[64:67], a[52:55], v[148:151]
    v_mfma_f32_16x16x32_bf16 v[152:155], a[64:67], a[56:59], v[152:155]
    v_mfma_f32_16x16x32_bf16 v[156:159], a[64:67], a[60:63], v[156:159]
    s_waitcnt lgkmcnt(5)
    v_mfma_f32_16x16x32_bf16 v[160:163], a[68:71], a[32:35], v[160:163]
    v_mfma_f32_16x16x32_bf16 v[164:167], a[68:71], a[36:39], v[164:167]
    v_mfma_f32_16x16x32_bf16 v[168:171], a[68:71], a[40:43], v[168:171]
    buffer_load_dwordx4 v8, s[8:11], s24 offen offset:3072 lds
    v_mfma_f32_16x16x32_bf16 v[172:175], a[68:71], a[44:47], v[172:175]
    s_lshr_b32 s98, s98, 4
    s_and_b32 s24, s98, 7
    s_lshl_b32 s24, s24, 8
    v_mfma_f32_16x16x32_bf16 v[176:179], a[68:71], a[48:51], v[176:179]
    v_mfma_f32_16x16x32_bf16 v[180:183], a[68:71], a[52:55], v[180:183]
    v_mfma_f32_16x16x32_bf16 v[184:187], a[68:71], a[56:59], v[184:187]
    v_mfma_f32_16x16x32_bf16 v[188:191], a[68:71], a[60:63], v[188:191]
    s_waitcnt lgkmcnt(0)
    s_barrier
    v_mfma_f32_16x16x32_bf16 v[192:195], a[72:75], a[32:35], v[192:195]
    ds_read_b64_tr_b16 a[64:65], v18 offset:128
    v_mfma_f32_16x16x32_bf16 v[196:199], a[72:75], a[36:39], v[196:199]
    s_add_u32 m0, s29, 61440
    ds_read_b64_tr_b16 a[66:67], v18 offset:1664
    v_mfma_f32_16x16x32_bf16 v[200:203], a[72:75], a[40:43], v[200:203]
    buffer_load_dwordx4 v9, s[12:15], s25 offen offset:0 lds
    v_mfma_f32_16x16x32_bf16 v[204:207], a[72:75], a[44:47], v[204:207]
    v_mfma_f32_16x16x32_bf16 v[208:211], a[72:75], a[48:51], v[208:211]
    v_mfma_f32_16x16x32_bf16 v[212:215], a[72:75], a[52:55], v[212:215]
    v_mfma_f32_16x16x32_bf16 v[216:219], a[72:75], a[56:59], v[216:219]
    v_mfma_f32_16x16x32_bf16 v[220:223], a[72:75], a[60:63], v[220:223]
    v_mfma_f32_16x16x32_bf16 v[224:227], a[76:79], a[32:35], v[224:227]
    ds_read_b64_tr_b16 a[68:69], v20 offset:160
    v_mfma_f32_16x16x32_bf16 v[228:231], a[76:79], a[36:39], v[228:231]
    ds_read_b64_tr_b16 a[70:71], v20 offset:1696
    v_mfma_f32_16x16x32_bf16 v[232:235], a[76:79], a[40:43], v[232:235]
    buffer_load_dwordx4 v10, s[12:15], s25 offen offset:1024 lds
    v_mfma_f32_16x16x32_bf16 v[236:239], a[76:79], a[44:47], v[236:239]
    v_mfma_f32_16x16x32_bf16 v[240:243], a[76:79], a[48:51], v[240:243]
    v_mfma_f32_16x16x32_bf16 v[244:247], a[76:79], a[52:55], v[244:247]
    v_mfma_f32_16x16x32_bf16 v[248:251], a[76:79], a[56:59], v[248:251]
    v_mfma_f32_16x16x32_bf16 v[252:255], a[76:79], a[60:63], v[252:255]
L_k2_w0_after:
    s_cmp_eq_u32 s32, s78
    s_cbranch_scc1 L_k2_w0_a1
L_k2_w0_b1:
    s_cmp_eq_u32 s32, s99
    s_cbranch_scc1 L_k2_w0_a2
L_k2_w0_b2:
    s_cmp_eq_u32 s32, 0
    s_cbranch_scc1 L_k2_w0_s0
L_k2_w0_bs0:
    s_cmp_ge_u32 s32, 3
    s_cbranch_scc1 L_k2_w0_c
L_k2_w0_bc:
    s_cmp_eq_u32 s32, 5
    s_cbranch_scc1 L_k2_w0_a3
L_k2_w0_b3:
    s_cmp_eq_u32 s32, 6
    s_cbranch_scc1 L_k2_w0_a36
L_k2_w0_b4:
    s_add_u32 s32, s32, 1
    s_cmp_lt_u32 s32, 7
    s_cbranch_scc1 L_k2_w0_top
    s_waitcnt lgkmcnt(2)
    v_mfma_f32_16x16x32_bf16 a[80:83], a[64:67], a[0:3], a[80:83]
    ds_read_b64_tr_b16 a[72:73], v16 offset:6144
    v_mfma_f32_16x16x32_bf16 a[84:87], a[64:67], a[4:7], a[84:87]
    ds_read_b64_tr_b16 a[74:75], v16 offset:7936
    v_mfma_f32_16x16x32_bf16 a[88:91], a[64:67], a[8:11], a[88:91]
    ds_read_b128 a[32:35], v15 offset:0
    v_mfma_f32_16x16x32_bf16 a[92:95], a[64:67], a[12:15], a[92:95]
    ds_read_b128 a[36:39], v15 offset:2048
    v_mfma_f32_16x16x32_bf16 a[96:99], a[64:67], a[16:19], a[96:99]
    buffer_load_dwordx4 v11, s[12:15], s25 offen offset:2048 lds
    v_mfma_f32_16x16x32_bf16 a[100:103], a[64:67], a[20:23], a[100:103]
    v_mfma_f32_16x16x32_bf16 a[104:107], a[64:67], a[24:27], a[104:107]
    v_mfma_f32_16x16x32_bf16 a[108:111], a[64:67], a[28:31], a[108:111]
    s_waitcnt lgkmcnt(4)
    v_mfma_f32_16x16x32_bf16 a[112:115], a[68:71], a[0:3], a[112:115]
    ds_read_b64_tr_b16 a[76:77], v16 offset:6176
    v_mfma_f32_16x16x32_bf16 a[116:119], a[68:71], a[4:7], a[116:119]
    ds_read_b64_tr_b16 a[78:79], v16 offset:7968
    v_mfma_f32_16x16x32_bf16 a[120:123], a[68:71], a[8:11], a[120:123]
    ds_read_b128 a[40:43], v15 offset:4096
    v_mfma_f32_16x16x32_bf16 a[124:127], a[68:71], a[12:15], a[124:127]
    s_add_u32 m0, s30, 61440
    ds_read_b128 a[44:47], v15 offset:6144
    v_mfma_f32_16x16x32_bf16 a[128:131], a[68:71], a[16:19], a[128:131]
    buffer_load_dwordx4 v12, s[16:19], s26 offen offset:0 lds
    v_mfma_f32_16x16x32_bf16 a[132:135], a[68:71], a[20:23], a[132:135]
    v_mfma_f32_16x16x32_bf16 a[136:139], a[68:71], a[24:27], a[136:139]
    v_mfma_f32_16x16x32_bf16 a[140:143], a[68:71], a[28:31], a[140:143]
    s_waitcnt lgkmcnt(6)
    v_mfma_f32_16x16x32_bf16 a[144:147], a[72:75], a[0:3], a[144:147]
    ds_read_b64_tr_b16 a[64:65], v16 offset:6208
    v_mfma_f32_16x16x32_bf16 a[148:151], a[72:75], a[4:7], a[148:151]
    ds_read_b64_tr_b16 a[66:67], v16 offset:8000
    v_mfma_f32_16x16x32_bf16 a[152:155], a[72:75], a[8:11], a[152:155]
    ds_read_b128 a[48:51], v15 offset:8192
    v_mfma_f32_16x16x32_bf16 a[156:159], a[72:75], a[12:15], a[156:159]
    buffer_load_dwordx4 v13, s[16:19], s26 offen offset:1024 lds
    v_mfma_f32_16x16x32_bf16 a[160:163], a[72:75], a[16:19], a[160:163]
    s_lshr_b32 s97, s97, 4
    s_and_b32 s33, s97, 7
    s_lshl_b32 s33, s33, 2
    s_mul_i32 s25, s33, s27
    s_mul_i32 s26, s33, s28
    v_mfma_f32_16x16x32_bf16 a[164:167], a[72:75], a[20:23], a[164:167]
    v_mfma_f32_16x16x32_bf16 a[168:171], a[72:75], a[24:27], a[168:171]
    v_mfma_f32_16x16x32_bf16 a[172:175], a[72:75], a[28:31], a[172:175]
    s_waitcnt lgkmcnt(5)
    v_mfma_f32_16x16x32_bf16 a[176:179], a[76:79], a[0:3], a[176:179]
    ds_read_b64_tr_b16 a[68:69], v16 offset:6240
    v_mfma_f32_16x16x32_bf16 a[180:183], a[76:79], a[4:7], a[180:183]
    ds_read_b64_tr_b16 a[70:71], v16 offset:8032
    v_mfma_f32_16x16x32_bf16 a[184:187], a[76:79], a[8:11], a[184:187]
    ds_read_b128 a[52:55], v15 offset:10240
    v_mfma_f32_16x16x32_bf16 a[188:191], a[76:79], a[12:15], a[188:191]
    v_mfma_f32_16x16x32_bf16 a[192:195], a[76:79], a[16:19], a[192:195]
    v_mfma_f32_16x16x32_bf16 a[196:199], a[76:79], a[20:23], a[196:199]
    v_mfma_f32_16x16x32_bf16 a[200:203], a[76:79], a[24:27], a[200:203]
    v_mfma_f32_16x16x32_bf16 a[204:207], a[76:79], a[28:31], a[204:207]
    s_waitcnt lgkmcnt(4)
    v_mfma_f32_16x16x32_bf16 a[208:211], a[64:67], a[0:3], a[208:211]
    ds_read_b64_tr_b16 a[72:73], v16 offset:13312
    v_mfma_f32_16x16x32_bf16 a[212:215], a[64:67], a[4:7], a[212:215]
    ds_read_b64_tr_b16 a[74:75], v16 offset:15104
    v_mfma_f32_16x16x32_bf16 a[216:219], a[64:67], a[8:11], a[216:219]
    ds_read_b128 a[56:59], v15 offset:12288
    v_mfma_f32_16x16x32_bf16 a[220:223], a[64:67], a[12:15], a[220:223]
    v_mfma_f32_16x16x32_bf16 a[224:227], a[64:67], a[16:19], a[224:227]
    v_mfma_f32_16x16x32_bf16 a[228:231], a[64:67], a[20:23], a[228:231]
    v_mfma_f32_16x16x32_bf16 a[232:235], a[64:67], a[24:27], a[232:235]
    v_mfma_f32_16x16x32_bf16 a[236:239], a[64:67], a[28:31], a[236:239]
    s_waitcnt lgkmcnt(4)
    v_mfma_f32_16x16x32_bf16 a[240:243], a[68:71], a[0:3], a[240:243]
    ds_read_b64_tr_b16 a[76:77], v16 offset:13344
    v_mfma_f32_16x16x32_bf16 a[244:247], a[68:71], a[4:7], a[244:247]
    ds_read_b64_tr_b16 a[78:79], v16 offset:15136
    v_mfma_f32_16x16x32_bf16 a[248:251], a[68:71], a[8:11], a[248:251]
    ds_read_b128 a[60:63], v15 offset:14336
    v_mfma_f32_16x16x32_bf16 a[252:255], a[68:71], a[12:15], a[252:255]
    v_mfma_f32_16x16x32_bf16 v[112:115], a[68:71], a[16:19], v[112:115]
    v_mfma_f32_16x16x32_bf16 v[116:119], a[68:71], a[20:23], v[116:119]
    v_mfma_f32_16x16x32_bf16 v[120:123], a[68:71], a[24:27], v[120:123]
    v_mfma_f32_16x16x32_bf16 v[124:127], a[68:71], a[28:31], v[124:127]
    s_waitcnt lgkmcnt(4)
    v_mfma_f32_16x16x32_bf16 v[128:131], a[72:75], a[0:3], v[128:131]
    ds_read_b64_tr_b16 a[64:65], v16 offset:13376
    v_mfma_f32_16x16x32_bf16 v[132:135], a[72:75], a[4:7], v[132:135]
    ds_read_b64_tr_b16 a[66:67], v16 offset:15168
    v_mfma_f32_16x16x32_bf16 v[136:139], a[72:75], a[8:11], v[136:139]
    ds_read_b64_tr_b16 a[68:69], v16 offset:13408
    v_mfma_f32_16x16x32_bf16 v[140:143], a[72:75], a[12:15], v[140:143]
    ds_read_b64_tr_b16 a[70:71], v16 offset:15200
    v_mfma_f32_16x16x32_bf16 v[144:147], a[72:75], a[16:19], v[144:147]
    v_mfma_f32_16x16x32_bf16 v[148:151], a[72:75], a[20:23], v[148:151]
    v_mfma_f32_16x16x32_bf16 v[152:155], a[72:75], a[24:27], v[152:155]
    v_mfma_f32_16x16x32_bf16 v[156:159], a[72:75], a[28:31], v[156:159]
    s_waitcnt lgkmcnt(5)
    v_mfma_f32_16x16x32_bf16 v[160:163], a[76:79], a[0:3], v[160:163]
    v_mfma_f32_16x16x32_bf16 v[164:167], a[76:79], a[4:7], v[164:167]
    v_mfma_f32_16x16x32_bf16 v[168:171], a[76:79], a[8:11], v[168:171]
    v_mfma_f32_16x16x32_bf16 v[172:175], a[76:79], a[12:15], v[172:175]
    v_mfma_f32_16x16x32_bf16 v[176:179], a[76:79], a[16:19], v[176:179]
    v_mfma_f32_16x16x32_bf16 v[180:183], a[76:79], a[20:23], v[180:183]
    v_mfma_f32_16x16x32_bf16 v[184:187], a[76:79], a[24:27], v[184:187]
    v_mfma_f32_16x16x32_bf16 v[188:191], a[76:79], a[28:31], v[188:191]
    s_waitcnt vmcnt(9) lgkmcnt(0)
    s_barrier
    v_mfma_f32_16x16x32_bf16 v[192:195], a[64:67], a[0:3], v[192:195]
    ds_read_b64_tr_b16 a[72:73], v18 offset:20608
    v_mfma_f32_16x16x32_bf16 v[196:199], a[64:67], a[4:7], v[196:199]
    ds_read_b64_tr_b16 a[74:75], v18 offset:22144
    v_mfma_f32_16x16x32_bf16 v[200:203], a[64:67], a[8:11], v[200:203]
    v_mfma_f32_16x16x32_bf16 v[204:207], a[64:67], a[12:15], v[204:207]
    v_mfma_f32_16x16x32_bf16 v[208:211], a[64:67], a[16:19], v[208:211]
    v_mfma_f32_16x16x32_bf16 v[212:215], a[64:67], a[20:23], v[212:215]
    v_mfma_f32_16x16x32_bf16 v[216:219], a[64:67], a[24:27], v[216:219]
    v_mfma_f32_16x16x32_bf16 v[220:223], a[64:67], a[28:31], v[220:223]
    v_mfma_f32_16x16x32_bf16 v[224:227], a[68:71], a[0:3], v[224:227]
    ds_read_b64_tr_b16 a[76:77], v20 offset:20640
    v_mfma_f32_16x16x32_bf16 v[228:231], a[68:71], a[4:7], v[228:231]
    ds_read_b64_tr_b16 a[78:79], v20 offset:22176
    v_mfma_f32_16x16x32_bf16 v[232:235], a[68:71], a[8:11], v[232:235]
    v_mfma_f32_16x16x32_bf16 v[236:239], a[68:71], a[12:15], v[236:239]
    v_mfma_f32_16x16x32_bf16 v[240:243], a[68:71], a[16:19], v[240:243]
    v_mfma_f32_16x16x32_bf16 v[244:247], a[68:71], a[20:23], v[244:247]
    v_mfma_f32_16x16x32_bf16 v[248:251], a[68:71], a[24:27], v[248:251]
    v_mfma_f32_16x16x32_bf16 v[252:255], a[68:71], a[28:31], v[252:255]
    s_waitcnt vmcnt(3)
    v_readfirstlane_b32 s33, v25
    s_nop 0
    s_cmp_ge_u32 s33, 256
    s_cbranch_scc1 L_k2_w0_a4go
    s_mov_b32 s34, 0
L_k2_w0_a4spin:
    v_mov_b32 v23, 0
    global_load_dword v25, v23, s[42:43] sc1
    s_waitcnt vmcnt(0)
    v_readfirstlane_b32 s33, v25
    s_add_u32 s34, s34, 1
    s_cmp_gt_u32 s34, 0x40000
    s_cbranch_scc1 L_k2_w0_a4go
    s_cmp_ge_u32 s33, 256
    s_cbranch_scc0 L_k2_w0_a4spin
L_k2_w0_a4go:
    s_or_b32 s33, s77, s3
    s_cmp_lg_u32 s33, 0
    s_cbranch_scc1 L_k2_w0_a4noep
    s_add_u32 s33, s96, 1
    v_mov_b32 v23, 0
    v_mov_b32 v24, s33
    s_mov_b32 s33, 41156608
    s_mov_b64 exec, 1
    buffer_store_dword v24, v23, s[36:39], s33 offen sc1
    s_mov_b64 exec, -1
L_k2_w0_a4noep:
    s_lshl_b32 s33, s3, 6
    s_add_u32 s33, s33, s41
    s_lshl_b32 s33, s33, 3
    s_add_u32 s33, s33, 39911424
    v_lshlrev_b32 v23, 3, v22
    buffer_load_dwordx2 v[108:109], v23, s[36:39], s33 offen sc1
    s_mul_i32 s33, s21, 10240
    s_add_u32 s33, s33, 39976960
    s_mul_i32 s34, s3, 320
    v_lshlrev_b32 v24, 4, v22
    v_add_u32 v24, s34, v24
    s_mov_b64 exec, 0xfffff
    buffer_load_dwordx4 v[76:79], v24, s[36:39], s33 offen sc1
    s_add_u32 s33, s33, 1280
    buffer_load_dwordx4 v[80:83], v24, s[36:39], s33 offen sc1
    s_add_u32 s33, s33, 1280
    buffer_load_dwordx4 v[84:87], v24, s[36:39], s33 offen sc1
    s_add_u32 s33, s33, 1280
    buffer_load_dwordx4 v[88:91], v24, s[36:39], s33 offen sc1
    s_add_u32 s33, s33, 1280
    buffer_load_dwordx4 v[92:95], v24, s[36:39], s33 offen sc1
    s_add_u32 s33, s33, 1280
    buffer_load_dwordx4 v[96:99], v24, s[36:39], s33 offen sc1
    s_add_u32 s33, s33, 1280
    buffer_load_dwordx4 v[100:103], v24, s[36:39], s33 offen sc1
    s_add_u32 s33, s33, 1280
    buffer_load_dwordx4 v[104:107], v24, s[36:39], s33 offen sc1
    s_mov_b64 exec, -1
    s_waitcnt lgkmcnt(2)
    v_mfma_f32_16x16x32_bf16 a[80:83], a[72:75], a[32:35], a[80:83]
    ds_read_b64_tr_b16 a[64:65], v16 offset:26624
    v_mfma_f32_16x16x32_bf16 a[84:87], a[72:75], a[36:39], a[84:87]
    ds_read_b64_tr_b16 a[66:67], v16 offset:28416
    v_mfma_f32_16x16x32_bf16 a[88:91], a[72:75], a[40:43], a[88:91]
    ds_read_b128 a[0:3], v14 offset:32768
    v_mfma_f32_16x16x32_bf16 a[92:95], a[72:75], a[44:47], a[92:95]
    ds_read_b128 a[4:7], v14 offset:34816
    v_mfma_f32_16x16x32_bf16 a[96:99], a[72:75], a[48:51], a[96:99]
    v_mfma_f32_16x16x32_bf16 a[100:103], a[72:75], a[52:55], a[100:103]
    v_mfma_f32_16x16x32_bf16 a[104:107], a[72:75], a[56:59], a[104:107]
    v_mfma_f32_16x16x32_bf16 a[108:111], a[72:75], a[60:63], a[108:111]
    s_waitcnt lgkmcnt(4)
    v_mfma_f32_16x16x32_bf16 a[112:115], a[76:79], a[32:35], a[112:115]
    ds_read_b64_tr_b16 a[68:69], v16 offset:26656
    v_mfma_f32_16x16x32_bf16 a[116:119], a[76:79], a[36:39], a[116:119]
    ds_read_b64_tr_b16 a[70:71], v16 offset:28448
    v_mfma_f32_16x16x32_bf16 a[120:123], a[76:79], a[40:43], a[120:123]
    ds_read_b128 a[8:11], v14 offset:36864
    v_mfma_f32_16x16x32_bf16 a[124:127], a[76:79], a[44:47], a[124:127]
    ds_read_b128 a[12:15], v14 offset:38912
    v_mfma_f32_16x16x32_bf16 a[128:131], a[76:79], a[48:51], a[128:131]
    v_mfma_f32_16x16x32_bf16 a[132:135], a[76:79], a[52:55], a[132:135]
    v_mfma_f32_16x16x32_bf16 a[136:139], a[76:79], a[56:59], a[136:139]
    v_mfma_f32_16x16x32_bf16 a[140:143], a[76:79], a[60:63], a[140:143]
    s_waitcnt lgkmcnt(6)
    v_mfma_f32_16x16x32_bf16 a[144:147], a[64:67], a[32:35], a[144:147]
    ds_read_b64_tr_b16 a[72:73], v16 offset:26688
    v_mfma_f32_16x16x32_bf16 a[148:151], a[64:67], a[36:39], a[148:151]
    ds_read_b64_tr_b16 a[74:75], v16 offset:28480
    v_mfma_f32_16x16x32_bf16 a[152:155], a[64:67], a[40:43], a[152:155]
    ds_read_b128 a[16:19], v14 offset:40960
    v_mfma_f32_16x16x32_bf16 a[156:159], a[64:67], a[44:47], a[156:159]
    v_mfma_f32_16x16x32_bf16 a[160:163], a[64:67], a[48:51], a[160:163]
    v_mfma_f32_16x16x32_bf16 a[164:167], a[64:67], a[52:55], a[164:167]
    v_mfma_f32_16x16x32_bf16 a[168:171], a[64:67], a[56:59], a[168:171]
    v_mfma_f32_16x16x32_bf16 a[172:175], a[64:67], a[60:63], a[172:175]
    s_waitcnt lgkmcnt(5)
    v_mfma_f32_16x16x32_bf16 a[176:179], a[68:71], a[32:35], a[176:179]
    ds_read_b64_tr_b16 a[76:77], v16 offset:26720
    v_mfma_f32_16x16x32_bf16 a[180:183], a[68:71], a[36:39], a[180:183]
    ds_read_b64_tr_b16 a[78:79], v16 offset:28512
    v_mfma_f32_16x16x32_bf16 a[184:187], a[68:71], a[40:43], a[184:187]
    ds_read_b128 a[20:23], v14 offset:43008
    v_mfma_f32_16x16x32_bf16 a[188:191], a[68:71], a[44:47], a[188:191]
    v_mfma_f32_16x16x32_bf16 a[192:195], a[68:71], a[48:51], a[192:195]
    v_mfma_f32_16x16x32_bf16 a[196:199], a[68:71], a[52:55], a[196:199]
    v_mfma_f32_16x16x32_bf16 a[200:203], a[68:71], a[56:59], a[200:203]
    v_mfma_f32_16x16x32_bf16 a[204:207], a[68:71], a[60:63], a[204:207]
    s_waitcnt lgkmcnt(4)
    v_mfma_f32_16x16x32_bf16 a[208:211], a[72:75], a[32:35], a[208:211]
    ds_read_b64_tr_b16 a[64:65], v16 offset:33792
    v_mfma_f32_16x16x32_bf16 a[212:215], a[72:75], a[36:39], a[212:215]
    ds_read_b64_tr_b16 a[66:67], v16 offset:35584
    v_mfma_f32_16x16x32_bf16 a[216:219], a[72:75], a[40:43], a[216:219]
    ds_read_b128 a[24:27], v14 offset:45056
    v_mfma_f32_16x16x32_bf16 a[220:223], a[72:75], a[44:47], a[220:223]
    v_mfma_f32_16x16x32_bf16 a[224:227], a[72:75], a[48:51], a[224:227]
    v_mfma_f32_16x16x32_bf16 a[228:231], a[72:75], a[52:55], a[228:231]
    v_mfma_f32_16x16x32_bf16 a[232:235], a[72:75], a[56:59], a[232:235]
    v_mfma_f32_16x16x32_bf16 a[236:239], a[72:75], a[60:63], a[236:239]
    s_waitcnt lgkmcnt(4)
    v_mfma_f32_16x16x32_bf16 a[240:243], a[76:79], a[32:35], a[240:243]
    ds_read_b64_tr_b16 a[68:69], v16 offset:33824
    v_mfma_f32_16x16x32_bf16 a[244:247], a[76:79], a[36:39], a[244:247]
    ds_read_b64_tr_b16 a[70:71], v16 offset:35616
    v_mfma_f32_16x16x32_bf16 a[248:251], a[76:79], a[40:43], a[248:251]
    ds_read_b128 a[28:31], v14 offset:47104
    v_mfma_f32_16x16x32_bf16 a[252:255], a[76:79], a[44:47], a[252:255]
    v_mfma_f32_16x16x32_bf16 v[112:115], a[76:79], a[48:51], v[112:115]
    v_mfma_f32_16x16x32_bf16 v[116:119], a[76:79], a[52:55], v[116:119]
    v_mfma_f32_16x16x32_bf16 v[120:123], a[76:79], a[56:59], v[120:123]
    v_mfma_f32_16x16x32_bf16 v[124:127], a[76:79], a[60:63], v[124:127]
    s_waitcnt lgkmcnt(4)
    v_mfma_f32_16x16x32_bf16 v[128:131], a[64:67], a[32:35], v[128:131]
    ds_read_b64_tr_b16 a[72:73], v16 offset:33856
    v_mfma_f32_16x16x32_bf16 v[132:135], a[64:67], a[36:39], v[132:135]
    ds_read_b64_tr_b16 a[74:75], v16 offset:35648
    v_mfma_f32_16x16x32_bf16 v[136:139], a[64:67], a[40:43], v[136:139]
    ds_read_b64_tr_b16 a[76:77], v16 offset:33888
    v_mfma_f32_16x16x32_bf16 v[140:143], a[64:67], a[44:47], v[140:143]
    ds_read_b64_tr_b16 a[78:79], v16 offset:35680
    v_mfma_f32_16x16x32_bf16 v[144:147], a[64:67], a[48:51], v[144:147]
    v_mfma_f32_16x16x32_bf16 v[148:151], a[64:67], a[52:55], v[148:151]
    v_mfma_f32_16x16x32_bf16 v[152:155], a[64:67], a[56:59], v[152:155]
    v_mfma_f32_16x16x32_bf16 v[156:159], a[64:67], a[60:63], v[156:159]
    s_waitcnt lgkmcnt(5)
    v_mfma_f32_16x16x32_bf16 v[160:163], a[68:71], a[32:35], v[160:163]
    v_mfma_f32_16x16x32_bf16 v[164:167], a[68:71], a[36:39], v[164:167]
    v_mfma_f32_16x16x32_bf16 v[168:171], a[68:71], a[40:43], v[168:171]
    v_mfma_f32_16x16x32_bf16 v[172:175], a[68:71], a[44:47], v[172:175]
    v_mfma_f32_16x16x32_bf16 v[176:179], a[68:71], a[48:51], v[176:179]
    v_mfma_f32_16x16x32_bf16 v[180:183], a[68:71], a[52:55], v[180:183]
    v_mfma_f32_16x16x32_bf16 v[184:187], a[68:71], a[56:59], v[184:187]
    v_mfma_f32_16x16x32_bf16 v[188:191], a[68:71], a[60:63], v[188:191]
    s_waitcnt lgkmcnt(0)
    s_barrier
    v_mfma_f32_16x16x32_bf16 v[192:195], a[72:75], a[32:35], v[192:195]
    ds_read_b64_tr_b16 a[64:65], v19 offset:128
    v_mfma_f32_16x16x32_bf16 v[196:199], a[72:75], a[36:39], v[196:199]
    ds_read_b64_tr_b16 a[66:67], v19 offset:1664
    v_mfma_f32_16x16x32_bf16 v[200:203], a[72:75], a[40:43], v[200:203]
    v_mfma_f32_16x16x32_bf16 v[204:207], a[72:75], a[44:47], v[204:207]
    v_mfma_f32_16x16x32_bf16 v[208:211], a[72:75], a[48:51], v[208:211]
    v_mfma_f32_16x16x32_bf16 v[212:215], a[72:75], a[52:55], v[212:215]
    v_mfma_f32_16x16x32_bf16 v[216:219], a[72:75], a[56:59], v[216:219]
    v_mfma_f32_16x16x32_bf16 v[220:223], a[72:75], a[60:63], v[220:223]
    v_mfma_f32_16x16x32_bf16 v[224:227], a[76:79], a[32:35], v[224:227]
    ds_read_b64_tr_b16 a[68:69], v21 offset:160
    v_mfma_f32_16x16x32_bf16 v[228:231], a[76:79], a[36:39], v[228:231]
    ds_read_b64_tr_b16 a[70:71], v21 offset:1696
    v_mfma_f32_16x16x32_bf16 v[232:235], a[76:79], a[40:43], v[232:235]
    v_mfma_f32_16x16x32_bf16 v[236:239], a[76:79], a[44:47], v[236:239]
    v_mfma_f32_16x16x32_bf16 v[240:243], a[76:79], a[48:51], v[240:243]
    v_mfma_f32_16x16x32_bf16 v[244:247], a[76:79], a[52:55], v[244:247]
    v_mfma_f32_16x16x32_bf16 v[248:251], a[76:79], a[56:59], v[248:251]
    v_mfma_f32_16x16x32_bf16 v[252:255], a[76:79], a[60:63], v[252:255]
    s_waitcnt lgkmcnt(2)
    v_mfma_f32_16x16x32_bf16 a[80:83], a[64:67], a[0:3], a[80:83]
    ds_read_b64_tr_b16 a[72:73], v17 offset:6144
    v_mfma_f32_16x16x32_bf16 a[84:87], a[64:67], a[4:7], a[84:87]
    ds_read_b64_tr_b16 a[74:75], v17 offset:7936
    v_mfma_f32_16x16x32_bf16 a[88:91], a[64:67], a[8:11], a[88:91]
    ds_read_b128 a[32:35], v15 offset:32768
    v_mfma_f32_16x16x32_bf16 a[92:95], a[64:67], a[12:15], a[92:95]
    ds_read_b128 a[36:39], v15 offset:34816
    v_mfma_f32_16x16x32_bf16 a[96:99], a[64:67], a[16:19], a[96:99]
    v_mfma_f32_16x16x32_bf16 a[100:103], a[64:67], a[20:23], a[100:103]
    v_mfma_f32_16x16x32_bf16 a[104:107], a[64:67], a[24:27], a[104:107]
    v_mfma_f32_16x16x32_bf16 a[108:111], a[64:67], a[28:31], a[108:111]
    s_waitcnt lgkmcnt(4)
    v_mfma_f32_16x16x32_bf16 a[112:115], a[68:71], a[0:3], a[112:115]
    ds_read_b64_tr_b16 a[76:77], v17 offset:6176
    v_mfma_f32_16x16x32_bf16 a[116:119], a[68:71], a[4:7], a[116:119]
    ds_read_b64_tr_b16 a[78:79], v17 offset:7968
    v_mfma_f32_16x16x32_bf16 a[120:123], a[68:71], a[8:11], a[120:123]
    ds_read_b128 a[40:43], v15 offset:36864
    v_mfma_f32_16x16x32_bf16 a[124:127], a[68:71], a[12:15], a[124:127]
    ds_read_b128 a[44:47], v15 offset:38912
    v_mfma_f32_16x16x32_bf16 a[128:131], a[68:71], a[16:19], a[128:131]
    v_mfma_f32_16x16x32_bf16 a[132:135], a[68:71], a[20:23], a[132:135]
    v_mfma_f32_16x16x32_bf16 a[136:139], a[68:71], a[24:27], a[136:139]
    v_mfma_f32_16x16x32_bf16 a[140:143], a[68:71], a[28:31], a[140:143]
    s_waitcnt lgkmcnt(6)
    v_mfma_f32_16x16x32_bf16 a[144:147], a[72:75], a[0:3], a[144:147]
    ds_read_b64_tr_b16 a[64:65], v17 offset:6208
    v_mfma_f32_16x16x32_bf16 a[148:151], a[72:75], a[4:7], a[148:151]
    ds_read_b64_tr_b16 a[66:67], v17 offset:8000
    v_mfma_f32_16x16x32_bf16 a[152:155], a[72:75], a[8:11], a[152:155]
    ds_read_b128 a[48:51], v15 offset:40960
    v_mfma_f32_16x16x32_bf16 a[156:159], a[72:75], a[12:15], a[156:159]
    v_mfma_f32_16x16x32_bf16 a[160:163], a[72:75], a[16:19], a[160:163]
    v_mfma_f32_16x16x32_bf16 a[164:167], a[72:75], a[20:23], a[164:167]
    v_mfma_f32_16x16x32_bf16 a[168:171], a[72:75], a[24:27], a[168:171]
    v_mfma_f32_16x16x32_bf16 a[172:175], a[72:75], a[28:31], a[172:175]
    s_waitcnt lgkmcnt(5)
    v_mfma_f32_16x16x32_bf16 a[176:179], a[76:79], a[0:3], a[176:179]
    ds_read_b64_tr_b16 a[68:69], v17 offset:6240
    v_mfma_f32_16x16x32_bf16 a[180:183], a[76:79], a[4:7], a[180:183]
    ds_read_b64_tr_b16 a[70:71], v17 offset:8032
    v_mfma_f32_16x16x32_bf16 a[184:187], a[76:79], a[8:11], a[184:187]
    ds_read_b128 a[52:55], v15 offset:43008
    v_mfma_f32_16x16x32_bf16 a[188:191], a[76:79], a[12:15], a[188:191]
    v_mfma_f32_16x16x32_bf16 a[192:195], a[76:79], a[16:19], a[192:195]
    v_mfma_f32_16x16x32_bf16 a[196:199], a[76:79], a[20:23], a[196:199]
    v_mfma_f32_16x16x32_bf16 a[200:203], a[76:79], a[24:27], a[200:203]
    v_mfma_f32_16x16x32_bf16 a[204:207], a[76:79], a[28:31], a[204:207]
    s_waitcnt lgkmcnt(4)
    v_mfma_f32_16x16x32_bf16 a[208:211], a[64:67], a[0:3], a[208:211]
    ds_read_b64_tr_b16 a[72:73], v17 offset:13312
    v_mfma_f32_16x16x32_bf16 a[212:215], a[64:67], a[4:7], a[212:215]
    ds_read_b64_tr_b16 a[74:75], v17 offset:15104
    v_mfma_f32_16x16x32_bf16 a[216:219], a[64:67], a[8:11], a[216:219]
    ds_read_b128 a[56:59], v15 offset:45056
    v_mfma_f32_16x16x32_bf16 a[220:223], a[64:67], a[12:15], a[220:223]
    v_mfma_f32_16x16x32_bf16 a[224:227], a[64:67], a[16:19], a[224:227]
    v_mfma_f32_16x16x32_bf16 a[228:231], a[64:67], a[20:23], a[228:231]
    v_mfma_f32_16x16x32_bf16 a[232:235], a[64:67], a[24:27], a[232:235]
    v_mfma_f32_16x16x32_bf16 a[236:239], a[64:67], a[28:31], a[236:239]
    s_waitcnt lgkmcnt(4)
    v_mfma_f32_16x16x32_bf16 a[240:243], a[68:71], a[0:3], a[240:243]
    ds_read_b64_tr_b16 a[76:77], v17 offset:13344
    v_mfma_f32_16x16x32_bf16 a[244:247], a[68:71], a[4:7], a[244:247]
    ds_read_b64_tr_b16 a[78:79], v17 offset:15136
    v_mfma_f32_16x16x32_bf16 a[248:251], a[68:71], a[8:11], a[248:251]
    ds_read_b128 a[60:63], v15 offset:47104
    v_mfma_f32_16x16x32_bf16 a[252:255], a[68:71], a[12:15], a[252:255]
    v_mfma_f32_16x16x32_bf16 v[112:115], a[68:71], a[16:19], v[112:115]
    v_mfma_f32_16x16x32_bf16 v[116:119], a[68:71], a[20:23], v[116:119]
    v_mfma_f32_16x16x32_bf16 v[120:123], a[68:71], a[24:27], v[120:123]
    v_mfma_f32_16x16x32_bf16 v[124:127], a[68:71], a[28:31], v[124:127]
    s_waitcnt lgkmcnt(4)
    v_mfma_f32_16x16x32_bf16 v[128:131], a[72:75], a[0:3], v[128:131]
    ds_read_b64_tr_b16 a[64:65], v17 offset:13376
    v_mfma_f32_16x16x32_bf16 v[132:135], a[72:75], a[4:7], v[132:135]
    ds_read_b64_tr_b16 a[66:67], v17 offset:15168
    v_mfma_f32_16x16x32_bf16 v[136:139], a[72:75], a[8:11], v[136:139]
    ds_read_b64_tr_b16 a[68:69], v17 offset:13408
    v_mfma_f32_16x16x32_bf16 v[140:143], a[72:75], a[12:15], v[140:143]
    ds_read_b64_tr_b16 a[70:71], v17 offset:15200
    v_mfma_f32_16x16x32_bf16 v[144:147], a[72:75], a[16:19], v[144:147]
    v_mfma_f32_16x16x32_bf16 v[148:151], a[72:75], a[20:23], v[148:151]
    v_mfma_f32_16x16x32_bf16 v[152:155], a[72:75], a[24:27], v[152:155]
    v_mfma_f32_16x16x32_bf16 v[156:159], a[72:75], a[28:31], v[156:159]
    s_waitcnt lgkmcnt(5)
    v_mfma_f32_16x16x32_bf16 v[160:163], a[76:79], a[0:3], v[160:163]
    v_mfma_f32_16x16x32_bf16 v[164:167], a[76:79], a[4:7], v[164:167]
    v_mfma_f32_16x16x32_bf16 v[168:171], a[76:79], a[8:11], v[168:171]
    v_mfma_f32_16x16x32_bf16 v[172:175], a[76:79], a[12:15], v[172:175]
    v_mfma_f32_16x16x32_bf16 v[176:179], a[76:79], a[16:19], v[176:179]
    v_mfma_f32_16x16x32_bf16 v[180:183], a[76:79], a[20:23], v[180:183]
    v_mfma_f32_16x16x32_bf16 v[184:187], a[76:79], a[24:27], v[184:187]
    v_mfma_f32_16x16x32_bf16 v[188:191], a[76:79], a[28:31], v[188:191]
    s_waitcnt lgkmcnt(0)
    s_barrier
    v_mfma_f32_16x16x32_bf16 v[192:195], a[64:67], a[0:3], v[192:195]
    ds_read_b64_tr_b16 a[72:73], v19 offset:20608
    v_mfma_f32_16x16x32_bf16 v[196:199], a[64:67], a[4:7], v[196:199]
    ds_read_b64_tr_b16 a[74:75], v19 offset:22144
    v_mfma_f32_16x16x32_bf16 v[200:203], a[64:67], a[8:11], v[200:203]
    v_mfma_f32_16x16x32_bf16 v[204:207], a[64:67], a[12:15], v[204:207]
    v_mfma_f32_16x16x32_bf16 v[208:211], a[64:67], a[16:19], v[208:211]
    v_mfma_f32_16x16x32_bf16 v[212:215], a[64:67], a[20:23], v[212:215]
    v_mfma_f32_16x16x32_bf16 v[216:219], a[64:67], a[24:27], v[216:219]
    v_mfma_f32_16x16x32_bf16 v[220:223], a[64:67], a[28:31], v[220:223]
    v_mfma_f32_16x16x32_bf16 v[224:227], a[68:71], a[0:3], v[224:227]
    ds_read_b64_tr_b16 a[76:77], v21 offset:20640
    v_mfma_f32_16x16x32_bf16 v[228:231], a[68:71], a[4:7], v[228:231]
    ds_read_b64_tr_b16 a[78:79], v21 offset:22176
    v_mfma_f32_16x16x32_bf16 v[232:235], a[68:71], a[8:11], v[232:235]
    v_mfma_f32_16x16x32_bf16 v[236:239], a[68:71], a[12:15], v[236:239]
    v_mfma_f32_16x16x32_bf16 v[240:243], a[68:71], a[16:19], v[240:243]
    v_mfma_f32_16x16x32_bf16 v[244:247], a[68:71], a[20:23], v[244:247]
    v_mfma_f32_16x16x32_bf16 v[248:251], a[68:71], a[24:27], v[248:251]
    v_mfma_f32_16x16x32_bf16 v[252:255], a[68:71], a[28:31], v[252:255]
    s_waitcnt vmcnt(3)
    v_pk_add_f32 v[76:77], v[76:77], v[92:93]
    v_pk_add_f32 v[78:79], v[78:79], v[94:95]
    s_waitcnt vmcnt(2)
    v_pk_add_f32 v[80:81], v[80:81], v[96:97]
    v_pk_add_f32 v[82:83], v[82:83], v[98:99]
    s_waitcnt vmcnt(1)
    v_pk_add_f32 v[84:85], v[84:85], v[100:101]
    v_pk_add_f32 v[86:87], v[86:87], v[102:103]
    s_waitcnt vmcnt(0)
    v_pk_add_f32 v[88:89], v[88:89], v[104:105]
    v_pk_add_f32 v[90:91], v[90:91], v[106:107]
    v_pk_add_f32 v[76:77], v[76:77], v[84:85]
    v_pk_add_f32 v[78:79], v[78:79], v[86:87]
    v_pk_add_f32 v[80:81], v[80:81], v[88:89]
    v_pk_add_f32 v[82:83], v[82:83], v[90:91]
    v_pk_add_f32 v[76:77], v[76:77], v[80:81]
    v_pk_add_f32 v[78:79], v[78:79], v[82:83]
    s_lshl_b32 s33, s3, 9
    v_lshlrev_b32 v23, 3, v22
    v_add_u32 v23, s33, v23
    v_add_u32 v23, 149504, v23
    ds_write_b64 v23, v[108:109]
    s_mul_i32 s34, s3, 320
    v_lshlrev_b32 v24, 4, v22
    v_add_u32 v24, s34, v24
    v_add_u32 v24, 147456, v24
    s_mov_b64 exec, 0xfffff
    ds_write_b128 v24, v[76:79]
    s_mov_b64 exec, -1
    s_waitcnt lgkmcnt(4)
    v_mfma_f32_16x16x32_bf16 a[80:83], a[72:75], a[32:35], a[80:83]
    ds_read_b64_tr_b16 a[64:65], v17 offset:26624
    v_mfma_f32_16x16x32_bf16 a[84:87], a[72:75], a[36:39], a[84:87]
    ds_read_b64_tr_b16 a[66:67], v17 offset:28416
    v_mfma_f32_16x16x32_bf16 a[88:91], a[72:75], a[40:43], a[88:91]
    v_mfma_f32_16x16x32_bf16 a[92:95], a[72:75], a[44:47], a[92:95]
    v_mfma_f32_16x16x32_bf16 a[96:99], a[72:75], a[48:51], a[96:99]
    v_mfma_f32_16x16x32_bf16 a[100:103], a[72:75], a[52:55], a[100:103]
    v_mfma_f32_16x16x32_bf16 a[104:107], a[72:75], a[56:59], a[104:107]
    v_mfma_f32_16x16x32_bf16 a[108:111], a[72:75], a[60:63], a[108:111]
    s_waitcnt lgkmcnt(4)
    v_mfma_f32_16x16x32_bf16 a[112:115], a[76:79], a[32:35], a[112:115]
    ds_read_b64_tr_b16 a[68:69], v17 offset:26656
    v_mfma_f32_16x16x32_bf16 a[116:119], a[76:79], a[36:39], a[116:119]
    ds_read_b64_tr_b16 a[70:71], v17 offset:28448
    v_mfma_f32_16x16x32_bf16 a[120:123], a[76:79], a[40:43], a[120:123]
    v_mfma_f32_16x16x32_bf16 a[124:127], a[76:79], a[44:47], a[124:127]
    v_mfma_f32_16x16x32_bf16 a[128:131], a[76:79], a[48:51], a[128:131]
    v_mfma_f32_16x16x32_bf16 a[132:135], a[76:79], a[52:55], a[132:135]
    v_mfma_f32_16x16x32_bf16 a[136:139], a[76:79], a[56:59], a[136:139]
    v_mfma_f32_16x16x32_bf16 a[140:143], a[76:79], a[60:63], a[140:143]
    s_waitcnt lgkmcnt(2)
    v_mfma_f32_16x16x32_bf16 a[144:147], a[64:67], a[32:35], a[144:147]
    ds_read_b64_tr_b16 a[72:73], v17 offset:26688
    v_mfma_f32_16x16x32_bf16 a[148:151], a[64:67], a[36:39], a[148:151]
    ds_read_b64_tr_b16 a[74:75], v17 offset:28480
    v_mfma_f32_16x16x32_bf16 a[152:155], a[64:67], a[40:43], a[152:155]
    v_mfma_f32_16x16x32_bf16 a[156:159], a[64:67], a[44:47], a[156:159]
    v_mfma_f32_16x16x32_bf16 a[160:163], a[64:67], a[48:51], a[160:163]
    v_mfma_f32_16x16x32_bf16 a[164:167], a[64:67], a[52:55], a[164:167]
    v_mfma_f32_16x16x32_bf16 a[168:171], a[64:67], a[56:59], a[168:171]
    v_mfma_f32_16x16x32_bf16 a[172:175], a[64:67], a[60:63], a[172:175]
    s_waitcnt lgkmcnt(2)
    v_mfma_f32_16x16x32_bf16 a[176:179], a[68:71], a[32:35], a[176:179]
    ds_read_b64_tr_b16 a[76:77], v17 offset:26720
    v_mfma_f32_16x16x32_bf16 a[180:183], a[68:71], a[36:39], a[180:183]
    ds_read_b64_tr_b16 a[78:79], v17 offset:28512
    v_mfma_f32_16x16x32_bf16 a[184:187], a[68:71], a[40:43], a[184:187]
    v_mfma_f32_16x16x32_bf16 a[188:191], a[68:71], a[44:47], a[188:191]
    v_mfma_f32_16x16x32_bf16 a[192:195], a[68:71], a[48:51], a[192:195]
    v_mfma_f32_16x16x32_bf16 a[196:199], a[68:71], a[52:55], a[196:199]
    v_mfma_f32_16x16x32_bf16 a[200:203], a[68:71], a[56:59], a[200:203]
    v_mfma_f32_16x16x32_bf16 a[204:207], a[68:71], a[60:63], a[204:207]
    s_waitcnt lgkmcnt(2)
    v_mfma_f32_16x16x32_bf16 a[208:211], a[72:75], a[32:35], a[208:211]
    ds_read_b64_tr_b16 a[64:65], v17 offset:33792
    v_mfma_f32_16x16x32_bf16 a[212:215], a[72:75], a[36:39], a[212:215]
    ds_read_b64_tr_b16 a[66:67], v17 offset:35584
    v_mfma_f32_16x16x32_bf16 a[216:219], a[72:75], a[40:43], a[216:219]
    v_mfma_f32_16x16x32_bf16 a[220:223], a[72:75], a[44:47], a[220:223]
    v_mfma_f32_16x16x32_bf16 a[224:227], a[72:75], a[48:51], a[224:227]
    v_mfma_f32_16x16x32_bf16 a[228:231], a[72:75], a[52:55], a[228:231]
    v_mfma_f32_16x16x32_bf16 a[232:235], a[72:75], a[56:59], a[232:235]
    v_mfma_f32_16x16x32_bf16 a[236:239], a[72:75], a[60:63], a[236:239]
    s_waitcnt lgkmcnt(2)
    v_mfma_f32_16x16x32_bf16 a[240:243], a[76:79], a[32:35], a[240:243]
    ds_read_b64_tr_b16 a[68:69], v17 offset:33824
    v_mfma_f32_16x16x32_bf16 a[244:247], a[76:79], a[36:39], a[244:247]
    ds_read_b64_tr_b16 a[70:71], v17 offset:35616
    v_mfma_f32_16x16x32_bf16 a[248:251], a[76:79], a[40:43], a[248:251]
    v_mfma_f32_16x16x32_bf16 a[252:255], a[76:79], a[44:47], a[252:255]
    v_mfma_f32_16x16x32_bf16 v[112:115], a[76:79], a[48:51], v[112:115]
    v_mfma_f32_16x16x32_bf16 v[116:119], a[76:79], a[52:55], v[116:119]
    v_mfma_f32_16x16x32_bf16 v[120:123], a[76:79], a[56:59], v[120:123]
    v_mfma_f32_16x16x32_bf16 v[124:127], a[76:79], a[60:63], v[124:127]
    s_waitcnt lgkmcnt(2)
    v_mfma_f32_16x16x32_bf16 v[128:131], a[64:67], a[32:35], v[128:131]
    ds_read_b64_tr_b16 a[72:73], v17 offset:33856
    v_mfma_f32_16x16x32_bf16 v[132:135], a[64:67], a[36:39], v[132:135]
    ds_read_b64_tr_b16 a[74:75], v17 offset:35648
    v_mfma_f32_16x16x32_bf16 v[136:139], a[64:67], a[40:43], v[136:139]
    ds_read_b64_tr_b16 a[76:77], v17 offset:33888
    v_mfma_f32_16x16x32_bf16 v[140:143], a[64:67], a[44:47], v[140:143]
    ds_read_b64_tr_b16 a[78:79], v17 offset:35680
    v_mfma_f32_16x16x32_bf16 v[144:147], a[64:67], a[48:51], v[144:147]
    v_mfma_f32_16x16x32_bf16 v[148:151], a[64:67], a[52:55], v[148:151]
    v_mfma_f32_16x16x32_bf16 v[152:155], a[64:67], a[56:59], v[152:155]
    v_mfma_f32_16x16x32_bf16 v[156:159], a[64:67], a[60:63], v[156:159]
    s_waitcnt lgkmcnt(4)
    v_mfma_f32_16x16x32_bf16 v[160:163], a[68:71], a[32:35], v[160:163]
    v_mfma_f32_16x16x32_bf16 v[164:167], a[68:71], a[36:39], v[164:167]
    v_mfma_f32_16x16x32_bf16 v[168:171], a[68:71], a[40:43], v[168:171]
    v_mfma_f32_16x16x32_bf16 v[172:175], a[68:71], a[44:47], v[172:175]
    v_mfma_f32_16x16x32_bf16 v[176:179], a[68:71], a[48:51], v[176:179]
    v_mfma_f32_16x16x32_bf16 v[180:183], a[68:71], a[52:55], v[180:183]
    v_mfma_f32_16x16x32_bf16 v[184:187], a[68:71], a[56:59], v[184:187]
    v_mfma_f32_16x16x32_bf16 v[188:191], a[68:71], a[60:63], v[188:191]
    s_waitcnt lgkmcnt(0)
    s_barrier
    v_mfma_f32_16x16x32_bf16 v[192:195], a[72:75], a[32:35], v[192:195]
    v_mfma_f32_16x16x32_bf16 v[196:199], a[72:75], a[36:39], v[196:199]
    v_mfma_f32_16x16x32_bf16 v[200:203], a[72:75], a[40:43], v[200:203]
    v_mfma_f32_16x16x32_bf16 v[204:207], a[72:75], a[44:47], v[204:207]
    v_mfma_f32_16x16x32_bf16 v[208:211], a[72:75], a[48:51], v[208:211]
    v_mfma_f32_16x16x32_bf16 v[212:215], a[72:75], a[52:55], v[212:215]
    v_mfma_f32_16x16x32_bf16 v[216:219], a[72:75], a[56:59], v[216:219]
    v_mfma_f32_16x16x32_bf16 v[220:223], a[72:75], a[60:63], v[220:223]
    v_mfma_f32_16x16x32_bf16 v[224:227], a[76:79], a[32:35], v[224:227]
    v_mfma_f32_16x16x32_bf16 v[228:231], a[76:79], a[36:39], v[228:231]
    v_mfma_f32_16x16x32_bf16 v[232:235], a[76:79], a[40:43], v[232:235]
    v_mfma_f32_16x16x32_bf16 v[236:239], a[76:79], a[44:47], v[236:239]
    v_mfma_f32_16x16x32_bf16 v[240:243], a[76:79], a[48:51], v[240:243]
    v_mfma_f32_16x16x32_bf16 v[244:247], a[76:79], a[52:55], v[244:247]
    v_mfma_f32_16x16x32_bf16 v[248:251], a[76:79], a[56:59], v[248:251]
    v_mfma_f32_16x16x32_bf16 v[252:255], a[76:79], a[60:63], v[252:255]
    v_and_b32 v23, 15, v22
    v_lshrrev_b32 v24, 4, v22
    s_lshl_b32 s33, s22, 10
    s_add_u32 s33, s33, 149504
    v_lshl_add_u32 v29, v23, 3, s33
    v_lshlrev_b32 v30, 4, v24
    v_add_u32 v30, 147456, v30
    ds_read_b64 v[72:73], v29 offset:0
    ds_read_b64 v[74:75], v29 offset:128
    ds_read_b64 v[76:77], v29 offset:256
    ds_read_b64 v[78:79], v29 offset:384
    ds_read_b64 v[80:81], v29 offset:512
    ds_read_b64 v[82:83], v29 offset:640
    ds_read_b64 v[84:85], v29 offset:768
    ds_read_b64 v[86:87], v29 offset:896
    ds_read_b128 v[32:35], v30 offset:0
    ds_read_b128 v[36:39], v30 offset:64
    ds_read_b128 v[40:43], v30 offset:128
    ds_read_b128 v[44:47], v30 offset:192
    ds_read_b128 v[48:51], v30 offset:256
    ds_read_b128 v[52:55], v30 offset:320
    ds_read_b128 v[56:59], v30 offset:384
    ds_read_b128 v[60:63], v30 offset:448
    ds_read_b128 v[64:67], v30 offset:512
    ds_read_b128 v[68:71], v30 offset:576
    v_and_b32 v23, 15, v22
    v_lshrrev_b32 v24, 4, v22
    v_and_b32 v25, 1, v24
    v_lshl_add_u32 v25, v25, 4, v23
    v_lshrrev_b32 v26, 1, v24
    v_lshlrev_b32 v1, 5, v25
    v_lshl_add_u32 v1, v26, 4, v1
    s_lshl_b32 s33, s22, 7
    v_add_u32 v25, s33, v25
    v_lshlrev_b32 v25, 6, v25
    v_lshrrev_b32 v27, 2, v23
    v_and_b32 v28, 2, v23
    v_xor_b32 v27, v27, v28
    v_xor_b32 v27, v27, v26
    v_lshl_add_u32 v2, v27, 4, v25
    v_xor_b32 v3, 32, v2
    v_lshrrev_b32 v27, 1, v23
    v_and_b32 v27, 3, v27
    v_xor_b32 v27, v27, v26
    v_lshl_add_u32 v4, v27, 4, v25
    v_xor_b32 v5, 32, v4
    v_add_u32 v6, 65536, v2
    v_add_u32 v7, 65536, v3
    v_accvgpr_read_b32 v92, a80
    v_accvgpr_read_b32 v93, a81
    v_accvgpr_read_b32 v94, a82
    v_accvgpr_read_b32 v95, a83
    v_accvgpr_read_b32 v96, a84
    v_accvgpr_read_b32 v97, a85
    v_accvgpr_read_b32 v98, a86
    v_accvgpr_read_b32 v99, a87
    s_waitcnt lgkmcnt(9)
    v_pk_fma_f32 v[92:93], v[32:33], v[72:73], v[92:93] op_sel:[0,0,0] op_sel_hi:[1,0,1]
    v_pk_fma_f32 v[94:95], v[34:35], v[72:73], v[94:95] op_sel:[0,0,0] op_sel_hi:[1,0,1]
    v_pk_fma_f32 v[96:97], v[32:33], v[74:75], v[96:97] op_sel:[0,0,0] op_sel_hi:[1,0,1]
    v_pk_fma_f32 v[98:99], v[34:35], v[74:75], v[98:99] op_sel:[0,0,0] op_sel_hi:[1,0,1]
    v_pk_mul_f32 v[92:93], v[92:93], v[72:73] op_sel:[0,1] op_sel_hi:[1,1]
    v_pk_mul_f32 v[94:95], v[94:95], v[72:73] op_sel:[0,1] op_sel_hi:[1,1]
    v_pk_mul_f32 v[96:97], v[96:97], v[74:75] op_sel:[0,1] op_sel_hi:[1,1]
    v_pk_mul_f32 v[98:99], v[98:99], v[74:75] op_sel:[0,1] op_sel_hi:[1,1]
    v_cvt_pk_bf16_f32 v88, v92, v93
    v_cvt_pk_bf16_f32 v89, v94, v95
    v_cvt_pk_bf16_f32 v90, v96, v97
    v_cvt_pk_bf16_f32 v91, v98, v99
    v_accvgpr_read_b32 v104, a88
    v_accvgpr_read_b32 v105, a89
    v_accvgpr_read_b32 v106, a90
    v_accvgpr_read_b32 v107, a91
    v_accvgpr_read_b32 v108, a92
    v_accvgpr_read_b32 v109, a93
    v_accvgpr_read_b32 v110, a94
    v_accvgpr_read_b32 v111, a95
    v_permlane16_swap_b32 v88, v90
    v_permlane16_swap_b32 v89, v91
    ds_write_b128 v4, v[88:91] offset:49152
    v_pk_fma_f32 v[104:105], v[32:33], v[76:77], v[104:105] op_sel:[0,0,0] op_sel_hi:[1,0,1]
    v_pk_fma_f32 v[106:107], v[34:35], v[76:77], v[106:107] op_sel:[0,0,0] op_sel_hi:[1,0,1]
    v_pk_fma_f32 v[108:109], v[32:33], v[78:79], v[108:109] op_sel:[0,0,0] op_sel_hi:[1,0,1]
    v_pk_fma_f32 v[110:111], v[34:35], v[78:79], v[110:111] op_sel:[0,0,0] op_sel_hi:[1,0,1]
    v_pk_mul_f32 v[104:105], v[104:105], v[76:77] op_sel:[0,1] op_sel_hi:[1,1]
    v_pk_mul_f32 v[106:107], v[106:107], v[76:77] op_sel:[0,1] op_sel_hi:[1,1]
    v_pk_mul_f32 v[108:109], v[108:109], v[78:79] op_sel:[0,1] op_sel_hi:[1,1]
    v_pk_mul_f32 v[110:111], v[110:111], v[78:79] op_sel:[0,1] op_sel_hi:[1,1]
    v_cvt_pk_bf16_f32 v100, v104, v105
    v_cvt_pk_bf16_f32 v101, v106, v107
    v_cvt_pk_bf16_f32 v102, v108, v109
    v_cvt_pk_bf16_f32 v103, v110, v111
    v_accvgpr_read_b32 v92, a96
    v_accvgpr_read_b32 v93, a97
    v_accvgpr_read_b32 v94, a98
    v_accvgpr_read_b32 v95, a99
    v_accvgpr_read_b32 v96, a100
    v_accvgpr_read_b32 v97, a101
    v_accvgpr_read_b32 v98, a102
    v_accvgpr_read_b32 v99, a103
    v_permlane16_swap_b32 v100, v102
    v_permlane16_swap_b32 v101, v103
    ds_write_b128 v4, v[100:103] offset:51200
    v_pk_fma_f32 v[92:93], v[32:33], v[80:81], v[92:93] op_sel:[0,0,0] op_sel_hi:[1,0,1]
    v_pk_fma_f32 v[94:95], v[34:35], v[80:81], v[94:95] op_sel:[0,0,0] op_sel_hi:[1,0,1]
    v_pk_fma_f32 v[96:97], v[32:33], v[82:83], v[96:97] op_sel:[0,0,0] op_sel_hi:[1,0,1]
    v_pk_fma_f32 v[98:99], v[34:35], v[82:83], v[98:99] op_sel:[0,0,0] op_sel_hi:[1,0,1]
    v_pk_mul_f32 v[92:93], v[92:93], v[80:81] op_sel:[0,1] op_sel_hi:[1,1]
    v_pk_mul_f32 v[94:95], v[94:95], v[80:81] op_sel:[0,1] op_sel_hi:[1,1]
    v_pk_mul_f32 v[96:97], v[96:97], v[82:83] op_sel:[0,1] op_sel_hi:[1,1]
    v_pk_mul_f32 v[98:99], v[98:99], v[82:83] op_sel:[0,1] op_sel_hi:[1,1]
    v_cvt_pk_bf16_f32 v88, v92, v93
    v_cvt_pk_bf16_f32 v89, v94, v95
    v_cvt_pk_bf16_f32 v90, v96, v97
    v_cvt_pk_bf16_f32 v91, v98, v99
    v_accvgpr_read_b32 v104, a104
    v_accvgpr_read_b32 v105, a105
    v_accvgpr_read_b32 v106, a106
    v_accvgpr_read_b32 v107, a107
    v_accvgpr_read_b32 v108, a108
    v_accvgpr_read_b32 v109, a109
    v_accvgpr_read_b32 v110, a110
    v_accvgpr_read_b32 v111, a111
    v_permlane16_swap_b32 v88, v90
    v_permlane16_swap_b32 v89, v91
    ds_write_b128 v4, v[88:91] offset:53248
    v_pk_fma_f32 v[104:105], v[32:33], v[84:85], v[104:105] op_sel:[0,0,0] op_sel_hi:[1,0,1]
    v_pk_fma_f32 v[106:107], v[34:35], v[84:85], v[106:107] op_sel:[0,0,0] op_sel_hi:[1,0,1]
    v_pk_fma_f32 v[108:109], v[32:33], v[86:87], v[108:109] op_sel:[0,0,0] op_sel_hi:[1,0,1]
    v_pk_fma_f32 v[110:111], v[34:35], v[86:87], v[110:111] op_sel:[0,0,0] op_sel_hi:[1,0,1]
    v_pk_mul_f32 v[104:105], v[104:105], v[84:85] op_sel:[0,1] op_sel_hi:[1,1]
    v_pk_mul_f32 v[106:107], v[106:107], v[84:85] op_sel:[0,1] op_sel_hi:[1,1]
    v_pk_mul_f32 v[108:109], v[108:109], v[86:87] op_sel:[0,1] op_sel_hi:[1,1]
    v_pk_mul_f32 v[110:111], v[110:111], v[86:87] op_sel:[0,1] op_sel_hi:[1,1]
    v_cvt_pk_bf16_f32 v100, v104, v105
    v_cvt_pk_bf16_f32 v101, v106, v107
    v_cvt_pk_bf16_f32 v102, v108, v109
    v_cvt_pk_bf16_f32 v103, v110, v111
    v_accvgpr_read_b32 v92, a112
    v_accvgpr_read_b32 v93, a113
    v_accvgpr_read_b32 v94, a114
    v_accvgpr_read_b32 v95, a115
    v_accvgpr_read_b32 v96, a116
    v_accvgpr_read_b32 v97, a117
    v_accvgpr_read_b32 v98, a118
    v_accvgpr_read_b32 v99, a119
    v_permlane16_swap_b32 v100, v102
    v_permlane16_swap_b32 v101, v103
    ds_write_b128 v4, v[100:103] offset:55296
    s_waitcnt lgkmcnt(12)
    v_pk_fma_f32 v[92:93], v[36:37], v[72:73], v[92:93] op_sel:[0,0,0] op_sel_hi:[1,0,1]
    v_pk_fma_f32 v[94:95], v[38:39], v[72:73], v[94:95] op_sel:[0,0,0] op_sel_hi:[1,0,1]
    v_pk_fma_f32 v[96:97], v[36:37], v[74:75], v[96:97] op_sel:[0,0,0] op_sel_hi:[1,0,1]
    v_pk_fma_f32 v[98:99], v[38:39], v[74:75], v[98:99] op_sel:[0,0,0] op_sel_hi:[1,0,1]
    v_pk_mul_f32 v[92:93], v[92:93], v[72:73] op_sel:[0,1] op_sel_hi:[1,1]
    v_pk_mul_f32 v[94:95], v[94:95], v[72:73] op_sel:[0,1] op_sel_hi:[1,1]
    v_pk_mul_f32 v[96:97], v[96:97], v[74:75] op_sel:[0,1] op_sel_hi:[1,1]
    v_pk_mul_f32 v[98:99], v[98:99], v[74:75] op_sel:[0,1] op_sel_hi:[1,1]
    v_cvt_pk_bf16_f32 v88, v92, v93
    v_cvt_pk_bf16_f32 v89, v94, v95
    v_cvt_pk_bf16_f32 v90, v96, v97
    v_cvt_pk_bf16_f32 v91, v98, v99
    v_accvgpr_read_b32 v104, a120
    v_accvgpr_read_b32 v105, a121
    v_accvgpr_read_b32 v106, a122
    v_accvgpr_read_b32 v107, a123
    v_accvgpr_read_b32 v108, a124
    v_accvgpr_read_b32 v109, a125
    v_accvgpr_read_b32 v110, a126
    v_accvgpr_read_b32 v111, a127
    v_permlane16_swap_b32 v88, v90
    v_permlane16_swap_b32 v89, v91
    ds_write_b128 v5, v[88:91] offset:49152
    v_pk_fma_f32 v[104:105], v[36:37], v[76:77], v[104:105] op_sel:[0,0,0] op_sel_hi:[1,0,1]
    v_pk_fma_f32 v[106:107], v[38:39], v[76:77], v[106:107] op_sel:[0,0,0] op_sel_hi:[1,0,1]
    v_pk_fma_f32 v[108:109], v[36:37], v[78:79], v[108:109] op_sel:[0,0,0] op_sel_hi:[1,0,1]
    v_pk_fma_f32 v[110:111], v[38:39], v[78:79], v[110:111] op_sel:[0,0,0] op_sel_hi:[1,0,1]
    v_pk_mul_f32 v[104:105], v[104:105], v[76:77] op_sel:[0,1] op_sel_hi:[1,1]
    v_pk_mul_f32 v[106:107], v[106:107], v[76:77] op_sel:[0,1] op_sel_hi:[1,1]
    v_pk_mul_f32 v[108:109], v[108:109], v[78:79] op_sel:[0,1] op_sel_hi:[1,1]
    v_pk_mul_f32 v[110:111], v[110:111], v[78:79] op_sel:[0,1] op_sel_hi:[1,1]
    v_cvt_pk_bf16_f32 v100, v104, v105
    v_cvt_pk_bf16_f32 v101, v106, v107
    v_cvt_pk_bf16_f32 v102, v108, v109
    v_cvt_pk_bf16_f32 v103, v110, v111
    v_accvgpr_read_b32 v92, a128
    v_accvgpr_read_b32 v93, a129
    v_accvgpr_read_b32 v94, a130
    v_accvgpr_read_b32 v95, a131
    v_accvgpr_read_b32 v96, a132
    v_accvgpr_read_b32 v97, a133
    v_accvgpr_read_b32 v98, a134
    v_accvgpr_read_b32 v99, a135
    v_permlane16_swap_b32 v100, v102
    v_permlane16_swap_b32 v101, v103
    ds_write_b128 v5, v[100:103] offset:51200
    v_pk_fma_f32 v[92:93], v[36:37], v[80:81], v[92:93] op_sel:[0,0,0] op_sel_hi:[1,0,1]
    v_pk_fma_f32 v[94:95], v[38:39], v[80:81], v[94:95] op_sel:[0,0,0] op_sel_hi:[1,0,1]
    v_pk_fma_f32 v[96:97], v[36:37], v[82:83], v[96:97] op_sel:[0,0,0] op_sel_hi:[1,0,1]
    v_pk_fma_f32 v[98:99], v[38:39], v[82:83], v[98:99] op_sel:[0,0,0] op_sel_hi:[1,0,1]
    v_pk_mul_f32 v[92:93], v[92:93], v[80:81] op_sel:[0,1] op_sel_hi:[1,1]
    v_pk_mul_f32 v[94:95], v[94:95], v[80:81] op_sel:[0,1] op_sel_hi:[1,1]
    v_pk_mul_f32 v[96:97], v[96:97], v[82:83] op_sel:[0,1] op_sel_hi:[1,1]
    v_pk_mul_f32 v[98:99], v[98:99], v[82:83] op_sel:[0,1] op_sel_hi:[1,1]
    v_cvt_pk_bf16_f32 v88, v92, v93
    v_cvt_pk_bf16_f32 v89, v94, v95
    v_cvt_pk_bf16_f32 v90, v96, v97
    v_cvt_pk_bf16_f32 v91, v98, v99
    v_accvgpr_read_b32 v104, a136
    v_accvgpr_read_b32 v105, a137
    v_accvgpr_read_b32 v106, a138
    v_accvgpr_read_b32 v107, a139
    v_accvgpr_read_b32 v108, a140
    v_accvgpr_read_b32 v109, a141
    v_accvgpr_read_b32 v110, a142
    v_accvgpr_read_b32 v111, a143
    v_permlane16_swap_b32 v88, v90
    v_permlane16_swap_b32 v89, v91
    ds_write_b128 v5, v[88:91] offset:53248
    v_pk_fma_f32 v[104:105], v[36:37], v[84:85], v[104:105] op_sel:[0,0,0] op_sel_hi:[1,0,1]
    v_pk_fma_f32 v[106:107], v[38:39], v[84:85], v[106:107] op_sel:[0,0,0] op_sel_hi:[1,0,1]
    v_pk_fma_f32 v[108:109], v[36:37], v[86:87], v[108:109] op_sel:[0,0,0] op_sel_hi:[1,0,1]
    v_pk_fma_f32 v[110:111], v[38:39], v[86:87], v[110:111] op_sel:[0,0,0] op_sel_hi:[1,0,1]
    v_pk_mul_f32 v[104:105], v[104:105], v[84:85] op_sel:[0,1] op_sel_hi:[1,1]
    v_pk_mul_f32 v[106:107], v[106:107], v[84:85] op_sel:[0,1] op_sel_hi:[1,1]
    v_pk_mul_f32 v[108:109], v[108:109], v[86:87] op_sel:[0,1] op_sel_hi:[1,1]
    v_pk_mul_f32 v[110:111], v[110:111], v[86:87] op_sel:[0,1] op_sel_hi:[1,1]
    v_cvt_pk_bf16_f32 v100, v104, v105
    v_cvt_pk_bf16_f32 v101, v106, v107
    v_cvt_pk_bf16_f32 v102, v108, v109
    v_cvt_pk_bf16_f32 v103, v110, v111
    s_nop 0
    v_permlane16_swap_b32 v100, v102
    s_nop 0
    v_permlane16_swap_b32 v101, v103
    ds_write_b128 v5, v[100:103] offset:55296
    s_waitcnt lgkmcnt(0)
    s_barrier
    v_lshlrev_b32 v23, 4, v22
    s_lshl_b32 s33, s3, 12
    v_add_u32 v23, s33, v23
    s_lshl_b32 s34, s20, 5
    s_add_u32 s34, s34, s21
    s_lshl_b32 s34, s34, 15
    s_add_u32 s34, s34, 23068672
    s_add_u32 s35, s34, 16384
    ds_read_b128 a[0:3], v23 offset:16384
    ds_read_b128 a[4:7], v23 offset:17408
    ds_read_b128 a[8:11], v23 offset:18432
    ds_read_b128 a[12:15], v23 offset:19456
    ds_read_b128 a[16:19], v23 offset:49152
    ds_read_b128 a[20:23], v23 offset:50176
    ds_read_b128 a[24:27], v23 offset:51200
    ds_read_b128 a[28:31], v23 offset:52224
    s_waitcnt lgkmcnt(7)
    buffer_store_dwordx4 a[0:3], v23, s[36:39], s34 offen offset:0 sc1
    s_waitcnt lgkmcnt(6)
    buffer_store_dwordx4 a[4:7], v23, s[36:39], s34 offen offset:1024 sc1
    s_waitcnt lgkmcnt(5)
    buffer_store_dwordx4 a[8:11], v23, s[36:39], s34 offen offset:2048 sc1
    s_waitcnt lgkmcnt(4)
    buffer_store_dwordx4 a[12:15], v23, s[36:39], s34 offen offset:3072 sc1
    s_waitcnt lgkmcnt(3)
    buffer_store_dwordx4 a[16:19], v23, s[36:39], s35 offen offset:0 sc1
    s_waitcnt lgkmcnt(2)
    buffer_store_dwordx4 a[20:23], v23, s[36:39], s35 offen offset:1024 sc1
    s_waitcnt lgkmcnt(1)
    buffer_store_dwordx4 a[24:27], v23, s[36:39], s35 offen offset:2048 sc1
    s_waitcnt lgkmcnt(0)
    buffer_store_dwordx4 a[28:31], v23, s[36:39], s35 offen offset:3072 sc1
    v_accvgpr_read_b32 v92, a144
    v_accvgpr_read_b32 v93, a145
    v_accvgpr_read_b32 v94, a146
    v_accvgpr_read_b32 v95, a147
    v_accvgpr_read_b32 v96, a148
    v_accvgpr_read_b32 v97, a149
    v_accvgpr_read_b32 v98, a150
    v_accvgpr_read_b32 v99, a151
    v_pk_fma_f32 v[92:93], v[40:41], v[72:73], v[92:93] op_sel:[0,0,0] op_sel_hi:[1,0,1]
    v_pk_fma_f32 v[94:95], v[42:43], v[72:73], v[94:95] op_sel:[0,0,0] op_sel_hi:[1,0,1]
    v_pk_fma_f32 v[128:129], v[56:57], v[72:73], v[128:129] op_sel:[0,0,0] op_sel_hi:[1,0,1]
    v_pk_fma_f32 v[130:131], v[58:59], v[72:73], v[130:131] op_sel:[0,0,0] op_sel_hi:[1,0,1]
    v_pk_fma_f32 v[96:97], v[40:41], v[74:75], v[96:97] op_sel:[0,0,0] op_sel_hi:[1,0,1]
    v_pk_fma_f32 v[98:99], v[42:43], v[74:75], v[98:99] op_sel:[0,0,0] op_sel_hi:[1,0,1]
    v_pk_fma_f32 v[132:133], v[56:57], v[74:75], v[132:133] op_sel:[0,0,0] op_sel_hi:[1,0,1]
    v_pk_fma_f32 v[134:135], v[58:59], v[74:75], v[134:135] op_sel:[0,0,0] op_sel_hi:[1,0,1]
    v_pk_mul_f32 v[128:129], v[92:93], v[128:129]
    v_pk_mul_f32 v[130:131], v[94:95], v[130:131]
    v_pk_mul_f32 v[132:133], v[96:97], v[132:133]
    v_pk_mul_f32 v[134:135], v[98:99], v[134:135]
    v_cvt_pk_bf16_f32 v128, v128, v129
    v_cvt_pk_bf16_f32 v129, v130, v131
    v_cvt_pk_bf16_f32 v130, v132, v133
    v_cvt_pk_bf16_f32 v131, v134, v135
    v_accvgpr_read_b32 v104, a152
    v_accvgpr_read_b32 v105, a153
    v_accvgpr_read_b32 v106, a154
    v_accvgpr_read_b32 v107, a155
    v_accvgpr_read_b32 v108, a156
    v_accvgpr_read_b32 v109, a157
    v_accvgpr_read_b32 v110, a158
    v_accvgpr_read_b32 v111, a159
    v_permlane16_swap_b32 v128, v130
    v_permlane16_swap_b32 v129, v131
    v_pk_fma_f32 v[104:105], v[40:41], v[76:77], v[104:105] op_sel:[0,0,0] op_sel_hi:[1,0,1]
    v_pk_fma_f32 v[106:107], v[42:43], v[76:77], v[106:107] op_sel:[0,0,0] op_sel_hi:[1,0,1]
    v_pk_fma_f32 v[136:137], v[56:57], v[76:77], v[136:137] op_sel:[0,0,0] op_sel_hi:[1,0,1]
    v_pk_fma_f32 v[138:139], v[58:59], v[76:77], v[138:139] op_sel:[0,0,0] op_sel_hi:[1,0,1]
    v_pk_fma_f32 v[108:109], v[40:41], v[78:79], v[108:109] op_sel:[0,0,0] op_sel_hi:[1,0,1]
    v_pk_fma_f32 v[110:111], v[42:43], v[78:79], v[110:111] op_sel:[0,0,0] op_sel_hi:[1,0,1]
    v_pk_fma_f32 v[140:141], v[56:57], v[78:79], v[140:141] op_sel:[0,0,0] op_sel_hi:[1,0,1]
    v_pk_fma_f32 v[142:143], v[58:59], v[78:79], v[142:143] op_sel:[0,0,0] op_sel_hi:[1,0,1]
    v_pk_mul_f32 v[136:137], v[104:105], v[136:137]
    v_pk_mul_f32 v[138:139], v[106:107], v[138:139]
    v_pk_mul_f32 v[140:141], v[108:109], v[140:141]
    v_pk_mul_f32 v[142:143], v[110:111], v[142:143]
    v_cvt_pk_bf16_f32 v136, v136, v137
    v_cvt_pk_bf16_f32 v137, v138, v139
    v_cvt_pk_bf16_f32 v138, v140, v141
    v_cvt_pk_bf16_f32 v139, v142, v143
    v_accvgpr_read_b32 v92, a160
    v_accvgpr_read_b32 v93, a161
    v_accvgpr_read_b32 v94, a162
    v_accvgpr_read_b32 v95, a163
    v_accvgpr_read_b32 v96, a164
    v_accvgpr_read_b32 v97, a165
    v_accvgpr_read_b32 v98, a166
    v_accvgpr_read_b32 v99, a167
    v_permlane16_swap_b32 v136, v138
    v_permlane16_swap_b32 v137, v139
    v_pk_fma_f32 v[92:93], v[40:41], v[80:81], v[92:93] op_sel:[0,0,0] op_sel_hi:[1,0,1]
    v_pk_fma_f32 v[94:95], v[42:43], v[80:81], v[94:95] op_sel:[0,0,0] op_sel_hi:[1,0,1]
    v_pk_fma_f32 v[144:145], v[56:57], v[80:81], v[144:145] op_sel:[0,0,0] op_sel_hi:[1,0,1]
    v_pk_fma_f32 v[146:147], v[58:59], v[80:81], v[146:147] op_sel:[0,0,0] op_sel_hi:[1,0,1]
    v_pk_fma_f32 v[96:97], v[40:41], v[82:83], v[96:97] op_sel:[0,0,0] op_sel_hi:[1,0,1]
    v_pk_fma_f32 v[98:99], v[42:43], v[82:83], v[98:99] op_sel:[0,0,0] op_sel_hi:[1,0,1]
    v_pk_fma_f32 v[148:149], v[56:57], v[82:83], v[148:149] op_sel:[0,0,0] op_sel_hi:[1,0,1]
    v_pk_fma_f32 v[150:151], v[58:59], v[82:83], v[150:151] op_sel:[0,0,0] op_sel_hi:[1,0,1]
    v_pk_mul_f32 v[144:145], v[92:93], v[144:145]
    v_pk_mul_f32 v[146:147], v[94:95], v[146:147]
    v_pk_mul_f32 v[148:149], v[96:97], v[148:149]
    v_pk_mul_f32 v[150:151], v[98:99], v[150:151]
    v_cvt_pk_bf16_f32 v144, v144, v145
    v_cvt_pk_bf16_f32 v145, v146, v147
    v_cvt_pk_bf16_f32 v146, v148, v149
    v_cvt_pk_bf16_f32 v147, v150, v151
    v_accvgpr_read_b32 v104, a168
    v_accvgpr_read_b32 v105, a169
    v_accvgpr_read_b32 v106, a170
    v_accvgpr_read_b32 v107, a171
    v_accvgpr_read_b32 v108, a172
    v_accvgpr_read_b32 v109, a173
    v_accvgpr_read_b32 v110, a174
    v_accvgpr_read_b32 v111, a175
    v_permlane16_swap_b32 v144, v146
    v_permlane16_swap_b32 v145, v147
    v_pk_fma_f32 v[104:105], v[40:41], v[84:85], v[104:105] op_sel:[0,0,0] op_sel_hi:[1,0,1]
    v_pk_fma_f32 v[106:107], v[42:43], v[84:85], v[106:107] op_sel:[0,0,0] op_sel_hi:[1,0,1]
    v_pk_fma_f32 v[152:153], v[56:57], v[84:85], v[152:153] op_sel:[0,0,0] op_sel_hi:[1,0,1]
    v_pk_fma_f32 v[154:155], v[58:59], v[84:85], v[154:155] op_sel:[0,0,0] op_sel_hi:[1,0,1]
    v_pk_fma_f32 v[108:109], v[40:41], v[86:87], v[108:109] op_sel:[0,0,0] op_sel_hi:[1,0,1]
    v_pk_fma_f32 v[110:111], v[42:43], v[86:87], v[110:111] op_sel:[0,0,0] op_sel_hi:[1,0,1]
    v_pk_fma_f32 v[156:157], v[56:57], v[86:87], v[156:157] op_sel:[0,0,0] op_sel_hi:[1,0,1]
    v_pk_fma_f32 v[158:159], v[58:59], v[86:87], v[158:159] op_sel:[0,0,0] op_sel_hi:[1,0,1]
    v_pk_mul_f32 v[152:153], v[104:105], v[152:153]
    v_pk_mul_f32 v[154:155], v[106:107], v[154:155]
    v_pk_mul_f32 v[156:157], v[108:109], v[156:157]
    v_pk_mul_f32 v[158:159], v[110:111], v[158:159]
    v_cvt_pk_bf16_f32 v152, v152, v153
    v_cvt_pk_bf16_f32 v153, v154, v155
    v_cvt_pk_bf16_f32 v154, v156, v157
    v_cvt_pk_bf16_f32 v155, v158, v159
    v_accvgpr_read_b32 v92, a176
    v_accvgpr_read_b32 v93, a177
    v_accvgpr_read_b32 v94, a178
    v_accvgpr_read_b32 v95, a179
    v_accvgpr_read_b32 v96, a180
    v_accvgpr_read_b32 v97, a181
    v_accvgpr_read_b32 v98, a182
    v_accvgpr_read_b32 v99, a183
    v_permlane16_swap_b32 v152, v154
    v_permlane16_swap_b32 v153, v155
    v_pk_fma_f32 v[92:93], v[44:45], v[72:73], v[92:93] op_sel:[0,0,0] op_sel_hi:[1,0,1]
    v_pk_fma_f32 v[94:95], v[46:47], v[72:73], v[94:95] op_sel:[0,0,0] op_sel_hi:[1,0,1]
    v_pk_fma_f32 v[160:161], v[60:61], v[72:73], v[160:161] op_sel:[0,0,0] op_sel_hi:[1,0,1]
    v_pk_fma_f32 v[162:163], v[62:63], v[72:73], v[162:163] op_sel:[0,0,0] op_sel_hi:[1,0,1]
    v_pk_fma_f32 v[96:97], v[44:45], v[74:75], v[96:97] op_sel:[0,0,0] op_sel_hi:[1,0,1]
    v_pk_fma_f32 v[98:99], v[46:47], v[74:75], v[98:99] op_sel:[0,0,0] op_sel_hi:[1,0,1]
    v_pk_fma_f32 v[164:165], v[60:61], v[74:75], v[164:165] op_sel:[0,0,0] op_sel_hi:[1,0,1]
    v_pk_fma_f32 v[166:167], v[62:63], v[74:75], v[166:167] op_sel:[0,0,0] op_sel_hi:[1,0,1]
    v_pk_mul_f32 v[160:161], v[92:93], v[160:161]
    v_pk_mul_f32 v[162:163], v[94:95], v[162:163]
    v_pk_mul_f32 v[164:165], v[96:97], v[164:165]
    v_pk_mul_f32 v[166:167], v[98:99], v[166:167]
    v_cvt_pk_bf16_f32 v160, v160, v161
    v_cvt_pk_bf16_f32 v161, v162, v163
    v_cvt_pk_bf16_f32 v162, v164, v165
    v_cvt_pk_bf16_f32 v163, v166, v167
    v_accvgpr_read_b32 v104, a184
    v_accvgpr_read_b32 v105, a185
    v_accvgpr_read_b32 v106, a186
    v_accvgpr_read_b32 v107, a187
    v_accvgpr_read_b32 v108, a188
    v_accvgpr_read_b32 v109, a189
    v_accvgpr_read_b32 v110, a190
    v_accvgpr_read_b32 v111, a191
    v_permlane16_swap_b32 v160, v162
    v_permlane16_swap_b32 v161, v163
    v_pk_fma_f32 v[104:105], v[44:45], v[76:77], v[104:105] op_sel:[0,0,0] op_sel_hi:[1,0,1]
    v_pk_fma_f32 v[106:107], v[46:47], v[76:77], v[106:107] op_sel:[0,0,0] op_sel_hi:[1,0,1]
    v_pk_fma_f32 v[168:169], v[60:61], v[76:77], v[168:169] op_sel:[0,0,0] op_sel_hi:[1,0,1]
    v_pk_fma_f32 v[170:171], v[62:63], v[76:77], v[170:171] op_sel:[0,0,0] op_sel_hi:[1,0,1]
    v_pk_fma_f32 v[108:109], v[44:45], v[78:79], v[108:109] op_sel:[0,0,0] op_sel_hi:[1,0,1]
    v_pk_fma_f32 v[110:111], v[46:47], v[78:79], v[110:111] op_sel:[0,0,0] op_sel_hi:[1,0,1]
    v_pk_fma_f32 v[172:173], v[60:61], v[78:79], v[172:173] op_sel:[0,0,0] op_sel_hi:[1,0,1]
    v_pk_fma_f32 v[174:175], v[62:63], v[78:79], v[174:175] op_sel:[0,0,0] op_sel_hi:[1,0,1]
    v_pk_mul_f32 v[168:169], v[104:105], v[168:169]
    v_pk_mul_f32 v[170:171], v[106:107], v[170:171]
    v_pk_mul_f32 v[172:173], v[108:109], v[172:173]
    v_pk_mul_f32 v[174:175], v[110:111], v[174:175]
    v_cvt_pk_bf16_f32 v168, v168, v169
    v_cvt_pk_bf16_f32 v169, v170, v171
    v_cvt_pk_bf16_f32 v170, v172, v173
    v_cvt_pk_bf16_f32 v171, v174, v175
    v_accvgpr_read_b32 v92, a192
    v_accvgpr_read_b32 v93, a193
    v_accvgpr_read_b32 v94, a194
    v_accvgpr_read_b32 v95, a195
    v_accvgpr_read_b32 v96, a196
    v_accvgpr_read_b32 v97, a197
    v_accvgpr_read_b32 v98, a198
    v_accvgpr_read_b32 v99, a199
    v_permlane16_swap_b32 v168, v170
    v_permlane16_swap_b32 v169, v171
    v_pk_fma_f32 v[92:93], v[44:45], v[80:81], v[92:93] op_sel:[0,0,0] op_sel_hi:[1,0,1]
    v_pk_fma_f32 v[94:95], v[46:47], v[80:81], v[94:95] op_sel:[0,0,0] op_sel_hi:[1,0,1]
    v_pk_fma_f32 v[176:177], v[60:61], v[80:81], v[176:177] op_sel:[0,0,0] op_sel_hi:[1,0,1]
    v_pk_fma_f32 v[178:179], v[62:63], v[80:81], v[178:179] op_sel:[0,0,0] op_sel_hi:[1,0,1]
    v_pk_fma_f32 v[96:97], v[44:45], v[82:83], v[96:97] op_sel:[0,0,0] op_sel_hi:[1,0,1]
    v_pk_fma_f32 v[98:99], v[46:47], v[82:83], v[98:99] op_sel:[0,0,0] op_sel_hi:[1,0,1]
    v_pk_fma_f32 v[180:181], v[60:61], v[82:83], v[180:181] op_sel:[0,0,0] op_sel_hi:[1,0,1]
    v_pk_fma_f32 v[182:183], v[62:63], v[82:83], v[182:183] op_sel:[0,0,0] op_sel_hi:[1,0,1]
    v_pk_mul_f32 v[176:177], v[92:93], v[176:177]
    v_pk_mul_f32 v[178:179], v[94:95], v[178:179]
    v_pk_mul_f32 v[180:181], v[96:97], v[180:181]
    v_pk_mul_f32 v[182:183], v[98:99], v[182:183]
    v_cvt_pk_bf16_f32 v176, v176, v177
    v_cvt_pk_bf16_f32 v177, v178, v179
    v_cvt_pk_bf16_f32 v178, v180, v181
    v_cvt_pk_bf16_f32 v179, v182, v183
    v_accvgpr_read_b32 v104, a200
    v_accvgpr_read_b32 v105, a201
    v_accvgpr_read_b32 v106, a202
    v_accvgpr_read_b32 v107, a203
    v_accvgpr_read_b32 v108, a204
    v_accvgpr_read_b32 v109, a205
    v_accvgpr_read_b32 v110, a206
    v_accvgpr_read_b32 v111, a207
    v_permlane16_swap_b32 v176, v178
    v_permlane16_swap_b32 v177, v179
    v_pk_fma_f32 v[104:105], v[44:45], v[84:85], v[104:105] op_sel:[0,0,0] op_sel_hi:[1,0,1]
    v_pk_fma_f32 v[106:107], v[46:47], v[84:85], v[106:107] op_sel:[0,0,0] op_sel_hi:[1,0,1]
    v_pk_fma_f32 v[184:185], v[60:61], v[84:85], v[184:185] op_sel:[0,0,0] op_sel_hi:[1,0,1]
    v_pk_fma_f32 v[186:187], v[62:63], v[84:85], v[186:187] op_sel:[0,0,0] op_sel_hi:[1,0,1]
    v_pk_fma_f32 v[108:109], v[44:45], v[86:87], v[108:109] op_sel:[0,0,0] op_sel_hi:[1,0,1]
    v_pk_fma_f32 v[110:111], v[46:47], v[86:87], v[110:111] op_sel:[0,0,0] op_sel_hi:[1,0,1]
    v_pk_fma_f32 v[188:189], v[60:61], v[86:87], v[188:189] op_sel:[0,0,0] op_sel_hi:[1,0,1]
    v_pk_fma_f32 v[190:191], v[62:63], v[86:87], v[190:191] op_sel:[0,0,0] op_sel_hi:[1,0,1]
    v_pk_mul_f32 v[184:185], v[104:105], v[184:185]
    v_pk_mul_f32 v[186:187], v[106:107], v[186:187]
    v_pk_mul_f32 v[188:189], v[108:109], v[188:189]
    v_pk_mul_f32 v[190:191], v[110:111], v[190:191]
    v_cvt_pk_bf16_f32 v184, v184, v185
    v_cvt_pk_bf16_f32 v185, v186, v187
    v_cvt_pk_bf16_f32 v186, v188, v189
    v_cvt_pk_bf16_f32 v187, v190, v191
    s_nop 0
    v_permlane16_swap_b32 v184, v186
    s_nop 0
    v_permlane16_swap_b32 v185, v187
    s_waitcnt vmcnt(0)
    s_lshl_b32 s33, s77, 9
    s_lshl_b32 s34, s3, 7
    s_add_u32 s33, s33, s34
    s_add_u32 s33, s33, 40632320
    s_add_u32 s34, s96, 1
    v_mov_b32 v24, s34
    v_mov_b32 v25, 0
    s_mov_b64 exec, 1
    buffer_store_dword v24, v25, s[36:39], s33 offen sc1
    s_mov_b64 exec, -1
    v_accvgpr_read_b32 v92, a208
    v_accvgpr_read_b32 v93, a209
    v_accvgpr_read_b32 v94, a210
    v_accvgpr_read_b32 v95, a211
    v_accvgpr_read_b32 v96, a212
    v_accvgpr_read_b32 v97, a213
    v_accvgpr_read_b32 v98, a214
    v_accvgpr_read_b32 v99, a215
    v_pk_fma_f32 v[92:93], v[48:49], v[72:73], v[92:93] op_sel:[0,0,0] op_sel_hi:[1,0,1]
    v_pk_fma_f32 v[94:95], v[50:51], v[72:73], v[94:95] op_sel:[0,0,0] op_sel_hi:[1,0,1]
    v_pk_fma_f32 v[192:193], v[64:65], v[72:73], v[192:193] op_sel:[0,0,0] op_sel_hi:[1,0,1]
    v_pk_fma_f32 v[194:195], v[66:67], v[72:73], v[194:195] op_sel:[0,0,0] op_sel_hi:[1,0,1]
    v_pk_fma_f32 v[96:97], v[48:49], v[74:75], v[96:97] op_sel:[0,0,0] op_sel_hi:[1,0,1]
    v_pk_fma_f32 v[98:99], v[50:51], v[74:75], v[98:99] op_sel:[0,0,0] op_sel_hi:[1,0,1]
    v_pk_fma_f32 v[196:197], v[64:65], v[74:75], v[196:197] op_sel:[0,0,0] op_sel_hi:[1,0,1]
    v_pk_fma_f32 v[198:199], v[66:67], v[74:75], v[198:199] op_sel:[0,0,0] op_sel_hi:[1,0,1]
    v_pk_mul_f32 v[192:193], v[92:93], v[192:193]
    v_pk_mul_f32 v[194:195], v[94:95], v[194:195]
    v_pk_mul_f32 v[196:197], v[96:97], v[196:197]
    v_pk_mul_f32 v[198:199], v[98:99], v[198:199]
    v_cvt_pk_bf16_f32 v192, v192, v193
    v_cvt_pk_bf16_f32 v193, v194, v195
    v_cvt_pk_bf16_f32 v194, v196, v197
    v_cvt_pk_bf16_f32 v195, v198, v199
    v_accvgpr_read_b32 v104, a216
    v_accvgpr_read_b32 v105, a217
    v_accvgpr_read_b32 v106, a218
    v_accvgpr_read_b32 v107, a219
    v_accvgpr_read_b32 v108, a220
    v_accvgpr_read_b32 v109, a221
    v_accvgpr_read_b32 v110, a222
    v_accvgpr_read_b32 v111, a223
    v_permlane16_swap_b32 v192, v194
    v_permlane16_swap_b32 v193, v195
    v_pk_fma_f32 v[104:105], v[48:49], v[76:77], v[104:105] op_sel:[0,0,0] op_sel_hi:[1,0,1]
    v_pk_fma_f32 v[106:107], v[50:51], v[76:77], v[106:107] op_sel:[0,0,0] op_sel_hi:[1,0,1]
    v_pk_fma_f32 v[200:201], v[64:65], v[76:77], v[200:201] op_sel:[0,0,0] op_sel_hi:[1,0,1]
    v_pk_fma_f32 v[202:203], v[66:67], v[76:77], v[202:203] op_sel:[0,0,0] op_sel_hi:[1,0,1]
    v_pk_fma_f32 v[108:109], v[48:49], v[78:79], v[108:109] op_sel:[0,0,0] op_sel_hi:[1,0,1]
    v_pk_fma_f32 v[110:111], v[50:51], v[78:79], v[110:111] op_sel:[0,0,0] op_sel_hi:[1,0,1]
    v_pk_fma_f32 v[204:205], v[64:65], v[78:79], v[204:205] op_sel:[0,0,0] op_sel_hi:[1,0,1]
    v_pk_fma_f32 v[206:207], v[66:67], v[78:79], v[206:207] op_sel:[0,0,0] op_sel_hi:[1,0,1]
    v_pk_mul_f32 v[200:201], v[104:105], v[200:201]
    v_pk_mul_f32 v[202:203], v[106:107], v[202:203]
    v_pk_mul_f32 v[204:205], v[108:109], v[204:205]
    v_pk_mul_f32 v[206:207], v[110:111], v[206:207]
    v_cvt_pk_bf16_f32 v200, v200, v201
    v_cvt_pk_bf16_f32 v201, v202, v203
    v_cvt_pk_bf16_f32 v202, v204, v205
    v_cvt_pk_bf16_f32 v203, v206, v207
    v_accvgpr_read_b32 v92, a224
    v_accvgpr_read_b32 v93, a225
    v_accvgpr_read_b32 v94, a226
    v_accvgpr_read_b32 v95, a227
    v_accvgpr_read_b32 v96, a228
    v_accvgpr_read_b32 v97, a229
    v_accvgpr_read_b32 v98, a230
    v_accvgpr_read_b32 v99, a231
    v_permlane16_swap_b32 v200, v202
    v_permlane16_swap_b32 v201, v203
    v_pk_fma_f32 v[92:93], v[48:49], v[80:81], v[92:93] op_sel:[0,0,0] op_sel_hi:[1,0,1]
    v_pk_fma_f32 v[94:95], v[50:51], v[80:81], v[94:95] op_sel:[0,0,0] op_sel_hi:[1,0,1]
    v_pk_fma_f32 v[208:209], v[64:65], v[80:81], v[208:209] op_sel:[0,0,0] op_sel_hi:[1,0,1]
    v_pk_fma_f32 v[210:211], v[66:67], v[80:81], v[210:211] op_sel:[0,0,0] op_sel_hi:[1,0,1]
    v_pk_fma_f32 v[96:97], v[48:49], v[82:83], v[96:97] op_sel:[0,0,0] op_sel_hi:[1,0,1]
    v_pk_fma_f32 v[98:99], v[50:51], v[82:83], v[98:99] op_sel:[0,0,0] op_sel_hi:[1,0,1]
    v_pk_fma_f32 v[212:213], v[64:65], v[82:83], v[212:213] op_sel:[0,0,0] op_sel_hi:[1,0,1]
    v_pk_fma_f32 v[214:215], v[66:67], v[82:83], v[214:215] op_sel:[0,0,0] op_sel_hi:[1,0,1]
    v_pk_mul_f32 v[208:209], v[92:93], v[208:209]
    v_pk_mul_f32 v[210:211], v[94:95], v[210:211]
    v_pk_mul_f32 v[212:213], v[96:97], v[212:213]
    v_pk_mul_f32 v[214:215], v[98:99], v[214:215]
    v_cvt_pk_bf16_f32 v208, v208, v209
    v_cvt_pk_bf16_f32 v209, v210, v211
    v_cvt_pk_bf16_f32 v210, v212, v213
    v_cvt_pk_bf16_f32 v211, v214, v215
    v_accvgpr_read_b32 v104, a232
    v_accvgpr_read_b32 v105, a233
    v_accvgpr_read_b32 v106, a234
    v_accvgpr_read_b32 v107, a235
    v_accvgpr_read_b32 v108, a236
    v_accvgpr_read_b32 v109, a237
    v_accvgpr_read_b32 v110, a238
    v_accvgpr_read_b32 v111, a239
    v_permlane16_swap_b32 v208, v210
    v_permlane16_swap_b32 v209, v211
    v_pk_fma_f32 v[104:105], v[48:49], v[84:85], v[104:105] op_sel:[0,0,0] op_sel_hi:[1,0,1]
    v_pk_fma_f32 v[106:107], v[50:51], v[84:85], v[106:107] op_sel:[0,0,0] op_sel_hi:[1,0,1]
    v_pk_fma_f32 v[216:217], v[64:65], v[84:85], v[216:217] op_sel:[0,0,0] op_sel_hi:[1,0,1]
    v_pk_fma_f32 v[218:219], v[66:67], v[84:85], v[218:219] op_sel:[0,0,0] op_sel_hi:[1,0,1]
    v_pk_fma_f32 v[108:109], v[48:49], v[86:87], v[108:109] op_sel:[0,0,0] op_sel_hi:[1,0,1]
    v_pk_fma_f32 v[110:111], v[50:51], v[86:87], v[110:111] op_sel:[0,0,0] op_sel_hi:[1,0,1]
    v_pk_fma_f32 v[220:221], v[64:65], v[86:87], v[220:221] op_sel:[0,0,0] op_sel_hi:[1,0,1]
    v_pk_fma_f32 v[222:223], v[66:67], v[86:87], v[222:223] op_sel:[0,0,0] op_sel_hi:[1,0,1]
    v_pk_mul_f32 v[216:217], v[104:105], v[216:217]
    v_pk_mul_f32 v[218:219], v[106:107], v[218:219]
    v_pk_mul_f32 v[220:221], v[108:109], v[220:221]
    v_pk_mul_f32 v[222:223], v[110:111], v[222:223]
    v_cvt_pk_bf16_f32 v216, v216, v217
    v_cvt_pk_bf16_f32 v217, v218, v219
    v_cvt_pk_bf16_f32 v218, v220, v221
    v_cvt_pk_bf16_f32 v219, v222, v223
    s_sub_u32 s33, s77, 8
    s_lshl_b32 s33, s33, 9
    s_lshl_b32 s34, s3, 7
    s_add_u32 s33, s33, s34
    s_add_u32 s63, s33, 40632320
    s_add_u32 s79, s79, 1
    v_mov_b32 v25, 0
    buffer_load_dword v24, v25, s[36:39], s63 offen sc1
    v_accvgpr_read_b32 v92, a240
    v_accvgpr_read_b32 v93, a241
    v_accvgpr_read_b32 v94, a242
    v_accvgpr_read_b32 v95, a243
    v_accvgpr_read_b32 v96, a244
    v_accvgpr_read_b32 v97, a245
    v_accvgpr_read_b32 v98, a246
    v_accvgpr_read_b32 v99, a247
    v_permlane16_swap_b32 v216, v218
    v_permlane16_swap_b32 v217, v219
    v_pk_fma_f32 v[92:93], v[52:53], v[72:73], v[92:93] op_sel:[0,0,0] op_sel_hi:[1,0,1]
    v_pk_fma_f32 v[94:95], v[54:55], v[72:73], v[94:95] op_sel:[0,0,0] op_sel_hi:[1,0,1]
    v_pk_fma_f32 v[224:225], v[68:69], v[72:73], v[224:225] op_sel:[0,0,0] op_sel_hi:[1,0,1]
    v_pk_fma_f32 v[226:227], v[70:71], v[72:73], v[226:227] op_sel:[0,0,0] op_sel_hi:[1,0,1]
    v_pk_fma_f32 v[96:97], v[52:53], v[74:75], v[96:97] op_sel:[0,0,0] op_sel_hi:[1,0,1]
    v_pk_fma_f32 v[98:99], v[54:55], v[74:75], v[98:99] op_sel:[0,0,0] op_sel_hi:[1,0,1]
    v_pk_fma_f32 v[228:229], v[68:69], v[74:75], v[228:229] op_sel:[0,0,0] op_sel_hi:[1,0,1]
    v_pk_fma_f32 v[230:231], v[70:71], v[74:75], v[230:231] op_sel:[0,0,0] op_sel_hi:[1,0,1]
    v_pk_mul_f32 v[224:225], v[92:93], v[224:225]
    v_pk_mul_f32 v[226:227], v[94:95], v[226:227]
    v_pk_mul_f32 v[228:229], v[96:97], v[228:229]
    v_pk_mul_f32 v[230:231], v[98:99], v[230:231]
    v_cvt_pk_bf16_f32 v224, v224, v225
    v_cvt_pk_bf16_f32 v225, v226, v227
    v_cvt_pk_bf16_f32 v226, v228, v229
    v_cvt_pk_bf16_f32 v227, v230, v231
    v_accvgpr_read_b32 v104, a248
    v_accvgpr_read_b32 v105, a249
    v_accvgpr_read_b32 v106, a250
    v_accvgpr_read_b32 v107, a251
    v_accvgpr_read_b32 v108, a252
    v_accvgpr_read_b32 v109, a253
    v_accvgpr_read_b32 v110, a254
    v_accvgpr_read_b32 v111, a255
    v_permlane16_swap_b32 v224, v226
    v_permlane16_swap_b32 v225, v227
    v_pk_fma_f32 v[104:105], v[52:53], v[76:77], v[104:105] op_sel:[0,0,0] op_sel_hi:[1,0,1]
    v_pk_fma_f32 v[106:107], v[54:55], v[76:77], v[106:107] op_sel:[0,0,0] op_sel_hi:[1,0,1]
    v_pk_fma_f32 v[232:233], v[68:69], v[76:77], v[232:233] op_sel:[0,0,0] op_sel_hi:[1,0,1]
    v_pk_fma_f32 v[234:235], v[70:71], v[76:77], v[234:235] op_sel:[0,0,0] op_sel_hi:[1,0,1]
    v_pk_fma_f32 v[108:109], v[52:53], v[78:79], v[108:109] op_sel:[0,0,0] op_sel_hi:[1,0,1]
    v_pk_fma_f32 v[110:111], v[54:55], v[78:79], v[110:111] op_sel:[0,0,0] op_sel_hi:[1,0,1]
    v_pk_fma_f32 v[236:237], v[68:69], v[78:79], v[236:237] op_sel:[0,0,0] op_sel_hi:[1,0,1]
    v_pk_fma_f32 v[238:239], v[70:71], v[78:79], v[238:239] op_sel:[0,0,0] op_sel_hi:[1,0,1]
    v_pk_mul_f32 v[232:233], v[104:105], v[232:233]
    v_pk_mul_f32 v[234:235], v[106:107], v[234:235]
    v_pk_mul_f32 v[236:237], v[108:109], v[236:237]
    v_pk_mul_f32 v[238:239], v[110:111], v[238:239]
    v_cvt_pk_bf16_f32 v232, v232, v233
    v_cvt_pk_bf16_f32 v233, v234, v235
    v_cvt_pk_bf16_f32 v234, v236, v237
    v_cvt_pk_bf16_f32 v235, v238, v239
    s_nop 0
    v_permlane16_swap_b32 v232, v234
    s_nop 0
    v_permlane16_swap_b32 v233, v235
    v_pk_fma_f32 v[112:113], v[52:53], v[80:81], v[112:113] op_sel:[0,0,0] op_sel_hi:[1,0,1]
    v_pk_fma_f32 v[114:115], v[54:55], v[80:81], v[114:115] op_sel:[0,0,0] op_sel_hi:[1,0,1]
    v_pk_fma_f32 v[240:241], v[68:69], v[80:81], v[240:241] op_sel:[0,0,0] op_sel_hi:[1,0,1]
    v_pk_fma_f32 v[242:243], v[70:71], v[80:81], v[242:243] op_sel:[0,0,0] op_sel_hi:[1,0,1]
    v_pk_fma_f32 v[116:117], v[52:53], v[82:83], v[116:117] op_sel:[0,0,0] op_sel_hi:[1,0,1]
    v_pk_fma_f32 v[118:119], v[54:55], v[82:83], v[118:119] op_sel:[0,0,0] op_sel_hi:[1,0,1]
    v_pk_fma_f32 v[244:245], v[68:69], v[82:83], v[244:245] op_sel:[0,0,0] op_sel_hi:[1,0,1]
    v_pk_fma_f32 v[246:247], v[70:71], v[82:83], v[246:247] op_sel:[0,0,0] op_sel_hi:[1,0,1]
    v_pk_mul_f32 v[240:241], v[112:113], v[240:241]
    v_pk_mul_f32 v[242:243], v[114:115], v[242:243]
    v_pk_mul_f32 v[244:245], v[116:117], v[244:245]
    v_pk_mul_f32 v[246:247], v[118:119], v[246:247]
    v_cvt_pk_bf16_f32 v240, v240, v241
    v_cvt_pk_bf16_f32 v241, v242, v243
    v_cvt_pk_bf16_f32 v242, v244, v245
    v_cvt_pk_bf16_f32 v243, v246, v247
    s_nop 0
    v_permlane16_swap_b32 v240, v242
    s_nop 0
    v_permlane16_swap_b32 v241, v243
    v_pk_fma_f32 v[120:121], v[52:53], v[84:85], v[120:121] op_sel:[0,0,0] op_sel_hi:[1,0,1]
    v_pk_fma_f32 v[122:123], v[54:55], v[84:85], v[122:123] op_sel:[0,0,0] op_sel_hi:[1,0,1]
    v_pk_fma_f32 v[248:249], v[68:69], v[84:85], v[248:249] op_sel:[0,0,0] op_sel_hi:[1,0,1]
    v_pk_fma_f32 v[250:251], v[70:71], v[84:85], v[250:251] op_sel:[0,0,0] op_sel_hi:[1,0,1]
    v_pk_fma_f32 v[124:125], v[52:53], v[86:87], v[124:125] op_sel:[0,0,0] op_sel_hi:[1,0,1]
    v_pk_fma_f32 v[126:127], v[54:55], v[86:87], v[126:127] op_sel:[0,0,0] op_sel_hi:[1,0,1]
    v_pk_fma_f32 v[252:253], v[68:69], v[86:87], v[252:253] op_sel:[0,0,0] op_sel_hi:[1,0,1]
    v_pk_fma_f32 v[254:255], v[70:71], v[86:87], v[254:255] op_sel:[0,0,0] op_sel_hi:[1,0,1]
    v_pk_mul_f32 v[248:249], v[120:121], v[248:249]
    v_pk_mul_f32 v[250:251], v[122:123], v[250:251]
    v_pk_mul_f32 v[252:253], v[124:125], v[252:253]
    v_pk_mul_f32 v[254:255], v[126:127], v[254:255]
    v_cvt_pk_bf16_f32 v248, v248, v249
    v_cvt_pk_bf16_f32 v249, v250, v251
    v_cvt_pk_bf16_f32 v250, v252, v253
    v_cvt_pk_bf16_f32 v251, v254, v255
    s_nop 0
    v_permlane16_swap_b32 v248, v250
    s_nop 0
    v_permlane16_swap_b32 v249, v251
    s_lshl_b32 s40, s22, 7
    s_add_u32 s40, s40, s41
    s_lshl_b32 s40, s40, 5
    s_add_u32 s40, s40, 4194304
    v_lshlrev_b32 v23, 4, v22
    s_lshl_b32 s33, s3, 12
    v_add_u32 v23, s33, v23
    s_cmp_eq_u32 s20, 0
    s_cbranch_scc1 L_k2_e0_first
    s_waitcnt vmcnt(0)
    v_readfirstlane_b32 s35, v24
    s_nop 0
    s_cmp_eq_u32 s35, s79
    s_cbranch_scc1 L_k2_e0_got
    s_mov_b32 s34, 0
L_k2_e0_poll:
    buffer_load_dword v24, v25, s[36:39], s63 offen sc1
    s_waitcnt vmcnt(0)
    v_readfirstlane_b32 s35, v24
    s_add_u32 s34, s34, 1
    s_cmp_gt_u32 s34, 0x40000
    s_cbranch_scc1 L_k2_e0_got
    s_cmp_eq_u32 s35, s79
    s_cbranch_scc0 L_k2_e0_poll
L_k2_e0_got:
    s_sub_u32 s34, s20, 1
    s_lshl_b32 s34, s34, 5
    s_add_u32 s34, s34, s21
    s_lshl_b32 s34, s34, 15
    s_add_u32 s34, s34, 23068672
    s_add_u32 s35, s34, 16384
    buffer_load_dwordx4 v[32:35], v23, s[36:39], s34 offen offset:0 sc1
    buffer_load_dwordx4 v[36:39], v23, s[36:39], s34 offen offset:1024 sc1
    buffer_load_dwordx4 v[40:43], v23, s[36:39], s34 offen offset:2048 sc1
    buffer_load_dwordx4 v[44:47], v23, s[36:39], s34 offen offset:3072 sc1
    buffer_load_dwordx4 v[48:51], v23, s[36:39], s35 offen offset:0 sc1
    buffer_load_dwordx4 v[52:55], v23, s[36:39], s35 offen offset:1024 sc1
    buffer_load_dwordx4 v[56:59], v23, s[36:39], s35 offen offset:2048 sc1
    buffer_load_dwordx4 v[60:63], v23, s[36:39], s35 offen offset:3072 sc1
L_k2_e0_have:
    s_mul_i32 s33, s21, 7
    s_add_u32 s33, s33, 64
    s_lshl_b32 s33, s33, 16
    s_add_u32 s33, s33, s40
    buffer_store_dwordx4 v[128:131], v1, s[36:39], s33 offen offset:0 sc1
    buffer_store_dwordx4 v[136:139], v1, s[36:39], s33 offen offset:1024 sc1
    buffer_store_dwordx4 v[144:147], v1, s[36:39], s33 offen offset:2048 sc1
    buffer_store_dwordx4 v[152:155], v1, s[36:39], s33 offen offset:3072 sc1
    s_mul_i32 s33, s21, 7
    s_add_u32 s33, s33, 65
    s_lshl_b32 s33, s33, 16
    s_add_u32 s33, s33, s40
    buffer_store_dwordx4 v[160:163], v1, s[36:39], s33 offen offset:0 sc1
    buffer_store_dwordx4 v[168:171], v1, s[36:39], s33 offen offset:1024 sc1
    buffer_store_dwordx4 v[176:179], v1, s[36:39], s33 offen offset:2048 sc1
    buffer_store_dwordx4 v[184:187], v1, s[36:39], s33 offen offset:3072 sc1
    s_mul_i32 s33, s21, 7
    s_add_u32 s33, s33, 66
    s_lshl_b32 s33, s33, 16
    s_add_u32 s33, s33, s40
    buffer_store_dwordx4 v[192:195], v1, s[36:39], s33 offen offset:0 sc1
    buffer_store_dwordx4 v[200:203], v1, s[36:39], s33 offen offset:1024 sc1
    buffer_store_dwordx4 v[208:211], v1, s[36:39], s33 offen offset:2048 sc1
    buffer_store_dwordx4 v[216:219], v1, s[36:39], s33 offen offset:3072 sc1
    s_mul_i32 s33, s21, 7
    s_add_u32 s33, s33, 67
    s_lshl_b32 s33, s33, 16
    s_add_u32 s33, s33, s40
    buffer_store_dwordx4 v[224:227], v1, s[36:39], s33 offen offset:0 sc1
    buffer_store_dwordx4 v[232:235], v1, s[36:39], s33 offen offset:1024 sc1
    buffer_store_dwordx4 v[240:243], v1, s[36:39], s33 offen offset:2048 sc1
    buffer_store_dwordx4 v[248:251], v1, s[36:39], s33 offen offset:3072 sc1
    v_and_b32 v24, 31, v22
    v_lshrrev_b32 v25, 5, v22
    v_lshlrev_b32 v13, 5, v24
    v_lshl_add_u32 v13, v25, 4, v13
    s_lshl_b32 s33, s3, 6
    v_add_u32 v27, s33, v24
    v_lshlrev_b32 v30, 3, v27
    v_add_u32 v30, 149508, v30
    ds_read_b32 v14, v30
    ds_read_b32 v16, v30 offset:256
    v_bfe_u32 v26, v24, 2, 2
    v_and_b32 v28, 2, v24
    v_xor_b32 v26, v26, v28
    v_xor_b32 v26, v26, v25
    v_lshlrev_b32 v27, 6, v27
    v_lshl_add_u32 v8, v26, 4, v27
    v_xor_b32 v9, 32, v8
    v_add_u32 v10, 65536, v8
    v_add_u32 v11, 65536, v9
    v_and_b32 v26, 15, v22
    v_lshrrev_b32 v27, 4, v22
    v_and_b32 v28, 1, v27
    v_lshlrev_b32 v28, 1, v28
    v_bfe_u32 v29, v26, 1, 1
    v_or_b32 v28, v28, v29
    v_lshrrev_b32 v29, 3, v26
    v_lshl_or_b32 v29, v25, 1, v29
    v_xor_b32 v28, v28, v29
    v_lshlrev_b32 v28, 4, v28
    v_and_b32 v29, 1, v26
    v_lshl_add_u32 v28, v29, 3, v28
    v_lshrrev_b32 v29, 2, v26
    v_lshl_add_u32 v29, v25, 2, v29
    v_add_u32 v29, s33, v29
    v_lshl_add_u32 v28, v29, 6, v28
    v_add_u32 v12, 32768, v28
    v_lshlrev_b32 v26, 2, v25
    v_add_u32 v27, 0, v26
    v_cmp_le_u32 s[44:45], v27, v24
    v_add_u32 v27, 1, v26
    v_cmp_le_u32 s[46:47], v27, v24
    v_add_u32 v27, 2, v26
    v_cmp_le_u32 s[48:49], v27, v24
    v_add_u32 v27, 3, v26
    v_cmp_le_u32 s[50:51], v27, v24
    v_add_u32 v27, 8, v26
    v_cmp_le_u32 s[52:53], v27, v24
    v_add_u32 v27, 9, v26
    v_cmp_le_u32 s[54:55], v27, v24
    v_add_u32 v27, 10, v26
    v_cmp_le_u32 s[56:57], v27, v24
    v_add_u32 v27, 11, v26
    v_cmp_le_u32 s[58:59], v27, v24
    v_add_u32 v27, 16, v26
    v_cmp_le_u32 s[60:61], v27, v24
    v_add_u32 v27, 17, v26
    v_cmp_le_u32 s[62:63], v27, v24
    v_add_u32 v27, 18, v26
    v_cmp_le_u32 s[64:65], v27, v24
    v_add_u32 v27, 19, v26
    v_cmp_le_u32 s[66:67], v27, v24
    v_add_u32 v27, 24, v26
    v_cmp_le_u32 s[68:69], v27, v24
    v_add_u32 v27, 25, v26
    v_cmp_le_u32 s[70:71], v27, v24
    v_add_u32 v27, 26, v26
    v_cmp_le_u32 s[72:73], v27, v24
    v_add_u32 v27, 27, v26
    v_cmp_le_u32 s[74:75], v27, v24
    s_mov_b32 s76, 0x3e8293ee
    s_waitcnt lgkmcnt(1)
    v_mul_f32 v14, s76, v14
    s_waitcnt lgkmcnt(0)
    v_mul_f32 v16, s76, v16
    v_mov_b32 v15, v14
    v_mov_b32 v17, v16
    v_mov_b32 v18, 0xff800000
    s_lshl_b32 s33, s3, 1
    s_sub_u32 s100, 8, s33
    s_sub_u32 s101, 7, s33
    s_cmp_eq_u32 s20, 0
    s_cselect_b32 s100, s100, 0
    s_cselect_b32 s101, s101, 0
    s_waitcnt vmcnt(23)
    ds_write_b128 v23, v[32:35] offset:0
    s_waitcnt vmcnt(22)
    ds_write_b128 v23, v[36:39] offset:1024
    s_waitcnt vmcnt(21)
    ds_write_b128 v23, v[40:43] offset:2048
    s_waitcnt vmcnt(20)
    ds_write_b128 v23, v[44:47] offset:3072
    s_waitcnt vmcnt(19)
    ds_write_b128 v23, v[48:51] offset:32768
    s_waitcnt vmcnt(18)
    ds_write_b128 v23, v[52:55] offset:33792
    s_waitcnt vmcnt(17)
    ds_write_b128 v23, v[56:59] offset:34816
    s_waitcnt vmcnt(16)
    ds_write_b128 v23, v[60:63] offset:35840
    s_waitcnt lgkmcnt(0)
    s_barrier
    s_branch L_k2_att
L_k2_e0_first:
    s_waitcnt vmcnt(7)
    v_mov_b32 v32, 0
    v_mov_b32 v33, 0
    v_mov_b32 v34, 0
    v_mov_b32 v35, 0
    s_waitcnt vmcnt(6)
    v_mov_b32 v36, 0
    v_mov_b32 v37, 0
    v_mov_b32 v38, 0
    v_mov_b32 v39, 0
    s_waitcnt vmcnt(5)
    v_mov_b32 v40, 0
    v_mov_b32 v41, 0
    v_mov_b32 v42, 0
    v_mov_b32 v43, 0
    s_waitcnt vmcnt(4)
    v_mov_b32 v44, 0
    v_mov_b32 v45, 0
    v_mov_b32 v46, 0
    v_mov_b32 v47, 0
    s_waitcnt vmcnt(3)
    v_mov_b32 v48, 0
    v_mov_b32 v49, 0
    v_mov_b32 v50, 0
    v_mov_b32 v51, 0
    s_waitcnt vmcnt(2)
    v_mov_b32 v52, 0
    v_mov_b32 v53, 0
    v_mov_b32 v54, 0
    v_mov_b32 v55, 0
    s_waitcnt vmcnt(1)
    v_mov_b32 v56, 0
    v_mov_b32 v57, 0
    v_mov_b32 v58, 0
    v_mov_b32 v59, 0
    s_waitcnt vmcnt(0)
    v_mov_b32 v60, 0
    v_mov_b32 v61, 0
    v_mov_b32 v62, 0
    v_mov_b32 v63, 0
    s_branch L_k2_e0_have
L_k2_w0_cs:
    s_waitcnt lgkmcnt(2)
    v_mfma_f32_16x16x32_bf16 a[80:83], a[64:67], a[0:3], a[80:83]
    ds_read_b64_tr_b16 a[72:73], v16 offset:6144
    v_mfma_f32_16x16x32_bf16 a[84:87], a[64:67], a[4:7], a[84:87]
    ds_read_b64_tr_b16 a[74:75], v16 offset:7936
    v_mfma_f32_16x16x32_bf16 a[88:91], a[64:67], a[8:11], a[88:91]
    ds_read_b128 a[32:35], v15 offset:0
    v_mfma_f32_16x16x32_bf16 a[92:95], a[64:67], a[12:15], a[92:95]
    ds_read_b128 a[36:39], v15 offset:2048
    v_mfma_f32_16x16x32_bf16 a[96:99], a[64:67], a[16:19], a[96:99]
    buffer_load_dwordx4 v11, s[12:15], s25 offen offset:2048 lds
    v_mfma_f32_16x16x32_bf16 a[100:103], a[64:67], a[20:23], a[100:103]
    v_mfma_f32_16x16x32_bf16 a[104:107], a[64:67], a[24:27], a[104:107]
    v_mfma_f32_16x16x32_bf16 a[108:111], a[64:67], a[28:31], a[108:111]
    v_mfma_f32_16x16x32_bf16 v[32:35], a[64:67], v[72:75], v[32:35]
    s_waitcnt lgkmcnt(4)
    v_mfma_f32_16x16x32_bf16 a[112:115], a[68:71], a[0:3], a[112:115]
    ds_read_b64_tr_b16 a[76:77], v16 offset:6176
    v_mfma_f32_16x16x32_bf16 a[116:119], a[68:71], a[4:7], a[116:119]
    ds_read_b64_tr_b16 a[78:79], v16 offset:7968
    v_mfma_f32_16x16x32_bf16 a[120:123], a[68:71], a[8:11], a[120:123]
    ds_read_b128 a[40:43], v15 offset:4096
    v_mfma_f32_16x16x32_bf16 a[124:127], a[68:71], a[12:15], a[124:127]
    s_add_u32 m0, s30, 61440
    ds_read_b128 a[44:47], v15 offset:6144
    v_mfma_f32_16x16x32_bf16 a[128:131], a[68:71], a[16:19], a[128:131]
    buffer_load_dwordx4 v12, s[16:19], s26 offen offset:0 lds
    v_mfma_f32_16x16x32_bf16 a[132:135], a[68:71], a[20:23], a[132:135]
    v_mfma_f32_16x16x32_bf16 a[136:139], a[68:71], a[24:27], a[136:139]
    v_mfma_f32_16x16x32_bf16 a[140:143], a[68:71], a[28:31], a[140:143]
    v_mfma_f32_16x16x32_bf16 v[36:39], a[68:71], v[72:75], v[36:39]
    s_waitcnt lgkmcnt(6)
    v_mfma_f32_16x16x32_bf16 a[144:147], a[72:75], a[0:3], a[144:147]
    ds_read_b64_tr_b16 a[64:65], v16 offset:6208
    v_mfma_f32_16x16x32_bf16 a[148:151], a[72:75], a[4:7], a[148:151]
    ds_read_b64_tr_b16 a[66:67], v16 offset:8000
    v_mfma_f32_16x16x32_bf16 a[152:155], a[72:75], a[8:11], a[152:155]
    ds_read_b128 a[48:51], v15 offset:8192
    v_mfma_f32_16x16x32_bf16 a[156:159], a[72:75], a[12:15], a[156:159]
    buffer_load_dwordx4 v13, s[16:19], s26 offen offset:1024 lds
    v_mfma_f32_16x16x32_bf16 a[160:163], a[72:75], a[16:19], a[160:163]
    s_lshr_b32 s97, s97, 4
    s_and_b32 s33, s97, 7
    s_lshl_b32 s33, s33, 2
    s_mul_i32 s25, s33, s27
    s_mul_i32 s26, s33, s28
    v_mfma_f32_16x16x32_bf16 a[164:167], a[72:75], a[20:23], a[164:167]
    v_mfma_f32_16x16x32_bf16 a[168:171], a[72:75], a[24:27], a[168:171]
    v_mfma_f32_16x16x32_bf16 a[172:175], a[72:75], a[28:31], a[172:175]
    v_mfma_f32_16x16x32_bf16 v[40:43], a[72:75], v[72:75], v[40:43]
    s_waitcnt lgkmcnt(5)
    v_mfma_f32_16x16x32_bf16 a[176:179], a[76:79], a[0:3], a[176:179]
    ds_read_b64_tr_b16 a[68:69], v16 offset:6240
    v_mfma_f32_16x16x32_bf16 a[180:183], a[76:79], a[4:7], a[180:183]
    ds_read_b64_tr_b16 a[70:71], v16 offset:8032
    v_mfma_f32_16x16x32_bf16 a[184:187], a[76:79], a[8:11], a[184:187]
    ds_read_b128 a[52:55], v15 offset:10240
    v_mfma_f32_16x16x32_bf16 a[188:191], a[76:79], a[12:15], a[188:191]
    v_mfma_f32_16x16x32_bf16 a[192:195], a[76:79], a[16:19], a[192:195]
    v_mfma_f32_16x16x32_bf16 a[196:199], a[76:79], a[20:23], a[196:199]
    v_mfma_f32_16x16x32_bf16 a[200:203], a[76:79], a[24:27], a[200:203]
    v_mfma_f32_16x16x32_bf16 a[204:207], a[76:79], a[28:31], a[204:207]
    v_mfma_f32_16x16x32_bf16 v[44:47], a[76:79], v[72:75], v[44:47]
    s_waitcnt lgkmcnt(4)
    v_mfma_f32_16x16x32_bf16 a[208:211], a[64:67], a[0:3], a[208:211]
    ds_read_b64_tr_b16 a[72:73], v16 offset:13312
    v_mfma_f32_16x16x32_bf16 a[212:215], a[64:67], a[4:7], a[212:215]
    ds_read_b64_tr_b16 a[74:75], v16 offset:15104
    v_mfma_f32_16x16x32_bf16 a[216:219], a[64:67], a[8:11], a[216:219]
    ds_read_b128 a[56:59], v15 offset:12288
    v_mfma_f32_16x16x32_bf16 a[220:223], a[64:67], a[12:15], a[220:223]
    v_mfma_f32_16x16x32_bf16 a[224:227], a[64:67], a[16:19], a[224:227]
    v_mfma_f32_16x16x32_bf16 a[228:231], a[64:67], a[20:23], a[228:231]
    v_mfma_f32_16x16x32_bf16 a[232:235], a[64:67], a[24:27], a[232:235]
    v_mfma_f32_16x16x32_bf16 a[236:239], a[64:67], a[28:31], a[236:239]
    v_mfma_f32_16x16x32_bf16 v[48:51], a[64:67], v[72:75], v[48:51]
    s_waitcnt lgkmcnt(4)
    v_mfma_f32_16x16x32_bf16 a[240:243], a[68:71], a[0:3], a[240:243]
    ds_read_b64_tr_b16 a[76:77], v16 offset:13344
    v_mfma_f32_16x16x32_bf16 a[244:247], a[68:71], a[4:7], a[244:247]
    ds_read_b64_tr_b16 a[78:79], v16 offset:15136
    v_mfma_f32_16x16x32_bf16 a[248:251], a[68:71], a[8:11], a[248:251]
    ds_read_b128 a[60:63], v15 offset:14336
    v_mfma_f32_16x16x32_bf16 a[252:255], a[68:71], a[12:15], a[252:255]
    v_mfma_f32_16x16x32_bf16 v[112:115], a[68:71], a[16:19], v[112:115]
    v_mfma_f32_16x16x32_bf16 v[116:119], a[68:71], a[20:23], v[116:119]
    v_mfma_f32_16x16x32_bf16 v[120:123], a[68:71], a[24:27], v[120:123]
    v_mfma_f32_16x16x32_bf16 v[124:127], a[68:71], a[28:31], v[124:127]
    v_mfma_f32_16x16x32_bf16 v[52:55], a[68:71], v[72:75], v[52:55]
    s_waitcnt lgkmcnt(4)
    v_mfma_f32_16x16x32_bf16 v[128:131], a[72:75], a[0:3], v[128:131]
    ds_read_b64_tr_b16 a[64:65], v16 offset:13376
    v_mfma_f32_16x16x32_bf16 v[132:135], a[72:75], a[4:7], v[132:135]
    ds_read_b64_tr_b16 a[66:67], v16 offset:15168
    v_mfma_f32_16x16x32_bf16 v[136:139], a[72:75], a[8:11], v[136:139]
    ds_read_b64_tr_b16 a[68:69], v16 offset:13408
    v_mfma_f32_16x16x32_bf16 v[140:143], a[72:75], a[12:15], v[140:143]
    ds_read_b64_tr_b16 a[70:71], v16 offset:15200
    v_mfma_f32_16x16x32_bf16 v[144:147], a[72:75], a[16:19], v[144:147]
    v_mfma_f32_16x16x32_bf16 v[148:151], a[72:75], a[20:23], v[148:151]
    v_mfma_f32_16x16x32_bf16 v[152:155], a[72:75], a[24:27], v[152:155]
    v_mfma_f32_16x16x32_bf16 v[156:159], a[72:75], a[28:31], v[156:159]
    v_mfma_f32_16x16x32_bf16 v[56:59], a[72:75], v[72:75], v[56:59]
    s_waitcnt lgkmcnt(5)
    v_mfma_f32_16x16x32_bf16 v[160:163], a[76:79], a[0:3], v[160:163]
    v_mfma_f32_16x16x32_bf16 v[164:167], a[76:79], a[4:7], v[164:167]
    v_mfma_f32_16x16x32_bf16 v[168:171], a[76:79], a[8:11], v[168:171]
    v_mfma_f32_16x16x32_bf16 v[172:175], a[76:79], a[12:15], v[172:175]
    v_mfma_f32_16x16x32_bf16 v[176:179], a[76:79], a[16:19], v[176:179]
    v_mfma_f32_16x16x32_bf16 v[180:183], a[76:79], a[20:23], v[180:183]
    v_mfma_f32_16x16x32_bf16 v[184:187], a[76:79], a[24:27], v[184:187]
    v_mfma_f32_16x16x32_bf16 v[188:191], a[76:79], a[28:31], v[188:191]
    v_mfma_f32_16x16x32_bf16 v[60:63], a[76:79], v[72:75], v[60:63]
    s_waitcnt vmcnt(5) lgkmcnt(0)
    s_barrier
    v_mfma_f32_16x16x32_bf16 v[192:195], a[64:67], a[0:3], v[192:195]
    ds_read_b64_tr_b16 a[72:73], v18 offset:20608
    v_mfma_f32_16x16x32_bf16 v[196:199], a[64:67], a[4:7], v[196:199]
    s_add_u32 m0, s29, 0
    ds_read_b64_tr_b16 a[74:75], v18 offset:22144
    v_mfma_f32_16x16x32_bf16 v[200:203], a[64:67], a[8:11], v[200:203]
    buffer_load_dwordx4 v9, s[12:15], s25 offen offset:0 lds
    v_mfma_f32_16x16x32_bf16 v[204:207], a[64:67], a[12:15], v[204:207]
    buffer_load_dwordx4 v10, s[12:15], s25 offen offset:1024 lds
    v_mfma_f32_16x16x32_bf16 v[208:211], a[64:67], a[16:19], v[208:211]
    v_mfma_f32_16x16x32_bf16 v[212:215], a[64:67], a[20:23], v[212:215]
    v_mfma_f32_16x16x32_bf16 v[216:219], a[64:67], a[24:27], v[216:219]
    v_mfma_f32_16x16x32_bf16 v[220:223], a[64:67], a[28:31], v[220:223]
    v_mfma_f32_16x16x32_bf16 v[64:67], a[64:67], v[72:75], v[64:67]
    v_mfma_f32_16x16x32_bf16 v[224:227], a[68:71], a[0:3], v[224:227]
    ds_read_b64_tr_b16 a[76:77], v20 offset:20640
    v_mfma_f32_16x16x32_bf16 v[228:231], a[68:71], a[4:7], v[228:231]
    ds_read_b64_tr_b16 a[78:79], v20 offset:22176
    v_mfma_f32_16x16x32_bf16 v[232:235], a[68:71], a[8:11], v[232:235]
    buffer_load_dwordx4 v11, s[12:15], s25 offen offset:2048 lds
    v_mfma_f32_16x16x32_bf16 v[236:239], a[68:71], a[12:15], v[236:239]
    s_add_u32 m0, s30, 0
    v_mfma_f32_16x16x32_bf16 v[240:243], a[68:71], a[16:19], v[240:243]
    buffer_load_dwordx4 v12, s[16:19], s26 offen offset:0 lds
    v_mfma_f32_16x16x32_bf16 v[244:247], a[68:71], a[20:23], v[244:247]
    v_mfma_f32_16x16x32_bf16 v[248:251], a[68:71], a[24:27], v[248:251]
    v_mfma_f32_16x16x32_bf16 v[252:255], a[68:71], a[28:31], v[252:255]
    v_mfma_f32_16x16x32_bf16 v[68:71], a[68:71], v[72:75], v[68:71]
    s_waitcnt lgkmcnt(2)
    v_mfma_f32_16x16x32_bf16 a[80:83], a[72:75], a[32:35], a[80:83]
    ds_read_b64_tr_b16 a[64:65], v16 offset:26624
    v_mfma_f32_16x16x32_bf16 a[84:87], a[72:75], a[36:39], a[84:87]
    ds_read_b64_tr_b16 a[66:67], v16 offset:28416
    v_mfma_f32_16x16x32_bf16 a[88:91], a[72:75], a[40:43], a[88:91]
    ds_read_b128 a[0:3], v14 offset:32768
    v_mfma_f32_16x16x32_bf16 a[92:95], a[72:75], a[44:47], a[92:95]
    ds_read_b128 a[4:7], v14 offset:34816
    v_mfma_f32_16x16x32_bf16 a[96:99], a[72:75], a[48:51], a[96:99]
    buffer_load_dwordx4 v13, s[16:19], s26 offen offset:1024 lds
    v_mfma_f32_16x16x32_bf16 a[100:103], a[72:75], a[52:55], a[100:103]
    s_add_u32 s25, s25, s27
    s_add_u32 s26, s26, s28
    s_add_u32 m0, s31, 81920
    v_mfma_f32_16x16x32_bf16 a[104:107], a[72:75], a[56:59], a[104:107]
    buffer_load_dwordx4 v1, s[8:11], s24 offen offset:0 lds
    v_mfma_f32_16x16x32_bf16 a[108:111], a[72:75], a[60:63], a[108:111]
    v_mfma_f32_16x16x32_bf16 v[32:35], a[72:75], v[72:75], v[32:35]
    s_waitcnt lgkmcnt(4)
    v_mfma_f32_16x16x32_bf16 a[112:115], a[76:79], a[32:35], a[112:115]
    ds_read_b64_tr_b16 a[68:69], v16 offset:26656
    v_mfma_f32_16x16x32_bf16 a[116:119], a[76:79], a[36:39], a[116:119]
    ds_read_b64_tr_b16 a[70:71], v16 offset:28448
    v_mfma_f32_16x16x32_bf16 a[120:123], a[76:79], a[40:43], a[120:123]
    ds_read_b128 a[8:11], v14 offset:36864
    v_mfma_f32_16x16x32_bf16 a[124:127], a[76:79], a[44:47], a[124:127]
    ds_read_b128 a[12:15], v14 offset:38912
    v_mfma_f32_16x16x32_bf16 a[128:131], a[76:79], a[48:51], a[128:131]
    buffer_load_dwordx4 v2, s[8:11], s24 offen offset:1024 lds
    v_mfma_f32_16x16x32_bf16 a[132:135], a[76:79], a[52:55], a[132:135]
    v_mfma_f32_16x16x32_bf16 a[136:139], a[76:79], a[56:59], a[136:139]
    v_mfma_f32_16x16x32_bf16 a[140:143], a[76:79], a[60:63], a[140:143]
    v_mfma_f32_16x16x32_bf16 v[36:39], a[76:79], v[72:75], v[36:39]
    s_waitcnt lgkmcnt(6)
    v_mfma_f32_16x16x32_bf16 a[144:147], a[64:67], a[32:35], a[144:147]
    ds_read_b64_tr_b16 a[72:73], v16 offset:26688
    v_mfma_f32_16x16x32_bf16 a[148:151], a[64:67], a[36:39], a[148:151]
    ds_read_b64_tr_b16 a[74:75], v16 offset:28480
    v_mfma_f32_16x16x32_bf16 a[152:155], a[64:67], a[40:43], a[152:155]
    ds_read_b128 a[16:19], v14 offset:40960
    v_mfma_f32_16x16x32_bf16 a[156:159], a[64:67], a[44:47], a[156:159]
    buffer_load_dwordx4 v3, s[8:11], s24 offen offset:2048 lds
    v_mfma_f32_16x16x32_bf16 a[160:163], a[64:67], a[48:51], a[160:163]
    v_mfma_f32_16x16x32_bf16 a[164:167], a[64:67], a[52:55], a[164:167]
    v_mfma_f32_16x16x32_bf16 a[168:171], a[64:67], a[56:59], a[168:171]
    v_mfma_f32_16x16x32_bf16 a[172:175], a[64:67], a[60:63], a[172:175]
    v_mfma_f32_16x16x32_bf16 v[40:43], a[64:67], v[72:75], v[40:43]
    s_waitcnt lgkmcnt(5)
    v_mfma_f32_16x16x32_bf16 a[176:179], a[68:71], a[32:35], a[176:179]
    ds_read_b64_tr_b16 a[76:77], v16 offset:26720
    v_mfma_f32_16x16x32_bf16 a[180:183], a[68:71], a[36:39], a[180:183]
    ds_read_b64_tr_b16 a[78:79], v16 offset:28512
    v_mfma_f32_16x16x32_bf16 a[184:187], a[68:71], a[40:43], a[184:187]
    ds_read_b128 a[20:23], v14 offset:43008
    v_mfma_f32_16x16x32_bf16 a[188:191], a[68:71], a[44:47], a[188:191]
    buffer_load_dwordx4 v4, s[8:11], s24 offen offset:3072 lds
    v_mfma_f32_16x16x32_bf16 a[192:195], a[68:71], a[48:51], a[192:195]
    v_mfma_f32_16x16x32_bf16 a[196:199], a[68:71], a[52:55], a[196:199]
    v_mfma_f32_16x16x32_bf16 a[200:203], a[68:71], a[56:59], a[200:203]
    v_mfma_f32_16x16x32_bf16 a[204:207], a[68:71], a[60:63], a[204:207]
    v_mfma_f32_16x16x32_bf16 v[44:47], a[68:71], v[72:75], v[44:47]
    s_waitcnt lgkmcnt(4)
    v_mfma_f32_16x16x32_bf16 a[208:211], a[72:75], a[32:35], a[208:211]
    ds_read_b64_tr_b16 a[64:65], v16 offset:33792
    v_mfma_f32_16x16x32_bf16 a[212:215], a[72:75], a[36:39], a[212:215]
    ds_read_b64_tr_b16 a[66:67], v16 offset:35584
    v_mfma_f32_16x16x32_bf16 a[216:219], a[72:75], a[40:43], a[216:219]
    s_add_u32 m0, s31, 86016
    ds_read_b128 a[24:27], v14 offset:45056
    v_mfma_f32_16x16x32_bf16 a[220:223], a[72:75], a[44:47], a[220:223]
    buffer_load_dwordx4 v5, s[8:11], s24 offen offset:0 lds
    v_mfma_f32_16x16x32_bf16 a[224:227], a[72:75], a[48:51], a[224:227]
    v_mfma_f32_16x16x32_bf16 a[228:231], a[72:75], a[52:55], a[228:231]
    v_mfma_f32_16x16x32_bf16 a[232:235], a[72:75], a[56:59], a[232:235]
    v_mfma_f32_16x16x32_bf16 a[236:239], a[72:75], a[60:63], a[236:239]
    v_mfma_f32_16x16x32_bf16 v[48:51], a[72:75], v[72:75], v[48:51]
    s_waitcnt lgkmcnt(4)
    v_mfma_f32_16x16x32_bf16 a[240:243], a[76:79], a[32:35], a[240:243]
    ds_read_b64_tr_b16 a[68:69], v16 offset:33824
    v_mfma_f32_16x16x32_bf16 a[244:247], a[76:79], a[36:39], a[244:247]
    ds_read_b64_tr_b16 a[70:71], v16 offset:35616
    v_mfma_f32_16x16x32_bf16 a[248:251], a[76:79], a[40:43], a[248:251]
    ds_read_b128 a[28:31], v14 offset:47104
    v_mfma_f32_16x16x32_bf16 a[252:255], a[76:79], a[44:47], a[252:255]
    buffer_load_dwordx4 v6, s[8:11], s24 offen offset:1024 lds
    v_mfma_f32_16x16x32_bf16 v[112:115], a[76:79], a[48:51], v[112:115]
    v_mfma_f32_16x16x32_bf16 v[116:119], a[76:79], a[52:55], v[116:119]
    v_mfma_f32_16x16x32_bf16 v[120:123], a[76:79], a[56:59], v[120:123]
    v_mfma_f32_16x16x32_bf16 v[124:127], a[76:79], a[60:63], v[124:127]
    v_mfma_f32_16x16x32_bf16 v[52:55], a[76:79], v[72:75], v[52:55]
    s_waitcnt lgkmcnt(4)
    v_mfma_f32_16x16x32_bf16 v[128:131], a[64:67], a[32:35], v[128:131]
    ds_read_b64_tr_b16 a[72:73], v16 offset:33856
    v_mfma_f32_16x16x32_bf16 v[132:135], a[64:67], a[36:39], v[132:135]
    ds_read_b64_tr_b16 a[74:75], v16 offset:35648
    v_mfma_f32_16x16x32_bf16 v[136:139], a[64:67], a[40:43], v[136:139]
    ds_read_b64_tr_b16 a[76:77], v16 offset:33888
    v_mfma_f32_16x16x32_bf16 v[140:143], a[64:67], a[44:47], v[140:143]
    ds_read_b64_tr_b16 a[78:79], v16 offset:35680
    v_mfma_f32_16x16x32_bf16 v[144:147], a[64:67], a[48:51], v[144:147]
    buffer_load_dwordx4 v7, s[8:11], s24 offen offset:2048 lds
    v_mfma_f32_16x16x32_bf16 v[148:151], a[64:67], a[52:55], v[148:151]
    v_mfma_f32_16x16x32_bf16 v[152:155], a[64:67], a[56:59], v[152:155]
    v_mfma_f32_16x16x32_bf16 v[156:159], a[64:67], a[60:63], v[156:159]
    v_mfma_f32_16x16x32_bf16 v[56:59], a[64:67], v[72:75], v[56:59]
    s_waitcnt lgkmcnt(5)
    v_mfma_f32_16x16x32_bf16 v[160:163], a[68:71], a[32:35], v[160:163]
    v_mfma_f32_16x16x32_bf16 v[164:167], a[68:71], a[36:39], v[164:167]
    v_mfma_f32_16x16x32_bf16 v[168:171], a[68:71], a[40:43], v[168:171]
    buffer_load_dwordx4 v8, s[8:11], s24 offen offset:3072 lds
    v_mfma_f32_16x16x32_bf16 v[172:175], a[68:71], a[44:47], v[172:175]
    s_add_u32 s24, s24, 128
    v_mfma_f32_16x16x32_bf16 v[176:179], a[68:71], a[48:51], v[176:179]
    v_mfma_f32_16x16x32_bf16 v[180:183], a[68:71], a[52:55], v[180:183]
    v_mfma_f32_16x16x32_bf16 v[184:187], a[68:71], a[56:59], v[184:187]
    v_mfma_f32_16x16x32_bf16 v[188:191], a[68:71], a[60:63], v[188:191]
    v_mfma_f32_16x16x32_bf16 v[60:63], a[68:71], v[72:75], v[60:63]
    s_waitcnt vmcnt(25) lgkmcnt(0)
    s_barrier
    v_mfma_f32_16x16x32_bf16 v[192:195], a[72:75], a[32:35], v[192:195]
    ds_read_b64_tr_b16 a[64:65], v19 offset:128
    v_mfma_f32_16x16x32_bf16 v[196:199], a[72:75], a[36:39], v[196:199]
    s_add_u32 m0, s29, 20480
    ds_read_b64_tr_b16 a[66:67], v19 offset:1664
    v_mfma_f32_16x16x32_bf16 v[200:203], a[72:75], a[40:43], v[200:203]
    buffer_load_dwordx4 v9, s[12:15], s25 offen offset:0 lds
    v_mfma_f32_16x16x32_bf16 v[204:207], a[72:75], a[44:47], v[204:207]
    v_mfma_f32_16x16x32_bf16 v[208:211], a[72:75], a[48:51], v[208:211]
    v_mfma_f32_16x16x32_bf16 v[212:215], a[72:75], a[52:55], v[212:215]
    v_mfma_f32_16x16x32_bf16 v[216:219], a[72:75], a[56:59], v[216:219]
    v_mfma_f32_16x16x32_bf16 v[220:223], a[72:75], a[60:63], v[220:223]
    v_mfma_f32_16x16x32_bf16 v[64:67], a[72:75], v[72:75], v[64:67]
    v_mfma_f32_16x16x32_bf16 v[224:227], a[76:79], a[32:35], v[224:227]
    ds_read_b64_tr_b16 a[68:69], v21 offset:160
    v_mfma_f32_16x16x32_bf16 v[228:231], a[76:79], a[36:39], v[228:231]
    ds_read_b64_tr_b16 a[70:71], v21 offset:1696
    v_mfma_f32_16x16x32_bf16 v[232:235], a[76:79], a[40:43], v[232:235]
    buffer_load_dwordx4 v10, s[12:15], s25 offen offset:1024 lds
    v_mfma_f32_16x16x32_bf16 v[236:239], a[76:79], a[44:47], v[236:239]
    v_mfma_f32_16x16x32_bf16 v[240:243], a[76:79], a[48:51], v[240:243]
    v_mfma_f32_16x16x32_bf16 v[244:247], a[76:79], a[52:55], v[244:247]
    v_mfma_f32_16x16x32_bf16 v[248:251], a[76:79], a[56:59], v[248:251]
    v_mfma_f32_16x16x32_bf16 v[252:255], a[76:79], a[60:63], v[252:255]
    v_mfma_f32_16x16x32_bf16 v[68:71], a[76:79], v[72:75], v[68:71]
    s_waitcnt lgkmcnt(2)
    v_mfma_f32_16x16x32_bf16 a[80:83], a[64:67], a[0:3], a[80:83]
    ds_read_b64_tr_b16 a[72:73], v17 offset:6144
    v_mfma_f32_16x16x32_bf16 a[84:87], a[64:67], a[4:7], a[84:87]
    ds_read_b64_tr_b16 a[74:75], v17 offset:7936
    v_mfma_f32_16x16x32_bf16 a[88:91], a[64:67], a[8:11], a[88:91]
    ds_read_b128 a[32:35], v15 offset:32768
    v_mfma_f32_16x16x32_bf16 a[92:95], a[64:67], a[12:15], a[92:95]
    ds_read_b128 a[36:39], v15 offset:34816
    v_mfma_f32_16x16x32_bf16 a[96:99], a[64:67], a[16:19], a[96:99]
    buffer_load_dwordx4 v11, s[12:15], s25 offen offset:2048 lds
    v_mfma_f32_16x16x32_bf16 a[100:103], a[64:67], a[20:23], a[100:103]
    v_mfma_f32_16x16x32_bf16 a[104:107], a[64:67], a[24:27], a[104:107]
    v_mfma_f32_16x16x32_bf16 a[108:111], a[64:67], a[28:31], a[108:111]
    v_mfma_f32_16x16x32_bf16 v[32:35], a[64:67], v[72:75], v[32:35]
    s_waitcnt lgkmcnt(4)
    v_mfma_f32_16x16x32_bf16 a[112:115], a[68:71], a[0:3], a[112:115]
    ds_read_b64_tr_b16 a[76:77], v17 offset:6176
    v_mfma_f32_16x16x32_bf16 a[116:119], a[68:71], a[4:7], a[116:119]
    ds_read_b64_tr_b16 a[78:79], v17 offset:7968
    v_mfma_f32_16x16x32_bf16 a[120:123], a[68:71], a[8:11], a[120:123]
    ds_read_b128 a[40:43], v15 offset:36864
    v_mfma_f32_16x16x32_bf16 a[124:127], a[68:71], a[12:15], a[124:127]
    s_add_u32 m0, s30, 20480
    ds_read_b128 a[44:47], v15 offset:38912
    v_mfma_f32_16x16x32_bf16 a[128:131], a[68:71], a[16:19], a[128:131]
    buffer_load_dwordx4 v12, s[16:19], s26 offen offset:0 lds
    v_mfma_f32_16x16x32_bf16 a[132:135], a[68:71], a[20:23], a[132:135]
    v_mfma_f32_16x16x32_bf16 a[136:139], a[68:71], a[24:27], a[136:139]
    v_mfma_f32_16x16x32_bf16 a[140:143], a[68:71], a[28:31], a[140:143]
    v_mfma_f32_16x16x32_bf16 v[36:39], a[68:71], v[72:75], v[36:39]
    s_waitcnt lgkmcnt(6)
    v_mfma_f32_16x16x32_bf16 a[144:147], a[72:75], a[0:3], a[144:147]
    ds_read_b64_tr_b16 a[64:65], v17 offset:6208
    v_mfma_f32_16x16x32_bf16 a[148:151], a[72:75], a[4:7], a[148:151]
    ds_read_b64_tr_b16 a[66:67], v17 offset:8000
    v_mfma_f32_16x16x32_bf16 a[152:155], a[72:75], a[8:11], a[152:155]
    ds_read_b128 a[48:51], v15 offset:40960
    v_mfma_f32_16x16x32_bf16 a[156:159], a[72:75], a[12:15], a[156:159]
    buffer_load_dwordx4 v13, s[16:19], s26 offen offset:1024 lds
    v_mfma_f32_16x16x32_bf16 a[160:163], a[72:75], a[16:19], a[160:163]
    s_add_u32 s25, s25, s27
    s_add_u32 s26, s26, s28
    v_mfma_f32_16x16x32_bf16 a[164:167], a[72:75], a[20:23], a[164:167]
    v_mfma_f32_16x16x32_bf16 a[168:171], a[72:75], a[24:27], a[168:171]
    v_mfma_f32_16x16x32_bf16 a[172:175], a[72:75], a[28:31], a[172:175]
    v_mfma_f32_16x16x32_bf16 v[40:43], a[72:75], v[72:75], v[40:43]
    s_waitcnt lgkmcnt(5)
    v_mfma_f32_16x16x32_bf16 a[176:179], a[76:79], a[0:3], a[176:179]
    ds_read_b64_tr_b16 a[68:69], v17 offset:6240
    v_mfma_f32_16x16x32_bf16 a[180:183], a[76:79], a[4:7], a[180:183]
    ds_read_b64_tr_b16 a[70:71], v17 offset:8032
    v_mfma_f32_16x16x32_bf16 a[184:187], a[76:79], a[8:11], a[184:187]
    ds_read_b128 a[52:55], v15 offset:43008
    v_mfma_f32_16x16x32_bf16 a[188:191], a[76:79], a[12:15], a[188:191]
    v_mfma_f32_16x16x32_bf16 a[192:195], a[76:79], a[16:19], a[192:195]
    v_mfma_f32_16x16x32_bf16 a[196:199], a[76:79], a[20:23], a[196:199]
    v_mfma_f32_16x16x32_bf16 a[200:203], a[76:79], a[24:27], a[200:203]
    v_mfma_f32_16x16x32_bf16 a[204:207], a[76:79], a[28:31], a[204:207]
    v_mfma_f32_16x16x32_bf16 v[44:47], a[76:79], v[72:75], v[44:47]
    s_waitcnt lgkmcnt(4)
    v_mfma_f32_16x16x32_bf16 a[208:211], a[64:67], a[0:3], a[208:211]
    ds_read_b64_tr_b16 a[72:73], v17 offset:13312
    v_mfma_f32_16x16x32_bf16 a[212:215], a[64:67], a[4:7], a[212:215]
    ds_read_b64_tr_b16 a[74:75], v17 offset:15104
    v_mfma_f32_16x16x32_bf16 a[216:219], a[64:67], a[8:11], a[216:219]
    ds_read_b128 a[56:59], v15 offset:45056
    v_mfma_f32_16x16x32_bf16 a[220:223], a[64:67], a[12:15], a[220:223]
    v_mfma_f32_16x16x32_bf16 a[224:227], a[64:67], a[16:19], a[224:227]
    v_mfma_f32_16x16x32_bf16 a[228:231], a[64:67], a[20:23], a[228:231]
    v_mfma_f32_16x16x32_bf16 a[232:235], a[64:67], a[24:27], a[232:235]
    v_mfma_f32_16x16x32_bf16 a[236:239], a[64:67], a[28:31], a[236:239]
    v_mfma_f32_16x16x32_bf16 v[48:51], a[64:67], v[72:75], v[48:51]
    s_waitcnt lgkmcnt(4)
    v_mfma_f32_16x16x32_bf16 a[240:243], a[68:71], a[0:3], a[240:243]
    ds_read_b64_tr_b16 a[76:77], v17 offset:13344
    v_mfma_f32_16x16x32_bf16 a[244:247], a[68:71], a[4:7], a[244:247]
    ds_read_b64_tr_b16 a[78:79], v17 offset:15136
    v_mfma_f32_16x16x32_bf16 a[248:251], a[68:71], a[8:11], a[248:251]
    ds_read_b128 a[60:63], v15 offset:47104
    v_mfma_f32_16x16x32_bf16 a[252:255], a[68:71], a[12:15], a[252:255]
    v_mfma_f32_16x16x32_bf16 v[112:115], a[68:71], a[16:19], v[112:115]
    v_mfma_f32_16x16x32_bf16 v[116:119], a[68:71], a[20:23], v[116:119]
    v_mfma_f32_16x16x32_bf16 v[120:123], a[68:71], a[24:27], v[120:123]
    v_mfma_f32_16x16x32_bf16 v[124:127], a[68:71], a[28:31], v[124:127]
    v_mfma_f32_16x16x32_bf16 v[52:55], a[68:71], v[72:75], v[52:55]
    s_waitcnt lgkmcnt(4)
    v_mfma_f32_16x16x32_bf16 v[128:131], a[72:75], a[0:3], v[128:131]
    ds_read_b64_tr_b16 a[64:65], v17 offset:13376
    v_mfma_f32_16x16x32_bf16 v[132:135], a[72:75], a[4:7], v[132:135]
    ds_read_b64_tr_b16 a[66:67], v17 offset:15168
    v_mfma_f32_16x16x32_bf16 v[136:139], a[72:75], a[8:11], v[136:139]
    ds_read_b64_tr_b16 a[68:69], v17 offset:13408
    v_mfma_f32_16x16x32_bf16 v[140:143], a[72:75], a[12:15], v[140:143]
    ds_read_b64_tr_b16 a[70:71], v17 offset:15200
    v_mfma_f32_16x16x32_bf16 v[144:147], a[72:75], a[16:19], v[144:147]
    v_mfma_f32_16x16x32_bf16 v[148:151], a[72:75], a[20:23], v[148:151]
    v_mfma_f32_16x16x32_bf16 v[152:155], a[72:75], a[24:27], v[152:155]
    v_mfma_f32_16x16x32_bf16 v[156:159], a[72:75], a[28:31], v[156:159]
    v_mfma_f32_16x16x32_bf16 v[56:59], a[72:75], v[72:75], v[56:59]
    s_waitcnt lgkmcnt(5)
    v_mfma_f32_16x16x32_bf16 v[160:163], a[76:79], a[0:3], v[160:163]
    v_mfma_f32_16x16x32_bf16 v[164:167], a[76:79], a[4:7], v[164:167]
    v_mfma_f32_16x16x32_bf16 v[168:171], a[76:79], a[8:11], v[168:171]
    v_mfma_f32_16x16x32_bf16 v[172:175], a[76:79], a[12:15], v[172:175]
    v_mfma_f32_16x16x32_bf16 v[176:179], a[76:79], a[16:19], v[176:179]
    v_mfma_f32_16x16x32_bf16 v[180:183], a[76:79], a[20:23], v[180:183]
    v_mfma_f32_16x16x32_bf16 v[184:187], a[76:79], a[24:27], v[184:187]
    v_mfma_f32_16x16x32_bf16 v[188:191], a[76:79], a[28:31], v[188:191]
    v_mfma_f32_16x16x32_bf16 v[60:63], a[76:79], v[72:75], v[60:63]
    s_waitcnt vmcnt(5) lgkmcnt(0)
    s_barrier
    v_mfma_f32_16x16x32_bf16 v[192:195], a[64:67], a[0:3], v[192:195]
    ds_read_b64_tr_b16 a[72:73], v19 offset:20608
    v_mfma_f32_16x16x32_bf16 v[196:199], a[64:67], a[4:7], v[196:199]
    s_add_u32 m0, s29, 40960
    ds_read_b64_tr_b16 a[74:75], v19 offset:22144
    v_mfma_f32_16x16x32_bf16 v[200:203], a[64:67], a[8:11], v[200:203]
    buffer_load_dwordx4 v9, s[12:15], s25 offen offset:0 lds
    v_mfma_f32_16x16x32_bf16 v[204:207], a[64:67], a[12:15], v[204:207]
    buffer_load_dwordx4 v10, s[12:15], s25 offen offset:1024 lds
    v_mfma_f32_16x16x32_bf16 v[208:211], a[64:67], a[16:19], v[208:211]
    v_mfma_f32_16x16x32_bf16 v[212:215], a[64:67], a[20:23], v[212:215]
    v_mfma_f32_16x16x32_bf16 v[216:219], a[64:67], a[24:27], v[216:219]
    v_mfma_f32_16x16x32_bf16 v[220:223], a[64:67], a[28:31], v[220:223]
    v_mfma_f32_16x16x32_bf16 v[64:67], a[64:67], v[72:75], v[64:67]
    v_mfma_f32_16x16x32_bf16 v[224:227], a[68:71], a[0:3], v[224:227]
    ds_read_b64_tr_b16 a[76:77], v21 offset:20640
    v_mfma_f32_16x16x32_bf16 v[228:231], a[68:71], a[4:7], v[228:231]
    ds_read_b64_tr_b16 a[78:79], v21 offset:22176
    v_mfma_f32_16x16x32_bf16 v[232:235], a[68:71], a[8:11], v[232:235]
    buffer_load_dwordx4 v11, s[12:15], s25 offen offset:2048 lds
    v_mfma_f32_16x16x32_bf16 v[236:239], a[68:71], a[12:15], v[236:239]
    s_add_u32 m0, s30, 40960
    v_mfma_f32_16x16x32_bf16 v[240:243], a[68:71], a[16:19], v[240:243]
    buffer_load_dwordx4 v12, s[16:19], s26 offen offset:0 lds
    v_mfma_f32_16x16x32_bf16 v[244:247], a[68:71], a[20:23], v[244:247]
    v_mfma_f32_16x16x32_bf16 v[248:251], a[68:71], a[24:27], v[248:251]
    v_mfma_f32_16x16x32_bf16 v[252:255], a[68:71], a[28:31], v[252:255]
    v_mfma_f32_16x16x32_bf16 v[68:71], a[68:71], v[72:75], v[68:71]
    s_waitcnt lgkmcnt(2)
    v_mfma_f32_16x16x32_bf16 a[80:83], a[72:75], a[32:35], a[80:83]
    ds_read_b64_tr_b16 a[64:65], v17 offset:26624
    v_mfma_f32_16x16x32_bf16 a[84:87], a[72:75], a[36:39], a[84:87]
    ds_read_b64_tr_b16 a[66:67], v17 offset:28416
    v_mfma_f32_16x16x32_bf16 a[88:91], a[72:75], a[40:43], a[88:91]
    ds_read_b128 a[0:3], v14 offset:0
    v_mfma_f32_16x16x32_bf16 a[92:95], a[72:75], a[44:47], a[92:95]
    ds_read_b128 a[4:7], v14 offset:2048
    v_mfma_f32_16x16x32_bf16 a[96:99], a[72:75], a[48:51], a[96:99]
    buffer_load_dwordx4 v13, s[16:19], s26 offen offset:1024 lds
    v_mfma_f32_16x16x32_bf16 a[100:103], a[72:75], a[52:55], a[100:103]
    s_add_u32 s25, s25, s27
    s_add_u32 s26, s26, s28
    s_add_u32 m0, s31, 114688
    v_mfma_f32_16x16x32_bf16 a[104:107], a[72:75], a[56:59], a[104:107]
    buffer_load_dwordx4 v1, s[8:11], s24 offen offset:0 lds
    v_mfma_f32_16x16x32_bf16 a[108:111], a[72:75], a[60:63], a[108:111]
    v_mfma_f32_16x16x32_bf16 v[32:35], a[72:75], v[72:75], v[32:35]
    s_waitcnt lgkmcnt(4)
    v_mfma_f32_16x16x32_bf16 a[112:115], a[76:79], a[32:35], a[112:115]
    ds_read_b64_tr_b16 a[68:69], v17 offset:26656
    v_mfma_f32_16x16x32_bf16 a[116:119], a[76:79], a[36:39], a[116:119]
    ds_read_b64_tr_b16 a[70:71], v17 offset:28448
    v_mfma_f32_16x16x32_bf16 a[120:123], a[76:79], a[40:43], a[120:123]
    ds_read_b128 a[8:11], v14 offset:4096
    v_mfma_f32_16x16x32_bf16 a[124:127], a[76:79], a[44:47], a[124:127]
    ds_read_b128 a[12:15], v14 offset:6144
    v_mfma_f32_16x16x32_bf16 a[128:131], a[76:79], a[48:51], a[128:131]
    buffer_load_dwordx4 v2, s[8:11], s24 offen offset:1024 lds
    v_mfma_f32_16x16x32_bf16 a[132:135], a[76:79], a[52:55], a[132:135]
    v_mfma_f32_16x16x32_bf16 a[136:139], a[76:79], a[56:59], a[136:139]
    v_mfma_f32_16x16x32_bf16 a[140:143], a[76:79], a[60:63], a[140:143]
    v_mfma_f32_16x16x32_bf16 v[36:39], a[76:79], v[72:75], v[36:39]
    s_waitcnt lgkmcnt(6)
    v_mfma_f32_16x16x32_bf16 a[144:147], a[64:67], a[32:35], a[144:147]
    ds_read_b64_tr_b16 a[72:73], v17 offset:26688
    v_mfma_f32_16x16x32_bf16 a[148:151], a[64:67], a[36:39], a[148:151]
    ds_read_b64_tr_b16 a[74:75], v17 offset:28480
    v_mfma_f32_16x16x32_bf16 a[152:155], a[64:67], a[40:43], a[152:155]
    ds_read_b128 a[16:19], v14 offset:8192
    v_mfma_f32_16x16x32_bf16 a[156:159], a[64:67], a[44:47], a[156:159]
    buffer_load_dwordx4 v3, s[8:11], s24 offen offset:2048 lds
    v_mfma_f32_16x16x32_bf16 a[160:163], a[64:67], a[48:51], a[160:163]
    v_mfma_f32_16x16x32_bf16 a[164:167], a[64:67], a[52:55], a[164:167]
    v_mfma_f32_16x16x32_bf16 a[168:171], a[64:67], a[56:59], a[168:171]
    v_mfma_f32_16x16x32_bf16 a[172:175], a[64:67], a[60:63], a[172:175]
    v_mfma_f32_16x16x32_bf16 v[40:43], a[64:67], v[72:75], v[40:43]
    s_waitcnt lgkmcnt(5)
    v_mfma_f32_16x16x32_bf16 a[176:179], a[68:71], a[32:35], a[176:179]
    ds_read_b64_tr_b16 a[76:77], v17 offset:26720
    v_mfma_f32_16x16x32_bf16 a[180:183], a[68:71], a[36:39], a[180:183]
    ds_read_b64_tr_b16 a[78:79], v17 offset:28512
    v_mfma_f32_16x16x32_bf16 a[184:187], a[68:71], a[40:43], a[184:187]
    ds_read_b128 a[20:23], v14 offset:10240
    v_mfma_f32_16x16x32_bf16 a[188:191], a[68:71], a[44:47], a[188:191]
    buffer_load_dwordx4 v4, s[8:11], s24 offen offset:3072 lds
    v_mfma_f32_16x16x32_bf16 a[192:195], a[68:71], a[48:51], a[192:195]
    v_mfma_f32_16x16x32_bf16 a[196:199], a[68:71], a[52:55], a[196:199]
    v_mfma_f32_16x16x32_bf16 a[200:203], a[68:71], a[56:59], a[200:203]
    v_mfma_f32_16x16x32_bf16 a[204:207], a[68:71], a[60:63], a[204:207]
    v_mfma_f32_16x16x32_bf16 v[44:47], a[68:71], v[72:75], v[44:47]
    s_waitcnt lgkmcnt(4)
    v_mfma_f32_16x16x32_bf16 a[208:211], a[72:75], a[32:35], a[208:211]
    ds_read_b64_tr_b16 a[64:65], v17 offset:33792
    v_mfma_f32_16x16x32_bf16 a[212:215], a[72:75], a[36:39], a[212:215]
    ds_read_b64_tr_b16 a[66:67], v17 offset:35584
    v_mfma_f32_16x16x32_bf16 a[216:219], a[72:75], a[40:43], a[216:219]
    s_add_u32 m0, s31, 118784
    ds_read_b128 a[24:27], v14 offset:12288
    v_mfma_f32_16x16x32_bf16 a[220:223], a[72:75], a[44:47], a[220:223]
    buffer_load_dwordx4 v5, s[8:11], s24 offen offset:0 lds
    v_mfma_f32_16x16x32_bf16 a[224:227], a[72:75], a[48:51], a[224:227]
    v_mfma_f32_16x16x32_bf16 a[228:231], a[72:75], a[52:55], a[228:231]
    v_mfma_f32_16x16x32_bf16 a[232:235], a[72:75], a[56:59], a[232:235]
    v_mfma_f32_16x16x32_bf16 a[236:239], a[72:75], a[60:63], a[236:239]
    v_mfma_f32_16x16x32_bf16 v[48:51], a[72:75], v[72:75], v[48:51]
    s_waitcnt lgkmcnt(4)
    v_mfma_f32_16x16x32_bf16 a[240:243], a[76:79], a[32:35], a[240:243]
    ds_read_b64_tr_b16 a[68:69], v17 offset:33824
    v_mfma_f32_16x16x32_bf16 a[244:247], a[76:79], a[36:39], a[244:247]
    ds_read_b64_tr_b16 a[70:71], v17 offset:35616
    v_mfma_f32_16x16x32_bf16 a[248:251], a[76:79], a[40:43], a[248:251]
    ds_read_b128 a[28:31], v14 offset:14336
    v_mfma_f32_16x16x32_bf16 a[252:255], a[76:79], a[44:47], a[252:255]
    buffer_load_dwordx4 v6, s[8:11], s24 offen offset:1024 lds
    v_mfma_f32_16x16x32_bf16 v[112:115], a[76:79], a[48:51], v[112:115]
    v_mfma_f32_16x16x32_bf16 v[116:119], a[76:79], a[52:55], v[116:119]
    v_mfma_f32_16x16x32_bf16 v[120:123], a[76:79], a[56:59], v[120:123]
    v_mfma_f32_16x16x32_bf16 v[124:127], a[76:79], a[60:63], v[124:127]
    v_mfma_f32_16x16x32_bf16 v[52:55], a[76:79], v[72:75], v[52:55]
    s_waitcnt lgkmcnt(4)
    v_mfma_f32_16x16x32_bf16 v[128:131], a[64:67], a[32:35], v[128:131]
    ds_read_b64_tr_b16 a[72:73], v17 offset:33856
    v_mfma_f32_16x16x32_bf16 v[132:135], a[64:67], a[36:39], v[132:135]
    ds_read_b64_tr_b16 a[74:75], v17 offset:35648
    v_mfma_f32_16x16x32_bf16 v[136:139], a[64:67], a[40:43], v[136:139]
    ds_read_b64_tr_b16 a[76:77], v17 offset:33888
    v_mfma_f32_16x16x32_bf16 v[140:143], a[64:67], a[44:47], v[140:143]
    ds_read_b64_tr_b16 a[78:79], v17 offset:35680
    v_mfma_f32_16x16x32_bf16 v[144:147], a[64:67], a[48:51], v[144:147]
    buffer_load_dwordx4 v7, s[8:11], s24 offen offset:2048 lds
    v_mfma_f32_16x16x32_bf16 v[148:151], a[64:67], a[52:55], v[148:151]
    v_mfma_f32_16x16x32_bf16 v[152:155], a[64:67], a[56:59], v[152:155]
    v_mfma_f32_16x16x32_bf16 v[156:159], a[64:67], a[60:63], v[156:159]
    v_mfma_f32_16x16x32_bf16 v[56:59], a[64:67], v[72:75], v[56:59]
    s_waitcnt lgkmcnt(5)
    v_mfma_f32_16x16x32_bf16 v[160:163], a[68:71], a[32:35], v[160:163]
    v_mfma_f32_16x16x32_bf16 v[164:167], a[68:71], a[36:39], v[164:167]
    v_mfma_f32_16x16x32_bf16 v[168:171], a[68:71], a[40:43], v[168:171]
    buffer_load_dwordx4 v8, s[8:11], s24 offen offset:3072 lds
    v_mfma_f32_16x16x32_bf16 v[172:175], a[68:71], a[44:47], v[172:175]
    s_lshr_b32 s98, s98, 4
    s_and_b32 s24, s98, 7
    s_lshl_b32 s24, s24, 8
    v_mfma_f32_16x16x32_bf16 v[176:179], a[68:71], a[48:51], v[176:179]
    v_mfma_f32_16x16x32_bf16 v[180:183], a[68:71], a[52:55], v[180:183]
    v_mfma_f32_16x16x32_bf16 v[184:187], a[68:71], a[56:59], v[184:187]
    v_mfma_f32_16x16x32_bf16 v[188:191], a[68:71], a[60:63], v[188:191]
    v_mfma_f32_16x16x32_bf16 v[60:63], a[68:71], v[72:75], v[60:63]
    s_waitcnt lgkmcnt(0)
    s_barrier
    v_mfma_f32_16x16x32_bf16 v[192:195], a[72:75], a[32:35], v[192:195]
    ds_read_b64_tr_b16 a[64:65], v18 offset:128
    v_mfma_f32_16x16x32_bf16 v[196:199], a[72:75], a[36:39], v[196:199]
    s_add_u32 m0, s29, 61440
    ds_read_b64_tr_b16 a[66:67], v18 offset:1664
    v_mfma_f32_16x16x32_bf16 v[200:203], a[72:75], a[40:43], v[200:203]
    buffer_load_dwordx4 v9, s[12:15], s25 offen offset:0 lds
    v_mfma_f32_16x16x32_bf16 v[204:207], a[72:75], a[44:47], v[204:207]
    v_mfma_f32_16x16x32_bf16 v[208:211], a[72:75], a[48:51], v[208:211]
    v_mfma_f32_16x16x32_bf16 v[212:215], a[72:75], a[52:55], v[212:215]
    v_mfma_f32_16x16x32_bf16 v[216:219], a[72:75], a[56:59], v[216:219]
    v_mfma_f32_16x16x32_bf16 v[220:223], a[72:75], a[60:63], v[220:223]
    v_mfma_f32_16x16x32_bf16 v[64:67], a[72:75], v[72:75], v[64:67]
    v_mfma_f32_16x16x32_bf16 v[224:227], a[76:79], a[32:35], v[224:227]
    ds_read_b64_tr_b16 a[68:69], v20 offset:160
    v_mfma_f32_16x16x32_bf16 v[228:231], a[76:79], a[36:39], v[228:231]
    ds_read_b64_tr_b16 a[70:71], v20 offset:1696
    v_mfma_f32_16x16x32_bf16 v[232:235], a[76:79], a[40:43], v[232:235]
    buffer_load_dwordx4 v10, s[12:15], s25 offen offset:1024 lds
    v_mfma_f32_16x16x32_bf16 v[236:239], a[76:79], a[44:47], v[236:239]
    v_mfma_f32_16x16x32_bf16 v[240:243], a[76:79], a[48:51], v[240:243]
    v_mfma_f32_16x16x32_bf16 v[244:247], a[76:79], a[52:55], v[244:247]
    v_mfma_f32_16x16x32_bf16 v[248:251], a[76:79], a[56:59], v[248:251]
    v_mfma_f32_16x16x32_bf16 v[252:255], a[76:79], a[60:63], v[252:255]
    v_mfma_f32_16x16x32_bf16 v[68:71], a[76:79], v[72:75], v[68:71]
    s_branch L_k2_w0_after
L_k2_w0_a1:
    s_lshl_b32 s33, s21, 3
    s_add_u32 s33, s33, s20
    s_mul_i32 s33, s33, 1280
    s_add_u32 s33, s33, 39976960
    v_lshrrev_b32 v23, 4, v22
    v_lshlrev_b32 v23, 4, v23
    s_mov_b32 s44, 0x00010001
    s_mov_b32 s45, 0x00010001
    s_mov_b64 exec, s[44:45]
    buffer_store_dwordx4 v[32:35], v23, s[36:39], s33 offen offset:0 sc1
    buffer_store_dwordx4 v[36:39], v23, s[36:39], s33 offen offset:64 sc1
    buffer_store_dwordx4 v[40:43], v23, s[36:39], s33 offen offset:128 sc1
    buffer_store_dwordx4 v[44:47], v23, s[36:39], s33 offen offset:192 sc1
    buffer_store_dwordx4 v[48:51], v23, s[36:39], s33 offen offset:256 sc1
    buffer_store_dwordx4 v[52:55], v23, s[36:39], s33 offen offset:320 sc1
    buffer_store_dwordx4 v[56:59], v23, s[36:39], s33 offen offset:384 sc1
    buffer_store_dwordx4 v[60:63], v23, s[36:39], s33 offen offset:448 sc1
    buffer_store_dwordx4 v[64:67], v23, s[36:39], s33 offen offset:512 sc1
    buffer_store_dwordx4 v[68:71], v23, s[36:39], s33 offen offset:576 sc1
    s_mov_b64 exec, -1
    s_branch L_k2_w0_b1
L_k2_w0_a2:
    v_readfirstlane_b32 s96, v110
    v_readfirstlane_b32 s79, v110
    s_cmp_lg_u32 s3, 0
    s_cbranch_scc1 L_k2_w0_b2
    v_mov_b32 v23, 0
    v_mov_b32 v24, 1
    s_mov_b64 exec, 1
    global_atomic_add v23, v24, s[42:43] sc1
    s_mov_b64 exec, -1
    s_branch L_k2_w0_b2
L_k2_w0_s0:
    s_mov_b32 s58, 0xffff0000
    s_mov_b32 s59, 0xba800000
    s_mov_b32 s60, 0x3727c5ac
    s_mov_b32 s61, 0x3a800000
    v_mov_b32 v92, 0x3f803f80
    v_dot2_f32_bf16 v96, v76, v92, 0
    v_dot2_f32_bf16 v97, v76, v76, 0
    v_dot2_f32_bf16 v98, v84, v92, 0
    v_dot2_f32_bf16 v99, v84, v84, 0
    v_dot2_f32_bf16 v96, v77, v92, v96
    v_dot2_f32_bf16 v97, v77, v77, v97
    v_dot2_f32_bf16 v98, v85, v92, v98
    v_dot2_f32_bf16 v99, v85, v85, v99
    v_dot2_f32_bf16 v96, v78, v92, v96
    v_dot2_f32_bf16 v97, v78, v78, v97
    v_dot2_f32_bf16 v98, v86, v92, v98
    v_dot2_f32_bf16 v99, v86, v86, v99
    v_dot2_f32_bf16 v96, v79, v92, v96
    v_dot2_f32_bf16 v97, v79, v79, v97
    v_dot2_f32_bf16 v98, v87, v92, v98
    v_dot2_f32_bf16 v99, v87, v87, v99
    v_dot2_f32_bf16 v96, v80, v92, v96
    v_dot2_f32_bf16 v97, v80, v80, v97
    v_dot2_f32_bf16 v98, v88, v92, v98
    v_dot2_f32_bf16 v99, v88, v88, v99
    v_dot2_f32_bf16 v96, v81, v92, v96
    v_dot2_f32_bf16 v97, v81, v81, v97
    v_dot2_f32_bf16 v98, v89, v92, v98
    v_dot2_f32_bf16 v99, v89, v89, v99
    v_dot2_f32_bf16 v96, v82, v92, v96
    v_dot2_f32_bf16 v97, v82, v82, v97
    v_dot2_f32_bf16 v98, v90, v92, v98
    v_dot2_f32_bf16 v99, v90, v90, v99
    v_dot2_f32_bf16 v96, v83, v92, v96
    v_dot2_f32_bf16 v97, v83, v83, v97
    v_dot2_f32_bf16 v98, v91, v92, v98
    v_dot2_f32_bf16 v99, v91, v91, v99
    v_add_f32_dpp v96, v96, v96 row_ror:8 row_mask:0xf bank_mask:0xf
    v_add_f32_dpp v97, v97, v97 row_ror:8 row_mask:0xf bank_mask:0xf
    v_add_f32_dpp v98, v98, v98 row_ror:8 row_mask:0xf bank_mask:0xf
    v_add_f32_dpp v99, v99, v99 row_ror:8 row_mask:0xf bank_mask:0xf
    v_add_f32_dpp v96, v96, v96 row_ror:4 row_mask:0xf bank_mask:0xf
    v_add_f32_dpp v97, v97, v97 row_ror:4 row_mask:0xf bank_mask:0xf
    v_add_f32_dpp v98, v98, v98 row_ror:4 row_mask:0xf bank_mask:0xf
    v_add_f32_dpp v99, v99, v99 row_ror:4 row_mask:0xf bank_mask:0xf
    v_add_f32_dpp v96, v96, v96 row_ror:2 row_mask:0xf bank_mask:0xf
    v_add_f32_dpp v97, v97, v97 row_ror:2 row_mask:0xf bank_mask:0xf
    v_add_f32_dpp v98, v98, v98 row_ror:2 row_mask:0xf bank_mask:0xf
    v_add_f32_dpp v99, v99, v99 row_ror:2 row_mask:0xf bank_mask:0xf
    v_add_f32_dpp v96, v96, v96 row_ror:1 row_mask:0xf bank_mask:0xf
    v_add_f32_dpp v97, v97, v97 row_ror:1 row_mask:0xf bank_mask:0xf
    v_add_f32_dpp v98, v98, v98 row_ror:1 row_mask:0xf bank_mask:0xf
    v_add_f32_dpp v99, v99, v99 row_ror:1 row_mask:0xf bank_mask:0xf
    v_mov_b32 v100, v96
    v_mov_b32 v101, v97
    v_mov_b32 v102, v98
    v_mov_b32 v103, v99
    v_permlane16_swap_b32 v100, v96
    v_permlane16_swap_b32 v101, v97
    v_permlane16_swap_b32 v102, v98
    v_permlane16_swap_b32 v103, v99
    v_add_f32 v96, v96, v100
    v_add_f32 v97, v97, v101
    v_add_f32 v98, v98, v102
    v_add_f32 v99, v99, v103
    v_mov_b32 v100, v96
    v_mov_b32 v101, v97
    v_mov_b32 v102, v98
    v_mov_b32 v103, v99
    v_permlane32_swap_b32 v100, v96
    v_permlane32_swap_b32 v101, v97
    v_permlane32_swap_b32 v102, v98
    v_permlane32_swap_b32 v103, v99
    v_add_f32 v96, v96, v100
    v_add_f32 v97, v97, v101
    v_add_f32 v98, v98, v102
    v_add_f32 v99, v99, v103
    v_mul_f32 v76, s59, v96
    v_mul_f32 v100, s61, v97
    v_fma_f32 v100, -v76, v76, v100
    v_max_f32 v100, 0, v100
    v_add_f32 v100, s60, v100
    v_rsq_f32 v77, v100
    v_mul_f32 v78, s59, v98
    v_mul_f32 v100, s61, v99
    v_fma_f32 v100, -v78, v78, v100
    v_max_f32 v100, 0, v100
    v_add_f32 v100, s60, v100
    v_rsq_f32 v79, v100
    s_lshl_b32 s33, s62, 3
    s_add_u32 s33, s33, 39911424
    v_mov_b32 v108, 0
    s_mov_b64 exec, 1
    buffer_store_dwordx4 v[76:79], v108, s[36:39], s33 offen sc1
    s_mov_b64 exec, -1
    s_branch L_k2_w0_bs0
L_k2_w0_c:
    s_cmp_eq_u32 s32, 4
    s_cbranch_scc1 L_k2_w0_c4
    s_cmp_eq_u32 s32, 5
    s_cbranch_scc1 L_k2_w0_c5
    s_cmp_eq_u32 s32, 6
    s_cbranch_scc1 L_k2_w0_c6
    s_branch L_k2_w0_c3
L_k2_w0_c3:
    s_and_b32 s33, s50, 2
    s_lshl_b32 s33, s33, 6
    v_xor_b32 v28, s33, v26
    s_add_u32 s50, s50, 1
    global_load_dwordx4 v[76:79], v28, s[46:47] nt
    s_add_u32 s46, s46, 8192
    s_addc_u32 s47, s47, 0
    s_cmp_eq_u32 s50, 256
    s_cselect_b32 s46, s48, s46
    s_cselect_b32 s47, s49, s47
    s_and_b32 s33, s50, 2
    s_lshl_b32 s33, s33, 6
    v_xor_b32 v28, s33, v26
    s_add_u32 s50, s50, 1
    global_load_dwordx4 v[80:83], v28, s[46:47] nt
    s_add_u32 s46, s46, 8192
    s_addc_u32 s47, s47, 0
    s_cmp_eq_u32 s50, 256
    s_cselect_b32 s46, s48, s46
    s_cselect_b32 s47, s49, s47
    s_and_b32 s33, s50, 2
    s_lshl_b32 s33, s33, 6
    v_xor_b32 v28, s33, v26
    s_add_u32 s50, s50, 1
    global_load_dwordx4 v[84:87], v28, s[46:47] nt
    s_add_u32 s46, s46, 8192
    s_addc_u32 s47, s47, 0
    s_cmp_eq_u32 s50, 256
    s_cselect_b32 s46, s48, s46
    s_cselect_b32 s47, s49, s47
    s_branch L_k2_w0_bc
L_k2_w0_c4:
    buffer_store_dwordx4 v[76:79], v27, s[36:39], s51 offen sc1
    s_add_u32 s51, s51, 1024
    buffer_store_dwordx4 v[80:83], v27, s[36:39], s51 offen sc1
    s_add_u32 s51, s51, 1024
    buffer_store_dwordx4 v[84:87], v27, s[36:39], s51 offen sc1
    s_add_u32 s51, s51, 1024
    s_and_b32 s33, s50, 2
    s_lshl_b32 s33, s33, 6
    v_xor_b32 v28, s33, v26
    s_add_u32 s50, s50, 1
    global_load_dwordx4 v[76:79], v28, s[46:47] nt
    s_add_u32 s46, s46, 8192
    s_addc_u32 s47, s47, 0
    s_cmp_eq_u32 s50, 256
    s_cselect_b32 s46, s48, s46
    s_cselect_b32 s47, s49, s47
    s_and_b32 s33, s50, 2
    s_lshl_b32 s33, s33, 6
    v_xor_b32 v28, s33, v26
    s_add_u32 s50, s50, 1
    global_load_dwordx4 v[80:83], v28, s[46:47] nt
    s_add_u32 s46, s46, 8192
    s_addc_u32 s47, s47, 0
    s_cmp_eq_u32 s50, 256
    s_cselect_b32 s46, s48, s46
    s_cselect_b32 s47, s49, s47
    s_and_b32 s33, s50, 2
    s_lshl_b32 s33, s33, 6
    v_xor_b32 v28, s33, v26
    s_add_u32 s50, s50, 1
    global_load_dwordx4 v[84:87], v28, s[46:47] nt
    s_add_u32 s46, s46, 8192
    s_addc_u32 s47, s47, 0
    s_cmp_eq_u32 s50, 256
    s_cselect_b32 s46, s48, s46
    s_cselect_b32 s47, s49, s47
    s_branch L_k2_w0_bc
L_k2_w0_c5:
    buffer_store_dwordx4 v[76:79], v27, s[36:39], s51 offen sc1
    s_add_u32 s51, s51, 1024
    buffer_store_dwordx4 v[80:83], v27, s[36:39], s51 offen sc1
    s_add_u32 s51, s51, 1024
    buffer_store_dwordx4 v[84:87], v27, s[36:39], s51 offen sc1
    s_add_u32 s51, s51, 1024
    s_and_b32 s33, s50, 2
    s_lshl_b32 s33, s33, 6
    v_xor_b32 v28, s33, v26
    s_add_u32 s50, s50, 1
    global_load_dwordx4 v[76:79], v28, s[46:47] nt
    s_add_u32 s46, s46, 8192
    s_addc_u32 s47, s47, 0
    s_cmp_eq_u32 s50, 256
    s_cselect_b32 s46, s48, s46
    s_cselect_b32 s47, s49, s47
    s_and_b32 s33, s50, 2
    s_lshl_b32 s33, s33, 6
    v_xor_b32 v28, s33, v26
    s_add_u32 s50, s50, 1
    global_load_dwordx4 v[80:83], v28, s[46:47] nt
    s_add_u32 s46, s46, 8192
    s_addc_u32 s47, s47, 0
    s_cmp_eq_u32 s50, 256
    s_cselect_b32 s46, s48, s46
    s_cselect_b32 s47, s49, s47
    s_and_b32 s33, s50, 2
    s_lshl_b32 s33, s33, 6
    v_xor_b32 v28, s33, v26
    s_add_u32 s50, s50, 1
    global_load_dwordx4 v[84:87], v28, s[46:47] nt
    s_add_u32 s46, s46, 8192
    s_addc_u32 s47, s47, 0
    s_cmp_eq_u32 s50, 256
    s_cselect_b32 s46, s48, s46
    s_cselect_b32 s47, s49, s47
    s_branch L_k2_w0_bc
L_k2_w0_c6:
    buffer_store_dwordx4 v[76:79], v27, s[36:39], s51 offen sc1
    s_add_u32 s51, s51, 1024
    buffer_store_dwordx4 v[80:83], v27, s[36:39], s51 offen sc1
    s_add_u32 s51, s51, 1024
    buffer_store_dwordx4 v[84:87], v27, s[36:39], s51 offen sc1
    s_add_u32 s51, s51, 1024
    s_branch L_k2_w0_bc
L_k2_w0_a36:
    v_mov_b32 v23, 0
    global_load_dword v25, v23, s[42:43] sc1
    s_branch L_k2_w0_b4
L_k2_w0_a3:
    s_getpc_b64 s[44:45]
L_pc_s0:
    s_sub_u32 s44, s44, L_pc_s0-recurrent_scan__sliding_block__glu_gated_bilinear__prompt_kernel
    s_subb_u32 s45, s45, 0
    s_lshr_b32 s33, s77, 3
    s_lshl_b32 s33, s33, 2
    s_add_u32 s33, s33, s3
    s_mul_i32 s33, s33, 7
    v_min_u32 v23, 6, v22
    v_add_u32 v23, s33, v23
    v_lshlrev_b32 v23, 7, v23
    v_min_u32 v23, L_text_end-recurrent_scan__sliding_block__glu_gated_bilinear__prompt_kernel-4, v23
    s_mov_b64 exec, 127
    global_load_dword v0, v23, s[44:45]
    s_mov_b64 exec, -1
    s_branch L_k2_w0_b3
L_k2_wn1:
    v_add_u32 v23, 128, v22
    v_mul_u32_u24 v24, 4682, v23
    v_lshrrev_b32 v24, 16, v24
    v_mul_u32_u24 v25, 14, v24
    v_sub_u32 v25, v23, v25
    v_and_b32 v26, 19, v24
    v_lshrrev_b32 v27, 2, v24
    v_and_b32 v27, 1, v27
    v_lshl_add_u32 v26, v27, 3, v26
    v_lshrrev_b32 v27, 3, v24
    v_and_b32 v27, 1, v27
    v_lshl_add_u32 v26, v27, 2, v26
    v_mul_u32_u24 v26, 7168, v26
    v_lshl_add_u32 v26, v25, 4, v26
    s_mul_i32 s33, s21, 224
    s_sub_u32 s33, s33, 0
    v_add_u32 v9, s33, v26
    v_add_u32 v23, 192, v22
    v_mul_u32_u24 v24, 4682, v23
    v_lshrrev_b32 v24, 16, v24
    v_mul_u32_u24 v25, 14, v24
    v_sub_u32 v25, v23, v25
    v_and_b32 v26, 19, v24
    v_lshrrev_b32 v27, 2, v24
    v_and_b32 v27, 1, v27
    v_lshl_add_u32 v26, v27, 3, v26
    v_lshrrev_b32 v27, 3, v24
    v_and_b32 v27, 1, v27
    v_lshl_add_u32 v26, v27, 2, v26
    v_mul_u32_u24 v26, 7168, v26
    v_lshl_add_u32 v26, v25, 4, v26
    s_mul_i32 s33, s21, 224
    s_sub_u32 s33, s33, 1024
    v_add_u32 v10, s33, v26
    v_add_u32 v23, 256, v22
    v_mul_u32_u24 v24, 4682, v23
    v_lshrrev_b32 v24, 16, v24
    v_mul_u32_u24 v25, 14, v24
    v_sub_u32 v25, v23, v25
    v_and_b32 v26, 19, v24
    v_lshrrev_b32 v27, 2, v24
    v_and_b32 v27, 1, v27
    v_lshl_add_u32 v26, v27, 3, v26
    v_lshrrev_b32 v27, 3, v24
    v_and_b32 v27, 1, v27
    v_lshl_add_u32 v26, v27, 2, v26
    v_mul_u32_u24 v26, 7168, v26
    v_lshl_add_u32 v26, v25, 4, v26
    s_mul_i32 s33, s21, 224
    s_sub_u32 s33, s33, 2048
    v_add_u32 v11, s33, v26
    v_add_u32 v23, 320, v22
    v_mul_u32_u24 v24, 4682, v23
    v_lshrrev_b32 v24, 16, v24
    v_mul_u32_u24 v25, 14, v24
    v_sub_u32 v25, v23, v25
    v_and_b32 v26, 19, v24
    v_lshrrev_b32 v27, 2, v24
    v_and_b32 v27, 1, v27
    v_lshl_add_u32 v26, v27, 3, v26
    v_lshrrev_b32 v27, 3, v24
    v_and_b32 v27, 1, v27
    v_lshl_add_u32 v26, v27, 2, v26
    v_mul_u32_u24 v26, 7168, v26
    v_lshl_add_u32 v26, v25, 4, v26
    s_mul_i32 s33, s21, 224
    s_sub_u32 s33, s33, 3072
    v_add_u32 v12, s33, v26
    v_add_u32 v23, 384, v22
    v_mul_u32_u24 v24, 4682, v23
    v_lshrrev_b32 v24, 16, v24
    v_mul_u32_u24 v25, 14, v24
    v_sub_u32 v25, v23, v25
    v_and_b32 v26, 19, v24
    v_lshrrev_b32 v27, 2, v24
    v_and_b32 v27, 1, v27
    v_lshl_add_u32 v26, v27, 3, v26
    v_lshrrev_b32 v27, 3, v24
    v_and_b32 v27, 1, v27
    v_lshl_add_u32 v26, v27, 2, v26
    v_mul_u32_u24 v26, 7168, v26
    v_lshl_add_u32 v26, v25, 4, v26
    s_mul_i32 s33, s21, 224
    s_sub_u32 s33, s33, 0
    v_add_u32 v13, s33, v26
    s_mul_i32 s29, s22, 7168
    s_add_u32 s30, s29, 12288
    s_add_u32 s29, s29, 8192
    s_add_u32 m0, s29, 0
    s_nop 0
    buffer_load_dwordx4 v9, s[12:15], s25 offen offset:0 lds
    buffer_load_dwordx4 v10, s[12:15], s25 offen offset:1024 lds
    buffer_load_dwordx4 v11, s[12:15], s25 offen offset:2048 lds
    buffer_load_dwordx4 v12, s[12:15], s25 offen offset:3072 lds
    s_add_u32 m0, s30, 0
    s_nop 0
    buffer_load_dwordx4 v13, s[12:15], s25 offen offset:0 lds
    s_add_u32 s25, s25, s27
    s_add_u32 m0, s29, 20480
    s_nop 0
    buffer_load_dwordx4 v9, s[12:15], s25 offen offset:0 lds
    buffer_load_dwordx4 v10, s[12:15], s25 offen offset:1024 lds
    buffer_load_dwordx4 v11, s[12:15], s25 offen offset:2048 lds
    buffer_load_dwordx4 v12, s[12:15], s25 offen offset:3072 lds
    s_add_u32 m0, s30, 20480
    s_nop 0
    buffer_load_dwordx4 v13, s[12:15], s25 offen offset:0 lds
    s_add_u32 s25, s25, s27
    s_add_u32 m0, s31, 114688
    s_nop 0
    buffer_load_dwordx4 v1, s[8:11], s24 offen offset:0 lds
    buffer_load_dwordx4 v2, s[8:11], s24 offen offset:1024 lds
    buffer_load_dwordx4 v3, s[8:11], s24 offen offset:2048 lds
    buffer_load_dwordx4 v4, s[8:11], s24 offen offset:3072 lds
    s_add_u32 m0, s31, 118784
    s_nop 0
    buffer_load_dwordx4 v5, s[8:11], s24 offen offset:0 lds
    buffer_load_dwordx4 v6, s[8:11], s24 offen offset:1024 lds
    buffer_load_dwordx4 v7, s[8:11], s24 offen offset:2048 lds
    buffer_load_dwordx4 v8, s[8:11], s24 offen offset:3072 lds
    s_lshr_b32 s98, s98, 4
    s_and_b32 s24, s98, 7
    s_lshl_b32 s24, s24, 8
    v_and_b32 v23, 15, v22
    v_lshrrev_b32 v24, 4, v22
    v_lshrrev_b32 v25, 1, v23
    v_xor_b32 v25, v25, v24
    v_lshlrev_b32 v25, 4, v25
    v_lshl_add_u32 v25, v23, 7, v25
    s_lshl_b32 s33, s22, 14
    s_add_u32 s33, s33, 81920
    v_add_u32 v14, s33, v25
    v_xor_b32 v15, 64, v14
    v_lshrrev_b32 v25, 1, v24
    v_lshlrev_b32 v25, 4, v25
    v_and_b32 v26, 1, v24
    v_lshl_add_u32 v25, v26, 2, v25
    v_lshrrev_b32 v27, 2, v23
    v_add_u32 v25, v25, v27
    v_and_b32 v27, 3, v23
    v_lshlrev_b32 v27, 3, v27
    v_mul_u32_u24 v28, 224, v25
    v_add_u32 v16, v28, v27
    v_add_u32 v17, 40960, v16
    v_mul_u32_u24 v28, 192, v25
    v_add_u32 v28, v28, v27
    v_lshlrev_b32 v26, 5, v26
    v_add_u32 v18, v28, v26
    v_add_u32 v19, 40960, v18
    v_sub_u32 v20, v28, v26
    v_add_u32 v21, 40960, v20
    v_mov_b32 v72, 0
    v_mov_b32 v73, 0
    v_mov_b32 v74, 0
    v_mov_b32 v75, 0
    s_nop 1
    v_mfma_f32_32x32x16_bf16 a[80:95], v[72:75], v[72:75], 0
    v_mfma_f32_32x32x16_bf16 a[96:111], v[72:75], v[72:75], 0
    v_mfma_f32_32x32x16_bf16 a[112:127], v[72:75], v[72:75], 0
    v_mfma_f32_32x32x16_bf16 a[128:143], v[72:75], v[72:75], 0
    v_mfma_f32_32x32x16_bf16 a[144:159], v[72:75], v[72:75], 0
    v_mfma_f32_32x32x16_bf16 a[160:175], v[72:75], v[72:75], 0
    v_mfma_f32_32x32x16_bf16 a[176:191], v[72:75], v[72:75], 0
    v_mfma_f32_32x32x16_bf16 a[192:207], v[72:75], v[72:75], 0
    v_mfma_f32_32x32x16_bf16 a[208:223], v[72:75], v[72:75], 0
    v_mfma_f32_32x32x16_bf16 a[224:239], v[72:75], v[72:75], 0
    v_mfma_f32_32x32x16_bf16 a[240:255], v[72:75], v[72:75], 0
    v_mfma_f32_32x32x16_bf16 v[112:127], v[72:75], v[72:75], 0
    v_mfma_f32_32x32x16_bf16 v[128:143], v[72:75], v[72:75], 0
    v_mfma_f32_32x32x16_bf16 v[144:159], v[72:75], v[72:75], 0
    v_mfma_f32_32x32x16_bf16 v[160:175], v[72:75], v[72:75], 0
    v_mfma_f32_32x32x16_bf16 v[176:191], v[72:75], v[72:75], 0
    v_mfma_f32_32x32x16_bf16 v[192:207], v[72:75], v[72:75], 0
    v_mfma_f32_32x32x16_bf16 v[208:223], v[72:75], v[72:75], 0
    v_mfma_f32_32x32x16_bf16 v[224:239], v[72:75], v[72:75], 0
    v_mfma_f32_32x32x16_bf16 v[240:255], v[72:75], v[72:75], 0
    v_mfma_f32_32x32x16_bf16 v[32:47], v[72:75], v[72:75], 0
    v_mfma_f32_32x32x16_bf16 v[48:63], v[72:75], v[72:75], 0
    v_mfma_f32_16x16x32_bf16 v[64:67], v[72:75], v[72:75], 0
    v_mfma_f32_16x16x32_bf16 v[68:71], v[72:75], v[72:75], 0
    v_mov_b32 v72, 0x3f803f80
    v_mov_b32 v73, 0x3f803f80
    v_mov_b32 v74, 0x3f803f80
    v_mov_b32 v75, 0x3f803f80
    s_waitcnt vmcnt(13)
    s_barrier
    ds_read_b128 a[0:3], v14 offset:0
    ds_read_b128 a[4:7], v14 offset:2048
    ds_read_b128 a[8:11], v14 offset:4096
    ds_read_b128 a[12:15], v14 offset:6144
    ds_read_b128 a[16:19], v14 offset:8192
    ds_read_b128 a[20:23], v14 offset:10240
    ds_read_b128 a[24:27], v14 offset:12288
    ds_read_b128 a[28:31], v14 offset:14336
    ds_read_b64_tr_b16 a[64:65], v18 offset:0
    ds_read_b64_tr_b16 a[66:67], v18 offset:1536
    ds_read_b64_tr_b16 a[68:69], v20 offset:32
    ds_read_b64_tr_b16 a[70:71], v20 offset:1568
    s_add_u32 m0, s29, 40960
    s_nop 0
    buffer_load_dwordx4 v9, s[12:15], s25 offen offset:0 lds
    buffer_load_dwordx4 v10, s[12:15], s25 offen offset:1024 lds
    buffer_load_dwordx4 v11, s[12:15], s25 offen offset:2048 lds
    buffer_load_dwordx4 v12, s[12:15], s25 offen offset:3072 lds
    s_add_u32 m0, s30, 40960
    s_nop 0
    buffer_load_dwordx4 v13, s[12:15], s25 offen offset:0 lds
    s_add_u32 s25, s25, s27
    s_add_u32 m0, s29, 61440
    s_nop 0
    buffer_load_dwordx4 v9, s[12:15], s25 offen offset:0 lds
    buffer_load_dwordx4 v10, s[12:15], s25 offen offset:1024 lds
    buffer_load_dwordx4 v[76:79], v31, s[8:11], 0 offen offset:0
    buffer_load_dwordx4 v[80:83], v31, s[8:11], 0 offen offset:1024
    buffer_load_dwordx4 v[84:87], v31, s[8:11], 0 offen offset:2048
    buffer_load_dwordx4 v[88:91], v31, s[8:11], 0 offen offset:3072
    v_mov_b32 v23, 0
    s_mov_b32 s33, 41156608
    buffer_load_dword v110, v23, s[36:39], s33 offen sc1
    s_lshl_b32 s33, s77, 9
    s_lshl_b32 s34, s3, 7
    s_add_u32 s33, s33, s34
    s_add_u32 s34, s33, 40632320
    v_mov_b32 v23, s34
    s_add_u32 s34, s33, 40894464
    v_writelane_b32 v23, s34, 1
    s_lshl_b32 s33, s77, 7
    s_add_u32 s34, s33, 41091072
    v_writelane_b32 v23, s34, 2
    s_add_u32 s34, s33, 41123840
    v_writelane_b32 v23, s34, 3
    s_mov_b64 exec, 15
    buffer_load_dword v0, v23, s[36:39], 0 offen
    s_mov_b64 exec, -1
    s_load_dwordx2 s[44:45], s[0:1], 16
    s_load_dwordx2 s[48:49], s[0:1], 48
    v_lshrrev_b32 v23, 4, v22
    v_and_b32 v24, 15, v22
    v_lshrrev_b32 v26, 1, v24
    v_and_b32 v24, 1, v24
    v_xor_b32 v26, v26, v23
    v_lshlrev_b32 v26, 5, v26
    v_lshl_add_u32 v26, v24, 4, v26
    v_lshl_add_u32 v26, v23, 11, v26
    v_lshlrev_b32 v27, 4, v22
    s_lshr_b32 s50, s77, 3
    s_mul_i32 s50, s50, 36
    s_mul_i32 s34, s3, 9
    s_add_u32 s50, s50, s34
    s_and_b32 s35, s77, 7
    s_mul_i32 s51, s35, 1152
    s_add_u32 s51, s51, s50
    s_lshl_b32 s51, s51, 10
    s_add_u32 s51, s51, 41943040
    s_lshl_b32 s35, s35, 8
    s_waitcnt lgkmcnt(0)
    s_add_u32 s48, s48, s35
    s_addc_u32 s49, s49, 0
    s_add_u32 s44, s44, s35
    s_addc_u32 s45, s45, 0
    s_sub_u32 s34, s50, 256
    s_cmp_lt_u32 s50, 256
    s_cselect_b32 s46, s44, s48
    s_cselect_b32 s47, s45, s49
    s_cselect_b32 s34, s50, s34
    s_lshl_b32 s34, s34, 13
    s_add_u32 s46, s46, s34
    s_addc_u32 s47, s47, 0
    s_getpc_b64 s[44:45]
L_pc_p1:
    s_sub_u32 s44, s44, L_pc_p1-recurrent_scan__sliding_block__glu_gated_bilinear__prompt_kernel
    s_subb_u32 s45, s45, 0
    s_lshr_b32 s33, s77, 3
    s_lshl_b32 s33, s33, 2
    s_add_u32 s33, s33, s3
    s_mul_i32 s33, s33, 7
    v_min_u32 v23, 6, v22
    v_add_u32 v23, s33, v23
    v_lshlrev_b32 v23, 7, v23
    v_min_u32 v23, L_text_end-recurrent_scan__sliding_block__glu_gated_bilinear__prompt_kernel-4, v23
    s_mov_b64 exec, 127
    global_load_dword v0, v23, s[44:45]
    s_mov_b64 exec, -1
    s_mov_b32 s32, 0
L_k2_w1_top:
    s_cmp_eq_u32 s32, s78
    s_cbranch_scc1 L_k2_w1_cs
    s_waitcnt lgkmcnt(2)
    v_mfma_f32_16x16x32_bf16 a[80:83], a[64:67], a[0:3], a[80:83]
    ds_read_b64_tr_b16 a[72:73], v18 offset:64
    v_mfma_f32_16x16x32_bf16 a[84:87], a[64:67], a[4:7], a[84:87]
    ds_read_b64_tr_b16 a[74:75], v18 offset:1600
    v_mfma_f32_16x16x32_bf16 a[88:91], a[64:67], a[8:11], a[88:91]
    ds_read_b128 a[32:35], v15 offset:0
    v_mfma_f32_16x16x32_bf16 a[92:95], a[64:67], a[12:15], a[92:95]
    ds_read_b128 a[36:39], v15 offset:2048
    v_mfma_f32_16x16x32_bf16 a[96:99], a[64:67], a[16:19], a[96:99]
    buffer_load_dwordx4 v11, s[12:15], s25 offen offset:2048 lds
    v_mfma_f32_16x16x32_bf16 a[100:103], a[64:67], a[20:23], a[100:103]
    v_mfma_f32_16x16x32_bf16 a[104:107], a[64:67], a[24:27], a[104:107]
    v_mfma_f32_16x16x32_bf16 a[108:111], a[64:67], a[28:31], a[108:111]
    s_waitcnt lgkmcnt(4)
    v_mfma_f32_16x16x32_bf16 a[112:115], a[68:71], a[0:3], a[112:115]
    ds_read_b64_tr_b16 a[76:77], v20 offset:96
    v_mfma_f32_16x16x32_bf16 a[116:119], a[68:71], a[4:7], a[116:119]
    ds_read_b64_tr_b16 a[78:79], v20 offset:1632
    v_mfma_f32_16x16x32_bf16 a[120:123], a[68:71], a[8:11], a[120:123]
    ds_read_b128 a[40:43], v15 offset:4096
    v_mfma_f32_16x16x32_bf16 a[124:127], a[68:71], a[12:15], a[124:127]
    ds_read_b128 a[44:47], v15 offset:6144
    v_mfma_f32_16x16x32_bf16 a[128:131], a[68:71], a[16:19], a[128:131]
    buffer_load_dwordx4 v12, s[12:15], s25 offen offset:3072 lds
    v_mfma_f32_16x16x32_bf16 a[132:135], a[68:71], a[20:23], a[132:135]
    v_mfma_f32_16x16x32_bf16 a[136:139], a[68:71], a[24:27], a[136:139]
    v_mfma_f32_16x16x32_bf16 a[140:143], a[68:71], a[28:31], a[140:143]
    s_waitcnt lgkmcnt(6)
    v_mfma_f32_16x16x32_bf16 a[144:147], a[72:75], a[0:3], a[144:147]
    ds_read_b64_tr_b16 a[64:65], v16 offset:6272
    v_mfma_f32_16x16x32_bf16 a[148:151], a[72:75], a[4:7], a[148:151]
    ds_read_b64_tr_b16 a[66:67], v16 offset:8064
    v_mfma_f32_16x16x32_bf16 a[152:155], a[72:75], a[8:11], a[152:155]
    s_add_u32 m0, s30, 61440
    ds_read_b128 a[48:51], v15 offset:8192
    v_mfma_f32_16x16x32_bf16 a[156:159], a[72:75], a[12:15], a[156:159]
    buffer_load_dwordx4 v13, s[12:15], s25 offen offset:0 lds
    v_mfma_f32_16x16x32_bf16 a[160:163], a[72:75], a[16:19], a[160:163]
    s_lshr_b32 s97, s97, 4
    s_and_b32 s33, s97, 7
    s_lshl_b32 s33, s33, 2
    s_mul_i32 s25, s33, s27
    v_mfma_f32_16x16x32_bf16 a[164:167], a[72:75], a[20:23], a[164:167]
    v_mfma_f32_16x16x32_bf16 a[168:171], a[72:75], a[24:27], a[168:171]
    v_mfma_f32_16x16x32_bf16 a[172:175], a[72:75], a[28:31], a[172:175]
    s_waitcnt lgkmcnt(5)
    v_mfma_f32_16x16x32_bf16 a[176:179], a[76:79], a[0:3], a[176:179]
    ds_read_b64_tr_b16 a[68:69], v16 offset:6304
    v_mfma_f32_16x16x32_bf16 a[180:183], a[76:79], a[4:7], a[180:183]
    ds_read_b64_tr_b16 a[70:71], v16 offset:8096
    v_mfma_f32_16x16x32_bf16 a[184:187], a[76:79], a[8:11], a[184:187]
    ds_read_b128 a[52:55], v15 offset:10240
    v_mfma_f32_16x16x32_bf16 a[188:191], a[76:79], a[12:15], a[188:191]
    v_mfma_f32_16x16x32_bf16 a[192:195], a[76:79], a[16:19], a[192:195]
    v_mfma_f32_16x16x32_bf16 a[196:199], a[76:79], a[20:23], a[196:199]
    v_mfma_f32_16x16x32_bf16 a[200:203], a[76:79], a[24:27], a[200:203]
    v_mfma_f32_16x16x32_bf16 a[204:207], a[76:79], a[28:31], a[204:207]
    s_waitcnt lgkmcnt(4)
    v_mfma_f32_16x16x32_bf16 a[208:211], a[64:67], a[0:3], a[208:211]
    ds_read_b64_tr_b16 a[72:73], v16 offset:6336
    v_mfma_f32_16x16x32_bf16 a[212:215], a[64:67], a[4:7], a[212:215]
    ds_read_b64_tr_b16 a[74:75], v16 offset:8128
    v_mfma_f32_16x16x32_bf16 a[216:219], a[64:67], a[8:11], a[216:219]
    ds_read_b128 a[56:59], v15 offset:12288
    v_mfma_f32_16x16x32_bf16 a[220:223], a[64:67], a[12:15], a[220:223]
    v_mfma_f32_16x16x32_bf16 a[224:227], a[64:67], a[16:19], a[224:227]
    v_mfma_f32_16x16x32_bf16 a[228:231], a[64:67], a[20:23], a[228:231]
    v_mfma_f32_16x16x32_bf16 a[232:235], a[64:67], a[24:27], a[232:235]
    v_mfma_f32_16x16x32_bf16 a[236:239], a[64:67], a[28:31], a[236:239]
    s_waitcnt lgkmcnt(4)
    v_mfma_f32_16x16x32_bf16 a[240:243], a[68:71], a[0:3], a[240:243]
    ds_read_b64_tr_b16 a[76:77], v16 offset:13440
    v_mfma_f32_16x16x32_bf16 a[244:247], a[68:71], a[4:7], a[244:247]
    ds_read_b64_tr_b16 a[78:79], v16 offset:15232
    v_mfma_f32_16x16x32_bf16 a[248:251], a[68:71], a[8:11], a[248:251]
    ds_read_b128 a[60:63], v15 offset:14336
    v_mfma_f32_16x16x32_bf16 a[252:255], a[68:71], a[12:15], a[252:255]
    v_mfma_f32_16x16x32_bf16 v[112:115], a[68:71], a[16:19], v[112:115]
    v_mfma_f32_16x16x32_bf16 v[116:119], a[68:71], a[20:23], v[116:119]
    v_mfma_f32_16x16x32_bf16 v[120:123], a[68:71], a[24:27], v[120:123]
    v_mfma_f32_16x16x32_bf16 v[124:127], a[68:71], a[28:31], v[124:127]
    s_waitcnt lgkmcnt(4)
    v_mfma_f32_16x16x32_bf16 v[128:131], a[72:75], a[0:3], v[128:131]
    ds_read_b64_tr_b16 a[64:65], v16 offset:13472
    v_mfma_f32_16x16x32_bf16 v[132:135], a[72:75], a[4:7], v[132:135]
    ds_read_b64_tr_b16 a[66:67], v16 offset:15264
    v_mfma_f32_16x16x32_bf16 v[136:139], a[72:75], a[8:11], v[136:139]
    ds_read_b64_tr_b16 a[68:69], v16 offset:13504
    v_mfma_f32_16x16x32_bf16 v[140:143], a[72:75], a[12:15], v[140:143]
    ds_read_b64_tr_b16 a[70:71], v16 offset:15296
    v_mfma_f32_16x16x32_bf16 v[144:147], a[72:75], a[16:19], v[144:147]
    v_mfma_f32_16x16x32_bf16 v[148:151], a[72:75], a[20:23], v[148:151]
    v_mfma_f32_16x16x32_bf16 v[152:155], a[72:75], a[24:27], v[152:155]
    v_mfma_f32_16x16x32_bf16 v[156:159], a[72:75], a[28:31], v[156:159]
    s_waitcnt lgkmcnt(5)
    v_mfma_f32_16x16x32_bf16 v[160:163], a[76:79], a[0:3], v[160:163]
    v_mfma_f32_16x16x32_bf16 v[164:167], a[76:79], a[4:7], v[164:167]
    v_mfma_f32_16x16x32_bf16 v[168:171], a[76:79], a[8:11], v[168:171]
    v_mfma_f32_16x16x32_bf16 v[172:175], a[76:79], a[12:15], v[172:175]
    v_mfma_f32_16x16x32_bf16 v[176:179], a[76:79], a[16:19], v[176:179]
    v_mfma_f32_16x16x32_bf16 v[180:183], a[76:79], a[20:23], v[180:183]
    v_mfma_f32_16x16x32_bf16 v[184:187], a[76:79], a[24:27], v[184:187]
    v_mfma_f32_16x16x32_bf16 v[188:191], a[76:79], a[28:31], v[188:191]
    s_waitcnt vmcnt(5) lgkmcnt(0)
    s_barrier
    v_mfma_f32_16x16x32_bf16 v[192:195], a[64:67], a[0:3], v[192:195]
    ds_read_b64_tr_b16 a[72:73], v18 offset:20480
    v_mfma_f32_16x16x32_bf16 v[196:199], a[64:67], a[4:7], v[196:199]
    s_add_u32 m0, s29, 0
    ds_read_b64_tr_b16 a[74:75], v18 offset:22016
    v_mfma_f32_16x16x32_bf16 v[200:203], a[64:67], a[8:11], v[200:203]
    buffer_load_dwordx4 v9, s[12:15], s25 offen offset:0 lds
    v_mfma_f32_16x16x32_bf16 v[204:207], a[64:67], a[12:15], v[204:207]
    buffer_load_dwordx4 v10, s[12:15], s25 offen offset:1024 lds
    v_mfma_f32_16x16x32_bf16 v[208:211], a[64:67], a[16:19], v[208:211]
    v_mfma_f32_16x16x32_bf16 v[212:215], a[64:67], a[20:23], v[212:215]
    v_mfma_f32_16x16x32_bf16 v[216:219], a[64:67], a[24:27], v[216:219]
    v_mfma_f32_16x16x32_bf16 v[220:223], a[64:67], a[28:31], v[220:223]
    v_mfma_f32_16x16x32_bf16 v[224:227], a[68:71], a[0:3], v[224:227]
    ds_read_b64_tr_b16 a[76:77], v20 offset:20512
    v_mfma_f32_16x16x32_bf16 v[228:231], a[68:71], a[4:7], v[228:231]
    ds_read_b64_tr_b16 a[78:79], v20 offset:22048
    v_mfma_f32_16x16x32_bf16 v[232:235], a[68:71], a[8:11], v[232:235]
    buffer_load_dwordx4 v11, s[12:15], s25 offen offset:2048 lds
    v_mfma_f32_16x16x32_bf16 v[236:239], a[68:71], a[12:15], v[236:239]
    buffer_load_dwordx4 v12, s[12:15], s25 offen offset:3072 lds
    v_mfma_f32_16x16x32_bf16 v[240:243], a[68:71], a[16:19], v[240:243]
    v_mfma_f32_16x16x32_bf16 v[244:247], a[68:71], a[20:23], v[244:247]
    v_mfma_f32_16x16x32_bf16 v[248:251], a[68:71], a[24:27], v[248:251]
    v_mfma_f32_16x16x32_bf16 v[252:255], a[68:71], a[28:31], v[252:255]
    s_waitcnt lgkmcnt(2)
    v_mfma_f32_16x16x32_bf16 a[80:83], a[72:75], a[32:35], a[80:83]
    ds_read_b64_tr_b16 a[64:65], v18 offset:20544
    v_mfma_f32_16x16x32_bf16 a[84:87], a[72:75], a[36:39], a[84:87]
    ds_read_b64_tr_b16 a[66:67], v18 offset:22080
    v_mfma_f32_16x16x32_bf16 a[88:91], a[72:75], a[40:43], a[88:91]
    ds_read_b128 a[0:3], v14 offset:32768
    v_mfma_f32_16x16x32_bf16 a[92:95], a[72:75], a[44:47], a[92:95]
    s_add_u32 m0, s30, 0
    ds_read_b128 a[4:7], v14 offset:34816
    v_mfma_f32_16x16x32_bf16 a[96:99], a[72:75], a[48:51], a[96:99]
    buffer_load_dwordx4 v13, s[12:15], s25 offen offset:0 lds
    v_mfma_f32_16x16x32_bf16 a[100:103], a[72:75], a[52:55], a[100:103]
    s_add_u32 s25, s25, s27
    s_add_u32 m0, s31, 81920
    v_mfma_f32_16x16x32_bf16 a[104:107], a[72:75], a[56:59], a[104:107]
    buffer_load_dwordx4 v1, s[8:11], s24 offen offset:0 lds
    v_mfma_f32_16x16x32_bf16 a[108:111], a[72:75], a[60:63], a[108:111]
    s_waitcnt lgkmcnt(4)
    v_mfma_f32_16x16x32_bf16 a[112:115], a[76:79], a[32:35], a[112:115]
    ds_read_b64_tr_b16 a[68:69], v20 offset:20576
    v_mfma_f32_16x16x32_bf16 a[116:119], a[76:79], a[36:39], a[116:119]
    ds_read_b64_tr_b16 a[70:71], v20 offset:22112
    v_mfma_f32_16x16x32_bf16 a[120:123], a[76:79], a[40:43], a[120:123]
    ds_read_b128 a[8:11], v14 offset:36864
    v_mfma_f32_16x16x32_bf16 a[124:127], a[76:79], a[44:47], a[124:127]
    ds_read_b128 a[12:15], v14 offset:38912
    v_mfma_f32_16x16x32_bf16 a[128:131], a[76:79], a[48:51], a[128:131]
    buffer_load_dwordx4 v2, s[8:11], s24 offen offset:1024 lds
    v_mfma_f32_16x16x32_bf16 a[132:135], a[76:79], a[52:55], a[132:135]
    v_mfma_f32_16x16x32_bf16 a[136:139], a[76:79], a[56:59], a[136:139]
    v_mfma_f32_16x16x32_bf16 a[140:143], a[76:79], a[60:63], a[140:143]
    s_waitcnt lgkmcnt(6)
    v_mfma_f32_16x16x32_bf16 a[144:147], a[64:67], a[32:35], a[144:147]
    ds_read_b64_tr_b16 a[72:73], v16 offset:26752
    v_mfma_f32_16x16x32_bf16 a[148:151], a[64:67], a[36:39], a[148:151]
    ds_read_b64_tr_b16 a[74:75], v16 offset:28544
    v_mfma_f32_16x16x32_bf16 a[152:155], a[64:67], a[40:43], a[152:155]
    ds_read_b128 a[16:19], v14 offset:40960
    v_mfma_f32_16x16x32_bf16 a[156:159], a[64:67], a[44:47], a[156:159]
    buffer_load_dwordx4 v3, s[8:11], s24 offen offset:2048 lds
    v_mfma_f32_16x16x32_bf16 a[160:163], a[64:67], a[48:51], a[160:163]
    v_mfma_f32_16x16x32_bf16 a[164:167], a[64:67], a[52:55], a[164:167]
    v_mfma_f32_16x16x32_bf16 a[168:171], a[64:67], a[56:59], a[168:171]
    v_mfma_f32_16x16x32_bf16 a[172:175], a[64:67], a[60:63], a[172:175]
    s_waitcnt lgkmcnt(5)
    v_mfma_f32_16x16x32_bf16 a[176:179], a[68:71], a[32:35], a[176:179]
    ds_read_b64_tr_b16 a[76:77], v16 offset:26784
    v_mfma_f32_16x16x32_bf16 a[180:183], a[68:71], a[36:39], a[180:183]
    ds_read_b64_tr_b16 a[78:79], v16 offset:28576
    v_mfma_f32_16x16x32_bf16 a[184:187], a[68:71], a[40:43], a[184:187]
    ds_read_b128 a[20:23], v14 offset:43008
    v_mfma_f32_16x16x32_bf16 a[188:191], a[68:71], a[44:47], a[188:191]
    buffer_load_dwordx4 v4, s[8:11], s24 offen offset:3072 lds
    v_mfma_f32_16x16x32_bf16 a[192:195], a[68:71], a[48:51], a[192:195]
    v_mfma_f32_16x16x32_bf16 a[196:199], a[68:71], a[52:55], a[196:199]
    v_mfma_f32_16x16x32_bf16 a[200:203], a[68:71], a[56:59], a[200:203]
    v_mfma_f32_16x16x32_bf16 a[204:207], a[68:71], a[60:63], a[204:207]
    s_waitcnt lgkmcnt(4)
    v_mfma_f32_16x16x32_bf16 a[208:211], a[72:75], a[32:35], a[208:211]
    ds_read_b64_tr_b16 a[64:65], v16 offset:26816
    v_mfma_f32_16x16x32_bf16 a[212:215], a[72:75], a[36:39], a[212:215]
    ds_read_b64_tr_b16 a[66:67], v16 offset:28608
    v_mfma_f32_16x16x32_bf16 a[216:219], a[72:75], a[40:43], a[216:219]
    s_add_u32 m0, s31, 86016
    ds_read_b128 a[24:27], v14 offset:45056
    v_mfma_f32_16x16x32_bf16 a[220:223], a[72:75], a[44:47], a[220:223]
    buffer_load_dwordx4 v5, s[8:11], s24 offen offset:0 lds
    v_mfma_f32_16x16x32_bf16 a[224:227], a[72:75], a[48:51], a[224:227]
    v_mfma_f32_16x16x32_bf16 a[228:231], a[72:75], a[52:55], a[228:231]
    v_mfma_f32_16x16x32_bf16 a[232:235], a[72:75], a[56:59], a[232:235]
    v_mfma_f32_16x16x32_bf16 a[236:239], a[72:75], a[60:63], a[236:239]
    s_waitcnt lgkmcnt(4)
    v_mfma_f32_16x16x32_bf16 a[240:243], a[76:79], a[32:35], a[240:243]
    ds_read_b64_tr_b16 a[68:69], v16 offset:33920
    v_mfma_f32_16x16x32_bf16 a[244:247], a[76:79], a[36:39], a[244:247]
    ds_read_b64_tr_b16 a[70:71], v16 offset:35712
    v_mfma_f32_16x16x32_bf16 a[248:251], a[76:79], a[40:43], a[248:251]
    ds_read_b128 a[28:31], v14 offset:47104
    v_mfma_f32_16x16x32_bf16 a[252:255], a[76:79], a[44:47], a[252:255]
    buffer_load_dwordx4 v6, s[8:11], s24 offen offset:1024 lds
    v_mfma_f32_16x16x32_bf16 v[112:115], a[76:79], a[48:51], v[112:115]
    v_mfma_f32_16x16x32_bf16 v[116:119], a[76:79], a[52:55], v[116:119]
    v_mfma_f32_16x16x32_bf16 v[120:123], a[76:79], a[56:59], v[120:123]
    v_mfma_f32_16x16x32_bf16 v[124:127], a[76:79], a[60:63], v[124:127]
    s_waitcnt lgkmcnt(4)
    v_mfma_f32_16x16x32_bf16 v[128:131], a[64:67], a[32:35], v[128:131]
    ds_read_b64_tr_b16 a[72:73], v16 offset:33952
    v_mfma_f32_16x16x32_bf16 v[132:135], a[64:67], a[36:39], v[132:135]
    ds_read_b64_tr_b16 a[74:75], v16 offset:35744
    v_mfma_f32_16x16x32_bf16 v[136:139], a[64:67], a[40:43], v[136:139]
    ds_read_b64_tr_b16 a[76:77], v16 offset:33984
    v_mfma_f32_16x16x32_bf16 v[140:143], a[64:67], a[44:47], v[140:143]
    ds_read_b64_tr_b16 a[78:79], v16 offset:35776
    v_mfma_f32_16x16x32_bf16 v[144:147], a[64:67], a[48:51], v[144:147]
    buffer_load_dwordx4 v7, s[8:11], s24 offen offset:2048 lds
    v_mfma_f32_16x16x32_bf16 v[148:151], a[64:67], a[52:55], v[148:151]
    v_mfma_f32_16x16x32_bf16 v[152:155], a[64:67], a[56:59], v[152:155]
    v_mfma_f32_16x16x32_bf16 v[156:159], a[64:67], a[60:63], v[156:159]
    s_waitcnt lgkmcnt(5)
    v_mfma_f32_16x16x32_bf16 v[160:163], a[68:71], a[32:35], v[160:163]
    v_mfma_f32_16x16x32_bf16 v[164:167], a[68:71], a[36:39], v[164:167]
    v_mfma_f32_16x16x32_bf16 v[168:171], a[68:71], a[40:43], v[168:171]
    buffer_load_dwordx4 v8, s[8:11], s24 offen offset:3072 lds
    v_mfma_f32_16x16x32_bf16 v[172:175], a[68:71], a[44:47], v[172:175]
    s_add_u32 s24, s24, 128
    v_mfma_f32_16x16x32_bf16 v[176:179], a[68:71], a[48:51], v[176:179]
    v_mfma_f32_16x16x32_bf16 v[180:183], a[68:71], a[52:55], v[180:183]
    v_mfma_f32_16x16x32_bf16 v[184:187], a[68:71], a[56:59], v[184:187]
    v_mfma_f32_16x16x32_bf16 v[188:191], a[68:71], a[60:63], v[188:191]
    s_waitcnt vmcnt(25) lgkmcnt(0)
    s_barrier
    v_mfma_f32_16x16x32_bf16 v[192:195], a[72:75], a[32:35], v[192:195]
    ds_read_b64_tr_b16 a[64:65], v19 offset:0
    v_mfma_f32_16x16x32_bf16 v[196:199], a[72:75], a[36:39], v[196:199]
    s_add_u32 m0, s29, 20480
    ds_read_b64_tr_b16 a[66:67], v19 offset:1536
    v_mfma_f32_16x16x32_bf16 v[200:203], a[72:75], a[40:43], v[200:203]
    buffer_load_dwordx4 v9, s[12:15], s25 offen offset:0 lds
    v_mfma_f32_16x16x32_bf16 v[204:207], a[72:75], a[44:47], v[204:207]
    v_mfma_f32_16x16x32_bf16 v[208:211], a[72:75], a[48:51], v[208:211]
    v_mfma_f32_16x16x32_bf16 v[212:215], a[72:75], a[52:55], v[212:215]
    v_mfma_f32_16x16x32_bf16 v[216:219], a[72:75], a[56:59], v[216:219]
    v_mfma_f32_16x16x32_bf16 v[220:223], a[72:75], a[60:63], v[220:223]
    v_mfma_f32_16x16x32_bf16 v[224:227], a[76:79], a[32:35], v[224:227]
    ds_read_b64_tr_b16 a[68:69], v21 offset:32
    v_mfma_f32_16x16x32_bf16 v[228:231], a[76:79], a[36:39], v[228:231]
    ds_read_b64_tr_b16 a[70:71], v21 offset:1568
    v_mfma_f32_16x16x32_bf16 v[232:235], a[76:79], a[40:43], v[232:235]
    buffer_load_dwordx4 v10, s[12:15], s25 offen offset:1024 lds
    v_mfma_f32_16x16x32_bf16 v[236:239], a[76:79], a[44:47], v[236:239]
    v_mfma_f32_16x16x32_bf16 v[240:243], a[76:79], a[48:51], v[240:243]
    v_mfma_f32_16x16x32_bf16 v[244:247], a[76:79], a[52:55], v[244:247]
    v_mfma_f32_16x16x32_bf16 v[248:251], a[76:79], a[56:59], v[248:251]
    v_mfma_f32_16x16x32_bf16 v[252:255], a[76:79], a[60:63], v[252:255]
    s_waitcnt lgkmcnt(2)
    v_mfma_f32_16x16x32_bf16 a[80:83], a[64:67], a[0:3], a[80:83]
    ds_read_b64_tr_b16 a[72:73], v19 offset:64
    v_mfma_f32_16x16x32_bf16 a[84:87], a[64:67], a[4:7], a[84:87]
    ds_read_b64_tr_b16 a[74:75], v19 offset:1600
    v_mfma_f32_16x16x32_bf16 a[88:91], a[64:67], a[8:11], a[88:91]
    ds_read_b128 a[32:35], v15 offset:32768
    v_mfma_f32_16x16x32_bf16 a[92:95], a[64:67], a[12:15], a[92:95]
    ds_read_b128 a[36:39], v15 offset:34816
    v_mfma_f32_16x16x32_bf16 a[96:99], a[64:67], a[16:19], a[96:99]
    buffer_load_dwordx4 v11, s[12:15], s25 offen offset:2048 lds
    v_mfma_f32_16x16x32_bf16 a[100:103], a[64:67], a[20:23], a[100:103]
    v_mfma_f32_16x16x32_bf16 a[104:107], a[64:67], a[24:27], a[104:107]
    v_mfma_f32_16x16x32_bf16 a[108:111], a[64:67], a[28:31], a[108:111]
    s_waitcnt lgkmcnt(4)
    v_mfma_f32_16x16x32_bf16 a[112:115], a[68:71], a[0:3], a[112:115]
    ds_read_b64_tr_b16 a[76:77], v21 offset:96
    v_mfma_f32_16x16x32_bf16 a[116:119], a[68:71], a[4:7], a[116:119]
    ds_read_b64_tr_b16 a[78:79], v21 offset:1632
    v_mfma_f32_16x16x32_bf16 a[120:123], a[68:71], a[8:11], a[120:123]
    ds_read_b128 a[40:43], v15 offset:36864
    v_mfma_f32_16x16x32_bf16 a[124:127], a[68:71], a[12:15], a[124:127]
    ds_read_b128 a[44:47], v15 offset:38912
    v_mfma_f32_16x16x32_bf16 a[128:131], a[68:71], a[16:19], a[128:131]
    buffer_load_dwordx4 v12, s[12:15], s25 offen offset:3072 lds
    v_mfma_f32_16x16x32_bf16 a[132:135], a[68:71], a[20:23], a[132:135]
    v_mfma_f32_16x16x32_bf16 a[136:139], a[68:71], a[24:27], a[136:139]
    v_mfma_f32_16x16x32_bf16 a[140:143], a[68:71], a[28:31], a[140:143]
    s_waitcnt lgkmcnt(6)
    v_mfma_f32_16x16x32_bf16 a[144:147], a[72:75], a[0:3], a[144:147]
    ds_read_b64_tr_b16 a[64:65], v17 offset:6272
    v_mfma_f32_16x16x32_bf16 a[148:151], a[72:75], a[4:7], a[148:151]
    ds_read_b64_tr_b16 a[66:67], v17 offset:8064
    v_mfma_f32_16x16x32_bf16 a[152:155], a[72:75], a[8:11], a[152:155]
    s_add_u32 m0, s30, 20480
    ds_read_b128 a[48:51], v15 offset:40960
    v_mfma_f32_16x16x32_bf16 a[156:159], a[72:75], a[12:15], a[156:159]
    buffer_load_dwordx4 v13, s[12:15], s25 offen offset:0 lds
    v_mfma_f32_16x16x32_bf16 a[160:163], a[72:75], a[16:19], a[160:163]
    s_add_u32 s25, s25, s27
    v_mfma_f32_16x16x32_bf16 a[164:167], a[72:75], a[20:23], a[164:167]
    v_mfma_f32_16x16x32_bf16 a[168:171], a[72:75], a[24:27], a[168:171]
    v_mfma_f32_16x16x32_bf16 a[172:175], a[72:75], a[28:31], a[172:175]
    s_waitcnt lgkmcnt(5)
    v_mfma_f32_16x16x32_bf16 a[176:179], a[76:79], a[0:3], a[176:179]
    ds_read_b64_tr_b16 a[68:69], v17 offset:6304
    v_mfma_f32_16x16x32_bf16 a[180:183], a[76:79], a[4:7], a[180:183]
    ds_read_b64_tr_b16 a[70:71], v17 offset:8096
    v_mfma_f32_16x16x32_bf16 a[184:187], a[76:79], a[8:11], a[184:187]
    ds_read_b128 a[52:55], v15 offset:43008
    v_mfma_f32_16x16x32_bf16 a[188:191], a[76:79], a[12:15], a[188:191]
    v_mfma_f32_16x16x32_bf16 a[192:195], a[76:79], a[16:19], a[192:195]
    v_mfma_f32_16x16x32_bf16 a[196:199], a[76:79], a[20:23], a[196:199]
    v_mfma_f32_16x16x32_bf16 a[200:203], a[76:79], a[24:27], a[200:203]
    v_mfma_f32_16x16x32_bf16 a[204:207], a[76:79], a[28:31], a[204:207]
    s_waitcnt lgkmcnt(4)
    v_mfma_f32_16x16x32_bf16 a[208:211], a[64:67], a[0:3], a[208:211]
    ds_read_b64_tr_b16 a[72:73], v17 offset:6336
    v_mfma_f32_16x16x32_bf16 a[212:215], a[64:67], a[4:7], a[212:215]
    ds_read_b64_tr_b16 a[74:75], v17 offset:8128
    v_mfma_f32_16x16x32_bf16 a[216:219], a[64:67], a[8:11], a[216:219]
    ds_read_b128 a[56:59], v15 offset:45056
    v_mfma_f32_16x16x32_bf16 a[220:223], a[64:67], a[12:15], a[220:223]
    v_mfma_f32_16x16x32_bf16 a[224:227], a[64:67], a[16:19], a[224:227]
    v_mfma_f32_16x16x32_bf16 a[228:231], a[64:67], a[20:23], a[228:231]
    v_mfma_f32_16x16x32_bf16 a[232:235], a[64:67], a[24:27], a[232:235]
    v_mfma_f32_16x16x32_bf16 a[236:239], a[64:67], a[28:31], a[236:239]
    s_waitcnt lgkmcnt(4)
    v_mfma_f32_16x16x32_bf16 a[240:243], a[68:71], a[0:3], a[240:243]
    ds_read_b64_tr_b16 a[76:77], v17 offset:13440
    v_mfma_f32_16x16x32_bf16 a[244:247], a[68:71], a[4:7], a[244:247]
    ds_read_b64_tr_b16 a[78:79], v17 offset:15232
    v_mfma_f32_16x16x32_bf16 a[248:251], a[68:71], a[8:11], a[248:251]
    ds_read_b128 a[60:63], v15 offset:47104
    v_mfma_f32_16x16x32_bf16 a[252:255], a[68:71], a[12:15], a[252:255]
    v_mfma_f32_16x16x32_bf16 v[112:115], a[68:71], a[16:19], v[112:115]
    v_mfma_f32_16x16x32_bf16 v[116:119], a[68:71], a[20:23], v[116:119]
    v_mfma_f32_16x16x32_bf16 v[120:123], a[68:71], a[24:27], v[120:123]
    v_mfma_f32_16x16x32_bf16 v[124:127], a[68:71], a[28:31], v[124:127]
    s_waitcnt lgkmcnt(4)
    v_mfma_f32_16x16x32_bf16 v[128:131], a[72:75], a[0:3], v[128:131]
    ds_read_b64_tr_b16 a[64:65], v17 offset:13472
    v_mfma_f32_16x16x32_bf16 v[132:135], a[72:75], a[4:7], v[132:135]
    ds_read_b64_tr_b16 a[66:67], v17 offset:15264
    v_mfma_f32_16x16x32_bf16 v[136:139], a[72:75], a[8:11], v[136:139]
    ds_read_b64_tr_b16 a[68:69], v17 offset:13504
    v_mfma_f32_16x16x32_bf16 v[140:143], a[72:75], a[12:15], v[140:143]
    ds_read_b64_tr_b16 a[70:71], v17 offset:15296
    v_mfma_f32_16x16x32_bf16 v[144:147], a[72:75], a[16:19], v[144:147]
    v_mfma_f32_16x16x32_bf16 v[148:151], a[72:75], a[20:23], v[148:151]
    v_mfma_f32_16x16x32_bf16 v[152:155], a[72:75], a[24:27], v[152:155]
    v_mfma_f32_16x16x32_bf16 v[156:159], a[72:75], a[28:31], v[156:159]
    s_waitcnt lgkmcnt(5)
    v_mfma_f32_16x16x32_bf16 v[160:163], a[76:79], a[0:3], v[160:163]
    v_mfma_f32_16x16x32_bf16 v[164:167], a[76:79], a[4:7], v[164:167]
    v_mfma_f32_16x16x32_bf16 v[168:171], a[76:79], a[8:11], v[168:171]
    v_mfma_f32_16x16x32_bf16 v[172:175], a[76:79], a[12:15], v[172:175]
    v_mfma_f32_16x16x32_bf16 v[176:179], a[76:79], a[16:19], v[176:179]
    v_mfma_f32_16x16x32_bf16 v[180:183], a[76:79], a[20:23], v[180:183]
    v_mfma_f32_16x16x32_bf16 v[184:187], a[76:79], a[24:27], v[184:187]
    v_mfma_f32_16x16x32_bf16 v[188:191], a[76:79], a[28:31], v[188:191]
    s_waitcnt vmcnt(5) lgkmcnt(0)
    s_barrier
    v_mfma_f32_16x16x32_bf16 v[192:195], a[64:67], a[0:3], v[192:195]
    ds_read_b64_tr_b16 a[72:73], v19 offset:20480
    v_mfma_f32_16x16x32_bf16 v[196:199], a[64:67], a[4:7], v[196:199]
    s_add_u32 m0, s29, 40960
    ds_read_b64_tr_b16 a[74:75], v19 offset:22016
    v_mfma_f32_16x16x32_bf16 v[200:203], a[64:67], a[8:11], v[200:203]
    buffer_load_dwordx4 v9, s[12:15], s25 offen offset:0 lds
    v_mfma_f32_16x16x32_bf16 v[204:207], a[64:67], a[12:15], v[204:207]
    buffer_load_dwordx4 v10, s[12:15], s25 offen offset:1024 lds
    v_mfma_f32_16x16x32_bf16 v[208:211], a[64:67], a[16:19], v[208:211]
    v_mfma_f32_16x16x32_bf16 v[212:215], a[64:67], a[20:23], v[212:215]
    v_mfma_f32_16x16x32_bf16 v[216:219], a[64:67], a[24:27], v[216:219]
    v_mfma_f32_16x16x32_bf16 v[220:223], a[64:67], a[28:31], v[220:223]
    v_mfma_f32_16x16x32_bf16 v[224:227], a[68:71], a[0:3], v[224:227]
    ds_read_b64_tr_b16 a[76:77], v21 offset:20512
    v_mfma_f32_16x16x32_bf16 v[228:231], a[68:71], a[4:7], v[228:231]
    ds_read_b64_tr_b16 a[78:79], v21 offset:22048
    v_mfma_f32_16x16x32_bf16 v[232:235], a[68:71], a[8:11], v[232:235]
    buffer_load_dwordx4 v11, s[12:15], s25 offen offset:2048 lds
    v_mfma_f32_16x16x32_bf16 v[236:239], a[68:71], a[12:15], v[236:239]
    buffer_load_dwordx4 v12, s[12:15], s25 offen offset:3072 lds
    v_mfma_f32_16x16x32_bf16 v[240:243], a[68:71], a[16:19], v[240:243]
    v_mfma_f32_16x16x32_bf16 v[244:247], a[68:71], a[20:23], v[244:247]
    v_mfma_f32_16x16x32_bf16 v[248:251], a[68:71], a[24:27], v[248:251]
    v_mfma_f32_16x16x32_bf16 v[252:255], a[68:71], a[28:31], v[252:255]
    s_waitcnt lgkmcnt(2)
    v_mfma_f32_16x16x32_bf16 a[80:83], a[72:75], a[32:35], a[80:83]
    ds_read_b64_tr_b16 a[64:65], v19 offset:20544
    v_mfma_f32_16x16x32_bf16 a[84:87], a[72:75], a[36:39], a[84:87]
    ds_read_b64_tr_b16 a[66:67], v19 offset:22080
    v_mfma_f32_16x16x32_bf16 a[88:91], a[72:75], a[40:43], a[88:91]
    ds_read_b128 a[0:3], v14 offset:0
    v_mfma_f32_16x16x32_bf16 a[92:95], a[72:75], a[44:47], a[92:95]
    s_add_u32 m0, s30, 40960
    ds_read_b128 a[4:7], v14 offset:2048
    v_mfma_f32_16x16x32_bf16 a[96:99], a[72:75], a[48:51], a[96:99]
    buffer_load_dwordx4 v13, s[12:15], s25 offen offset:0 lds
    v_mfma_f32_16x16x32_bf16 a[100:103], a[72:75], a[52:55], a[100:103]
    s_add_u32 s25, s25, s27
    s_add_u32 m0, s31, 114688
    v_mfma_f32_16x16x32_bf16 a[104:107], a[72:75], a[56:59], a[104:107]
    buffer_load_dwordx4 v1, s[8:11], s24 offen offset:0 lds
    v_mfma_f32_16x16x32_bf16 a[108:111], a[72:75], a[60:63], a[108:111]
    s_waitcnt lgkmcnt(4)
    v_mfma_f32_16x16x32_bf16 a[112:115], a[76:79], a[32:35], a[112:115]
    ds_read_b64_tr_b16 a[68:69], v21 offset:20576
    v_mfma_f32_16x16x32_bf16 a[116:119], a[76:79], a[36:39], a[116:119]
    ds_read_b64_tr_b16 a[70:71], v21 offset:22112
    v_mfma_f32_16x16x32_bf16 a[120:123], a[76:79], a[40:43], a[120:123]
    ds_read_b128 a[8:11], v14 offset:4096
    v_mfma_f32_16x16x32_bf16 a[124:127], a[76:79], a[44:47], a[124:127]
    ds_read_b128 a[12:15], v14 offset:6144
    v_mfma_f32_16x16x32_bf16 a[128:131], a[76:79], a[48:51], a[128:131]
    buffer_load_dwordx4 v2, s[8:11], s24 offen offset:1024 lds
    v_mfma_f32_16x16x32_bf16 a[132:135], a[76:79], a[52:55], a[132:135]
    v_mfma_f32_16x16x32_bf16 a[136:139], a[76:79], a[56:59], a[136:139]
    v_mfma_f32_16x16x32_bf16 a[140:143], a[76:79], a[60:63], a[140:143]
    s_waitcnt lgkmcnt(6)
    v_mfma_f32_16x16x32_bf16 a[144:147], a[64:67], a[32:35], a[144:147]
    ds_read_b64_tr_b16 a[72:73], v17 offset:26752
    v_mfma_f32_16x16x32_bf16 a[148:151], a[64:67], a[36:39], a[148:151]
    ds_read_b64_tr_b16 a[74:75], v17 offset:28544
    v_mfma_f32_16x16x32_bf16 a[152:155], a[64:67], a[40:43], a[152:155]
    ds_read_b128 a[16:19], v14 offset:8192
    v_mfma_f32_16x16x32_bf16 a[156:159], a[64:67], a[44:47], a[156:159]
    buffer_load_dwordx4 v3, s[8:11], s24 offen offset:2048 lds
    v_mfma_f32_16x16x32_bf16 a[160:163], a[64:67], a[48:51], a[160:163]
    v_mfma_f32_16x16x32_bf16 a[164:167], a[64:67], a[52:55], a[164:167]
    v_mfma_f32_16x16x32_bf16 a[168:171], a[64:67], a[56:59], a[168:171]
    v_mfma_f32_16x16x32_bf16 a[172:175], a[64:67], a[60:63], a[172:175]
    s_waitcnt lgkmcnt(5)
    v_mfma_f32_16x16x32_bf16 a[176:179], a[68:71], a[32:35], a[176:179]
    ds_read_b64_tr_b16 a[76:77], v17 offset:26784
    v_mfma_f32_16x16x32_bf16 a[180:183], a[68:71], a[36:39], a[180:183]
    ds_read_b64_tr_b16 a[78:79], v17 offset:28576
    v_mfma_f32_16x16x32_bf16 a[184:187], a[68:71], a[40:43], a[184:187]
    ds_read_b128 a[20:23], v14 offset:10240
    v_mfma_f32_16x16x32_bf16 a[188:191], a[68:71], a[44:47], a[188:191]
    buffer_load_dwordx4 v4, s[8:11], s24 offen offset:3072 lds
    v_mfma_f32_16x16x32_bf16 a[192:195], a[68:71], a[48:51], a[192:195]
    v_mfma_f32_16x16x32_bf16 a[196:199], a[68:71], a[52:55], a[196:199]
    v_mfma_f32_16x16x32_bf16 a[200:203], a[68:71], a[56:59], a[200:203]
    v_mfma_f32_16x16x32_bf16 a[204:207], a[68:71], a[60:63], a[204:207]
    s_waitcnt lgkmcnt(4)
    v_mfma_f32_16x16x32_bf16 a[208:211], a[72:75], a[32:35], a[208:211]
    ds_read_b64_tr_b16 a[64:65], v17 offset:26816
    v_mfma_f32_16x16x32_bf16 a[212:215], a[72:75], a[36:39], a[212:215]
    ds_read_b64_tr_b16 a[66:67], v17 offset:28608
    v_mfma_f32_16x16x32_bf16 a[216:219], a[72:75], a[40:43], a[216:219]
    s_add_u32 m0, s31, 118784
    ds_read_b128 a[24:27], v14 offset:12288
    v_mfma_f32_16x16x32_bf16 a[220:223], a[72:75], a[44:47], a[220:223]
    buffer_load_dwordx4 v5, s[8:11], s24 offen offset:0 lds
    v_mfma_f32_16x16x32_bf16 a[224:227], a[72:75], a[48:51], a[224:227]
    v_mfma_f32_16x16x32_bf16 a[228:231], a[72:75], a[52:55], a[228:231]
    v_mfma_f32_16x16x32_bf16 a[232:235], a[72:75], a[56:59], a[232:235]
    v_mfma_f32_16x16x32_bf16 a[236:239], a[72:75], a[60:63], a[236:239]
    s_waitcnt lgkmcnt(4)
    v_mfma_f32_16x16x32_bf16 a[240:243], a[76:79], a[32:35], a[240:243]
    ds_read_b64_tr_b16 a[68:69], v17 offset:33920
    v_mfma_f32_16x16x32_bf16 a[244:247], a[76:79], a[36:39], a[244:247]
    ds_read_b64_tr_b16 a[70:71], v17 offset:35712
    v_mfma_f32_16x16x32_bf16 a[248:251], a[76:79], a[40:43], a[248:251]
    ds_read_b128 a[28:31], v14 offset:14336
    v_mfma_f32_16x16x32_bf16 a[252:255], a[76:79], a[44:47], a[252:255]
    buffer_load_dwordx4 v6, s[8:11], s24 offen offset:1024 lds
    v_mfma_f32_16x16x32_bf16 v[112:115], a[76:79], a[48:51], v[112:115]
    v_mfma_f32_16x16x32_bf16 v[116:119], a[76:79], a[52:55], v[116:119]
    v_mfma_f32_16x16x32_bf16 v[120:123], a[76:79], a[56:59], v[120:123]
    v_mfma_f32_16x16x32_bf16 v[124:127], a[76:79], a[60:63], v[124:127]
    s_waitcnt lgkmcnt(4)
    v_mfma_f32_16x16x32_bf16 v[128:131], a[64:67], a[32:35], v[128:131]
    ds_read_b64_tr_b16 a[72:73], v17 offset:33952
    v_mfma_f32_16x16x32_bf16 v[132:135], a[64:67], a[36:39], v[132:135]
    ds_read_b64_tr_b16 a[74:75], v17 offset:35744
    v_mfma_f32_16x16x32_bf16 v[136:139], a[64:67], a[40:43], v[136:139]
    ds_read_b64_tr_b16 a[76:77], v17 offset:33984
    v_mfma_f32_16x16x32_bf16 v[140:143], a[64:67], a[44:47], v[140:143]
    ds_read_b64_tr_b16 a[78:79], v17 offset:35776
    v_mfma_f32_16x16x32_bf16 v[144:147], a[64:67], a[48:51], v[144:147]
    buffer_load_dwordx4 v7, s[8:11], s24 offen offset:2048 lds
    v_mfma_f32_16x16x32_bf16 v[148:151], a[64:67], a[52:55], v[148:151]
    v_mfma_f32_16x16x32_bf16 v[152:155], a[64:67], a[56:59], v[152:155]
    v_mfma_f32_16x16x32_bf16 v[156:159], a[64:67], a[60:63], v[156:159]
    s_waitcnt lgkmcnt(5)
    v_mfma_f32_16x16x32_bf16 v[160:163], a[68:71], a[32:35], v[160:163]
    v_mfma_f32_16x16x32_bf16 v[164:167], a[68:71], a[36:39], v[164:167]
    v_mfma_f32_16x16x32_bf16 v[168:171], a[68:71], a[40:43], v[168:171]
    buffer_load_dwordx4 v8, s[8:11], s24 offen offset:3072 lds
    v_mfma_f32_16x16x32_bf16 v[172:175], a[68:71], a[44:47], v[172:175]
    s_lshr_b32 s98, s98, 4
    s_and_b32 s24, s98, 7
    s_lshl_b32 s24, s24, 8
    v_mfma_f32_16x16x32_bf16 v[176:179], a[68:71], a[48:51], v[176:179]
    v_mfma_f32_16x16x32_bf16 v[180:183], a[68:71], a[52:55], v[180:183]
    v_mfma_f32_16x16x32_bf16 v[184:187], a[68:71], a[56:59], v[184:187]
    v_mfma_f32_16x16x32_bf16 v[188:191], a[68:71], a[60:63], v[188:191]
    s_waitcnt lgkmcnt(0)
    s_barrier
    v_mfma_f32_16x16x32_bf16 v[192:195], a[72:75], a[32:35], v[192:195]
    ds_read_b64_tr_b16 a[64:65], v18 offset:0
    v_mfma_f32_16x16x32_bf16 v[196:199], a[72:75], a[36:39], v[196:199]
    s_add_u32 m0, s29, 61440
    ds_read_b64_tr_b16 a[66:67], v18 offset:1536
    v_mfma_f32_16x16x32_bf16 v[200:203], a[72:75], a[40:43], v[200:203]
    buffer_load_dwordx4 v9, s[12:15], s25 offen offset:0 lds
    v_mfma_f32_16x16x32_bf16 v[204:207], a[72:75], a[44:47], v[204:207]
    v_mfma_f32_16x16x32_bf16 v[208:211], a[72:75], a[48:51], v[208:211]
    v_mfma_f32_16x16x32_bf16 v[212:215], a[72:75], a[52:55], v[212:215]
    v_mfma_f32_16x16x32_bf16 v[216:219], a[72:75], a[56:59], v[216:219]
    v_mfma_f32_16x16x32_bf16 v[220:223], a[72:75], a[60:63], v[220:223]
    v_mfma_f32_16x16x32_bf16 v[224:227], a[76:79], a[32:35], v[224:227]
    ds_read_b64_tr_b16 a[68:69], v20 offset:32
    v_mfma_f32_16x16x32_bf16 v[228:231], a[76:79], a[36:39], v[228:231]
    ds_read_b64_tr_b16 a[70:71], v20 offset:1568
    v_mfma_f32_16x16x32_bf16 v[232:235], a[76:79], a[40:43], v[232:235]
    buffer_load_dwordx4 v10, s[12:15], s25 offen offset:1024 lds
    v_mfma_f32_16x16x32_bf16 v[236:239], a[76:79], a[44:47], v[236:239]
    v_mfma_f32_16x16x32_bf16 v[240:243], a[76:79], a[48:51], v[240:243]
    v_mfma_f32_16x16x32_bf16 v[244:247], a[76:79], a[52:55], v[244:247]
    v_mfma_f32_16x16x32_bf16 v[248:251], a[76:79], a[56:59], v[248:251]
    v_mfma_f32_16x16x32_bf16 v[252:255], a[76:79], a[60:63], v[252:255]
L_k2_w1_after:
    s_cmp_eq_u32 s32, s78
    s_cbranch_scc1 L_k2_w1_a1
L_k2_w1_b1:
    s_cmp_eq_u32 s32, s99
    s_cbranch_scc1 L_k2_w1_a2
L_k2_w1_b2:
    s_cmp_eq_u32 s32, 0
    s_cbranch_scc1 L_k2_w1_s0
L_k2_w1_bs0:
    s_cmp_ge_u32 s32, 3
    s_cbranch_scc1 L_k2_w1_c
L_k2_w1_bc:
    s_cmp_eq_u32 s32, 5
    s_cbranch_scc1 L_k2_w1_a3
L_k2_w1_b3:
    s_cmp_eq_u32 s32, 6
    s_cbranch_scc1 L_k2_w1_a36
L_k2_w1_b4:
    s_add_u32 s32, s32, 1
    s_cmp_lt_u32 s32, 7
    s_cbranch_scc1 L_k2_w1_top
    s_waitcnt lgkmcnt(2)
    v_mfma_f32_16x16x32_bf16 a[80:83], a[64:67], a[0:3], a[80:83]
    ds_read_b64_tr_b16 a[72:73], v18 offset:64
    v_mfma_f32_16x16x32_bf16 a[84:87], a[64:67], a[4:7], a[84:87]
    ds_read_b64_tr_b16 a[74:75], v18 offset:1600
    v_mfma_f32_16x16x32_bf16 a[88:91], a[64:67], a[8:11], a[88:91]
    ds_read_b128 a[32:35], v15 offset:0
    v_mfma_f32_16x16x32_bf16 a[92:95], a[64:67], a[12:15], a[92:95]
    ds_read_b128 a[36:39], v15 offset:2048
    v_mfma_f32_16x16x32_bf16 a[96:99], a[64:67], a[16:19], a[96:99]
    buffer_load_dwordx4 v11, s[12:15], s25 offen offset:2048 lds
    v_mfma_f32_16x16x32_bf16 a[100:103], a[64:67], a[20:23], a[100:103]
    v_mfma_f32_16x16x32_bf16 a[104:107], a[64:67], a[24:27], a[104:107]
    v_mfma_f32_16x16x32_bf16 a[108:111], a[64:67], a[28:31], a[108:111]
    s_waitcnt lgkmcnt(4)
    v_mfma_f32_16x16x32_bf16 a[112:115], a[68:71], a[0:3], a[112:115]
    ds_read_b64_tr_b16 a[76:77], v20 offset:96
    v_mfma_f32_16x16x32_bf16 a[116:119], a[68:71], a[4:7], a[116:119]
    ds_read_b64_tr_b16 a[78:79], v20 offset:1632
    v_mfma_f32_16x16x32_bf16 a[120:123], a[68:71], a[8:11], a[120:123]
    ds_read_b128 a[40:43], v15 offset:4096
    v_mfma_f32_16x16x32_bf16 a[124:127], a[68:71], a[12:15], a[124:127]
    ds_read_b128 a[44:47], v15 offset:6144
    v_mfma_f32_16x16x32_bf16 a[128:131], a[68:71], a[16:19], a[128:131]
    buffer_load_dwordx4 v12, s[12:15], s25 offen offset:3072 lds
    v_mfma_f32_16x16x32_bf16 a[132:135], a[68:71], a[20:23], a[132:135]
    v_mfma_f32_16x16x32_bf16 a[136:139], a[68:71], a[24:27], a[136:139]
    v_mfma_f32_16x16x32_bf16 a[140:143], a[68:71], a[28:31], a[140:143]
    s_waitcnt lgkmcnt(6)
    v_mfma_f32_16x16x32_bf16 a[144:147], a[72:75], a[0:3], a[144:147]
    ds_read_b64_tr_b16 a[64:65], v16 offset:6272
    v_mfma_f32_16x16x32_bf16 a[148:151], a[72:75], a[4:7], a[148:151]
    ds_read_b64_tr_b16 a[66:67], v16 offset:8064
    v_mfma_f32_16x16x32_bf16 a[152:155], a[72:75], a[8:11], a[152:155]
    s_add_u32 m0, s30, 61440
    ds_read_b128 a[48:51], v15 offset:8192
    v_mfma_f32_16x16x32_bf16 a[156:159], a[72:75], a[12:15], a[156:159]
    buffer_load_dwordx4 v13, s[12:15], s25 offen offset:0 lds
    v_mfma_f32_16x16x32_bf16 a[160:163], a[72:75], a[16:19], a[160:163]
    s_lshr_b32 s97, s97, 4
    s_and_b32 s33, s97, 7
    s_lshl_b32 s33, s33, 2
    s_mul_i32 s25, s33, s27
    v_mfma_f32_16x16x32_bf16 a[164:167], a[72:75], a[20:23], a[164:167]
    v_mfma_f32_16x16x32_bf16 a[168:171], a[72:75], a[24:27], a[168:171]
    v_mfma_f32_16x16x32_bf16 a[172:175], a[72:75], a[28:31], a[172:175]
    s_waitcnt lgkmcnt(5)
    v_mfma_f32_16x16x32_bf16 a[176:179], a[76:79], a[0:3], a[176:179]
    ds_read_b64_tr_b16 a[68:69], v16 offset:6304
    v_mfma_f32_16x16x32_bf16 a[180:183], a[76:79], a[4:7], a[180:183]
    ds_read_b64_tr_b16 a[70:71], v16 offset:8096
    v_mfma_f32_16x16x32_bf16 a[184:187], a[76:79], a[8:11], a[184:187]
    ds_read_b128 a[52:55], v15 offset:10240
    v_mfma_f32_16x16x32_bf16 a[188:191], a[76:79], a[12:15], a[188:191]
    v_mfma_f32_16x16x32_bf16 a[192:195], a[76:79], a[16:19], a[192:195]
    v_mfma_f32_16x16x32_bf16 a[196:199], a[76:79], a[20:23], a[196:199]
    v_mfma_f32_16x16x32_bf16 a[200:203], a[76:79], a[24:27], a[200:203]
    v_mfma_f32_16x16x32_bf16 a[204:207], a[76:79], a[28:31], a[204:207]
    s_waitcnt lgkmcnt(4)
    v_mfma_f32_16x16x32_bf16 a[208:211], a[64:67], a[0:3], a[208:211]
    ds_read_b64_tr_b16 a[72:73], v16 offset:6336
    v_mfma_f32_16x16x32_bf16 a[212:215], a[64:67], a[4:7], a[212:215]
    ds_read_b64_tr_b16 a[74:75], v16 offset:8128
    v_mfma_f32_16x16x32_bf16 a[216:219], a[64:67], a[8:11], a[216:219]
    ds_read_b128 a[56:59], v15 offset:12288
    v_mfma_f32_16x16x32_bf16 a[220:223], a[64:67], a[12:15], a[220:223]
    v_mfma_f32_16x16x32_bf16 a[224:227], a[64:67], a[16:19], a[224:227]
    v_mfma_f32_16x16x32_bf16 a[228:231], a[64:67], a[20:23], a[228:231]
    v_mfma_f32_16x16x32_bf16 a[232:235], a[64:67], a[24:27], a[232:235]
    v_mfma_f32_16x16x32_bf16 a[236:239], a[64:67], a[28:31], a[236:239]
    s_waitcnt lgkmcnt(4)
    v_mfma_f32_16x16x32_bf16 a[240:243], a[68:71], a[0:3], a[240:243]
    ds_read_b64_tr_b16 a[76:77], v16 offset:13440
    v_mfma_f32_16x16x32_bf16 a[244:247], a[68:71], a[4:7], a[244:247]
    ds_read_b64_tr_b16 a[78:79], v16 offset:15232
    v_mfma_f32_16x16x32_bf16 a[248:251], a[68:71], a[8:11], a[248:251]
    ds_read_b128 a[60:63], v15 offset:14336
    v_mfma_f32_16x16x32_bf16 a[252:255], a[68:71], a[12:15], a[252:255]
    v_mfma_f32_16x16x32_bf16 v[112:115], a[68:71], a[16:19], v[112:115]
    v_mfma_f32_16x16x32_bf16 v[116:119], a[68:71], a[20:23], v[116:119]
    v_mfma_f32_16x16x32_bf16 v[120:123], a[68:71], a[24:27], v[120:123]
    v_mfma_f32_16x16x32_bf16 v[124:127], a[68:71], a[28:31], v[124:127]
    s_waitcnt lgkmcnt(4)
    v_mfma_f32_16x16x32_bf16 v[128:131], a[72:75], a[0:3], v[128:131]
    ds_read_b64_tr_b16 a[64:65], v16 offset:13472
    v_mfma_f32_16x16x32_bf16 v[132:135], a[72:75], a[4:7], v[132:135]
    ds_read_b64_tr_b16 a[66:67], v16 offset:15264
    v_mfma_f32_16x16x32_bf16 v[136:139], a[72:75], a[8:11], v[136:139]
    ds_read_b64_tr_b16 a[68:69], v16 offset:13504
    v_mfma_f32_16x16x32_bf16 v[140:143], a[72:75], a[12:15], v[140:143]
    ds_read_b64_tr_b16 a[70:71], v16 offset:15296
    v_mfma_f32_16x16x32_bf16 v[144:147], a[72:75], a[16:19], v[144:147]
    v_mfma_f32_16x16x32_bf16 v[148:151], a[72:75], a[20:23], v[148:151]
    v_mfma_f32_16x16x32_bf16 v[152:155], a[72:75], a[24:27], v[152:155]
    v_mfma_f32_16x16x32_bf16 v[156:159], a[72:75], a[28:31], v[156:159]
    s_waitcnt lgkmcnt(5)
    v_mfma_f32_16x16x32_bf16 v[160:163], a[76:79], a[0:3], v[160:163]
    v_mfma_f32_16x16x32_bf16 v[164:167], a[76:79], a[4:7], v[164:167]
    v_mfma_f32_16x16x32_bf16 v[168:171], a[76:79], a[8:11], v[168:171]
    v_mfma_f32_16x16x32_bf16 v[172:175], a[76:79], a[12:15], v[172:175]
    v_mfma_f32_16x16x32_bf16 v[176:179], a[76:79], a[16:19], v[176:179]
    v_mfma_f32_16x16x32_bf16 v[180:183], a[76:79], a[20:23], v[180:183]
    v_mfma_f32_16x16x32_bf16 v[184:187], a[76:79], a[24:27], v[184:187]
    v_mfma_f32_16x16x32_bf16 v[188:191], a[76:79], a[28:31], v[188:191]
    s_waitcnt vmcnt(9) lgkmcnt(0)
    s_barrier
    v_mfma_f32_16x16x32_bf16 v[192:195], a[64:67], a[0:3], v[192:195]
    ds_read_b64_tr_b16 a[72:73], v18 offset:20480
    v_mfma_f32_16x16x32_bf16 v[196:199], a[64:67], a[4:7], v[196:199]
    ds_read_b64_tr_b16 a[74:75], v18 offset:22016
    v_mfma_f32_16x16x32_bf16 v[200:203], a[64:67], a[8:11], v[200:203]
    v_mfma_f32_16x16x32_bf16 v[204:207], a[64:67], a[12:15], v[204:207]
    v_mfma_f32_16x16x32_bf16 v[208:211], a[64:67], a[16:19], v[208:211]
    v_mfma_f32_16x16x32_bf16 v[212:215], a[64:67], a[20:23], v[212:215]
    v_mfma_f32_16x16x32_bf16 v[216:219], a[64:67], a[24:27], v[216:219]
    v_mfma_f32_16x16x32_bf16 v[220:223], a[64:67], a[28:31], v[220:223]
    v_mfma_f32_16x16x32_bf16 v[224:227], a[68:71], a[0:3], v[224:227]
    ds_read_b64_tr_b16 a[76:77], v20 offset:20512
    v_mfma_f32_16x16x32_bf16 v[228:231], a[68:71], a[4:7], v[228:231]
    ds_read_b64_tr_b16 a[78:79], v20 offset:22048
    v_mfma_f32_16x16x32_bf16 v[232:235], a[68:71], a[8:11], v[232:235]
    v_mfma_f32_16x16x32_bf16 v[236:239], a[68:71], a[12:15], v[236:239]
    v_mfma_f32_16x16x32_bf16 v[240:243], a[68:71], a[16:19], v[240:243]
    v_mfma_f32_16x16x32_bf16 v[244:247], a[68:71], a[20:23], v[244:247]
    v_mfma_f32_16x16x32_bf16 v[248:251], a[68:71], a[24:27], v[248:251]
    v_mfma_f32_16x16x32_bf16 v[252:255], a[68:71], a[28:31], v[252:255]
    s_waitcnt vmcnt(3)
    v_readfirstlane_b32 s33, v25
    s_nop 0
    s_cmp_ge_u32 s33, 256
    s_cbranch_scc1 L_k2_w1_a4go
    s_mov_b32 s34, 0
L_k2_w1_a4spin:
    v_mov_b32 v23, 0
    global_load_dword v25, v23, s[42:43] sc1
    s_waitcnt vmcnt(0)
    v_readfirstlane_b32 s33, v25
    s_add_u32 s34, s34, 1
    s_cmp_gt_u32 s34, 0x40000
    s_cbranch_scc1 L_k2_w1_a4go
    s_cmp_ge_u32 s33, 256
    s_cbranch_scc0 L_k2_w1_a4spin
L_k2_w1_a4go:
    s_or_b32 s33, s77, s3
    s_cmp_lg_u32 s33, 0
    s_cbranch_scc1 L_k2_w1_a4noep
    s_add_u32 s33, s96, 1
    v_mov_b32 v23, 0
    v_mov_b32 v24, s33
    s_mov_b32 s33, 41156608
    s_mov_b64 exec, 1
    buffer_store_dword v24, v23, s[36:39], s33 offen sc1
    s_mov_b64 exec, -1
L_k2_w1_a4noep:
    s_lshl_b32 s33, s3, 6
    s_add_u32 s33, s33, s41
    s_lshl_b32 s33, s33, 3
    s_add_u32 s33, s33, 39911424
    v_lshlrev_b32 v23, 3, v22
    buffer_load_dwordx2 v[108:109], v23, s[36:39], s33 offen sc1
    s_mul_i32 s33, s21, 10240
    s_add_u32 s33, s33, 39976960
    s_mul_i32 s34, s3, 320
    v_lshlrev_b32 v24, 4, v22
    v_add_u32 v24, s34, v24
    s_mov_b64 exec, 0xfffff
    buffer_load_dwordx4 v[76:79], v24, s[36:39], s33 offen sc1
    s_add_u32 s33, s33, 1280
    buffer_load_dwordx4 v[80:83], v24, s[36:39], s33 offen sc1
    s_add_u32 s33, s33, 1280
    buffer_load_dwordx4 v[84:87], v24, s[36:39], s33 offen sc1
    s_add_u32 s33, s33, 1280
    buffer_load_dwordx4 v[88:91], v24, s[36:39], s33 offen sc1
    s_add_u32 s33, s33, 1280
    buffer_load_dwordx4 v[92:95], v24, s[36:39], s33 offen sc1
    s_add_u32 s33, s33, 1280
    buffer_load_dwordx4 v[96:99], v24, s[36:39], s33 offen sc1
    s_add_u32 s33, s33, 1280
    buffer_load_dwordx4 v[100:103], v24, s[36:39], s33 offen sc1
    s_add_u32 s33, s33, 1280
    buffer_load_dwordx4 v[104:107], v24, s[36:39], s33 offen sc1
    s_mov_b64 exec, -1
    s_waitcnt lgkmcnt(2)
    v_mfma_f32_16x16x32_bf16 a[80:83], a[72:75], a[32:35], a[80:83]
    ds_read_b64_tr_b16 a[64:65], v18 offset:20544
    v_mfma_f32_16x16x32_bf16 a[84:87], a[72:75], a[36:39], a[84:87]
    ds_read_b64_tr_b16 a[66:67], v18 offset:22080
    v_mfma_f32_16x16x32_bf16 a[88:91], a[72:75], a[40:43], a[88:91]
    ds_read_b128 a[0:3], v14 offset:32768
    v_mfma_f32_16x16x32_bf16 a[92:95], a[72:75], a[44:47], a[92:95]
    ds_read_b128 a[4:7], v14 offset:34816
    v_mfma_f32_16x16x32_bf16 a[96:99], a[72:75], a[48:51], a[96:99]
    v_mfma_f32_16x16x32_bf16 a[100:103], a[72:75], a[52:55], a[100:103]
    v_mfma_f32_16x16x32_bf16 a[104:107], a[72:75], a[56:59], a[104:107]
    v_mfma_f32_16x16x32_bf16 a[108:111], a[72:75], a[60:63], a[108:111]
    s_waitcnt lgkmcnt(4)
    v_mfma_f32_16x16x32_bf16 a[112:115], a[76:79], a[32:35], a[112:115]
    ds_read_b64_tr_b16 a[68:69], v20 offset:20576
    v_mfma_f32_16x16x32_bf16 a[116:119], a[76:79], a[36:39], a[116:119]
    ds_read_b64_tr_b16 a[70:71], v20 offset:22112
    v_mfma_f32_16x16x32_bf16 a[120:123], a[76:79], a[40:43], a[120:123]
    ds_read_b128 a[8:11], v14 offset:36864
    v_mfma_f32_16x16x32_bf16 a[124:127], a[76:79], a[44:47], a[124:127]
    ds_read_b128 a[12:15], v14 offset:38912
    v_mfma_f32_16x16x32_bf16 a[128:131], a[76:79], a[48:51], a[128:131]
    v_mfma_f32_16x16x32_bf16 a[132:135], a[76:79], a[52:55], a[132:135]
    v_mfma_f32_16x16x32_bf16 a[136:139], a[76:79], a[56:59], a[136:139]
    v_mfma_f32_16x16x32_bf16 a[140:143], a[76:79], a[60:63], a[140:143]
    s_waitcnt lgkmcnt(6)
    v_mfma_f32_16x16x32_bf16 a[144:147], a[64:67], a[32:35], a[144:147]
    ds_read_b64_tr_b16 a[72:73], v16 offset:26752
    v_mfma_f32_16x16x32_bf16 a[148:151], a[64:67], a[36:39], a[148:151]
    ds_read_b64_tr_b16 a[74:75], v16 offset:28544
    v_mfma_f32_16x16x32_bf16 a[152:155], a[64:67], a[40:43], a[152:155]
    ds_read_b128 a[16:19], v14 offset:40960
    v_mfma_f32_16x16x32_bf16 a[156:159], a[64:67], a[44:47], a[156:159]
    v_mfma_f32_16x16x32_bf16 a[160:163], a[64:67], a[48:51], a[160:163]
    v_mfma_f32_16x16x32_bf16 a[164:167], a[64:67], a[52:55], a[164:167]
    v_mfma_f32_16x16x32_bf16 a[168:171], a[64:67], a[56:59], a[168:171]
    v_mfma_f32_16x16x32_bf16 a[172:175], a[64:67], a[60:63], a[172:175]
    s_waitcnt lgkmcnt(5)
    v_mfma_f32_16x16x32_bf16 a[176:179], a[68:71], a[32:35], a[176:179]
    ds_read_b64_tr_b16 a[76:77], v16 offset:26784
    v_mfma_f32_16x16x32_bf16 a[180:183], a[68:71], a[36:39], a[180:183]
    ds_read_b64_tr_b16 a[78:79], v16 offset:28576
    v_mfma_f32_16x16x32_bf16 a[184:187], a[68:71], a[40:43], a[184:187]
    ds_read_b128 a[20:23], v14 offset:43008
    v_mfma_f32_16x16x32_bf16 a[188:191], a[68:71], a[44:47], a[188:191]
    v_mfma_f32_16x16x32_bf16 a[192:195], a[68:71], a[48:51], a[192:195]
    v_mfma_f32_16x16x32_bf16 a[196:199], a[68:71], a[52:55], a[196:199]
    v_mfma_f32_16x16x32_bf16 a[200:203], a[68:71], a[56:59], a[200:203]
    v_mfma_f32_16x16x32_bf16 a[204:207], a[68:71], a[60:63], a[204:207]
    s_waitcnt lgkmcnt(4)
    v_mfma_f32_16x16x32_bf16 a[208:211], a[72:75], a[32:35], a[208:211]
    ds_read_b64_tr_b16 a[64:65], v16 offset:26816
    v_mfma_f32_16x16x32_bf16 a[212:215], a[72:75], a[36:39], a[212:215]
    ds_read_b64_tr_b16 a[66:67], v16 offset:28608
    v_mfma_f32_16x16x32_bf16 a[216:219], a[72:75], a[40:43], a[216:219]
    ds_read_b128 a[24:27], v14 offset:45056
    v_mfma_f32_16x16x32_bf16 a[220:223], a[72:75], a[44:47], a[220:223]
    v_mfma_f32_16x16x32_bf16 a[224:227], a[72:75], a[48:51], a[224:227]
    v_mfma_f32_16x16x32_bf16 a[228:231], a[72:75], a[52:55], a[228:231]
    v_mfma_f32_16x16x32_bf16 a[232:235], a[72:75], a[56:59], a[232:235]
    v_mfma_f32_16x16x32_bf16 a[236:239], a[72:75], a[60:63], a[236:239]
    s_waitcnt lgkmcnt(4)
    v_mfma_f32_16x16x32_bf16 a[240:243], a[76:79], a[32:35], a[240:243]
    ds_read_b64_tr_b16 a[68:69], v16 offset:33920
    v_mfma_f32_16x16x32_bf16 a[244:247], a[76:79], a[36:39], a[244:247]
    ds_read_b64_tr_b16 a[70:71], v16 offset:35712
    v_mfma_f32_16x16x32_bf16 a[248:251], a[76:79], a[40:43], a[248:251]
    ds_read_b128 a[28:31], v14 offset:47104
    v_mfma_f32_16x16x32_bf16 a[252:255], a[76:79], a[44:47], a[252:255]
    v_mfma_f32_16x16x32_bf16 v[112:115], a[76:79], a[48:51], v[112:115]
    v_mfma_f32_16x16x32_bf16 v[116:119], a[76:79], a[52:55], v[116:119]
    v_mfma_f32_16x16x32_bf16 v[120:123], a[76:79], a[56:59], v[120:123]
    v_mfma_f32_16x16x32_bf16 v[124:127], a[76:79], a[60:63], v[124:127]
    s_waitcnt lgkmcnt(4)
    v_mfma_f32_16x16x32_bf16 v[128:131], a[64:67], a[32:35], v[128:131]
    ds_read_b64_tr_b16 a[72:73], v16 offset:33952
    v_mfma_f32_16x16x32_bf16 v[132:135], a[64:67], a[36:39], v[132:135]
    ds_read_b64_tr_b16 a[74:75], v16 offset:35744
    v_mfma_f32_16x16x32_bf16 v[136:139], a[64:67], a[40:43], v[136:139]
    ds_read_b64_tr_b16 a[76:77], v16 offset:33984
    v_mfma_f32_16x16x32_bf16 v[140:143], a[64:67], a[44:47], v[140:143]
    ds_read_b64_tr_b16 a[78:79], v16 offset:35776
    v_mfma_f32_16x16x32_bf16 v[144:147], a[64:67], a[48:51], v[144:147]
    v_mfma_f32_16x16x32_bf16 v[148:151], a[64:67], a[52:55], v[148:151]
    v_mfma_f32_16x16x32_bf16 v[152:155], a[64:67], a[56:59], v[152:155]
    v_mfma_f32_16x16x32_bf16 v[156:159], a[64:67], a[60:63], v[156:159]
    s_waitcnt lgkmcnt(5)
    v_mfma_f32_16x16x32_bf16 v[160:163], a[68:71], a[32:35], v[160:163]
    v_mfma_f32_16x16x32_bf16 v[164:167], a[68:71], a[36:39], v[164:167]
    v_mfma_f32_16x16x32_bf16 v[168:171], a[68:71], a[40:43], v[168:171]
    v_mfma_f32_16x16x32_bf16 v[172:175], a[68:71], a[44:47], v[172:175]
    v_mfma_f32_16x16x32_bf16 v[176:179], a[68:71], a[48:51], v[176:179]
    v_mfma_f32_16x16x32_bf16 v[180:183], a[68:71], a[52:55], v[180:183]
    v_mfma_f32_16x16x32_bf16 v[184:187], a[68:71], a[56:59], v[184:187]
    v_mfma_f32_16x16x32_bf16 v[188:191], a[68:71], a[60:63], v[188:191]
    s_waitcnt lgkmcnt(0)
    s_barrier
    v_mfma_f32_16x16x32_bf16 v[192:195], a[72:75], a[32:35], v[192:195]
    ds_read_b64_tr_b16 a[64:65], v19 offset:0
    v_mfma_f32_16x16x32_bf16 v[196:199], a[72:75], a[36:39], v[196:199]
    ds_read_b64_tr_b16 a[66:67], v19 offset:1536
    v_mfma_f32_16x16x32_bf16 v[200:203], a[72:75], a[40:43], v[200:203]
    v_mfma_f32_16x16x32_bf16 v[204:207], a[72:75], a[44:47], v[204:207]
    v_mfma_f32_16x16x32_bf16 v[208:211], a[72:75], a[48:51], v[208:211]
    v_mfma_f32_16x16x32_bf16 v[212:215], a[72:75], a[52:55], v[212:215]
    v_mfma_f32_16x16x32_bf16 v[216:219], a[72:75], a[56:59], v[216:219]
    v_mfma_f32_16x16x32_bf16 v[220:223], a[72:75], a[60:63], v[220:223]
    v_mfma_f32_16x16x32_bf16 v[224:227], a[76:79], a[32:35], v[224:227]
    ds_read_b64_tr_b16 a[68:69], v21 offset:32
    v_mfma_f32_16x16x32_bf16 v[228:231], a[76:79], a[36:39], v[228:231]
    ds_read_b64_tr_b16 a[70:71], v21 offset:1568
    v_mfma_f32_16x16x32_bf16 v[232:235], a[76:79], a[40:43], v[232:235]
    v_mfma_f32_16x16x32_bf16 v[236:239], a[76:79], a[44:47], v[236:239]
    v_mfma_f32_16x16x32_bf16 v[240:243], a[76:79], a[48:51], v[240:243]
    v_mfma_f32_16x16x32_bf16 v[244:247], a[76:79], a[52:55], v[244:247]
    v_mfma_f32_16x16x32_bf16 v[248:251], a[76:79], a[56:59], v[248:251]
    v_mfma_f32_16x16x32_bf16 v[252:255], a[76:79], a[60:63], v[252:255]
    s_waitcnt lgkmcnt(2)
    v_mfma_f32_16x16x32_bf16 a[80:83], a[64:67], a[0:3], a[80:83]
    ds_read_b64_tr_b16 a[72:73], v19 offset:64
    v_mfma_f32_16x16x32_bf16 a[84:87], a[64:67], a[4:7], a[84:87]
    ds_read_b64_tr_b16 a[74:75], v19 offset:1600
    v_mfma_f32_16x16x32_bf16 a[88:91], a[64:67], a[8:11], a[88:91]
    ds_read_b128 a[32:35], v15 offset:32768
    v_mfma_f32_16x16x32_bf16 a[92:95], a[64:67], a[12:15], a[92:95]
    ds_read_b128 a[36:39], v15 offset:34816
    v_mfma_f32_16x16x32_bf16 a[96:99], a[64:67], a[16:19], a[96:99]
    v_mfma_f32_16x16x32_bf16 a[100:103], a[64:67], a[20:23], a[100:103]
    v_mfma_f32_16x16x32_bf16 a[104:107], a[64:67], a[24:27], a[104:107]
    v_mfma_f32_16x16x32_bf16 a[108:111], a[64:67], a[28:31], a[108:111]
    s_waitcnt lgkmcnt(4)
    v_mfma_f32_16x16x32_bf16 a[112:115], a[68:71], a[0:3], a[112:115]
    ds_read_b64_tr_b16 a[76:77], v21 offset:96
    v_mfma_f32_16x16x32_bf16 a[116:119], a[68:71], a[4:7], a[116:119]
    ds_read_b64_tr_b16 a[78:79], v21 offset:1632
    v_mfma_f32_16x16x32_bf16 a[120:123], a[68:71], a[8:11], a[120:123]
    ds_read_b128 a[40:43], v15 offset:36864
    v_mfma_f32_16x16x32_bf16 a[124:127], a[68:71], a[12:15], a[124:127]
    ds_read_b128 a[44:47], v15 offset:38912
    v_mfma_f32_16x16x32_bf16 a[128:131], a[68:71], a[16:19], a[128:131]
    v_mfma_f32_16x16x32_bf16 a[132:135], a[68:71], a[20:23], a[132:135]
    v_mfma_f32_16x16x32_bf16 a[136:139], a[68:71], a[24:27], a[136:139]
    v_mfma_f32_16x16x32_bf16 a[140:143], a[68:71], a[28:31], a[140:143]
    s_waitcnt lgkmcnt(6)
    v_mfma_f32_16x16x32_bf16 a[144:147], a[72:75], a[0:3], a[144:147]
    ds_read_b64_tr_b16 a[64:65], v17 offset:6272
    v_mfma_f32_16x16x32_bf16 a[148:151], a[72:75], a[4:7], a[148:151]
    ds_read_b64_tr_b16 a[66:67], v17 offset:8064
    v_mfma_f32_16x16x32_bf16 a[152:155], a[72:75], a[8:11], a[152:155]
    ds_read_b128 a[48:51], v15 offset:40960
    v_mfma_f32_16x16x32_bf16 a[156:159], a[72:75], a[12:15], a[156:159]
    v_mfma_f32_16x16x32_bf16 a[160:163], a[72:75], a[16:19], a[160:163]
    v_mfma_f32_16x16x32_bf16 a[164:167], a[72:75], a[20:23], a[164:167]
    v_mfma_f32_16x16x32_bf16 a[168:171], a[72:75], a[24:27], a[168:171]
    v_mfma_f32_16x16x32_bf16 a[172:175], a[72:75], a[28:31], a[172:175]
    s_waitcnt lgkmcnt(5)
    v_mfma_f32_16x16x32_bf16 a[176:179], a[76:79], a[0:3], a[176:179]
    ds_read_b64_tr_b16 a[68:69], v17 offset:6304
    v_mfma_f32_16x16x32_bf16 a[180:183], a[76:79], a[4:7], a[180:183]
    ds_read_b64_tr_b16 a[70:71], v17 offset:8096
    v_mfma_f32_16x16x32_bf16 a[184:187], a[76:79], a[8:11], a[184:187]
    ds_read_b128 a[52:55], v15 offset:43008
    v_mfma_f32_16x16x32_bf16 a[188:191], a[76:79], a[12:15], a[188:191]
    v_mfma_f32_16x16x32_bf16 a[192:195], a[76:79], a[16:19], a[192:195]
    v_mfma_f32_16x16x32_bf16 a[196:199], a[76:79], a[20:23], a[196:199]
    v_mfma_f32_16x16x32_bf16 a[200:203], a[76:79], a[24:27], a[200:203]
    v_mfma_f32_16x16x32_bf16 a[204:207], a[76:79], a[28:31], a[204:207]
    s_waitcnt lgkmcnt(4)
    v_mfma_f32_16x16x32_bf16 a[208:211], a[64:67], a[0:3], a[208:211]
    ds_read_b64_tr_b16 a[72:73], v17 offset:6336
    v_mfma_f32_16x16x32_bf16 a[212:215], a[64:67], a[4:7], a[212:215]
    ds_read_b64_tr_b16 a[74:75], v17 offset:8128
    v_mfma_f32_16x16x32_bf16 a[216:219], a[64:67], a[8:11], a[216:219]
    ds_read_b128 a[56:59], v15 offset:45056
    v_mfma_f32_16x16x32_bf16 a[220:223], a[64:67], a[12:15], a[220:223]
    v_mfma_f32_16x16x32_bf16 a[224:227], a[64:67], a[16:19], a[224:227]
    v_mfma_f32_16x16x32_bf16 a[228:231], a[64:67], a[20:23], a[228:231]
    v_mfma_f32_16x16x32_bf16 a[232:235], a[64:67], a[24:27], a[232:235]
    v_mfma_f32_16x16x32_bf16 a[236:239], a[64:67], a[28:31], a[236:239]
    s_waitcnt lgkmcnt(4)
    v_mfma_f32_16x16x32_bf16 a[240:243], a[68:71], a[0:3], a[240:243]
    ds_read_b64_tr_b16 a[76:77], v17 offset:13440
    v_mfma_f32_16x16x32_bf16 a[244:247], a[68:71], a[4:7], a[244:247]
    ds_read_b64_tr_b16 a[78:79], v17 offset:15232
    v_mfma_f32_16x16x32_bf16 a[248:251], a[68:71], a[8:11], a[248:251]
    ds_read_b128 a[60:63], v15 offset:47104
    v_mfma_f32_16x16x32_bf16 a[252:255], a[68:71], a[12:15], a[252:255]
    v_mfma_f32_16x16x32_bf16 v[112:115], a[68:71], a[16:19], v[112:115]
    v_mfma_f32_16x16x32_bf16 v[116:119], a[68:71], a[20:23], v[116:119]
    v_mfma_f32_16x16x32_bf16 v[120:123], a[68:71], a[24:27], v[120:123]
    v_mfma_f32_16x16x32_bf16 v[124:127], a[68:71], a[28:31], v[124:127]
    s_waitcnt lgkmcnt(4)
    v_mfma_f32_16x16x32_bf16 v[128:131], a[72:75], a[0:3], v[128:131]
    ds_read_b64_tr_b16 a[64:65], v17 offset:13472
    v_mfma_f32_16x16x32_bf16 v[132:135], a[72:75], a[4:7], v[132:135]
    ds_read_b64_tr_b16 a[66:67], v17 offset:15264
    v_mfma_f32_16x16x32_bf16 v[136:139], a[72:75], a[8:11], v[136:139]
    ds_read_b64_tr_b16 a[68:69], v17 offset:13504
    v_mfma_f32_16x16x32_bf16 v[140:143], a[72:75], a[12:15], v[140:143]
    ds_read_b64_tr_b16 a[70:71], v17 offset:15296
    v_mfma_f32_16x16x32_bf16 v[144:147], a[72:75], a[16:19], v[144:147]
    v_mfma_f32_16x16x32_bf16 v[148:151], a[72:75], a[20:23], v[148:151]
    v_mfma_f32_16x16x32_bf16 v[152:155], a[72:75], a[24:27], v[152:155]
    v_mfma_f32_16x16x32_bf16 v[156:159], a[72:75], a[28:31], v[156:159]
    s_waitcnt lgkmcnt(5)
    v_mfma_f32_16x16x32_bf16 v[160:163], a[76:79], a[0:3], v[160:163]
    v_mfma_f32_16x16x32_bf16 v[164:167], a[76:79], a[4:7], v[164:167]
    v_mfma_f32_16x16x32_bf16 v[168:171], a[76:79], a[8:11], v[168:171]
    v_mfma_f32_16x16x32_bf16 v[172:175], a[76:79], a[12:15], v[172:175]
    v_mfma_f32_16x16x32_bf16 v[176:179], a[76:79], a[16:19], v[176:179]
    v_mfma_f32_16x16x32_bf16 v[180:183], a[76:79], a[20:23], v[180:183]
    v_mfma_f32_16x16x32_bf16 v[184:187], a[76:79], a[24:27], v[184:187]
    v_mfma_f32_16x16x32_bf16 v[188:191], a[76:79], a[28:31], v[188:191]
    s_waitcnt lgkmcnt(0)
    s_barrier
    v_mfma_f32_16x16x32_bf16 v[192:195], a[64:67], a[0:3], v[192:195]
    ds_read_b64_tr_b16 a[72:73], v19 offset:20480
    v_mfma_f32_16x16x32_bf16 v[196:199], a[64:67], a[4:7], v[196:199]
    ds_read_b64_tr_b16 a[74:75], v19 offset:22016
    v_mfma_f32_16x16x32_bf16 v[200:203], a[64:67], a[8:11], v[200:203]
    v_mfma_f32_16x16x32_bf16 v[204:207], a[64:67], a[12:15], v[204:207]
    v_mfma_f32_16x16x32_bf16 v[208:211], a[64:67], a[16:19], v[208:211]
    v_mfma_f32_16x16x32_bf16 v[212:215], a[64:67], a[20:23], v[212:215]
    v_mfma_f32_16x16x32_bf16 v[216:219], a[64:67], a[24:27], v[216:219]
    v_mfma_f32_16x16x32_bf16 v[220:223], a[64:67], a[28:31], v[220:223]
    v_mfma_f32_16x16x32_bf16 v[224:227], a[68:71], a[0:3], v[224:227]
    ds_read_b64_tr_b16 a[76:77], v21 offset:20512
    v_mfma_f32_16x16x32_bf16 v[228:231], a[68:71], a[4:7], v[228:231]
    ds_read_b64_tr_b16 a[78:79], v21 offset:22048
    v_mfma_f32_16x16x32_bf16 v[232:235], a[68:71], a[8:11], v[232:235]
    v_mfma_f32_16x16x32_bf16 v[236:239], a[68:71], a[12:15], v[236:239]
    v_mfma_f32_16x16x32_bf16 v[240:243], a[68:71], a[16:19], v[240:243]
    v_mfma_f32_16x16x32_bf16 v[244:247], a[68:71], a[20:23], v[244:247]
    v_mfma_f32_16x16x32_bf16 v[248:251], a[68:71], a[24:27], v[248:251]
    v_mfma_f32_16x16x32_bf16 v[252:255], a[68:71], a[28:31], v[252:255]
    s_waitcnt vmcnt(3)
    v_pk_add_f32 v[76:77], v[76:77], v[92:93]
    v_pk_add_f32 v[78:79], v[78:79], v[94:95]
    s_waitcnt vmcnt(2)
    v_pk_add_f32 v[80:81], v[80:81], v[96:97]
    v_pk_add_f32 v[82:83], v[82:83], v[98:99]
    s_waitcnt vmcnt(1)
    v_pk_add_f32 v[84:85], v[84:85], v[100:101]
    v_pk_add_f32 v[86:87], v[86:87], v[102:103]
    s_waitcnt vmcnt(0)
    v_pk_add_f32 v[88:89], v[88:89], v[104:105]
    v_pk_add_f32 v[90:91], v[90:91], v[106:107]
    v_pk_add_f32 v[76:77], v[76:77], v[84:85]
    v_pk_add_f32 v[78:79], v[78:79], v[86:87]
    v_pk_add_f32 v[80:81], v[80:81], v[88:89]
    v_pk_add_f32 v[82:83], v[82:83], v[90:91]
    v_pk_add_f32 v[76:77], v[76:77], v[80:81]
    v_pk_add_f32 v[78:79], v[78:79], v[82:83]
    s_lshl_b32 s33, s3, 9
    v_lshlrev_b32 v23, 3, v22
    v_add_u32 v23, s33, v23
    v_add_u32 v23, 149504, v23
    ds_write_b64 v23, v[108:109]
    s_mul_i32 s34, s3, 320
    v_lshlrev_b32 v24, 4, v22
    v_add_u32 v24, s34, v24
    v_add_u32 v24, 147456, v24
    s_mov_b64 exec, 0xfffff
    ds_write_b128 v24, v[76:79]
    s_mov_b64 exec, -1
    s_waitcnt lgkmcnt(4)
    v_mfma_f32_16x16x32_bf16 a[80:83], a[72:75], a[32:35], a[80:83]
    ds_read_b64_tr_b16 a[64:65], v19 offset:20544
    v_mfma_f32_16x16x32_bf16 a[84:87], a[72:75], a[36:39], a[84:87]
    ds_read_b64_tr_b16 a[66:67], v19 offset:22080
    v_mfma_f32_16x16x32_bf16 a[88:91], a[72:75], a[40:43], a[88:91]
    v_mfma_f32_16x16x32_bf16 a[92:95], a[72:75], a[44:47], a[92:95]
    v_mfma_f32_16x16x32_bf16 a[96:99], a[72:75], a[48:51], a[96:99]
    v_mfma_f32_16x16x32_bf16 a[100:103], a[72:75], a[52:55], a[100:103]
    v_mfma_f32_16x16x32_bf16 a[104:107], a[72:75], a[56:59], a[104:107]
    v_mfma_f32_16x16x32_bf16 a[108:111], a[72:75], a[60:63], a[108:111]
    s_waitcnt lgkmcnt(4)
    v_mfma_f32_16x16x32_bf16 a[112:115], a[76:79], a[32:35], a[112:115]
    ds_read_b64_tr_b16 a[68:69], v21 offset:20576
    v_mfma_f32_16x16x32_bf16 a[116:119], a[76:79], a[36:39], a[116:119]
    ds_read_b64_tr_b16 a[70:71], v21 offset:22112
    v_mfma_f32_16x16x32_bf16 a[120:123], a[76:79], a[40:43], a[120:123]
    v_mfma_f32_16x16x32_bf16 a[124:127], a[76:79], a[44:47], a[124:127]
    v_mfma_f32_16x16x32_bf16 a[128:131], a[76:79], a[48:51], a[128:131]
    v_mfma_f32_16x16x32_bf16 a[132:135], a[76:79], a[52:55], a[132:135]
    v_mfma_f32_16x16x32_bf16 a[136:139], a[76:79], a[56:59], a[136:139]
    v_mfma_f32_16x16x32_bf16 a[140:143], a[76:79], a[60:63], a[140:143]
    s_waitcnt lgkmcnt(2)
    v_mfma_f32_16x16x32_bf16 a[144:147], a[64:67], a[32:35], a[144:147]
    ds_read_b64_tr_b16 a[72:73], v17 offset:26752
    v_mfma_f32_16x16x32_bf16 a[148:151], a[64:67], a[36:39], a[148:151]
    ds_read_b64_tr_b16 a[74:75], v17 offset:28544
    v_mfma_f32_16x16x32_bf16 a[152:155], a[64:67], a[40:43], a[152:155]
    v_mfma_f32_16x16x32_bf16 a[156:159], a[64:67], a[44:47], a[156:159]
    v_mfma_f32_16x16x32_bf16 a[160:163], a[64:67], a[48:51], a[160:163]
    v_mfma_f32_16x16x32_bf16 a[164:167], a[64:67], a[52:55], a[164:167]
    v_mfma_f32_16x16x32_bf16 a[168:171], a[64:67], a[56:59], a[168:171]
    v_mfma_f32_16x16x32_bf16 a[172:175], a[64:67], a[60:63], a[172:175]
    s_waitcnt lgkmcnt(2)
    v_mfma_f32_16x16x32_bf16 a[176:179], a[68:71], a[32:35], a[176:179]
    ds_read_b64_tr_b16 a[76:77], v17 offset:26784
    v_mfma_f32_16x16x32_bf16 a[180:183], a[68:71], a[36:39], a[180:183]
    ds_read_b64_tr_b16 a[78:79], v17 offset:28576
    v_mfma_f32_16x16x32_bf16 a[184:187], a[68:71], a[40:43], a[184:187]
    v_mfma_f32_16x16x32_bf16 a[188:191], a[68:71], a[44:47], a[188:191]
    v_mfma_f32_16x16x32_bf16 a[192:195], a[68:71], a[48:51], a[192:195]
    v_mfma_f32_16x16x32_bf16 a[196:199], a[68:71], a[52:55], a[196:199]
    v_mfma_f32_16x16x32_bf16 a[200:203], a[68:71], a[56:59], a[200:203]
    v_mfma_f32_16x16x32_bf16 a[204:207], a[68:71], a[60:63], a[204:207]
    s_waitcnt lgkmcnt(2)
    v_mfma_f32_16x16x32_bf16 a[208:211], a[72:75], a[32:35], a[208:211]
    ds_read_b64_tr_b16 a[64:65], v17 offset:26816
    v_mfma_f32_16x16x32_bf16 a[212:215], a[72:75], a[36:39], a[212:215]
    ds_read_b64_tr_b16 a[66:67], v17 offset:28608
    v_mfma_f32_16x16x32_bf16 a[216:219], a[72:75], a[40:43], a[216:219]
    v_mfma_f32_16x16x32_bf16 a[220:223], a[72:75], a[44:47], a[220:223]
    v_mfma_f32_16x16x32_bf16 a[224:227], a[72:75], a[48:51], a[224:227]
    v_mfma_f32_16x16x32_bf16 a[228:231], a[72:75], a[52:55], a[228:231]
    v_mfma_f32_16x16x32_bf16 a[232:235], a[72:75], a[56:59], a[232:235]
    v_mfma_f32_16x16x32_bf16 a[236:239], a[72:75], a[60:63], a[236:239]
    s_waitcnt lgkmcnt(2)
    v_mfma_f32_16x16x32_bf16 a[240:243], a[76:79], a[32:35], a[240:243]
    ds_read_b64_tr_b16 a[68:69], v17 offset:33920
    v_mfma_f32_16x16x32_bf16 a[244:247], a[76:79], a[36:39], a[244:247]
    ds_read_b64_tr_b16 a[70:71], v17 offset:35712
    v_mfma_f32_16x16x32_bf16 a[248:251], a[76:79], a[40:43], a[248:251]
    v_mfma_f32_16x16x32_bf16 a[252:255], a[76:79], a[44:47], a[252:255]
    v_mfma_f32_16x16x32_bf16 v[112:115], a[76:79], a[48:51], v[112:115]
    v_mfma_f32_16x16x32_bf16 v[116:119], a[76:79], a[52:55], v[116:119]
    v_mfma_f32_16x16x32_bf16 v[120:123], a[76:79], a[56:59], v[120:123]
    v_mfma_f32_16x16x32_bf16 v[124:127], a[76:79], a[60:63], v[124:127]
    s_waitcnt lgkmcnt(2)
    v_mfma_f32_16x16x32_bf16 v[128:131], a[64:67], a[32:35], v[128:131]
    ds_read_b64_tr_b16 a[72:73], v17 offset:33952
    v_mfma_f32_16x16x32_bf16 v[132:135], a[64:67], a[36:39], v[132:135]
    ds_read_b64_tr_b16 a[74:75], v17 offset:35744
    v_mfma_f32_16x16x32_bf16 v[136:139], a[64:67], a[40:43], v[136:139]
    ds_read_b64_tr_b16 a[76:77], v17 offset:33984
    v_mfma_f32_16x16x32_bf16 v[140:143], a[64:67], a[44:47], v[140:143]
    ds_read_b64_tr_b16 a[78:79], v17 offset:35776
    v_mfma_f32_16x16x32_bf16 v[144:147], a[64:67], a[48:51], v[144:147]
    v_mfma_f32_16x16x32_bf16 v[148:151], a[64:67], a[52:55], v[148:151]
    v_mfma_f32_16x16x32_bf16 v[152:155], a[64:67], a[56:59], v[152:155]
    v_mfma_f32_16x16x32_bf16 v[156:159], a[64:67], a[60:63], v[156:159]
    s_waitcnt lgkmcnt(4)
    v_mfma_f32_16x16x32_bf16 v[160:163], a[68:71], a[32:35], v[160:163]
    v_mfma_f32_16x16x32_bf16 v[164:167], a[68:71], a[36:39], v[164:167]
    v_mfma_f32_16x16x32_bf16 v[168:171], a[68:71], a[40:43], v[168:171]
    v_mfma_f32_16x16x32_bf16 v[172:175], a[68:71], a[44:47], v[172:175]
    v_mfma_f32_16x16x32_bf16 v[176:179], a[68:71], a[48:51], v[176:179]
    v_mfma_f32_16x16x32_bf16 v[180:183], a[68:71], a[52:55], v[180:183]
    v_mfma_f32_16x16x32_bf16 v[184:187], a[68:71], a[56:59], v[184:187]
    v_mfma_f32_16x16x32_bf16 v[188:191], a[68:71], a[60:63], v[188:191]
    s_waitcnt lgkmcnt(0)
    s_barrier
    v_mfma_f32_16x16x32_bf16 v[192:195], a[72:75], a[32:35], v[192:195]
    v_mfma_f32_16x16x32_bf16 v[196:199], a[72:75], a[36:39], v[196:199]
    v_mfma_f32_16x16x32_bf16 v[200:203], a[72:75], a[40:43], v[200:203]
    v_mfma_f32_16x16x32_bf16 v[204:207], a[72:75], a[44:47], v[204:207]
    v_mfma_f32_16x16x32_bf16 v[208:211], a[72:75], a[48:51], v[208:211]
    v_mfma_f32_16x16x32_bf16 v[212:215], a[72:75], a[52:55], v[212:215]
    v_mfma_f32_16x16x32_bf16 v[216:219], a[72:75], a[56:59], v[216:219]
    v_mfma_f32_16x16x32_bf16 v[220:223], a[72:75], a[60:63], v[220:223]
    v_mfma_f32_16x16x32_bf16 v[224:227], a[76:79], a[32:35], v[224:227]
    v_mfma_f32_16x16x32_bf16 v[228:231], a[76:79], a[36:39], v[228:231]
    v_mfma_f32_16x16x32_bf16 v[232:235], a[76:79], a[40:43], v[232:235]
    v_mfma_f32_16x16x32_bf16 v[236:239], a[76:79], a[44:47], v[236:239]
    v_mfma_f32_16x16x32_bf16 v[240:243], a[76:79], a[48:51], v[240:243]
    v_mfma_f32_16x16x32_bf16 v[244:247], a[76:79], a[52:55], v[244:247]
    v_mfma_f32_16x16x32_bf16 v[248:251], a[76:79], a[56:59], v[248:251]
    v_mfma_f32_16x16x32_bf16 v[252:255], a[76:79], a[60:63], v[252:255]
    v_and_b32 v23, 15, v22
    v_lshrrev_b32 v24, 4, v22
    s_lshl_b32 s33, s22, 10
    s_add_u32 s33, s33, 149504
    v_lshl_add_u32 v29, v23, 3, s33
    v_lshlrev_b32 v30, 4, v24
    v_add_u32 v30, 148096, v30
    ds_read_b64 v[72:73], v29 offset:0
    ds_read_b64 v[74:75], v29 offset:128
    ds_read_b64 v[76:77], v29 offset:256
    ds_read_b64 v[78:79], v29 offset:384
    ds_read_b64 v[80:81], v29 offset:512
    ds_read_b64 v[82:83], v29 offset:640
    ds_read_b64 v[84:85], v29 offset:768
    ds_read_b64 v[86:87], v29 offset:896
    ds_read_b128 v[32:35], v30 offset:0
    ds_read_b128 v[36:39], v30 offset:64
    ds_read_b128 v[40:43], v30 offset:128
    ds_read_b128 v[44:47], v30 offset:192
    ds_read_b128 v[48:51], v30 offset:256
    ds_read_b128 v[52:55], v30 offset:320
    ds_read_b128 v[56:59], v30 offset:384
    ds_read_b128 v[60:63], v30 offset:448
    ds_read_b128 v[64:67], v30 offset:512
    ds_read_b128 v[68:71], v30 offset:576
    v_and_b32 v23, 15, v22
    v_lshrrev_b32 v24, 4, v22
    v_and_b32 v25, 1, v24
    v_lshl_add_u32 v25, v25, 4, v23
    v_lshrrev_b32 v26, 1, v24
    v_lshlrev_b32 v1, 5, v25
    v_lshl_add_u32 v1, v26, 4, v1
    s_lshl_b32 s33, s22, 7
    v_add_u32 v25, s33, v25
    v_lshlrev_b32 v25, 6, v25
    v_lshrrev_b32 v27, 2, v23
    v_and_b32 v28, 2, v23
    v_xor_b32 v27, v27, v28
    v_xor_b32 v27, v27, v26
    v_lshl_add_u32 v2, v27, 4, v25
    v_xor_b32 v3, 32, v2
    v_lshrrev_b32 v27, 1, v23
    v_and_b32 v27, 3, v27
    v_xor_b32 v27, v27, v26
    v_lshl_add_u32 v4, v27, 4, v25
    v_xor_b32 v5, 32, v4
    v_add_u32 v6, 65536, v2
    v_add_u32 v7, 65536, v3
    v_accvgpr_read_b32 v92, a144
    v_accvgpr_read_b32 v93, a145
    v_accvgpr_read_b32 v94, a146
    v_accvgpr_read_b32 v95, a147
    v_accvgpr_read_b32 v96, a148
    v_accvgpr_read_b32 v97, a149
    v_accvgpr_read_b32 v98, a150
    v_accvgpr_read_b32 v99, a151
    s_waitcnt lgkmcnt(7)
    v_pk_fma_f32 v[92:93], v[40:41], v[72:73], v[92:93] op_sel:[0,0,0] op_sel_hi:[1,0,1]
    v_pk_fma_f32 v[94:95], v[42:43], v[72:73], v[94:95] op_sel:[0,0,0] op_sel_hi:[1,0,1]
    v_pk_fma_f32 v[96:97], v[40:41], v[74:75], v[96:97] op_sel:[0,0,0] op_sel_hi:[1,0,1]
    v_pk_fma_f32 v[98:99], v[42:43], v[74:75], v[98:99] op_sel:[0,0,0] op_sel_hi:[1,0,1]
    v_pk_mul_f32 v[92:93], v[92:93], v[72:73] op_sel:[0,1] op_sel_hi:[1,1]
    v_pk_mul_f32 v[94:95], v[94:95], v[72:73] op_sel:[0,1] op_sel_hi:[1,1]
    v_pk_mul_f32 v[96:97], v[96:97], v[74:75] op_sel:[0,1] op_sel_hi:[1,1]
    v_pk_mul_f32 v[98:99], v[98:99], v[74:75] op_sel:[0,1] op_sel_hi:[1,1]
    v_cvt_pk_bf16_f32 v88, v92, v93
    v_cvt_pk_bf16_f32 v89, v94, v95
    v_cvt_pk_bf16_f32 v90, v96, v97
    v_cvt_pk_bf16_f32 v91, v98, v99
    v_accvgpr_read_b32 v104, a152
    v_accvgpr_read_b32 v105, a153
    v_accvgpr_read_b32 v106, a154
    v_accvgpr_read_b32 v107, a155
    v_accvgpr_read_b32 v108, a156
    v_accvgpr_read_b32 v109, a157
    v_accvgpr_read_b32 v110, a158
    v_accvgpr_read_b32 v111, a159
    v_permlane16_swap_b32 v88, v90
    v_permlane16_swap_b32 v89, v91
    ds_write_b128 v2, v[88:91] offset:16384
    v_pk_fma_f32 v[104:105], v[40:41], v[76:77], v[104:105] op_sel:[0,0,0] op_sel_hi:[1,0,1]
    v_pk_fma_f32 v[106:107], v[42:43], v[76:77], v[106:107] op_sel:[0,0,0] op_sel_hi:[1,0,1]
    v_pk_fma_f32 v[108:109], v[40:41], v[78:79], v[108:109] op_sel:[0,0,0] op_sel_hi:[1,0,1]
    v_pk_fma_f32 v[110:111], v[42:43], v[78:79], v[110:111] op_sel:[0,0,0] op_sel_hi:[1,0,1]
    v_pk_mul_f32 v[104:105], v[104:105], v[76:77] op_sel:[0,1] op_sel_hi:[1,1]
    v_pk_mul_f32 v[106:107], v[106:107], v[76:77] op_sel:[0,1] op_sel_hi:[1,1]
    v_pk_mul_f32 v[108:109], v[108:109], v[78:79] op_sel:[0,1] op_sel_hi:[1,1]
    v_pk_mul_f32 v[110:111], v[110:111], v[78:79] op_sel:[0,1] op_sel_hi:[1,1]
    v_cvt_pk_bf16_f32 v100, v104, v105
    v_cvt_pk_bf16_f32 v101, v106, v107
    v_cvt_pk_bf16_f32 v102, v108, v109
    v_cvt_pk_bf16_f32 v103, v110, v111
    v_accvgpr_read_b32 v92, a160
    v_accvgpr_read_b32 v93, a161
    v_accvgpr_read_b32 v94, a162
    v_accvgpr_read_b32 v95, a163
    v_accvgpr_read_b32 v96, a164
    v_accvgpr_read_b32 v97, a165
    v_accvgpr_read_b32 v98, a166
    v_accvgpr_read_b32 v99, a167
    v_permlane16_swap_b32 v100, v102
    v_permlane16_swap_b32 v101, v103
    ds_write_b128 v2, v[100:103] offset:18432
    v_pk_fma_f32 v[92:93], v[40:41], v[80:81], v[92:93] op_sel:[0,0,0] op_sel_hi:[1,0,1]
    v_pk_fma_f32 v[94:95], v[42:43], v[80:81], v[94:95] op_sel:[0,0,0] op_sel_hi:[1,0,1]
    v_pk_fma_f32 v[96:97], v[40:41], v[82:83], v[96:97] op_sel:[0,0,0] op_sel_hi:[1,0,1]
    v_pk_fma_f32 v[98:99], v[42:43], v[82:83], v[98:99] op_sel:[0,0,0] op_sel_hi:[1,0,1]
    v_pk_mul_f32 v[92:93], v[92:93], v[80:81] op_sel:[0,1] op_sel_hi:[1,1]
    v_pk_mul_f32 v[94:95], v[94:95], v[80:81] op_sel:[0,1] op_sel_hi:[1,1]
    v_pk_mul_f32 v[96:97], v[96:97], v[82:83] op_sel:[0,1] op_sel_hi:[1,1]
    v_pk_mul_f32 v[98:99], v[98:99], v[82:83] op_sel:[0,1] op_sel_hi:[1,1]
    v_cvt_pk_bf16_f32 v88, v92, v93
    v_cvt_pk_bf16_f32 v89, v94, v95
    v_cvt_pk_bf16_f32 v90, v96, v97
    v_cvt_pk_bf16_f32 v91, v98, v99
    v_accvgpr_read_b32 v104, a168
    v_accvgpr_read_b32 v105, a169
    v_accvgpr_read_b32 v106, a170
    v_accvgpr_read_b32 v107, a171
    v_accvgpr_read_b32 v108, a172
    v_accvgpr_read_b32 v109, a173
    v_accvgpr_read_b32 v110, a174
    v_accvgpr_read_b32 v111, a175
    v_permlane16_swap_b32 v88, v90
    v_permlane16_swap_b32 v89, v91
    ds_write_b128 v2, v[88:91] offset:20480
    v_pk_fma_f32 v[104:105], v[40:41], v[84:85], v[104:105] op_sel:[0,0,0] op_sel_hi:[1,0,1]
    v_pk_fma_f32 v[106:107], v[42:43], v[84:85], v[106:107] op_sel:[0,0,0] op_sel_hi:[1,0,1]
    v_pk_fma_f32 v[108:109], v[40:41], v[86:87], v[108:109] op_sel:[0,0,0] op_sel_hi:[1,0,1]
    v_pk_fma_f32 v[110:111], v[42:43], v[86:87], v[110:111] op_sel:[0,0,0] op_sel_hi:[1,0,1]
    v_pk_mul_f32 v[104:105], v[104:105], v[84:85] op_sel:[0,1] op_sel_hi:[1,1]
    v_pk_mul_f32 v[106:107], v[106:107], v[84:85] op_sel:[0,1] op_sel_hi:[1,1]
    v_pk_mul_f32 v[108:109], v[108:109], v[86:87] op_sel:[0,1] op_sel_hi:[1,1]
    v_pk_mul_f32 v[110:111], v[110:111], v[86:87] op_sel:[0,1] op_sel_hi:[1,1]
    v_cvt_pk_bf16_f32 v100, v104, v105
    v_cvt_pk_bf16_f32 v101, v106, v107
    v_cvt_pk_bf16_f32 v102, v108, v109
    v_cvt_pk_bf16_f32 v103, v110, v111
    v_accvgpr_read_b32 v92, a176
    v_accvgpr_read_b32 v93, a177
    v_accvgpr_read_b32 v94, a178
    v_accvgpr_read_b32 v95, a179
    v_accvgpr_read_b32 v96, a180
    v_accvgpr_read_b32 v97, a181
    v_accvgpr_read_b32 v98, a182
    v_accvgpr_read_b32 v99, a183
    v_permlane16_swap_b32 v100, v102
    v_permlane16_swap_b32 v101, v103
    ds_write_b128 v2, v[100:103] offset:22528
    s_waitcnt lgkmcnt(10)
    v_pk_fma_f32 v[92:93], v[44:45], v[72:73], v[92:93] op_sel:[0,0,0] op_sel_hi:[1,0,1]
    v_pk_fma_f32 v[94:95], v[46:47], v[72:73], v[94:95] op_sel:[0,0,0] op_sel_hi:[1,0,1]
    v_pk_fma_f32 v[96:97], v[44:45], v[74:75], v[96:97] op_sel:[0,0,0] op_sel_hi:[1,0,1]
    v_pk_fma_f32 v[98:99], v[46:47], v[74:75], v[98:99] op_sel:[0,0,0] op_sel_hi:[1,0,1]
    v_pk_mul_f32 v[92:93], v[92:93], v[72:73] op_sel:[0,1] op_sel_hi:[1,1]
    v_pk_mul_f32 v[94:95], v[94:95], v[72:73] op_sel:[0,1] op_sel_hi:[1,1]
    v_pk_mul_f32 v[96:97], v[96:97], v[74:75] op_sel:[0,1] op_sel_hi:[1,1]
    v_pk_mul_f32 v[98:99], v[98:99], v[74:75] op_sel:[0,1] op_sel_hi:[1,1]
    v_cvt_pk_bf16_f32 v88, v92, v93
    v_cvt_pk_bf16_f32 v89, v94, v95
    v_cvt_pk_bf16_f32 v90, v96, v97
    v_cvt_pk_bf16_f32 v91, v98, v99
    v_accvgpr_read_b32 v104, a184
    v_accvgpr_read_b32 v105, a185
    v_accvgpr_read_b32 v106, a186
    v_accvgpr_read_b32 v107, a187
    v_accvgpr_read_b32 v108, a188
    v_accvgpr_read_b32 v109, a189
    v_accvgpr_read_b32 v110, a190
    v_accvgpr_read_b32 v111, a191
    v_permlane16_swap_b32 v88, v90
    v_permlane16_swap_b32 v89, v91
    ds_write_b128 v3, v[88:91] offset:16384
    v_pk_fma_f32 v[104:105], v[44:45], v[76:77], v[104:105] op_sel:[0,0,0] op_sel_hi:[1,0,1]
    v_pk_fma_f32 v[106:107], v[46:47], v[76:77], v[106:107] op_sel:[0,0,0] op_sel_hi:[1,0,1]
    v_pk_fma_f32 v[108:109], v[44:45], v[78:79], v[108:109] op_sel:[0,0,0] op_sel_hi:[1,0,1]
    v_pk_fma_f32 v[110:111], v[46:47], v[78:79], v[110:111] op_sel:[0,0,0] op_sel_hi:[1,0,1]
    v_pk_mul_f32 v[104:105], v[104:105], v[76:77] op_sel:[0,1] op_sel_hi:[1,1]
    v_pk_mul_f32 v[106:107], v[106:107], v[76:77] op_sel:[0,1] op_sel_hi:[1,1]
    v_pk_mul_f32 v[108:109], v[108:109], v[78:79] op_sel:[0,1] op_sel_hi:[1,1]
    v_pk_mul_f32 v[110:111], v[110:111], v[78:79] op_sel:[0,1] op_sel_hi:[1,1]
    v_cvt_pk_bf16_f32 v100, v104, v105
    v_cvt_pk_bf16_f32 v101, v106, v107
    v_cvt_pk_bf16_f32 v102, v108, v109
    v_cvt_pk_bf16_f32 v103, v110, v111
    v_accvgpr_read_b32 v92, a192
    v_accvgpr_read_b32 v93, a193
    v_accvgpr_read_b32 v94, a194
    v_accvgpr_read_b32 v95, a195
    v_accvgpr_read_b32 v96, a196
    v_accvgpr_read_b32 v97, a197
    v_accvgpr_read_b32 v98, a198
    v_accvgpr_read_b32 v99, a199
    v_permlane16_swap_b32 v100, v102
    v_permlane16_swap_b32 v101, v103
    ds_write_b128 v3, v[100:103] offset:18432
    v_pk_fma_f32 v[92:93], v[44:45], v[80:81], v[92:93] op_sel:[0,0,0] op_sel_hi:[1,0,1]
    v_pk_fma_f32 v[94:95], v[46:47], v[80:81], v[94:95] op_sel:[0,0,0] op_sel_hi:[1,0,1]
    v_pk_fma_f32 v[96:97], v[44:45], v[82:83], v[96:97] op_sel:[0,0,0] op_sel_hi:[1,0,1]
    v_pk_fma_f32 v[98:99], v[46:47], v[82:83], v[98:99] op_sel:[0,0,0] op_sel_hi:[1,0,1]
    v_pk_mul_f32 v[92:93], v[92:93], v[80:81] op_sel:[0,1] op_sel_hi:[1,1]
    v_pk_mul_f32 v[94:95], v[94:95], v[80:81] op_sel:[0,1] op_sel_hi:[1,1]
    v_pk_mul_f32 v[96:97], v[96:97], v[82:83] op_sel:[0,1] op_sel_hi:[1,1]
    v_pk_mul_f32 v[98:99], v[98:99], v[82:83] op_sel:[0,1] op_sel_hi:[1,1]
    v_cvt_pk_bf16_f32 v88, v92, v93
    v_cvt_pk_bf16_f32 v89, v94, v95
    v_cvt_pk_bf16_f32 v90, v96, v97
    v_cvt_pk_bf16_f32 v91, v98, v99
    v_accvgpr_read_b32 v104, a200
    v_accvgpr_read_b32 v105, a201
    v_accvgpr_read_b32 v106, a202
    v_accvgpr_read_b32 v107, a203
    v_accvgpr_read_b32 v108, a204
    v_accvgpr_read_b32 v109, a205
    v_accvgpr_read_b32 v110, a206
    v_accvgpr_read_b32 v111, a207
    v_permlane16_swap_b32 v88, v90
    v_permlane16_swap_b32 v89, v91
    ds_write_b128 v3, v[88:91] offset:20480
    v_pk_fma_f32 v[104:105], v[44:45], v[84:85], v[104:105] op_sel:[0,0,0] op_sel_hi:[1,0,1]
    v_pk_fma_f32 v[106:107], v[46:47], v[84:85], v[106:107] op_sel:[0,0,0] op_sel_hi:[1,0,1]
    v_pk_fma_f32 v[108:109], v[44:45], v[86:87], v[108:109] op_sel:[0,0,0] op_sel_hi:[1,0,1]
    v_pk_fma_f32 v[110:111], v[46:47], v[86:87], v[110:111] op_sel:[0,0,0] op_sel_hi:[1,0,1]
    v_pk_mul_f32 v[104:105], v[104:105], v[84:85] op_sel:[0,1] op_sel_hi:[1,1]
    v_pk_mul_f32 v[106:107], v[106:107], v[84:85] op_sel:[0,1] op_sel_hi:[1,1]
    v_pk_mul_f32 v[108:109], v[108:109], v[86:87] op_sel:[0,1] op_sel_hi:[1,1]
    v_pk_mul_f32 v[110:111], v[110:111], v[86:87] op_sel:[0,1] op_sel_hi:[1,1]
    v_cvt_pk_bf16_f32 v100, v104, v105
    v_cvt_pk_bf16_f32 v101, v106, v107
    v_cvt_pk_bf16_f32 v102, v108, v109
    v_cvt_pk_bf16_f32 v103, v110, v111
    s_nop 0
    v_permlane16_swap_b32 v100, v102
    s_nop 0
    v_permlane16_swap_b32 v101, v103
    ds_write_b128 v3, v[100:103] offset:22528
    s_waitcnt lgkmcnt(0)
    s_barrier
    v_lshlrev_b32 v23, 4, v22
    s_lshl_b32 s33, s3, 12
    v_add_u32 v23, s33, v23
    s_lshl_b32 s34, s20, 5
    s_add_u32 s34, s34, s21
    s_lshl_b32 s34, s34, 15
    s_add_u32 s34, s34, 23068672
    s_add_u32 s35, s34, 16384
    ds_read_b128 a[0:3], v23 offset:16384
    ds_read_b128 a[4:7], v23 offset:17408
    ds_read_b128 a[8:11], v23 offset:18432
    ds_read_b128 a[12:15], v23 offset:19456
    ds_read_b128 a[16:19], v23 offset:49152
    ds_read_b128 a[20:23], v23 offset:50176
    ds_read_b128 a[24:27], v23 offset:51200
    ds_read_b128 a[28:31], v23 offset:52224
    s_waitcnt lgkmcnt(7)
    buffer_store_dwordx4 a[0:3], v23, s[36:39], s34 offen offset:0 sc1
    s_waitcnt lgkmcnt(6)
    buffer_store_dwordx4 a[4:7], v23, s[36:39], s34 offen offset:1024 sc1
    s_waitcnt lgkmcnt(5)
    buffer_store_dwordx4 a[8:11], v23, s[36:39], s34 offen offset:2048 sc1
    s_waitcnt lgkmcnt(4)
    buffer_store_dwordx4 a[12:15], v23, s[36:39], s34 offen offset:3072 sc1
    s_waitcnt lgkmcnt(3)
    buffer_store_dwordx4 a[16:19], v23, s[36:39], s35 offen offset:0 sc1
    s_waitcnt lgkmcnt(2)
    buffer_store_dwordx4 a[20:23], v23, s[36:39], s35 offen offset:1024 sc1
    s_waitcnt lgkmcnt(1)
    buffer_store_dwordx4 a[24:27], v23, s[36:39], s35 offen offset:2048 sc1
    s_waitcnt lgkmcnt(0)
    buffer_store_dwordx4 a[28:31], v23, s[36:39], s35 offen offset:3072 sc1
    v_accvgpr_read_b32 v92, a80
    v_accvgpr_read_b32 v93, a81
    v_accvgpr_read_b32 v94, a82
    v_accvgpr_read_b32 v95, a83
    v_accvgpr_read_b32 v96, a84
    v_accvgpr_read_b32 v97, a85
    v_accvgpr_read_b32 v98, a86
    v_accvgpr_read_b32 v99, a87
    v_pk_fma_f32 v[92:93], v[32:33], v[72:73], v[92:93] op_sel:[0,0,0] op_sel_hi:[1,0,1]
    v_pk_fma_f32 v[94:95], v[34:35], v[72:73], v[94:95] op_sel:[0,0,0] op_sel_hi:[1,0,1]
    v_pk_fma_f32 v[96:97], v[32:33], v[74:75], v[96:97] op_sel:[0,0,0] op_sel_hi:[1,0,1]
    v_pk_fma_f32 v[98:99], v[34:35], v[74:75], v[98:99] op_sel:[0,0,0] op_sel_hi:[1,0,1]
    v_cvt_pk_bf16_f32 v88, v92, v93
    v_cvt_pk_bf16_f32 v89, v94, v95
    v_cvt_pk_bf16_f32 v90, v96, v97
    v_cvt_pk_bf16_f32 v91, v98, v99
    v_accvgpr_read_b32 v104, a88
    v_accvgpr_read_b32 v105, a89
    v_accvgpr_read_b32 v106, a90
    v_accvgpr_read_b32 v107, a91
    v_accvgpr_read_b32 v108, a92
    v_accvgpr_read_b32 v109, a93
    v_accvgpr_read_b32 v110, a94
    v_accvgpr_read_b32 v111, a95
    v_permlane16_swap_b32 v88, v90
    v_permlane16_swap_b32 v89, v91
    ds_write_b128 v6, v[88:91] offset:0
    v_pk_fma_f32 v[104:105], v[32:33], v[76:77], v[104:105] op_sel:[0,0,0] op_sel_hi:[1,0,1]
    v_pk_fma_f32 v[106:107], v[34:35], v[76:77], v[106:107] op_sel:[0,0,0] op_sel_hi:[1,0,1]
    v_pk_fma_f32 v[108:109], v[32:33], v[78:79], v[108:109] op_sel:[0,0,0] op_sel_hi:[1,0,1]
    v_pk_fma_f32 v[110:111], v[34:35], v[78:79], v[110:111] op_sel:[0,0,0] op_sel_hi:[1,0,1]
    v_cvt_pk_bf16_f32 v100, v104, v105
    v_cvt_pk_bf16_f32 v101, v106, v107
    v_cvt_pk_bf16_f32 v102, v108, v109
    v_cvt_pk_bf16_f32 v103, v110, v111
    v_accvgpr_read_b32 v92, a96
    v_accvgpr_read_b32 v93, a97
    v_accvgpr_read_b32 v94, a98
    v_accvgpr_read_b32 v95, a99
    v_accvgpr_read_b32 v96, a100
    v_accvgpr_read_b32 v97, a101
    v_accvgpr_read_b32 v98, a102
    v_accvgpr_read_b32 v99, a103
    v_permlane16_swap_b32 v100, v102
    v_permlane16_swap_b32 v101, v103
    ds_write_b128 v6, v[100:103] offset:2048
    v_pk_fma_f32 v[92:93], v[32:33], v[80:81], v[92:93] op_sel:[0,0,0] op_sel_hi:[1,0,1]
    v_pk_fma_f32 v[94:95], v[34:35], v[80:81], v[94:95] op_sel:[0,0,0] op_sel_hi:[1,0,1]
    v_pk_fma_f32 v[96:97], v[32:33], v[82:83], v[96:97] op_sel:[0,0,0] op_sel_hi:[1,0,1]
    v_pk_fma_f32 v[98:99], v[34:35], v[82:83], v[98:99] op_sel:[0,0,0] op_sel_hi:[1,0,1]
    v_cvt_pk_bf16_f32 v88, v92, v93
    v_cvt_pk_bf16_f32 v89, v94, v95
    v_cvt_pk_bf16_f32 v90, v96, v97
    v_cvt_pk_bf16_f32 v91, v98, v99
    v_accvgpr_read_b32 v104, a104
    v_accvgpr_read_b32 v105, a105
    v_accvgpr_read_b32 v106, a106
    v_accvgpr_read_b32 v107, a107
    v_accvgpr_read_b32 v108, a108
    v_accvgpr_read_b32 v109, a109
    v_accvgpr_read_b32 v110, a110
    v_accvgpr_read_b32 v111, a111
    v_permlane16_swap_b32 v88, v90
    v_permlane16_swap_b32 v89, v91
    ds_write_b128 v6, v[88:91] offset:4096
    v_pk_fma_f32 v[104:105], v[32:33], v[84:85], v[104:105] op_sel:[0,0,0] op_sel_hi:[1,0,1]
    v_pk_fma_f32 v[106:107], v[34:35], v[84:85], v[106:107] op_sel:[0,0,0] op_sel_hi:[1,0,1]
    v_pk_fma_f32 v[108:109], v[32:33], v[86:87], v[108:109] op_sel:[0,0,0] op_sel_hi:[1,0,1]
    v_pk_fma_f32 v[110:111], v[34:35], v[86:87], v[110:111] op_sel:[0,0,0] op_sel_hi:[1,0,1]
    v_cvt_pk_bf16_f32 v100, v104, v105
    v_cvt_pk_bf16_f32 v101, v106, v107
    v_cvt_pk_bf16_f32 v102, v108, v109
    v_cvt_pk_bf16_f32 v103, v110, v111
    v_accvgpr_read_b32 v92, a112
    v_accvgpr_read_b32 v93, a113
    v_accvgpr_read_b32 v94, a114
    v_accvgpr_read_b32 v95, a115
    v_accvgpr_read_b32 v96, a116
    v_accvgpr_read_b32 v97, a117
    v_accvgpr_read_b32 v98, a118
    v_accvgpr_read_b32 v99, a119
    v_permlane16_swap_b32 v100, v102
    v_permlane16_swap_b32 v101, v103
    ds_write_b128 v6, v[100:103] offset:6144
    v_pk_fma_f32 v[92:93], v[36:37], v[72:73], v[92:93] op_sel:[0,0,0] op_sel_hi:[1,0,1]
    v_pk_fma_f32 v[94:95], v[38:39], v[72:73], v[94:95] op_sel:[0,0,0] op_sel_hi:[1,0,1]
    v_pk_fma_f32 v[96:97], v[36:37], v[74:75], v[96:97] op_sel:[0,0,0] op_sel_hi:[1,0,1]
    v_pk_fma_f32 v[98:99], v[38:39], v[74:75], v[98:99] op_sel:[0,0,0] op_sel_hi:[1,0,1]
    v_cvt_pk_bf16_f32 v88, v92, v93
    v_cvt_pk_bf16_f32 v89, v94, v95
    v_cvt_pk_bf16_f32 v90, v96, v97
    v_cvt_pk_bf16_f32 v91, v98, v99
    v_accvgpr_read_b32 v104, a120
    v_accvgpr_read_b32 v105, a121
    v_accvgpr_read_b32 v106, a122
    v_accvgpr_read_b32 v107, a123
    v_accvgpr_read_b32 v108, a124
    v_accvgpr_read_b32 v109, a125
    v_accvgpr_read_b32 v110, a126
    v_accvgpr_read_b32 v111, a127
    v_permlane16_swap_b32 v88, v90
    v_permlane16_swap_b32 v89, v91
    ds_write_b128 v7, v[88:91] offset:0
    v_pk_fma_f32 v[104:105], v[36:37], v[76:77], v[104:105] op_sel:[0,0,0] op_sel_hi:[1,0,1]
    v_pk_fma_f32 v[106:107], v[38:39], v[76:77], v[106:107] op_sel:[0,0,0] op_sel_hi:[1,0,1]
    v_pk_fma_f32 v[108:109], v[36:37], v[78:79], v[108:109] op_sel:[0,0,0] op_sel_hi:[1,0,1]
    v_pk_fma_f32 v[110:111], v[38:39], v[78:79], v[110:111] op_sel:[0,0,0] op_sel_hi:[1,0,1]
    v_cvt_pk_bf16_f32 v100, v104, v105
    v_cvt_pk_bf16_f32 v101, v106, v107
    v_cvt_pk_bf16_f32 v102, v108, v109
    v_cvt_pk_bf16_f32 v103, v110, v111
    v_accvgpr_read_b32 v92, a128
    v_accvgpr_read_b32 v93, a129
    v_accvgpr_read_b32 v94, a130
    v_accvgpr_read_b32 v95, a131
    v_accvgpr_read_b32 v96, a132
    v_accvgpr_read_b32 v97, a133
    v_accvgpr_read_b32 v98, a134
    v_accvgpr_read_b32 v99, a135
    v_permlane16_swap_b32 v100, v102
    v_permlane16_swap_b32 v101, v103
    ds_write_b128 v7, v[100:103] offset:2048
    v_pk_fma_f32 v[92:93], v[36:37], v[80:81], v[92:93] op_sel:[0,0,0] op_sel_hi:[1,0,1]
    v_pk_fma_f32 v[94:95], v[38:39], v[80:81], v[94:95] op_sel:[0,0,0] op_sel_hi:[1,0,1]
    v_pk_fma_f32 v[96:97], v[36:37], v[82:83], v[96:97] op_sel:[0,0,0] op_sel_hi:[1,0,1]
    v_pk_fma_f32 v[98:99], v[38:39], v[82:83], v[98:99] op_sel:[0,0,0] op_sel_hi:[1,0,1]
    v_cvt_pk_bf16_f32 v88, v92, v93
    v_cvt_pk_bf16_f32 v89, v94, v95
    v_cvt_pk_bf16_f32 v90, v96, v97
    v_cvt_pk_bf16_f32 v91, v98, v99
    v_accvgpr_read_b32 v104, a136
    v_accvgpr_read_b32 v105, a137
    v_accvgpr_read_b32 v106, a138
    v_accvgpr_read_b32 v107, a139
    v_accvgpr_read_b32 v108, a140
    v_accvgpr_read_b32 v109, a141
    v_accvgpr_read_b32 v110, a142
    v_accvgpr_read_b32 v111, a143
    v_permlane16_swap_b32 v88, v90
    v_permlane16_swap_b32 v89, v91
    ds_write_b128 v7, v[88:91] offset:4096
    v_pk_fma_f32 v[104:105], v[36:37], v[84:85], v[104:105] op_sel:[0,0,0] op_sel_hi:[1,0,1]
    v_pk_fma_f32 v[106:107], v[38:39], v[84:85], v[106:107] op_sel:[0,0,0] op_sel_hi:[1,0,1]
    v_pk_fma_f32 v[108:109], v[36:37], v[86:87], v[108:109] op_sel:[0,0,0] op_sel_hi:[1,0,1]
    v_pk_fma_f32 v[110:111], v[38:39], v[86:87], v[110:111] op_sel:[0,0,0] op_sel_hi:[1,0,1]
    v_cvt_pk_bf16_f32 v100, v104, v105
    v_cvt_pk_bf16_f32 v101, v106, v107
    v_cvt_pk_bf16_f32 v102, v108, v109
    v_cvt_pk_bf16_f32 v103, v110, v111
    v_accvgpr_read_b32 v92, a208
    v_accvgpr_read_b32 v93, a209
    v_accvgpr_read_b32 v94, a210
    v_accvgpr_read_b32 v95, a211
    v_accvgpr_read_b32 v96, a212
    v_accvgpr_read_b32 v97, a213
    v_accvgpr_read_b32 v98, a214
    v_accvgpr_read_b32 v99, a215
    v_permlane16_swap_b32 v100, v102
    v_permlane16_swap_b32 v101, v103
    ds_write_b128 v7, v[100:103] offset:6144
    v_pk_fma_f32 v[92:93], v[48:49], v[72:73], v[92:93] op_sel:[0,0,0] op_sel_hi:[1,0,1]
    v_pk_fma_f32 v[94:95], v[50:51], v[72:73], v[94:95] op_sel:[0,0,0] op_sel_hi:[1,0,1]
    v_pk_fma_f32 v[160:161], v[60:61], v[72:73], v[160:161] op_sel:[0,0,0] op_sel_hi:[1,0,1]
    v_pk_fma_f32 v[162:163], v[62:63], v[72:73], v[162:163] op_sel:[0,0,0] op_sel_hi:[1,0,1]
    v_pk_fma_f32 v[96:97], v[48:49], v[74:75], v[96:97] op_sel:[0,0,0] op_sel_hi:[1,0,1]
    v_pk_fma_f32 v[98:99], v[50:51], v[74:75], v[98:99] op_sel:[0,0,0] op_sel_hi:[1,0,1]
    v_pk_fma_f32 v[164:165], v[60:61], v[74:75], v[164:165] op_sel:[0,0,0] op_sel_hi:[1,0,1]
    v_pk_fma_f32 v[166:167], v[62:63], v[74:75], v[166:167] op_sel:[0,0,0] op_sel_hi:[1,0,1]
    v_pk_mul_f32 v[160:161], v[92:93], v[160:161]
    v_pk_mul_f32 v[162:163], v[94:95], v[162:163]
    v_pk_mul_f32 v[164:165], v[96:97], v[164:165]
    v_pk_mul_f32 v[166:167], v[98:99], v[166:167]
    v_cvt_pk_bf16_f32 v160, v160, v161
    v_cvt_pk_bf16_f32 v161, v162, v163
    v_cvt_pk_bf16_f32 v162, v164, v165
    v_cvt_pk_bf16_f32 v163, v166, v167
    v_accvgpr_read_b32 v104, a216
    v_accvgpr_read_b32 v105, a217
    v_accvgpr_read_b32 v106, a218
    v_accvgpr_read_b32 v107, a219
    v_accvgpr_read_b32 v108, a220
    v_accvgpr_read_b32 v109, a221
    v_accvgpr_read_b32 v110, a222
    v_accvgpr_read_b32 v111, a223
    v_permlane16_swap_b32 v160, v162
    v_permlane16_swap_b32 v161, v163
    v_pk_fma_f32 v[104:105], v[48:49], v[76:77], v[104:105] op_sel:[0,0,0] op_sel_hi:[1,0,1]
    v_pk_fma_f32 v[106:107], v[50:51], v[76:77], v[106:107] op_sel:[0,0,0] op_sel_hi:[1,0,1]
    v_pk_fma_f32 v[168:169], v[60:61], v[76:77], v[168:169] op_sel:[0,0,0] op_sel_hi:[1,0,1]
    v_pk_fma_f32 v[170:171], v[62:63], v[76:77], v[170:171] op_sel:[0,0,0] op_sel_hi:[1,0,1]
    v_pk_fma_f32 v[108:109], v[48:49], v[78:79], v[108:109] op_sel:[0,0,0] op_sel_hi:[1,0,1]
    v_pk_fma_f32 v[110:111], v[50:51], v[78:79], v[110:111] op_sel:[0,0,0] op_sel_hi:[1,0,1]
    v_pk_fma_f32 v[172:173], v[60:61], v[78:79], v[172:173] op_sel:[0,0,0] op_sel_hi:[1,0,1]
    v_pk_fma_f32 v[174:175], v[62:63], v[78:79], v[174:175] op_sel:[0,0,0] op_sel_hi:[1,0,1]
    v_pk_mul_f32 v[168:169], v[104:105], v[168:169]
    v_pk_mul_f32 v[170:171], v[106:107], v[170:171]
    v_pk_mul_f32 v[172:173], v[108:109], v[172:173]
    v_pk_mul_f32 v[174:175], v[110:111], v[174:175]
    v_cvt_pk_bf16_f32 v168, v168, v169
    v_cvt_pk_bf16_f32 v169, v170, v171
    v_cvt_pk_bf16_f32 v170, v172, v173
    v_cvt_pk_bf16_f32 v171, v174, v175
    s_nop 0
    v_permlane16_swap_b32 v168, v170
    s_nop 0
    v_permlane16_swap_b32 v169, v171
    s_waitcnt vmcnt(0)
    s_lshl_b32 s33, s77, 9
    s_lshl_b32 s34, s3, 7
    s_add_u32 s33, s33, s34
    s_add_u32 s33, s33, 40632320
    s_add_u32 s34, s96, 1
    v_mov_b32 v24, s34
    v_mov_b32 v25, 0
    s_mov_b64 exec, 1
    buffer_store_dword v24, v25, s[36:39], s33 offen sc1
    s_mov_b64 exec, -1
    v_accvgpr_read_b32 v92, a224
    v_accvgpr_read_b32 v93, a225
    v_accvgpr_read_b32 v94, a226
    v_accvgpr_read_b32 v95, a227
    v_accvgpr_read_b32 v96, a228
    v_accvgpr_read_b32 v97, a229
    v_accvgpr_read_b32 v98, a230
    v_accvgpr_read_b32 v99, a231
    v_pk_fma_f32 v[92:93], v[48:49], v[80:81], v[92:93] op_sel:[0,0,0] op_sel_hi:[1,0,1]
    v_pk_fma_f32 v[94:95], v[50:51], v[80:81], v[94:95] op_sel:[0,0,0] op_sel_hi:[1,0,1]
    v_pk_fma_f32 v[176:177], v[60:61], v[80:81], v[176:177] op_sel:[0,0,0] op_sel_hi:[1,0,1]
    v_pk_fma_f32 v[178:179], v[62:63], v[80:81], v[178:179] op_sel:[0,0,0] op_sel_hi:[1,0,1]
    v_pk_fma_f32 v[96:97], v[48:49], v[82:83], v[96:97] op_sel:[0,0,0] op_sel_hi:[1,0,1]
    v_pk_fma_f32 v[98:99], v[50:51], v[82:83], v[98:99] op_sel:[0,0,0] op_sel_hi:[1,0,1]
    v_pk_fma_f32 v[180:181], v[60:61], v[82:83], v[180:181] op_sel:[0,0,0] op_sel_hi:[1,0,1]
    v_pk_fma_f32 v[182:183], v[62:63], v[82:83], v[182:183] op_sel:[0,0,0] op_sel_hi:[1,0,1]
    v_pk_mul_f32 v[176:177], v[92:93], v[176:177]
    v_pk_mul_f32 v[178:179], v[94:95], v[178:179]
    v_pk_mul_f32 v[180:181], v[96:97], v[180:181]
    v_pk_mul_f32 v[182:183], v[98:99], v[182:183]
    v_cvt_pk_bf16_f32 v176, v176, v177
    v_cvt_pk_bf16_f32 v177, v178, v179
    v_cvt_pk_bf16_f32 v178, v180, v181
    v_cvt_pk_bf16_f32 v179, v182, v183
    v_accvgpr_read_b32 v104, a232
    v_accvgpr_read_b32 v105, a233
    v_accvgpr_read_b32 v106, a234
    v_accvgpr_read_b32 v107, a235
    v_accvgpr_read_b32 v108, a236
    v_accvgpr_read_b32 v109, a237
    v_accvgpr_read_b32 v110, a238
    v_accvgpr_read_b32 v111, a239
    v_permlane16_swap_b32 v176, v178
    v_permlane16_swap_b32 v177, v179
    v_pk_fma_f32 v[104:105], v[48:49], v[84:85], v[104:105] op_sel:[0,0,0] op_sel_hi:[1,0,1]
    v_pk_fma_f32 v[106:107], v[50:51], v[84:85], v[106:107] op_sel:[0,0,0] op_sel_hi:[1,0,1]
    v_pk_fma_f32 v[184:185], v[60:61], v[84:85], v[184:185] op_sel:[0,0,0] op_sel_hi:[1,0,1]
    v_pk_fma_f32 v[186:187], v[62:63], v[84:85], v[186:187] op_sel:[0,0,0] op_sel_hi:[1,0,1]
    v_pk_fma_f32 v[108:109], v[48:49], v[86:87], v[108:109] op_sel:[0,0,0] op_sel_hi:[1,0,1]
    v_pk_fma_f32 v[110:111], v[50:51], v[86:87], v[110:111] op_sel:[0,0,0] op_sel_hi:[1,0,1]
    v_pk_fma_f32 v[188:189], v[60:61], v[86:87], v[188:189] op_sel:[0,0,0] op_sel_hi:[1,0,1]
    v_pk_fma_f32 v[190:191], v[62:63], v[86:87], v[190:191] op_sel:[0,0,0] op_sel_hi:[1,0,1]
    v_pk_mul_f32 v[184:185], v[104:105], v[184:185]
    v_pk_mul_f32 v[186:187], v[106:107], v[186:187]
    v_pk_mul_f32 v[188:189], v[108:109], v[188:189]
    v_pk_mul_f32 v[190:191], v[110:111], v[190:191]
    v_cvt_pk_bf16_f32 v184, v184, v185
    v_cvt_pk_bf16_f32 v185, v186, v187
    v_cvt_pk_bf16_f32 v186, v188, v189
    v_cvt_pk_bf16_f32 v187, v190, v191
    v_accvgpr_read_b32 v92, a240
    v_accvgpr_read_b32 v93, a241
    v_accvgpr_read_b32 v94, a242
    v_accvgpr_read_b32 v95, a243
    v_accvgpr_read_b32 v96, a244
    v_accvgpr_read_b32 v97, a245
    v_accvgpr_read_b32 v98, a246
    v_accvgpr_read_b32 v99, a247
    v_permlane16_swap_b32 v184, v186
    v_permlane16_swap_b32 v185, v187
    v_pk_fma_f32 v[92:93], v[52:53], v[72:73], v[92:93] op_sel:[0,0,0] op_sel_hi:[1,0,1]
    v_pk_fma_f32 v[94:95], v[54:55], v[72:73], v[94:95] op_sel:[0,0,0] op_sel_hi:[1,0,1]
    v_pk_fma_f32 v[192:193], v[64:65], v[72:73], v[192:193] op_sel:[0,0,0] op_sel_hi:[1,0,1]
    v_pk_fma_f32 v[194:195], v[66:67], v[72:73], v[194:195] op_sel:[0,0,0] op_sel_hi:[1,0,1]
    v_pk_fma_f32 v[96:97], v[52:53], v[74:75], v[96:97] op_sel:[0,0,0] op_sel_hi:[1,0,1]
    v_pk_fma_f32 v[98:99], v[54:55], v[74:75], v[98:99] op_sel:[0,0,0] op_sel_hi:[1,0,1]
    v_pk_fma_f32 v[196:197], v[64:65], v[74:75], v[196:197] op_sel:[0,0,0] op_sel_hi:[1,0,1]
    v_pk_fma_f32 v[198:199], v[66:67], v[74:75], v[198:199] op_sel:[0,0,0] op_sel_hi:[1,0,1]
    v_pk_mul_f32 v[192:193], v[92:93], v[192:193]
    v_pk_mul_f32 v[194:195], v[94:95], v[194:195]
    v_pk_mul_f32 v[196:197], v[96:97], v[196:197]
    v_pk_mul_f32 v[198:199], v[98:99], v[198:199]
    v_cvt_pk_bf16_f32 v192, v192, v193
    v_cvt_pk_bf16_f32 v193, v194, v195
    v_cvt_pk_bf16_f32 v194, v196, v197
    v_cvt_pk_bf16_f32 v195, v198, v199
    v_accvgpr_read_b32 v104, a248
    v_accvgpr_read_b32 v105, a249
    v_accvgpr_read_b32 v106, a250
    v_accvgpr_read_b32 v107, a251
    v_accvgpr_read_b32 v108, a252
    v_accvgpr_read_b32 v109, a253
    v_accvgpr_read_b32 v110, a254
    v_accvgpr_read_b32 v111, a255
    v_permlane16_swap_b32 v192, v194
    v_permlane16_swap_b32 v193, v195
    v_pk_fma_f32 v[104:105], v[52:53], v[76:77], v[104:105] op_sel:[0,0,0] op_sel_hi:[1,0,1]
    v_pk_fma_f32 v[106:107], v[54:55], v[76:77], v[106:107] op_sel:[0,0,0] op_sel_hi:[1,0,1]
    v_pk_fma_f32 v[200:201], v[64:65], v[76:77], v[200:201] op_sel:[0,0,0] op_sel_hi:[1,0,1]
    v_pk_fma_f32 v[202:203], v[66:67], v[76:77], v[202:203] op_sel:[0,0,0] op_sel_hi:[1,0,1]
    v_pk_fma_f32 v[108:109], v[52:53], v[78:79], v[108:109] op_sel:[0,0,0] op_sel_hi:[1,0,1]
    v_pk_fma_f32 v[110:111], v[54:55], v[78:79], v[110:111] op_sel:[0,0,0] op_sel_hi:[1,0,1]
    v_pk_fma_f32 v[204:205], v[64:65], v[78:79], v[204:205] op_sel:[0,0,0] op_sel_hi:[1,0,1]
    v_pk_fma_f32 v[206:207], v[66:67], v[78:79], v[206:207] op_sel:[0,0,0] op_sel_hi:[1,0,1]
    v_pk_mul_f32 v[200:201], v[104:105], v[200:201]
    v_pk_mul_f32 v[202:203], v[106:107], v[202:203]
    v_pk_mul_f32 v[204:205], v[108:109], v[204:205]
    v_pk_mul_f32 v[206:207], v[110:111], v[206:207]
    v_cvt_pk_bf16_f32 v200, v200, v201
    v_cvt_pk_bf16_f32 v201, v202, v203
    v_cvt_pk_bf16_f32 v202, v204, v205
    v_cvt_pk_bf16_f32 v203, v206, v207
    s_nop 0
    v_permlane16_swap_b32 v200, v202
    s_nop 0
    v_permlane16_swap_b32 v201, v203
    v_pk_fma_f32 v[112:113], v[52:53], v[80:81], v[112:113] op_sel:[0,0,0] op_sel_hi:[1,0,1]
    v_pk_fma_f32 v[114:115], v[54:55], v[80:81], v[114:115] op_sel:[0,0,0] op_sel_hi:[1,0,1]
    v_pk_fma_f32 v[208:209], v[64:65], v[80:81], v[208:209] op_sel:[0,0,0] op_sel_hi:[1,0,1]
    v_pk_fma_f32 v[210:211], v[66:67], v[80:81], v[210:211] op_sel:[0,0,0] op_sel_hi:[1,0,1]
    v_pk_fma_f32 v[116:117], v[52:53], v[82:83], v[116:117] op_sel:[0,0,0] op_sel_hi:[1,0,1]
    v_pk_fma_f32 v[118:119], v[54:55], v[82:83], v[118:119] op_sel:[0,0,0] op_sel_hi:[1,0,1]
    v_pk_fma_f32 v[212:213], v[64:65], v[82:83], v[212:213] op_sel:[0,0,0] op_sel_hi:[1,0,1]
    v_pk_fma_f32 v[214:215], v[66:67], v[82:83], v[214:215] op_sel:[0,0,0] op_sel_hi:[1,0,1]
    v_pk_mul_f32 v[208:209], v[112:113], v[208:209]
    v_pk_mul_f32 v[210:211], v[114:115], v[210:211]
    v_pk_mul_f32 v[212:213], v[116:117], v[212:213]
    v_pk_mul_f32 v[214:215], v[118:119], v[214:215]
    v_cvt_pk_bf16_f32 v208, v208, v209
    v_cvt_pk_bf16_f32 v209, v210, v211
    v_cvt_pk_bf16_f32 v210, v212, v213
    v_cvt_pk_bf16_f32 v211, v214, v215
    s_sub_u32 s33, s77, 8
    s_lshl_b32 s33, s33, 9
    s_lshl_b32 s34, s3, 7
    s_add_u32 s33, s33, s34
    s_add_u32 s63, s33, 40632320
    s_add_u32 s79, s79, 1
    v_mov_b32 v25, 0
    buffer_load_dword v24, v25, s[36:39], s63 offen sc1
    v_permlane16_swap_b32 v208, v210
    v_permlane16_swap_b32 v209, v211
    v_pk_fma_f32 v[120:121], v[52:53], v[84:85], v[120:121] op_sel:[0,0,0] op_sel_hi:[1,0,1]
    v_pk_fma_f32 v[122:123], v[54:55], v[84:85], v[122:123] op_sel:[0,0,0] op_sel_hi:[1,0,1]
    v_pk_fma_f32 v[216:217], v[64:65], v[84:85], v[216:217] op_sel:[0,0,0] op_sel_hi:[1,0,1]
    v_pk_fma_f32 v[218:219], v[66:67], v[84:85], v[218:219] op_sel:[0,0,0] op_sel_hi:[1,0,1]
    v_pk_fma_f32 v[124:125], v[52:53], v[86:87], v[124:125] op_sel:[0,0,0] op_sel_hi:[1,0,1]
    v_pk_fma_f32 v[126:127], v[54:55], v[86:87], v[126:127] op_sel:[0,0,0] op_sel_hi:[1,0,1]
    v_pk_fma_f32 v[220:221], v[64:65], v[86:87], v[220:221] op_sel:[0,0,0] op_sel_hi:[1,0,1]
    v_pk_fma_f32 v[222:223], v[66:67], v[86:87], v[222:223] op_sel:[0,0,0] op_sel_hi:[1,0,1]
    v_pk_mul_f32 v[216:217], v[120:121], v[216:217]
    v_pk_mul_f32 v[218:219], v[122:123], v[218:219]
    v_pk_mul_f32 v[220:221], v[124:125], v[220:221]
    v_pk_mul_f32 v[222:223], v[126:127], v[222:223]
    v_cvt_pk_bf16_f32 v216, v216, v217
    v_cvt_pk_bf16_f32 v217, v218, v219
    v_cvt_pk_bf16_f32 v218, v220, v221
    v_cvt_pk_bf16_f32 v219, v222, v223
    s_nop 0
    v_permlane16_swap_b32 v216, v218
    s_nop 0
    v_permlane16_swap_b32 v217, v219
    v_pk_fma_f32 v[128:129], v[56:57], v[72:73], v[128:129] op_sel:[0,0,0] op_sel_hi:[1,0,1]
    v_pk_fma_f32 v[130:131], v[58:59], v[72:73], v[130:131] op_sel:[0,0,0] op_sel_hi:[1,0,1]
    v_pk_fma_f32 v[224:225], v[68:69], v[72:73], v[224:225] op_sel:[0,0,0] op_sel_hi:[1,0,1]
    v_pk_fma_f32 v[226:227], v[70:71], v[72:73], v[226:227] op_sel:[0,0,0] op_sel_hi:[1,0,1]
    v_pk_fma_f32 v[132:133], v[56:57], v[74:75], v[132:133] op_sel:[0,0,0] op_sel_hi:[1,0,1]
    v_pk_fma_f32 v[134:135], v[58:59], v[74:75], v[134:135] op_sel:[0,0,0] op_sel_hi:[1,0,1]
    v_pk_fma_f32 v[228:229], v[68:69], v[74:75], v[228:229] op_sel:[0,0,0] op_sel_hi:[1,0,1]
    v_pk_fma_f32 v[230:231], v[70:71], v[74:75], v[230:231] op_sel:[0,0,0] op_sel_hi:[1,0,1]
    v_pk_mul_f32 v[224:225], v[128:129], v[224:225]
    v_pk_mul_f32 v[226:227], v[130:131], v[226:227]
    v_pk_mul_f32 v[228:229], v[132:133], v[228:229]
    v_pk_mul_f32 v[230:231], v[134:135], v[230:231]
    v_cvt_pk_bf16_f32 v224, v224, v225
    v_cvt_pk_bf16_f32 v225, v226, v227
    v_cvt_pk_bf16_f32 v226, v228, v229
    v_cvt_pk_bf16_f32 v227, v230, v231
    s_nop 0
    v_permlane16_swap_b32 v224, v226
    s_nop 0
    v_permlane16_swap_b32 v225, v227
    v_pk_fma_f32 v[136:137], v[56:57], v[76:77], v[136:137] op_sel:[0,0,0] op_sel_hi:[1,0,1]
    v_pk_fma_f32 v[138:139], v[58:59], v[76:77], v[138:139] op_sel:[0,0,0] op_sel_hi:[1,0,1]
    v_pk_fma_f32 v[232:233], v[68:69], v[76:77], v[232:233] op_sel:[0,0,0] op_sel_hi:[1,0,1]
    v_pk_fma_f32 v[234:235], v[70:71], v[76:77], v[234:235] op_sel:[0,0,0] op_sel_hi:[1,0,1]
    v_pk_fma_f32 v[140:141], v[56:57], v[78:79], v[140:141] op_sel:[0,0,0] op_sel_hi:[1,0,1]
    v_pk_fma_f32 v[142:143], v[58:59], v[78:79], v[142:143] op_sel:[0,0,0] op_sel_hi:[1,0,1]
    v_pk_fma_f32 v[236:237], v[68:69], v[78:79], v[236:237] op_sel:[0,0,0] op_sel_hi:[1,0,1]
    v_pk_fma_f32 v[238:239], v[70:71], v[78:79], v[238:239] op_sel:[0,0,0] op_sel_hi:[1,0,1]
    v_pk_mul_f32 v[232:233], v[136:137], v[232:233]
    v_pk_mul_f32 v[234:235], v[138:139], v[234:235]
    v_pk_mul_f32 v[236:237], v[140:141], v[236:237]
    v_pk_mul_f32 v[238:239], v[142:143], v[238:239]
    v_cvt_pk_bf16_f32 v232, v232, v233
    v_cvt_pk_bf16_f32 v233, v234, v235
    v_cvt_pk_bf16_f32 v234, v236, v237
    v_cvt_pk_bf16_f32 v235, v238, v239
    s_nop 0
    v_permlane16_swap_b32 v232, v234
    s_nop 0
    v_permlane16_swap_b32 v233, v235
    v_pk_fma_f32 v[144:145], v[56:57], v[80:81], v[144:145] op_sel:[0,0,0] op_sel_hi:[1,0,1]
    v_pk_fma_f32 v[146:147], v[58:59], v[80:81], v[146:147] op_sel:[0,0,0] op_sel_hi:[1,0,1]
    v_pk_fma_f32 v[240:241], v[68:69], v[80:81], v[240:241] op_sel:[0,0,0] op_sel_hi:[1,0,1]
    v_pk_fma_f32 v[242:243], v[70:71], v[80:81], v[242:243] op_sel:[0,0,0] op_sel_hi:[1,0,1]
    v_pk_fma_f32 v[148:149], v[56:57], v[82:83], v[148:149] op_sel:[0,0,0] op_sel_hi:[1,0,1]
    v_pk_fma_f32 v[150:151], v[58:59], v[82:83], v[150:151] op_sel:[0,0,0] op_sel_hi:[1,0,1]
    v_pk_fma_f32 v[244:245], v[68:69], v[82:83], v[244:245] op_sel:[0,0,0] op_sel_hi:[1,0,1]
    v_pk_fma_f32 v[246:247], v[70:71], v[82:83], v[246:247] op_sel:[0,0,0] op_sel_hi:[1,0,1]
    v_pk_mul_f32 v[240:241], v[144:145], v[240:241]
    v_pk_mul_f32 v[242:243], v[146:147], v[242:243]
    v_pk_mul_f32 v[244:245], v[148:149], v[244:245]
    v_pk_mul_f32 v[246:247], v[150:151], v[246:247]
    v_cvt_pk_bf16_f32 v240, v240, v241
    v_cvt_pk_bf16_f32 v241, v242, v243
    v_cvt_pk_bf16_f32 v242, v244, v245
    v_cvt_pk_bf16_f32 v243, v246, v247
    s_nop 0
    v_permlane16_swap_b32 v240, v242
    s_nop 0
    v_permlane16_swap_b32 v241, v243
    v_pk_fma_f32 v[152:153], v[56:57], v[84:85], v[152:153] op_sel:[0,0,0] op_sel_hi:[1,0,1]
    v_pk_fma_f32 v[154:155], v[58:59], v[84:85], v[154:155] op_sel:[0,0,0] op_sel_hi:[1,0,1]
    v_pk_fma_f32 v[248:249], v[68:69], v[84:85], v[248:249] op_sel:[0,0,0] op_sel_hi:[1,0,1]
    v_pk_fma_f32 v[250:251], v[70:71], v[84:85], v[250:251] op_sel:[0,0,0] op_sel_hi:[1,0,1]
    v_pk_fma_f32 v[156:157], v[56:57], v[86:87], v[156:157] op_sel:[0,0,0] op_sel_hi:[1,0,1]
    v_pk_fma_f32 v[158:159], v[58:59], v[86:87], v[158:159] op_sel:[0,0,0] op_sel_hi:[1,0,1]
    v_pk_fma_f32 v[252:253], v[68:69], v[86:87], v[252:253] op_sel:[0,0,0] op_sel_hi:[1,0,1]
    v_pk_fma_f32 v[254:255], v[70:71], v[86:87], v[254:255] op_sel:[0,0,0] op_sel_hi:[1,0,1]
    v_pk_mul_f32 v[248:249], v[152:153], v[248:249]
    v_pk_mul_f32 v[250:251], v[154:155], v[250:251]
    v_pk_mul_f32 v[252:253], v[156:157], v[252:253]
    v_pk_mul_f32 v[254:255], v[158:159], v[254:255]
    v_cvt_pk_bf16_f32 v248, v248, v249
    v_cvt_pk_bf16_f32 v249, v250, v251
    v_cvt_pk_bf16_f32 v250, v252, v253
    v_cvt_pk_bf16_f32 v251, v254, v255
    s_nop 0
    v_permlane16_swap_b32 v248, v250
    s_nop 0
    v_permlane16_swap_b32 v249, v251
    s_lshl_b32 s40, s22, 7
    s_add_u32 s40, s40, s41
    s_lshl_b32 s40, s40, 5
    s_add_u32 s40, s40, 4194304
    v_lshlrev_b32 v23, 4, v22
    s_lshl_b32 s33, s3, 12
    v_add_u32 v23, s33, v23
    s_cmp_eq_u32 s20, 0
    s_cbranch_scc1 L_k2_e1_first
    s_waitcnt vmcnt(0)
    v_readfirstlane_b32 s35, v24
    s_nop 0
    s_cmp_eq_u32 s35, s79
    s_cbranch_scc1 L_k2_e1_got
    s_mov_b32 s34, 0
L_k2_e1_poll:
    buffer_load_dword v24, v25, s[36:39], s63 offen sc1
    s_waitcnt vmcnt(0)
    v_readfirstlane_b32 s35, v24
    s_add_u32 s34, s34, 1
    s_cmp_gt_u32 s34, 0x40000
    s_cbranch_scc1 L_k2_e1_got
    s_cmp_eq_u32 s35, s79
    s_cbranch_scc0 L_k2_e1_poll
L_k2_e1_got:
    s_sub_u32 s34, s20, 1
    s_lshl_b32 s34, s34, 5
    s_add_u32 s34, s34, s21
    s_lshl_b32 s34, s34, 15
    s_add_u32 s34, s34, 23068672
    s_add_u32 s35, s34, 16384
    buffer_load_dwordx4 v[32:35], v23, s[36:39], s34 offen offset:0 sc1
    buffer_load_dwordx4 v[36:39], v23, s[36:39], s34 offen offset:1024 sc1
    buffer_load_dwordx4 v[40:43], v23, s[36:39], s34 offen offset:2048 sc1
    buffer_load_dwordx4 v[44:47], v23, s[36:39], s34 offen offset:3072 sc1
    buffer_load_dwordx4 v[48:51], v23, s[36:39], s35 offen offset:0 sc1
    buffer_load_dwordx4 v[52:55], v23, s[36:39], s35 offen offset:1024 sc1
    buffer_load_dwordx4 v[56:59], v23, s[36:39], s35 offen offset:2048 sc1
    buffer_load_dwordx4 v[60:63], v23, s[36:39], s35 offen offset:3072 sc1
L_k2_e1_have:
    s_mul_i32 s33, s21, 7
    s_add_u32 s33, s33, 68
    s_lshl_b32 s33, s33, 16
    s_add_u32 s33, s33, s40
    buffer_store_dwordx4 v[160:163], v1, s[36:39], s33 offen offset:0 sc1
    buffer_store_dwordx4 v[168:171], v1, s[36:39], s33 offen offset:1024 sc1
    buffer_store_dwordx4 v[176:179], v1, s[36:39], s33 offen offset:2048 sc1
    buffer_store_dwordx4 v[184:187], v1, s[36:39], s33 offen offset:3072 sc1
    s_mul_i32 s33, s21, 7
    s_add_u32 s33, s33, 69
    s_lshl_b32 s33, s33, 16
    s_add_u32 s33, s33, s40
    buffer_store_dwordx4 v[192:195], v1, s[36:39], s33 offen offset:0 sc1
    buffer_store_dwordx4 v[200:203], v1, s[36:39], s33 offen offset:1024 sc1
    buffer_store_dwordx4 v[208:211], v1, s[36:39], s33 offen offset:2048 sc1
    buffer_store_dwordx4 v[216:219], v1, s[36:39], s33 offen offset:3072 sc1
    s_mul_i32 s33, s21, 7
    s_add_u32 s33, s33, 70
    s_lshl_b32 s33, s33, 16
    s_add_u32 s33, s33, s40
    buffer_store_dwordx4 v[224:227], v1, s[36:39], s33 offen offset:0 sc1
    buffer_store_dwordx4 v[232:235], v1, s[36:39], s33 offen offset:1024 sc1
    buffer_store_dwordx4 v[240:243], v1, s[36:39], s33 offen offset:2048 sc1
    buffer_store_dwordx4 v[248:251], v1, s[36:39], s33 offen offset:3072 sc1
    v_and_b32 v24, 31, v22
    v_lshrrev_b32 v25, 5, v22
    v_lshlrev_b32 v13, 5, v24
    v_lshl_add_u32 v13, v25, 4, v13
    s_lshl_b32 s33, s3, 6
    v_add_u32 v27, s33, v24
    v_lshlrev_b32 v30, 3, v27
    v_add_u32 v30, 149508, v30
    ds_read_b32 v14, v30
    ds_read_b32 v16, v30 offset:256
    v_bfe_u32 v26, v24, 2, 2
    v_and_b32 v28, 2, v24
    v_xor_b32 v26, v26, v28
    v_xor_b32 v26, v26, v25
    v_lshlrev_b32 v27, 6, v27
    v_lshl_add_u32 v8, v26, 4, v27
    v_xor_b32 v9, 32, v8
    v_add_u32 v10, 65536, v8
    v_add_u32 v11, 65536, v9
    v_and_b32 v26, 15, v22
    v_lshrrev_b32 v27, 4, v22
    v_and_b32 v28, 1, v27
    v_lshlrev_b32 v28, 1, v28
    v_bfe_u32 v29, v26, 1, 1
    v_or_b32 v28, v28, v29
    v_lshrrev_b32 v29, 3, v26
    v_lshl_or_b32 v29, v25, 1, v29
    v_xor_b32 v28, v28, v29
    v_lshlrev_b32 v28, 4, v28
    v_and_b32 v29, 1, v26
    v_lshl_add_u32 v28, v29, 3, v28
    v_lshrrev_b32 v29, 2, v26
    v_lshl_add_u32 v29, v25, 2, v29
    v_add_u32 v29, s33, v29
    v_lshl_add_u32 v28, v29, 6, v28
    v_add_u32 v12, 32768, v28
    v_lshlrev_b32 v26, 2, v25
    v_add_u32 v27, 0, v26
    v_cmp_le_u32 s[44:45], v27, v24
    v_add_u32 v27, 1, v26
    v_cmp_le_u32 s[46:47], v27, v24
    v_add_u32 v27, 2, v26
    v_cmp_le_u32 s[48:49], v27, v24
    v_add_u32 v27, 3, v26
    v_cmp_le_u32 s[50:51], v27, v24
    v_add_u32 v27, 8, v26
    v_cmp_le_u32 s[52:53], v27, v24
    v_add_u32 v27, 9, v26
    v_cmp_le_u32 s[54:55], v27, v24
    v_add_u32 v27, 10, v26
    v_cmp_le_u32 s[56:57], v27, v24
    v_add_u32 v27, 11, v26
    v_cmp_le_u32 s[58:59], v27, v24
    v_add_u32 v27, 16, v26
    v_cmp_le_u32 s[60:61], v27, v24
    v_add_u32 v27, 17, v26
    v_cmp_le_u32 s[62:63], v27, v24
    v_add_u32 v27, 18, v26
    v_cmp_le_u32 s[64:65], v27, v24
    v_add_u32 v27, 19, v26
    v_cmp_le_u32 s[66:67], v27, v24
    v_add_u32 v27, 24, v26
    v_cmp_le_u32 s[68:69], v27, v24
    v_add_u32 v27, 25, v26
    v_cmp_le_u32 s[70:71], v27, v24
    v_add_u32 v27, 26, v26
    v_cmp_le_u32 s[72:73], v27, v24
    v_add_u32 v27, 27, v26
    v_cmp_le_u32 s[74:75], v27, v24
    s_mov_b32 s76, 0x3e8293ee
    s_waitcnt lgkmcnt(1)
    v_mul_f32 v14, s76, v14
    s_waitcnt lgkmcnt(0)
    v_mul_f32 v16, s76, v16
    v_mov_b32 v15, v14
    v_mov_b32 v17, v16
    v_mov_b32 v18, 0xff800000
    s_lshl_b32 s33, s3, 1
    s_sub_u32 s100, 8, s33
    s_sub_u32 s101, 7, s33
    s_cmp_eq_u32 s20, 0
    s_cselect_b32 s100, s100, 0
    s_cselect_b32 s101, s101, 0
    s_waitcnt vmcnt(19)
    ds_write_b128 v23, v[32:35] offset:0
    s_waitcnt vmcnt(18)
    ds_write_b128 v23, v[36:39] offset:1024
    s_waitcnt vmcnt(17)
    ds_write_b128 v23, v[40:43] offset:2048
    s_waitcnt vmcnt(16)
    ds_write_b128 v23, v[44:47] offset:3072
    s_waitcnt vmcnt(15)
    ds_write_b128 v23, v[48:51] offset:32768
    s_waitcnt vmcnt(14)
    ds_write_b128 v23, v[52:55] offset:33792
    s_waitcnt vmcnt(13)
    ds_write_b128 v23, v[56:59] offset:34816
    s_waitcnt vmcnt(12)
    ds_write_b128 v23, v[60:63] offset:35840
    s_waitcnt lgkmcnt(0)
    s_barrier
    s_branch L_k2_att
L_k2_e1_first:
    s_waitcnt vmcnt(7)
    v_mov_b32 v32, 0
    v_mov_b32 v33, 0
    v_mov_b32 v34, 0
    v_mov_b32 v35, 0
    s_waitcnt vmcnt(6)
    v_mov_b32 v36, 0
    v_mov_b32 v37, 0
    v_mov_b32 v38, 0
    v_mov_b32 v39, 0
    s_waitcnt vmcnt(5)
    v_mov_b32 v40, 0
    v_mov_b32 v41, 0
    v_mov_b32 v42, 0
    v_mov_b32 v43, 0
    s_waitcnt vmcnt(4)
    v_mov_b32 v44, 0
    v_mov_b32 v45, 0
    v_mov_b32 v46, 0
    v_mov_b32 v47, 0
    s_waitcnt vmcnt(3)
    v_mov_b32 v48, 0
    v_mov_b32 v49, 0
    v_mov_b32 v50, 0
    v_mov_b32 v51, 0
    s_waitcnt vmcnt(2)
    v_mov_b32 v52, 0
    v_mov_b32 v53, 0
    v_mov_b32 v54, 0
    v_mov_b32 v55, 0
    s_waitcnt vmcnt(1)
    v_mov_b32 v56, 0
    v_mov_b32 v57, 0
    v_mov_b32 v58, 0
    v_mov_b32 v59, 0
    s_waitcnt vmcnt(0)
    v_mov_b32 v60, 0
    v_mov_b32 v61, 0
    v_mov_b32 v62, 0
    v_mov_b32 v63, 0
    s_branch L_k2_e1_have
L_k2_w1_cs:
    s_waitcnt lgkmcnt(2)
    v_mfma_f32_16x16x32_bf16 a[80:83], a[64:67], a[0:3], a[80:83]
    ds_read_b64_tr_b16 a[72:73], v18 offset:64
    v_mfma_f32_16x16x32_bf16 a[84:87], a[64:67], a[4:7], a[84:87]
    ds_read_b64_tr_b16 a[74:75], v18 offset:1600
    v_mfma_f32_16x16x32_bf16 a[88:91], a[64:67], a[8:11], a[88:91]
    ds_read_b128 a[32:35], v15 offset:0
    v_mfma_f32_16x16x32_bf16 a[92:95], a[64:67], a[12:15], a[92:95]
    ds_read_b128 a[36:39], v15 offset:2048
    v_mfma_f32_16x16x32_bf16 a[96:99], a[64:67], a[16:19], a[96:99]
    buffer_load_dwordx4 v11, s[12:15], s25 offen offset:2048 lds
    v_mfma_f32_16x16x32_bf16 a[100:103], a[64:67], a[20:23], a[100:103]
    v_mfma_f32_16x16x32_bf16 a[104:107], a[64:67], a[24:27], a[104:107]
    v_mfma_f32_16x16x32_bf16 a[108:111], a[64:67], a[28:31], a[108:111]
    v_mfma_f32_16x16x32_bf16 v[32:35], a[64:67], v[72:75], v[32:35]
    s_waitcnt lgkmcnt(4)
    v_mfma_f32_16x16x32_bf16 a[112:115], a[68:71], a[0:3], a[112:115]
    ds_read_b64_tr_b16 a[76:77], v20 offset:96
    v_mfma_f32_16x16x32_bf16 a[116:119], a[68:71], a[4:7], a[116:119]
    ds_read_b64_tr_b16 a[78:79], v20 offset:1632
    v_mfma_f32_16x16x32_bf16 a[120:123], a[68:71], a[8:11], a[120:123]
    ds_read_b128 a[40:43], v15 offset:4096
    v_mfma_f32_16x16x32_bf16 a[124:127], a[68:71], a[12:15], a[124:127]
    ds_read_b128 a[44:47], v15 offset:6144
    v_mfma_f32_16x16x32_bf16 a[128:131], a[68:71], a[16:19], a[128:131]
    buffer_load_dwordx4 v12, s[12:15], s25 offen offset:3072 lds
    v_mfma_f32_16x16x32_bf16 a[132:135], a[68:71], a[20:23], a[132:135]
    v_mfma_f32_16x16x32_bf16 a[136:139], a[68:71], a[24:27], a[136:139]
    v_mfma_f32_16x16x32_bf16 a[140:143], a[68:71], a[28:31], a[140:143]
    v_mfma_f32_16x16x32_bf16 v[36:39], a[68:71], v[72:75], v[36:39]
    s_waitcnt lgkmcnt(6)
    v_mfma_f32_16x16x32_bf16 a[144:147], a[72:75], a[0:3], a[144:147]
    ds_read_b64_tr_b16 a[64:65], v16 offset:6272
    v_mfma_f32_16x16x32_bf16 a[148:151], a[72:75], a[4:7], a[148:151]
    ds_read_b64_tr_b16 a[66:67], v16 offset:8064
    v_mfma_f32_16x16x32_bf16 a[152:155], a[72:75], a[8:11], a[152:155]
    s_add_u32 m0, s30, 61440
    ds_read_b128 a[48:51], v15 offset:8192
    v_mfma_f32_16x16x32_bf16 a[156:159], a[72:75], a[12:15], a[156:159]
    buffer_load_dwordx4 v13, s[12:15], s25 offen offset:0 lds
    v_mfma_f32_16x16x32_bf16 a[160:163], a[72:75], a[16:19], a[160:163]
    s_lshr_b32 s97, s97, 4
    s_and_b32 s33, s97, 7
    s_lshl_b32 s33, s33, 2
    s_mul_i32 s25, s33, s27
    v_mfma_f32_16x16x32_bf16 a[164:167], a[72:75], a[20:23], a[164:167]
    v_mfma_f32_16x16x32_bf16 a[168:171], a[72:75], a[24:27], a[168:171]
    v_mfma_f32_16x16x32_bf16 a[172:175], a[72:75], a[28:31], a[172:175]
    v_mfma_f32_16x16x32_bf16 v[40:43], a[72:75], v[72:75], v[40:43]
    s_waitcnt lgkmcnt(5)
    v_mfma_f32_16x16x32_bf16 a[176:179], a[76:79], a[0:3], a[176:179]
    ds_read_b64_tr_b16 a[68:69], v16 offset:6304
    v_mfma_f32_16x16x32_bf16 a[180:183], a[76:79], a[4:7], a[180:183]
    ds_read_b64_tr_b16 a[70:71], v16 offset:8096
    v_mfma_f32_16x16x32_bf16 a[184:187], a[76:79], a[8:11], a[184:187]
    ds_read_b128 a[52:55], v15 offset:10240
    v_mfma_f32_16x16x32_bf16 a[188:191], a[76:79], a[12:15], a[188:191]
    v_mfma_f32_16x16x32_bf16 a[192:195], a[76:79], a[16:19], a[192:195]
    v_mfma_f32_16x16x32_bf16 a[196:199], a[76:79], a[20:23], a[196:199]
    v_mfma_f32_16x16x32_bf16 a[200:203], a[76:79], a[24:27], a[200:203]
    v_mfma_f32_16x16x32_bf16 a[204:207], a[76:79], a[28:31], a[204:207]
    v_mfma_f32_16x16x32_bf16 v[44:47], a[76:79], v[72:75], v[44:47]
    s_waitcnt lgkmcnt(4)
    v_mfma_f32_16x16x32_bf16 a[208:211], a[64:67], a[0:3], a[208:211]
    ds_read_b64_tr_b16 a[72:73], v16 offset:6336
    v_mfma_f32_16x16x32_bf16 a[212:215], a[64:67], a[4:7], a[212:215]
    ds_read_b64_tr_b16 a[74:75], v16 offset:8128
    v_mfma_f32_16x16x32_bf16 a[216:219], a[64:67], a[8:11], a[216:219]
    ds_read_b128 a[56:59], v15 offset:12288
    v_mfma_f32_16x16x32_bf16 a[220:223], a[64:67], a[12:15], a[220:223]
    v_mfma_f32_16x16x32_bf16 a[224:227], a[64:67], a[16:19], a[224:227]
    v_mfma_f32_16x16x32_bf16 a[228:231], a[64:67], a[20:23], a[228:231]
    v_mfma_f32_16x16x32_bf16 a[232:235], a[64:67], a[24:27], a[232:235]
    v_mfma_f32_16x16x32_bf16 a[236:239], a[64:67], a[28:31], a[236:239]
    v_mfma_f32_16x16x32_bf16 v[48:51], a[64:67], v[72:75], v[48:51]
    s_waitcnt lgkmcnt(4)
    v_mfma_f32_16x16x32_bf16 a[240:243], a[68:71], a[0:3], a[240:243]
    ds_read_b64_tr_b16 a[76:77], v16 offset:13440
    v_mfma_f32_16x16x32_bf16 a[244:247], a[68:71], a[4:7], a[244:247]
    ds_read_b64_tr_b16 a[78:79], v16 offset:15232
    v_mfma_f32_16x16x32_bf16 a[248:251], a[68:71], a[8:11], a[248:251]
    ds_read_b128 a[60:63], v15 offset:14336
    v_mfma_f32_16x16x32_bf16 a[252:255], a[68:71], a[12:15], a[252:255]
    v_mfma_f32_16x16x32_bf16 v[112:115], a[68:71], a[16:19], v[112:115]
    v_mfma_f32_16x16x32_bf16 v[116:119], a[68:71], a[20:23], v[116:119]
    v_mfma_f32_16x16x32_bf16 v[120:123], a[68:71], a[24:27], v[120:123]
    v_mfma_f32_16x16x32_bf16 v[124:127], a[68:71], a[28:31], v[124:127]
    v_mfma_f32_16x16x32_bf16 v[52:55], a[68:71], v[72:75], v[52:55]
    s_waitcnt lgkmcnt(4)
    v_mfma_f32_16x16x32_bf16 v[128:131], a[72:75], a[0:3], v[128:131]
    ds_read_b64_tr_b16 a[64:65], v16 offset:13472
    v_mfma_f32_16x16x32_bf16 v[132:135], a[72:75], a[4:7], v[132:135]
    ds_read_b64_tr_b16 a[66:67], v16 offset:15264
    v_mfma_f32_16x16x32_bf16 v[136:139], a[72:75], a[8:11], v[136:139]
    ds_read_b64_tr_b16 a[68:69], v16 offset:13504
    v_mfma_f32_16x16x32_bf16 v[140:143], a[72:75], a[12:15], v[140:143]
    ds_read_b64_tr_b16 a[70:71], v16 offset:15296
    v_mfma_f32_16x16x32_bf16 v[144:147], a[72:75], a[16:19], v[144:147]
    v_mfma_f32_16x16x32_bf16 v[148:151], a[72:75], a[20:23], v[148:151]
    v_mfma_f32_16x16x32_bf16 v[152:155], a[72:75], a[24:27], v[152:155]
    v_mfma_f32_16x16x32_bf16 v[156:159], a[72:75], a[28:31], v[156:159]
    v_mfma_f32_16x16x32_bf16 v[56:59], a[72:75], v[72:75], v[56:59]
    s_waitcnt lgkmcnt(5)
    v_mfma_f32_16x16x32_bf16 v[160:163], a[76:79], a[0:3], v[160:163]
    v_mfma_f32_16x16x32_bf16 v[164:167], a[76:79], a[4:7], v[164:167]
    v_mfma_f32_16x16x32_bf16 v[168:171], a[76:79], a[8:11], v[168:171]
    v_mfma_f32_16x16x32_bf16 v[172:175], a[76:79], a[12:15], v[172:175]
    v_mfma_f32_16x16x32_bf16 v[176:179], a[76:79], a[16:19], v[176:179]
    v_mfma_f32_16x16x32_bf16 v[180:183], a[76:79], a[20:23], v[180:183]
    v_mfma_f32_16x16x32_bf16 v[184:187], a[76:79], a[24:27], v[184:187]
    v_mfma_f32_16x16x32_bf16 v[188:191], a[76:79], a[28:31], v[188:191]
    v_mfma_f32_16x16x32_bf16 v[60:63], a[76:79], v[72:75], v[60:63]
    s_waitcnt vmcnt(5) lgkmcnt(0)
    s_barrier
    v_mfma_f32_16x16x32_bf16 v[192:195], a[64:67], a[0:3], v[192:195]
    ds_read_b64_tr_b16 a[72:73], v18 offset:20480
    v_mfma_f32_16x16x32_bf16 v[196:199], a[64:67], a[4:7], v[196:199]
    s_add_u32 m0, s29, 0
    ds_read_b64_tr_b16 a[74:75], v18 offset:22016
    v_mfma_f32_16x16x32_bf16 v[200:203], a[64:67], a[8:11], v[200:203]
    buffer_load_dwordx4 v9, s[12:15], s25 offen offset:0 lds
    v_mfma_f32_16x16x32_bf16 v[204:207], a[64:67], a[12:15], v[204:207]
    buffer_load_dwordx4 v10, s[12:15], s25 offen offset:1024 lds
    v_mfma_f32_16x16x32_bf16 v[208:211], a[64:67], a[16:19], v[208:211]
    v_mfma_f32_16x16x32_bf16 v[212:215], a[64:67], a[20:23], v[212:215]
    v_mfma_f32_16x16x32_bf16 v[216:219], a[64:67], a[24:27], v[216:219]
    v_mfma_f32_16x16x32_bf16 v[220:223], a[64:67], a[28:31], v[220:223]
    v_mfma_f32_16x16x32_bf16 v[64:67], a[64:67], v[72:75], v[64:67]
    v_mfma_f32_16x16x32_bf16 v[224:227], a[68:71], a[0:3], v[224:227]
    ds_read_b64_tr_b16 a[76:77], v20 offset:20512
    v_mfma_f32_16x16x32_bf16 v[228:231], a[68:71], a[4:7], v[228:231]
    ds_read_b64_tr_b16 a[78:79], v20 offset:22048
    v_mfma_f32_16x16x32_bf16 v[232:235], a[68:71], a[8:11], v[232:235]
    buffer_load_dwordx4 v11, s[12:15], s25 offen offset:2048 lds
    v_mfma_f32_16x16x32_bf16 v[236:239], a[68:71], a[12:15], v[236:239]
    buffer_load_dwordx4 v12, s[12:15], s25 offen offset:3072 lds
    v_mfma_f32_16x16x32_bf16 v[240:243], a[68:71], a[16:19], v[240:243]
    v_mfma_f32_16x16x32_bf16 v[244:247], a[68:71], a[20:23], v[244:247]
    v_mfma_f32_16x16x32_bf16 v[248:251], a[68:71], a[24:27], v[248:251]
    v_mfma_f32_16x16x32_bf16 v[252:255], a[68:71], a[28:31], v[252:255]
    v_mfma_f32_16x16x32_bf16 v[68:71], a[68:71], v[72:75], v[68:71]
    s_waitcnt lgkmcnt(2)
    v_mfma_f32_16x16x32_bf16 a[80:83], a[72:75], a[32:35], a[80:83]
    ds_read_b64_tr_b16 a[64:65], v18 offset:20544
    v_mfma_f32_16x16x32_bf16 a[84:87], a[72:75], a[36:39], a[84:87]
    ds_read_b64_tr_b16 a[66:67], v18 offset:22080
    v_mfma_f32_16x16x32_bf16 a[88:91], a[72:75], a[40:43], a[88:91]
    ds_read_b128 a[0:3], v14 offset:32768
    v_mfma_f32_16x16x32_bf16 a[92:95], a[72:75], a[44:47], a[92:95]
    s_add_u32 m0, s30, 0
    ds_read_b128 a[4:7], v14 offset:34816
    v_mfma_f32_16x16x32_bf16 a[96:99], a[72:75], a[48:51], a[96:99]
    buffer_load_dwordx4 v13, s[12:15], s25 offen offset:0 lds
    v_mfma_f32_16x16x32_bf16 a[100:103], a[72:75], a[52:55], a[100:103]
    s_add_u32 s25, s25, s27
    s_add_u32 m0, s31, 81920
    v_mfma_f32_16x16x32_bf16 a[104:107], a[72:75], a[56:59], a[104:107]
    buffer_load_dwordx4 v1, s[8:11], s24 offen offset:0 lds
    v_mfma_f32_16x16x32_bf16 a[108:111], a[72:75], a[60:63], a[108:111]
    v_mfma_f32_16x16x32_bf16 v[32:35], a[72:75], v[72:75], v[32:35]
    s_waitcnt lgkmcnt(4)
    v_mfma_f32_16x16x32_bf16 a[112:115], a[76:79], a[32:35], a[112:115]
    ds_read_b64_tr_b16 a[68:69], v20 offset:20576
    v_mfma_f32_16x16x32_bf16 a[116:119], a[76:79], a[36:39], a[116:119]
    ds_read_b64_tr_b16 a[70:71], v20 offset:22112
    v_mfma_f32_16x16x32_bf16 a[120:123], a[76:79], a[40:43], a[120:123]
    ds_read_b128 a[8:11], v14 offset:36864
    v_mfma_f32_16x16x32_bf16 a[124:127], a[76:79], a[44:47], a[124:127]
    ds_read_b128 a[12:15], v14 offset:38912
    v_mfma_f32_16x16x32_bf16 a[128:131], a[76:79], a[48:51], a[128:131]
    buffer_load_dwordx4 v2, s[8:11], s24 offen offset:1024 lds
    v_mfma_f32_16x16x32_bf16 a[132:135], a[76:79], a[52:55], a[132:135]
    v_mfma_f32_16x16x32_bf16 a[136:139], a[76:79], a[56:59], a[136:139]
    v_mfma_f32_16x16x32_bf16 a[140:143], a[76:79], a[60:63], a[140:143]
    v_mfma_f32_16x16x32_bf16 v[36:39], a[76:79], v[72:75], v[36:39]
    s_waitcnt lgkmcnt(6)
    v_mfma_f32_16x16x32_bf16 a[144:147], a[64:67], a[32:35], a[144:147]
    ds_read_b64_tr_b16 a[72:73], v16 offset:26752
    v_mfma_f32_16x16x32_bf16 a[148:151], a[64:67], a[36:39], a[148:151]
    ds_read_b64_tr_b16 a[74:75], v16 offset:28544
    v_mfma_f32_16x16x32_bf16 a[152:155], a[64:67], a[40:43], a[152:155]
    ds_read_b128 a[16:19], v14 offset:40960
    v_mfma_f32_16x16x32_bf16 a[156:159], a[64:67], a[44:47], a[156:159]
    buffer_load_dwordx4 v3, s[8:11], s24 offen offset:2048 lds
    v_mfma_f32_16x16x32_bf16 a[160:163], a[64:67], a[48:51], a[160:163]
    v_mfma_f32_16x16x32_bf16 a[164:167], a[64:67], a[52:55], a[164:167]
    v_mfma_f32_16x16x32_bf16 a[168:171], a[64:67], a[56:59], a[168:171]
    v_mfma_f32_16x16x32_bf16 a[172:175], a[64:67], a[60:63], a[172:175]
    v_mfma_f32_16x16x32_bf16 v[40:43], a[64:67], v[72:75], v[40:43]
    s_waitcnt lgkmcnt(5)
    v_mfma_f32_16x16x32_bf16 a[176:179], a[68:71], a[32:35], a[176:179]
    ds_read_b64_tr_b16 a[76:77], v16 offset:26784
    v_mfma_f32_16x16x32_bf16 a[180:183], a[68:71], a[36:39], a[180:183]
    ds_read_b64_tr_b16 a[78:79], v16 offset:28576
    v_mfma_f32_16x16x32_bf16 a[184:187], a[68:71], a[40:43], a[184:187]
    ds_read_b128 a[20:23], v14 offset:43008
    v_mfma_f32_16x16x32_bf16 a[188:191], a[68:71], a[44:47], a[188:191]
    buffer_load_dwordx4 v4, s[8:11], s24 offen offset:3072 lds
    v_mfma_f32_16x16x32_bf16 a[192:195], a[68:71], a[48:51], a[192:195]
    v_mfma_f32_16x16x32_bf16 a[196:199], a[68:71], a[52:55], a[196:199]
    v_mfma_f32_16x16x32_bf16 a[200:203], a[68:71], a[56:59], a[200:203]
    v_mfma_f32_16x16x32_bf16 a[204:207], a[68:71], a[60:63], a[204:207]
    v_mfma_f32_16x16x32_bf16 v[44:47], a[68:71], v[72:75], v[44:47]
    s_waitcnt lgkmcnt(4)
    v_mfma_f32_16x16x32_bf16 a[208:211], a[72:75], a[32:35], a[208:211]
    ds_read_b64_tr_b16 a[64:65], v16 offset:26816
    v_mfma_f32_16x16x32_bf16 a[212:215], a[72:75], a[36:39], a[212:215]
    ds_read_b64_tr_b16 a[66:67], v16 offset:28608
    v_mfma_f32_16x16x32_bf16 a[216:219], a[72:75], a[40:43], a[216:219]
    s_add_u32 m0, s31, 86016
    ds_read_b128 a[24:27], v14 offset:45056
    v_mfma_f32_16x16x32_bf16 a[220:223], a[72:75], a[44:47], a[220:223]
    buffer_load_dwordx4 v5, s[8:11], s24 offen offset:0 lds
    v_mfma_f32_16x16x32_bf16 a[224:227], a[72:75], a[48:51], a[224:227]
    v_mfma_f32_16x16x32_bf16 a[228:231], a[72:75], a[52:55], a[228:231]
    v_mfma_f32_16x16x32_bf16 a[232:235], a[72:75], a[56:59], a[232:235]
    v_mfma_f32_16x16x32_bf16 a[236:239], a[72:75], a[60:63], a[236:239]
    v_mfma_f32_16x16x32_bf16 v[48:51], a[72:75], v[72:75], v[48:51]
    s_waitcnt lgkmcnt(4)
    v_mfma_f32_16x16x32_bf16 a[240:243], a[76:79], a[32:35], a[240:243]
    ds_read_b64_tr_b16 a[68:69], v16 offset:33920
    v_mfma_f32_16x16x32_bf16 a[244:247], a[76:79], a[36:39], a[244:247]
    ds_read_b64_tr_b16 a[70:71], v16 offset:35712
    v_mfma_f32_16x16x32_bf16 a[248:251], a[76:79], a[40:43], a[248:251]
    ds_read_b128 a[28:31], v14 offset:47104
    v_mfma_f32_16x16x32_bf16 a[252:255], a[76:79], a[44:47], a[252:255]
    buffer_load_dwordx4 v6, s[8:11], s24 offen offset:1024 lds
    v_mfma_f32_16x16x32_bf16 v[112:115], a[76:79], a[48:51], v[112:115]
    v_mfma_f32_16x16x32_bf16 v[116:119], a[76:79], a[52:55], v[116:119]
    v_mfma_f32_16x16x32_bf16 v[120:123], a[76:79], a[56:59], v[120:123]
    v_mfma_f32_16x16x32_bf16 v[124:127], a[76:79], a[60:63], v[124:127]
    v_mfma_f32_16x16x32_bf16 v[52:55], a[76:79], v[72:75], v[52:55]
    s_waitcnt lgkmcnt(4)
    v_mfma_f32_16x16x32_bf16 v[128:131], a[64:67], a[32:35], v[128:131]
    ds_read_b64_tr_b16 a[72:73], v16 offset:33952
    v_mfma_f32_16x16x32_bf16 v[132:135], a[64:67], a[36:39], v[132:135]
    ds_read_b64_tr_b16 a[74:75], v16 offset:35744
    v_mfma_f32_16x16x32_bf16 v[136:139], a[64:67], a[40:43], v[136:139]
    ds_read_b64_tr_b16 a[76:77], v16 offset:33984
    v_mfma_f32_16x16x32_bf16 v[140:143], a[64:67], a[44:47], v[140:143]
    ds_read_b64_tr_b16 a[78:79], v16 offset:35776
    v_mfma_f32_16x16x32_bf16 v[144:147], a[64:67], a[48:51], v[144:147]
    buffer_load_dwordx4 v7, s[8:11], s24 offen offset:2048 lds
    v_mfma_f32_16x16x32_bf16 v[148:151], a[64:67], a[52:55], v[148:151]
    v_mfma_f32_16x16x32_bf16 v[152:155], a[64:67], a[56:59], v[152:155]
    v_mfma_f32_16x16x32_bf16 v[156:159], a[64:67], a[60:63], v[156:159]
    v_mfma_f32_16x16x32_bf16 v[56:59], a[64:67], v[72:75], v[56:59]
    s_waitcnt lgkmcnt(5)
    v_mfma_f32_16x16x32_bf16 v[160:163], a[68:71], a[32:35], v[160:163]
    v_mfma_f32_16x16x32_bf16 v[164:167], a[68:71], a[36:39], v[164:167]
    v_mfma_f32_16x16x32_bf16 v[168:171], a[68:71], a[40:43], v[168:171]
    buffer_load_dwordx4 v8, s[8:11], s24 offen offset:3072 lds
    v_mfma_f32_16x16x32_bf16 v[172:175], a[68:71], a[44:47], v[172:175]
    s_add_u32 s24, s24, 128
    v_mfma_f32_16x16x32_bf16 v[176:179], a[68:71], a[48:51], v[176:179]
    v_mfma_f32_16x16x32_bf16 v[180:183], a[68:71], a[52:55], v[180:183]
    v_mfma_f32_16x16x32_bf16 v[184:187], a[68:71], a[56:59], v[184:187]
    v_mfma_f32_16x16x32_bf16 v[188:191], a[68:71], a[60:63], v[188:191]
    v_mfma_f32_16x16x32_bf16 v[60:63], a[68:71], v[72:75], v[60:63]
    s_waitcnt vmcnt(25) lgkmcnt(0)
    s_barrier
    v_mfma_f32_16x16x32_bf16 v[192:195], a[72:75], a[32:35], v[192:195]
    ds_read_b64_tr_b16 a[64:65], v19 offset:0
    v_mfma_f32_16x16x32_bf16 v[196:199], a[72:75], a[36:39], v[196:199]
    s_add_u32 m0, s29, 20480
    ds_read_b64_tr_b16 a[66:67], v19 offset:1536
    v_mfma_f32_16x16x32_bf16 v[200:203], a[72:75], a[40:43], v[200:203]
    buffer_load_dwordx4 v9, s[12:15], s25 offen offset:0 lds
    v_mfma_f32_16x16x32_bf16 v[204:207], a[72:75], a[44:47], v[204:207]
    v_mfma_f32_16x16x32_bf16 v[208:211], a[72:75], a[48:51], v[208:211]
    v_mfma_f32_16x16x32_bf16 v[212:215], a[72:75], a[52:55], v[212:215]
    v_mfma_f32_16x16x32_bf16 v[216:219], a[72:75], a[56:59], v[216:219]
    v_mfma_f32_16x16x32_bf16 v[220:223], a[72:75], a[60:63], v[220:223]
    v_mfma_f32_16x16x32_bf16 v[64:67], a[72:75], v[72:75], v[64:67]
    v_mfma_f32_16x16x32_bf16 v[224:227], a[76:79], a[32:35], v[224:227]
    ds_read_b64_tr_b16 a[68:69], v21 offset:32
    v_mfma_f32_16x16x32_bf16 v[228:231], a[76:79], a[36:39], v[228:231]
    ds_read_b64_tr_b16 a[70:71], v21 offset:1568
    v_mfma_f32_16x16x32_bf16 v[232:235], a[76:79], a[40:43], v[232:235]
    buffer_load_dwordx4 v10, s[12:15], s25 offen offset:1024 lds
    v_mfma_f32_16x16x32_bf16 v[236:239], a[76:79], a[44:47], v[236:239]
    v_mfma_f32_16x16x32_bf16 v[240:243], a[76:79], a[48:51], v[240:243]
    v_mfma_f32_16x16x32_bf16 v[244:247], a[76:79], a[52:55], v[244:247]
    v_mfma_f32_16x16x32_bf16 v[248:251], a[76:79], a[56:59], v[248:251]
    v_mfma_f32_16x16x32_bf16 v[252:255], a[76:79], a[60:63], v[252:255]
    v_mfma_f32_16x16x32_bf16 v[68:71], a[76:79], v[72:75], v[68:71]
    s_waitcnt lgkmcnt(2)
    v_mfma_f32_16x16x32_bf16 a[80:83], a[64:67], a[0:3], a[80:83]
    ds_read_b64_tr_b16 a[72:73], v19 offset:64
    v_mfma_f32_16x16x32_bf16 a[84:87], a[64:67], a[4:7], a[84:87]
    ds_read_b64_tr_b16 a[74:75], v19 offset:1600
    v_mfma_f32_16x16x32_bf16 a[88:91], a[64:67], a[8:11], a[88:91]
    ds_read_b128 a[32:35], v15 offset:32768
    v_mfma_f32_16x16x32_bf16 a[92:95], a[64:67], a[12:15], a[92:95]
    ds_read_b128 a[36:39], v15 offset:34816
    v_mfma_f32_16x16x32_bf16 a[96:99], a[64:67], a[16:19], a[96:99]
    buffer_load_dwordx4 v11, s[12:15], s25 offen offset:2048 lds
    v_mfma_f32_16x16x32_bf16 a[100:103], a[64:67], a[20:23], a[100:103]
    v_mfma_f32_16x16x32_bf16 a[104:107], a[64:67], a[24:27], a[104:107]
    v_mfma_f32_16x16x32_bf16 a[108:111], a[64:67], a[28:31], a[108:111]
    v_mfma_f32_16x16x32_bf16 v[32:35], a[64:67], v[72:75], v[32:35]
    s_waitcnt lgkmcnt(4)
    v_mfma_f32_16x16x32_bf16 a[112:115], a[68:71], a[0:3], a[112:115]
    ds_read_b64_tr_b16 a[76:77], v21 offset:96
    v_mfma_f32_16x16x32_bf16 a[116:119], a[68:71], a[4:7], a[116:119]
    ds_read_b64_tr_b16 a[78:79], v21 offset:1632
    v_mfma_f32_16x16x32_bf16 a[120:123], a[68:71], a[8:11], a[120:123]
    ds_read_b128 a[40:43], v15 offset:36864
    v_mfma_f32_16x16x32_bf16 a[124:127], a[68:71], a[12:15], a[124:127]
    ds_read_b128 a[44:47], v15 offset:38912
    v_mfma_f32_16x16x32_bf16 a[128:131], a[68:71], a[16:19], a[128:131]
    buffer_load_dwordx4 v12, s[12:15], s25 offen offset:3072 lds
    v_mfma_f32_16x16x32_bf16 a[132:135], a[68:71], a[20:23], a[132:135]
    v_mfma_f32_16x16x32_bf16 a[136:139], a[68:71], a[24:27], a[136:139]
    v_mfma_f32_16x16x32_bf16 a[140:143], a[68:71], a[28:31], a[140:143]
    v_mfma_f32_16x16x32_bf16 v[36:39], a[68:71], v[72:75], v[36:39]
    s_waitcnt lgkmcnt(6)
    v_mfma_f32_16x16x32_bf16 a[144:147], a[72:75], a[0:3], a[144:147]
    ds_read_b64_tr_b16 a[64:65], v17 offset:6272
    v_mfma_f32_16x16x32_bf16 a[148:151], a[72:75], a[4:7], a[148:151]
    ds_read_b64_tr_b16 a[66:67], v17 offset:8064
    v_mfma_f32_16x16x32_bf16 a[152:155], a[72:75], a[8:11], a[152:155]
    s_add_u32 m0, s30, 20480
    ds_read_b128 a[48:51], v15 offset:40960
    v_mfma_f32_16x16x32_bf16 a[156:159], a[72:75], a[12:15], a[156:159]
    buffer_load_dwordx4 v13, s[12:15], s25 offen offset:0 lds
    v_mfma_f32_16x16x32_bf16 a[160:163], a[72:75], a[16:19], a[160:163]
    s_add_u32 s25, s25, s27
    v_mfma_f32_16x16x32_bf16 a[164:167], a[72:75], a[20:23], a[164:167]
    v_mfma_f32_16x16x32_bf16 a[168:171], a[72:75], a[24:27], a[168:171]
    v_mfma_f32_16x16x32_bf16 a[172:175], a[72:75], a[28:31], a[172:175]
    v_mfma_f32_16x16x32_bf16 v[40:43], a[72:75], v[72:75], v[40:43]
    s_waitcnt lgkmcnt(5)
    v_mfma_f32_16x16x32_bf16 a[176:179], a[76:79], a[0:3], a[176:179]
    ds_read_b64_tr_b16 a[68:69], v17 offset:6304
    v_mfma_f32_16x16x32_bf16 a[180:183], a[76:79], a[4:7], a[180:183]
    ds_read_b64_tr_b16 a[70:71], v17 offset:8096
    v_mfma_f32_16x16x32_bf16 a[184:187], a[76:79], a[8:11], a[184:187]
    ds_read_b128 a[52:55], v15 offset:43008
    v_mfma_f32_16x16x32_bf16 a[188:191], a[76:79], a[12:15], a[188:191]
    v_mfma_f32_16x16x32_bf16 a[192:195], a[76:79], a[16:19], a[192:195]
    v_mfma_f32_16x16x32_bf16 a[196:199], a[76:79], a[20:23], a[196:199]
    v_mfma_f32_16x16x32_bf16 a[200:203], a[76:79], a[24:27], a[200:203]
    v_mfma_f32_16x16x32_bf16 a[204:207], a[76:79], a[28:31], a[204:207]
    v_mfma_f32_16x16x32_bf16 v[44:47], a[76:79], v[72:75], v[44:47]
    s_waitcnt lgkmcnt(4)
    v_mfma_f32_16x16x32_bf16 a[208:211], a[64:67], a[0:3], a[208:211]
    ds_read_b64_tr_b16 a[72:73], v17 offset:6336
    v_mfma_f32_16x16x32_bf16 a[212:215], a[64:67], a[4:7], a[212:215]
    ds_read_b64_tr_b16 a[74:75], v17 offset:8128
    v_mfma_f32_16x16x32_bf16 a[216:219], a[64:67], a[8:11], a[216:219]
    ds_read_b128 a[56:59], v15 offset:45056
    v_mfma_f32_16x16x32_bf16 a[220:223], a[64:67], a[12:15], a[220:223]
    v_mfma_f32_16x16x32_bf16 a[224:227], a[64:67], a[16:19], a[224:227]
    v_mfma_f32_16x16x32_bf16 a[228:231], a[64:67], a[20:23], a[228:231]
    v_mfma_f32_16x16x32_bf16 a[232:235], a[64:67], a[24:27], a[232:235]
    v_mfma_f32_16x16x32_bf16 a[236:239], a[64:67], a[28:31], a[236:239]
    v_mfma_f32_16x16x32_bf16 v[48:51], a[64:67], v[72:75], v[48:51]
    s_waitcnt lgkmcnt(4)
    v_mfma_f32_16x16x32_bf16 a[240:243], a[68:71], a[0:3], a[240:243]
    ds_read_b64_tr_b16 a[76:77], v17 offset:13440
    v_mfma_f32_16x16x32_bf16 a[244:247], a[68:71], a[4:7], a[244:247]
    ds_read_b64_tr_b16 a[78:79], v17 offset:15232
    v_mfma_f32_16x16x32_bf16 a[248:251], a[68:71], a[8:11], a[248:251]
    ds_read_b128 a[60:63], v15 offset:47104
    v_mfma_f32_16x16x32_bf16 a[252:255], a[68:71], a[12:15], a[252:255]
    v_mfma_f32_16x16x32_bf16 v[112:115], a[68:71], a[16:19], v[112:115]
    v_mfma_f32_16x16x32_bf16 v[116:119], a[68:71], a[20:23], v[116:119]
    v_mfma_f32_16x16x32_bf16 v[120:123], a[68:71], a[24:27], v[120:123]
    v_mfma_f32_16x16x32_bf16 v[124:127], a[68:71], a[28:31], v[124:127]
    v_mfma_f32_16x16x32_bf16 v[52:55], a[68:71], v[72:75], v[52:55]
    s_waitcnt lgkmcnt(4)
    v_mfma_f32_16x16x32_bf16 v[128:131], a[72:75], a[0:3], v[128:131]
    ds_read_b64_tr_b16 a[64:65], v17 offset:13472
    v_mfma_f32_16x16x32_bf16 v[132:135], a[72:75], a[4:7], v[132:135]
    ds_read_b64_tr_b16 a[66:67], v17 offset:15264
    v_mfma_f32_16x16x32_bf16 v[136:139], a[72:75], a[8:11], v[136:139]
    ds_read_b64_tr_b16 a[68:69], v17 offset:13504
    v_mfma_f32_16x16x32_bf16 v[140:143], a[72:75], a[12:15], v[140:143]
    ds_read_b64_tr_b16 a[70:71], v17 offset:15296
    v_mfma_f32_16x16x32_bf16 v[144:147], a[72:75], a[16:19], v[144:147]
    v_mfma_f32_16x16x32_bf16 v[148:151], a[72:75], a[20:23], v[148:151]
    v_mfma_f32_16x16x32_bf16 v[152:155], a[72:75], a[24:27], v[152:155]
    v_mfma_f32_16x16x32_bf16 v[156:159], a[72:75], a[28:31], v[156:159]
    v_mfma_f32_16x16x32_bf16 v[56:59], a[72:75], v[72:75], v[56:59]
    s_waitcnt lgkmcnt(5)
    v_mfma_f32_16x16x32_bf16 v[160:163], a[76:79], a[0:3], v[160:163]
    v_mfma_f32_16x16x32_bf16 v[164:167], a[76:79], a[4:7], v[164:167]
    v_mfma_f32_16x16x32_bf16 v[168:171], a[76:79], a[8:11], v[168:171]
    v_mfma_f32_16x16x32_bf16 v[172:175], a[76:79], a[12:15], v[172:175]
    v_mfma_f32_16x16x32_bf16 v[176:179], a[76:79], a[16:19], v[176:179]
    v_mfma_f32_16x16x32_bf16 v[180:183], a[76:79], a[20:23], v[180:183]
    v_mfma_f32_16x16x32_bf16 v[184:187], a[76:79], a[24:27], v[184:187]
    v_mfma_f32_16x16x32_bf16 v[188:191], a[76:79], a[28:31], v[188:191]
    v_mfma_f32_16x16x32_bf16 v[60:63], a[76:79], v[72:75], v[60:63]
    s_waitcnt vmcnt(5) lgkmcnt(0)
    s_barrier
    v_mfma_f32_16x16x32_bf16 v[192:195], a[64:67], a[0:3], v[192:195]
    ds_read_b64_tr_b16 a[72:73], v19 offset:20480
    v_mfma_f32_16x16x32_bf16 v[196:199], a[64:67], a[4:7], v[196:199]
    s_add_u32 m0, s29, 40960
    ds_read_b64_tr_b16 a[74:75], v19 offset:22016
    v_mfma_f32_16x16x32_bf16 v[200:203], a[64:67], a[8:11], v[200:203]
    buffer_load_dwordx4 v9, s[12:15], s25 offen offset:0 lds
    v_mfma_f32_16x16x32_bf16 v[204:207], a[64:67], a[12:15], v[204:207]
    buffer_load_dwordx4 v10, s[12:15], s25 offen offset:1024 lds
    v_mfma_f32_16x16x32_bf16 v[208:211], a[64:67], a[16:19], v[208:211]
    v_mfma_f32_16x16x32_bf16 v[212:215], a[64:67], a[20:23], v[212:215]
    v_mfma_f32_16x16x32_bf16 v[216:219], a[64:67], a[24:27], v[216:219]
    v_mfma_f32_16x16x32_bf16 v[220:223], a[64:67], a[28:31], v[220:223]
    v_mfma_f32_16x16x32_bf16 v[64:67], a[64:67], v[72:75], v[64:67]
    v_mfma_f32_16x16x32_bf16 v[224:227], a[68:71], a[0:3], v[224:227]
    ds_read_b64_tr_b16 a[76:77], v21 offset:20512
    v_mfma_f32_16x16x32_bf16 v[228:231], a[68:71], a[4:7], v[228:231]
    ds_read_b64_tr_b16 a[78:79], v21 offset:22048
    v_mfma_f32_16x16x32_bf16 v[232:235], a[68:71], a[8:11], v[232:235]
    buffer_load_dwordx4 v11, s[12:15], s25 offen offset:2048 lds
    v_mfma_f32_16x16x32_bf16 v[236:239], a[68:71], a[12:15], v[236:239]
    buffer_load_dwordx4 v12, s[12:15], s25 offen offset:3072 lds
    v_mfma_f32_16x16x32_bf16 v[240:243], a[68:71], a[16:19], v[240:243]
    v_mfma_f32_16x16x32_bf16 v[244:247], a[68:71], a[20:23], v[244:247]
    v_mfma_f32_16x16x32_bf16 v[248:251], a[68:71], a[24:27], v[248:251]
    v_mfma_f32_16x16x32_bf16 v[252:255], a[68:71], a[28:31], v[252:255]
    v_mfma_f32_16x16x32_bf16 v[68:71], a[68:71], v[72:75], v[68:71]
    s_waitcnt lgkmcnt(2)
    v_mfma_f32_16x16x32_bf16 a[80:83], a[72:75], a[32:35], a[80:83]
    ds_read_b64_tr_b16 a[64:65], v19 offset:20544
    v_mfma_f32_16x16x32_bf16 a[84:87], a[72:75], a[36:39], a[84:87]
    ds_read_b64_tr_b16 a[66:67], v19 offset:22080
    v_mfma_f32_16x16x32_bf16 a[88:91], a[72:75], a[40:43], a[88:91]
    ds_read_b128 a[0:3], v14 offset:0
    v_mfma_f32_16x16x32_bf16 a[92:95], a[72:75], a[44:47], a[92:95]
    s_add_u32 m0, s30, 40960
    ds_read_b128 a[4:7], v14 offset:2048
    v_mfma_f32_16x16x32_bf16 a[96:99], a[72:75], a[48:51], a[96:99]
    buffer_load_dwordx4 v13, s[12:15], s25 offen offset:0 lds
    v_mfma_f32_16x16x32_bf16 a[100:103], a[72:75], a[52:55], a[100:103]
    s_add_u32 s25, s25, s27
    s_add_u32 m0, s31, 114688
    v_mfma_f32_16x16x32_bf16 a[104:107], a[72:75], a[56:59], a[104:107]
    buffer_load_dwordx4 v1, s[8:11], s24 offen offset:0 lds
    v_mfma_f32_16x16x32_bf16 a[108:111], a[72:75], a[60:63], a[108:111]
    v_mfma_f32_16x16x32_bf16 v[32:35], a[72:75], v[72:75], v[32:35]
    s_waitcnt lgkmcnt(4)
    v_mfma_f32_16x16x32_bf16 a[112:115], a[76:79], a[32:35], a[112:115]
    ds_read_b64_tr_b16 a[68:69], v21 offset:20576
    v_mfma_f32_16x16x32_bf16 a[116:119], a[76:79], a[36:39], a[116:119]
    ds_read_b64_tr_b16 a[70:71], v21 offset:22112
    v_mfma_f32_16x16x32_bf16 a[120:123], a[76:79], a[40:43], a[120:123]
    ds_read_b128 a[8:11], v14 offset:4096
    v_mfma_f32_16x16x32_bf16 a[124:127], a[76:79], a[44:47], a[124:127]
    ds_read_b128 a[12:15], v14 offset:6144
    v_mfma_f32_16x16x32_bf16 a[128:131], a[76:79], a[48:51], a[128:131]
    buffer_load_dwordx4 v2, s[8:11], s24 offen offset:1024 lds
    v_mfma_f32_16x16x32_bf16 a[132:135], a[76:79], a[52:55], a[132:135]
    v_mfma_f32_16x16x32_bf16 a[136:139], a[76:79], a[56:59], a[136:139]
    v_mfma_f32_16x16x32_bf16 a[140:143], a[76:79], a[60:63], a[140:143]
    v_mfma_f32_16x16x32_bf16 v[36:39], a[76:79], v[72:75], v[36:39]
    s_waitcnt lgkmcnt(6)
    v_mfma_f32_16x16x32_bf16 a[144:147], a[64:67], a[32:35], a[144:147]
    ds_read_b64_tr_b16 a[72:73], v17 offset:26752
    v_mfma_f32_16x16x32_bf16 a[148:151], a[64:67], a[36:39], a[148:151]
    ds_read_b64_tr_b16 a[74:75], v17 offset:28544
    v_mfma_f32_16x16x32_bf16 a[152:155], a[64:67], a[40:43], a[152:155]
    ds_read_b128 a[16:19], v14 offset:8192
    v_mfma_f32_16x16x32_bf16 a[156:159], a[64:67], a[44:47], a[156:159]
    buffer_load_dwordx4 v3, s[8:11], s24 offen offset:2048 lds
    v_mfma_f32_16x16x32_bf16 a[160:163], a[64:67], a[48:51], a[160:163]
    v_mfma_f32_16x16x32_bf16 a[164:167], a[64:67], a[52:55], a[164:167]
    v_mfma_f32_16x16x32_bf16 a[168:171], a[64:67], a[56:59], a[168:171]
    v_mfma_f32_16x16x32_bf16 a[172:175], a[64:67], a[60:63], a[172:175]
    v_mfma_f32_16x16x32_bf16 v[40:43], a[64:67], v[72:75], v[40:43]
    s_waitcnt lgkmcnt(5)
    v_mfma_f32_16x16x32_bf16 a[176:179], a[68:71], a[32:35], a[176:179]
    ds_read_b64_tr_b16 a[76:77], v17 offset:26784
    v_mfma_f32_16x16x32_bf16 a[180:183], a[68:71], a[36:39], a[180:183]
    ds_read_b64_tr_b16 a[78:79], v17 offset:28576
    v_mfma_f32_16x16x32_bf16 a[184:187], a[68:71], a[40:43], a[184:187]
    ds_read_b128 a[20:23], v14 offset:10240
    v_mfma_f32_16x16x32_bf16 a[188:191], a[68:71], a[44:47], a[188:191]
    buffer_load_dwordx4 v4, s[8:11], s24 offen offset:3072 lds
    v_mfma_f32_16x16x32_bf16 a[192:195], a[68:71], a[48:51], a[192:195]
    v_mfma_f32_16x16x32_bf16 a[196:199], a[68:71], a[52:55], a[196:199]
    v_mfma_f32_16x16x32_bf16 a[200:203], a[68:71], a[56:59], a[200:203]
    v_mfma_f32_16x16x32_bf16 a[204:207], a[68:71], a[60:63], a[204:207]
    v_mfma_f32_16x16x32_bf16 v[44:47], a[68:71], v[72:75], v[44:47]
    s_waitcnt lgkmcnt(4)
    v_mfma_f32_16x16x32_bf16 a[208:211], a[72:75], a[32:35], a[208:211]
    ds_read_b64_tr_b16 a[64:65], v17 offset:26816
    v_mfma_f32_16x16x32_bf16 a[212:215], a[72:75], a[36:39], a[212:215]
    ds_read_b64_tr_b16 a[66:67], v17 offset:28608
    v_mfma_f32_16x16x32_bf16 a[216:219], a[72:75], a[40:43], a[216:219]
    s_add_u32 m0, s31, 118784
    ds_read_b128 a[24:27], v14 offset:12288
    v_mfma_f32_16x16x32_bf16 a[220:223], a[72:75], a[44:47], a[220:223]
    buffer_load_dwordx4 v5, s[8:11], s24 offen offset:0 lds
    v_mfma_f32_16x16x32_bf16 a[224:227], a[72:75], a[48:51], a[224:227]
    v_mfma_f32_16x16x32_bf16 a[228:231], a[72:75], a[52:55], a[228:231]
    v_mfma_f32_16x16x32_bf16 a[232:235], a[72:75], a[56:59], a[232:235]
    v_mfma_f32_16x16x32_bf16 a[236:239], a[72:75], a[60:63], a[236:239]
    v_mfma_f32_16x16x32_bf16 v[48:51], a[72:75], v[72:75], v[48:51]
    s_waitcnt lgkmcnt(4)
    v_mfma_f32_16x16x32_bf16 a[240:243], a[76:79], a[32:35], a[240:243]
    ds_read_b64_tr_b16 a[68:69], v17 offset:33920
    v_mfma_f32_16x16x32_bf16 a[244:247], a[76:79], a[36:39], a[244:247]
    ds_read_b64_tr_b16 a[70:71], v17 offset:35712
    v_mfma_f32_16x16x32_bf16 a[248:251], a[76:79], a[40:43], a[248:251]
    ds_read_b128 a[28:31], v14 offset:14336
    v_mfma_f32_16x16x32_bf16 a[252:255], a[76:79], a[44:47], a[252:255]
    buffer_load_dwordx4 v6, s[8:11], s24 offen offset:1024 lds
    v_mfma_f32_16x16x32_bf16 v[112:115], a[76:79], a[48:51], v[112:115]
    v_mfma_f32_16x16x32_bf16 v[116:119], a[76:79], a[52:55], v[116:119]
    v_mfma_f32_16x16x32_bf16 v[120:123], a[76:79], a[56:59], v[120:123]
    v_mfma_f32_16x16x32_bf16 v[124:127], a[76:79], a[60:63], v[124:127]
    v_mfma_f32_16x16x32_bf16 v[52:55], a[76:79], v[72:75], v[52:55]
    s_waitcnt lgkmcnt(4)
    v_mfma_f32_16x16x32_bf16 v[128:131], a[64:67], a[32:35], v[128:131]
    ds_read_b64_tr_b16 a[72:73], v17 offset:33952
    v_mfma_f32_16x16x32_bf16 v[132:135], a[64:67], a[36:39], v[132:135]
    ds_read_b64_tr_b16 a[74:75], v17 offset:35744
    v_mfma_f32_16x16x32_bf16 v[136:139], a[64:67], a[40:43], v[136:139]
    ds_read_b64_tr_b16 a[76:77], v17 offset:33984
    v_mfma_f32_16x16x32_bf16 v[140:143], a[64:67], a[44:47], v[140:143]
    ds_read_b64_tr_b16 a[78:79], v17 offset:35776
    v_mfma_f32_16x16x32_bf16 v[144:147], a[64:67], a[48:51], v[144:147]
    buffer_load_dwordx4 v7, s[8:11], s24 offen offset:2048 lds
    v_mfma_f32_16x16x32_bf16 v[148:151], a[64:67], a[52:55], v[148:151]
    v_mfma_f32_16x16x32_bf16 v[152:155], a[64:67], a[56:59], v[152:155]
    v_mfma_f32_16x16x32_bf16 v[156:159], a[64:67], a[60:63], v[156:159]
    v_mfma_f32_16x16x32_bf16 v[56:59], a[64:67], v[72:75], v[56:59]
    s_waitcnt lgkmcnt(5)
    v_mfma_f32_16x16x32_bf16 v[160:163], a[68:71], a[32:35], v[160:163]
    v_mfma_f32_16x16x32_bf16 v[164:167], a[68:71], a[36:39], v[164:167]
    v_mfma_f32_16x16x32_bf16 v[168:171], a[68:71], a[40:43], v[168:171]
    buffer_load_dwordx4 v8, s[8:11], s24 offen offset:3072 lds
    v_mfma_f32_16x16x32_bf16 v[172:175], a[68:71], a[44:47], v[172:175]
    s_lshr_b32 s98, s98, 4
    s_and_b32 s24, s98, 7
    s_lshl_b32 s24, s24, 8
    v_mfma_f32_16x16x32_bf16 v[176:179], a[68:71], a[48:51], v[176:179]
    v_mfma_f32_16x16x32_bf16 v[180:183], a[68:71], a[52:55], v[180:183]
    v_mfma_f32_16x16x32_bf16 v[184:187], a[68:71], a[56:59], v[184:187]
    v_mfma_f32_16x16x32_bf16 v[188:191], a[68:71], a[60:63], v[188:191]
    v_mfma_f32_16x16x32_bf16 v[60:63], a[68:71], v[72:75], v[60:63]
    s_waitcnt lgkmcnt(0)
    s_barrier
    v_mfma_f32_16x16x32_bf16 v[192:195], a[72:75], a[32:35], v[192:195]
    ds_read_b64_tr_b16 a[64:65], v18 offset:0
    v_mfma_f32_16x16x32_bf16 v[196:199], a[72:75], a[36:39], v[196:199]
    s_add_u32 m0, s29, 61440
    ds_read_b64_tr_b16 a[66:67], v18 offset:1536
    v_mfma_f32_16x16x32_bf16 v[200:203], a[72:75], a[40:43], v[200:203]
    buffer_load_dwordx4 v9, s[12:15], s25 offen offset:0 lds
    v_mfma_f32_16x16x32_bf16 v[204:207], a[72:75], a[44:47], v[204:207]
    v_mfma_f32_16x16x32_bf16 v[208:211], a[72:75], a[48:51], v[208:211]
    v_mfma_f32_16x16x32_bf16 v[212:215], a[72:75], a[52:55], v[212:215]
    v_mfma_f32_16x16x32_bf16 v[216:219], a[72:75], a[56:59], v[216:219]
    v_mfma_f32_16x16x32_bf16 v[220:223], a[72:75], a[60:63], v[220:223]
    v_mfma_f32_16x16x32_bf16 v[64:67], a[72:75], v[72:75], v[64:67]
    v_mfma_f32_16x16x32_bf16 v[224:227], a[76:79], a[32:35], v[224:227]
    ds_read_b64_tr_b16 a[68:69], v20 offset:32
    v_mfma_f32_16x16x32_bf16 v[228:231], a[76:79], a[36:39], v[228:231]
    ds_read_b64_tr_b16 a[70:71], v20 offset:1568
    v_mfma_f32_16x16x32_bf16 v[232:235], a[76:79], a[40:43], v[232:235]
    buffer_load_dwordx4 v10, s[12:15], s25 offen offset:1024 lds
    v_mfma_f32_16x16x32_bf16 v[236:239], a[76:79], a[44:47], v[236:239]
    v_mfma_f32_16x16x32_bf16 v[240:243], a[76:79], a[48:51], v[240:243]
    v_mfma_f32_16x16x32_bf16 v[244:247], a[76:79], a[52:55], v[244:247]
    v_mfma_f32_16x16x32_bf16 v[248:251], a[76:79], a[56:59], v[248:251]
    v_mfma_f32_16x16x32_bf16 v[252:255], a[76:79], a[60:63], v[252:255]
    v_mfma_f32_16x16x32_bf16 v[68:71], a[76:79], v[72:75], v[68:71]
    s_branch L_k2_w1_after
L_k2_w1_a1:
    s_lshl_b32 s33, s21, 3
    s_add_u32 s33, s33, s20
    s_mul_i32 s33, s33, 1280
    s_add_u32 s33, s33, 39977600
    v_lshrrev_b32 v23, 4, v22
    v_lshlrev_b32 v23, 4, v23
    s_mov_b32 s44, 0x00010001
    s_mov_b32 s45, 0x00010001
    s_mov_b64 exec, s[44:45]
    buffer_store_dwordx4 v[32:35], v23, s[36:39], s33 offen offset:0 sc1
    buffer_store_dwordx4 v[36:39], v23, s[36:39], s33 offen offset:64 sc1
    buffer_store_dwordx4 v[40:43], v23, s[36:39], s33 offen offset:128 sc1
    buffer_store_dwordx4 v[44:47], v23, s[36:39], s33 offen offset:192 sc1
    buffer_store_dwordx4 v[48:51], v23, s[36:39], s33 offen offset:256 sc1
    buffer_store_dwordx4 v[52:55], v23, s[36:39], s33 offen offset:320 sc1
    buffer_store_dwordx4 v[56:59], v23, s[36:39], s33 offen offset:384 sc1
    buffer_store_dwordx4 v[60:63], v23, s[36:39], s33 offen offset:448 sc1
    buffer_store_dwordx4 v[64:67], v23, s[36:39], s33 offen offset:512 sc1
    buffer_store_dwordx4 v[68:71], v23, s[36:39], s33 offen offset:576 sc1
    s_mov_b64 exec, -1
    s_branch L_k2_w1_b1
L_k2_w1_a2:
    v_readfirstlane_b32 s96, v110
    v_readfirstlane_b32 s79, v110
    s_cmp_lg_u32 s3, 0
    s_cbranch_scc1 L_k2_w1_b2
    v_mov_b32 v23, 0
    v_mov_b32 v24, 1
    s_mov_b64 exec, 1
    global_atomic_add v23, v24, s[42:43] sc1
    s_mov_b64 exec, -1
    s_branch L_k2_w1_b2
L_k2_w1_s0:
    s_mov_b32 s58, 0xffff0000
    s_mov_b32 s59, 0xba800000
    s_mov_b32 s60, 0x3727c5ac
    s_mov_b32 s61, 0x3a800000
    v_mov_b32 v92, 0x3f803f80
    v_dot2_f32_bf16 v96, v76, v92, 0
    v_dot2_f32_bf16 v97, v76, v76, 0
    v_dot2_f32_bf16 v98, v84, v92, 0
    v_dot2_f32_bf16 v99, v84, v84, 0
    v_dot2_f32_bf16 v96, v77, v92, v96
    v_dot2_f32_bf16 v97, v77, v77, v97
    v_dot2_f32_bf16 v98, v85, v92, v98
    v_dot2_f32_bf16 v99, v85, v85, v99
    v_dot2_f32_bf16 v96, v78, v92, v96
    v_dot2_f32_bf16 v97, v78, v78, v97
    v_dot2_f32_bf16 v98, v86, v92, v98
    v_dot2_f32_bf16 v99, v86, v86, v99
    v_dot2_f32_bf16 v96, v79, v92, v96
    v_dot2_f32_bf16 v97, v79, v79, v97
    v_dot2_f32_bf16 v98, v87, v92, v98
    v_dot2_f32_bf16 v99, v87, v87, v99
    v_dot2_f32_bf16 v96, v80, v92, v96
    v_dot2_f32_bf16 v97, v80, v80, v97
    v_dot2_f32_bf16 v98, v88, v92, v98
    v_dot2_f32_bf16 v99, v88, v88, v99
    v_dot2_f32_bf16 v96, v81, v92, v96
    v_dot2_f32_bf16 v97, v81, v81, v97
    v_dot2_f32_bf16 v98, v89, v92, v98
    v_dot2_f32_bf16 v99, v89, v89, v99
    v_dot2_f32_bf16 v96, v82, v92, v96
    v_dot2_f32_bf16 v97, v82, v82, v97
    v_dot2_f32_bf16 v98, v90, v92, v98
    v_dot2_f32_bf16 v99, v90, v90, v99
    v_dot2_f32_bf16 v96, v83, v92, v96
    v_dot2_f32_bf16 v97, v83, v83, v97
    v_dot2_f32_bf16 v98, v91, v92, v98
    v_dot2_f32_bf16 v99, v91, v91, v99
    v_add_f32_dpp v96, v96, v96 row_ror:8 row_mask:0xf bank_mask:0xf
    v_add_f32_dpp v97, v97, v97 row_ror:8 row_mask:0xf bank_mask:0xf
    v_add_f32_dpp v98, v98, v98 row_ror:8 row_mask:0xf bank_mask:0xf
    v_add_f32_dpp v99, v99, v99 row_ror:8 row_mask:0xf bank_mask:0xf
    v_add_f32_dpp v96, v96, v96 row_ror:4 row_mask:0xf bank_mask:0xf
    v_add_f32_dpp v97, v97, v97 row_ror:4 row_mask:0xf bank_mask:0xf
    v_add_f32_dpp v98, v98, v98 row_ror:4 row_mask:0xf bank_mask:0xf
    v_add_f32_dpp v99, v99, v99 row_ror:4 row_mask:0xf bank_mask:0xf
    v_add_f32_dpp v96, v96, v96 row_ror:2 row_mask:0xf bank_mask:0xf
    v_add_f32_dpp v97, v97, v97 row_ror:2 row_mask:0xf bank_mask:0xf
    v_add_f32_dpp v98, v98, v98 row_ror:2 row_mask:0xf bank_mask:0xf
    v_add_f32_dpp v99, v99, v99 row_ror:2 row_mask:0xf bank_mask:0xf
    v_add_f32_dpp v96, v96, v96 row_ror:1 row_mask:0xf bank_mask:0xf
    v_add_f32_dpp v97, v97, v97 row_ror:1 row_mask:0xf bank_mask:0xf
    v_add_f32_dpp v98, v98, v98 row_ror:1 row_mask:0xf bank_mask:0xf
    v_add_f32_dpp v99, v99, v99 row_ror:1 row_mask:0xf bank_mask:0xf
    v_mov_b32 v100, v96
    v_mov_b32 v101, v97
    v_mov_b32 v102, v98
    v_mov_b32 v103, v99
    v_permlane16_swap_b32 v100, v96
    v_permlane16_swap_b32 v101, v97
    v_permlane16_swap_b32 v102, v98
    v_permlane16_swap_b32 v103, v99
    v_add_f32 v96, v96, v100
    v_add_f32 v97, v97, v101
    v_add_f32 v98, v98, v102
    v_add_f32 v99, v99, v103
    v_mov_b32 v100, v96
    v_mov_b32 v101, v97
    v_mov_b32 v102, v98
    v_mov_b32 v103, v99
    v_permlane32_swap_b32 v100, v96
    v_permlane32_swap_b32 v101, v97
    v_permlane32_swap_b32 v102, v98
    v_permlane32_swap_b32 v103, v99
    v_add_f32 v96, v96, v100
    v_add_f32 v97, v97, v101
    v_add_f32 v98, v98, v102
    v_add_f32 v99, v99, v103
    v_mul_f32 v76, s59, v96
    v_mul_f32 v100, s61, v97
    v_fma_f32 v100, -v76, v76, v100
    v_max_f32 v100, 0, v100
    v_add_f32 v100, s60, v100
    v_rsq_f32 v77, v100
    v_mul_f32 v78, s59, v98
    v_mul_f32 v100, s61, v99
    v_fma_f32 v100, -v78, v78, v100
    v_max_f32 v100, 0, v100
    v_add_f32 v100, s60, v100
    v_rsq_f32 v79, v100
    s_lshl_b32 s33, s62, 3
    s_add_u32 s33, s33, 39911424
    v_mov_b32 v108, 0
    s_mov_b64 exec, 1
    buffer_store_dwordx4 v[76:79], v108, s[36:39], s33 offen sc1
    s_mov_b64 exec, -1
    s_branch L_k2_w1_bs0
L_k2_w1_c:
    s_cmp_eq_u32 s32, 4
    s_cbranch_scc1 L_k2_w1_c4
    s_cmp_eq_u32 s32, 5
    s_cbranch_scc1 L_k2_w1_c5
    s_cmp_eq_u32 s32, 6
    s_cbranch_scc1 L_k2_w1_c6
    s_branch L_k2_w1_c3
L_k2_w1_c3:
    s_and_b32 s33, s50, 2
    s_lshl_b32 s33, s33, 6
    v_xor_b32 v28, s33, v26
    s_add_u32 s50, s50, 1
    global_load_dwordx4 v[76:79], v28, s[46:47] nt
    s_add_u32 s46, s46, 8192
    s_addc_u32 s47, s47, 0
    s_cmp_eq_u32 s50, 256
    s_cselect_b32 s46, s48, s46
    s_cselect_b32 s47, s49, s47
    s_and_b32 s33, s50, 2
    s_lshl_b32 s33, s33, 6
    v_xor_b32 v28, s33, v26
    s_add_u32 s50, s50, 1
    global_load_dwordx4 v[80:83], v28, s[46:47] nt
    s_add_u32 s46, s46, 8192
    s_addc_u32 s47, s47, 0
    s_cmp_eq_u32 s50, 256
    s_cselect_b32 s46, s48, s46
    s_cselect_b32 s47, s49, s47
    s_and_b32 s33, s50, 2
    s_lshl_b32 s33, s33, 6
    v_xor_b32 v28, s33, v26
    s_add_u32 s50, s50, 1
    global_load_dwordx4 v[84:87], v28, s[46:47] nt
    s_add_u32 s46, s46, 8192
    s_addc_u32 s47, s47, 0
    s_cmp_eq_u32 s50, 256
    s_cselect_b32 s46, s48, s46
    s_cselect_b32 s47, s49, s47
    s_branch L_k2_w1_bc
L_k2_w1_c4:
    buffer_store_dwordx4 v[76:79], v27, s[36:39], s51 offen sc1
    s_add_u32 s51, s51, 1024
    buffer_store_dwordx4 v[80:83], v27, s[36:39], s51 offen sc1
    s_add_u32 s51, s51, 1024
    buffer_store_dwordx4 v[84:87], v27, s[36:39], s51 offen sc1
    s_add_u32 s51, s51, 1024
    s_and_b32 s33, s50, 2
    s_lshl_b32 s33, s33, 6
    v_xor_b32 v28, s33, v26
    s_add_u32 s50, s50, 1
    global_load_dwordx4 v[76:79], v28, s[46:47] nt
    s_add_u32 s46, s46, 8192
    s_addc_u32 s47, s47, 0
    s_cmp_eq_u32 s50, 256
    s_cselect_b32 s46, s48, s46
    s_cselect_b32 s47, s49, s47
    s_and_b32 s33, s50, 2
    s_lshl_b32 s33, s33, 6
    v_xor_b32 v28, s33, v26
    s_add_u32 s50, s50, 1
    global_load_dwordx4 v[80:83], v28, s[46:47] nt
    s_add_u32 s46, s46, 8192
    s_addc_u32 s47, s47, 0
    s_cmp_eq_u32 s50, 256
    s_cselect_b32 s46, s48, s46
    s_cselect_b32 s47, s49, s47
    s_and_b32 s33, s50, 2
    s_lshl_b32 s33, s33, 6
    v_xor_b32 v28, s33, v26
    s_add_u32 s50, s50, 1
    global_load_dwordx4 v[84:87], v28, s[46:47] nt
    s_add_u32 s46, s46, 8192
    s_addc_u32 s47, s47, 0
    s_cmp_eq_u32 s50, 256
    s_cselect_b32 s46, s48, s46
    s_cselect_b32 s47, s49, s47
    s_branch L_k2_w1_bc
L_k2_w1_c5:
    buffer_store_dwordx4 v[76:79], v27, s[36:39], s51 offen sc1
    s_add_u32 s51, s51, 1024
    buffer_store_dwordx4 v[80:83], v27, s[36:39], s51 offen sc1
    s_add_u32 s51, s51, 1024
    buffer_store_dwordx4 v[84:87], v27, s[36:39], s51 offen sc1
    s_add_u32 s51, s51, 1024
    s_and_b32 s33, s50, 2
    s_lshl_b32 s33, s33, 6
    v_xor_b32 v28, s33, v26
    s_add_u32 s50, s50, 1
    global_load_dwordx4 v[76:79], v28, s[46:47] nt
    s_add_u32 s46, s46, 8192
    s_addc_u32 s47, s47, 0
    s_cmp_eq_u32 s50, 256
    s_cselect_b32 s46, s48, s46
    s_cselect_b32 s47, s49, s47
    s_and_b32 s33, s50, 2
    s_lshl_b32 s33, s33, 6
    v_xor_b32 v28, s33, v26
    s_add_u32 s50, s50, 1
    global_load_dwordx4 v[80:83], v28, s[46:47] nt
    s_add_u32 s46, s46, 8192
    s_addc_u32 s47, s47, 0
    s_cmp_eq_u32 s50, 256
    s_cselect_b32 s46, s48, s46
    s_cselect_b32 s47, s49, s47
    s_and_b32 s33, s50, 2
    s_lshl_b32 s33, s33, 6
    v_xor_b32 v28, s33, v26
    s_add_u32 s50, s50, 1
    global_load_dwordx4 v[84:87], v28, s[46:47] nt
    s_add_u32 s46, s46, 8192
    s_addc_u32 s47, s47, 0
    s_cmp_eq_u32 s50, 256
    s_cselect_b32 s46, s48, s46
    s_cselect_b32 s47, s49, s47
    s_branch L_k2_w1_bc
L_k2_w1_c6:
    buffer_store_dwordx4 v[76:79], v27, s[36:39], s51 offen sc1
    s_add_u32 s51, s51, 1024
    buffer_store_dwordx4 v[80:83], v27, s[36:39], s51 offen sc1
    s_add_u32 s51, s51, 1024
    buffer_store_dwordx4 v[84:87], v27, s[36:39], s51 offen sc1
    s_add_u32 s51, s51, 1024
    s_branch L_k2_w1_bc
L_k2_w1_a36:
    v_mov_b32 v23, 0
    global_load_dword v25, v23, s[42:43] sc1
    s_branch L_k2_w1_b4
L_k2_w1_a3:
    s_getpc_b64 s[44:45]
L_pc_s1:
    s_sub_u32 s44, s44, L_pc_s1-recurrent_scan__sliding_block__glu_gated_bilinear__prompt_kernel
    s_subb_u32 s45, s45, 0
    s_lshr_b32 s33, s77, 3
    s_lshl_b32 s33, s33, 2
    s_add_u32 s33, s33, s3
    s_mul_i32 s33, s33, 7
    v_min_u32 v23, 6, v22
    v_add_u32 v23, s33, v23
    v_lshlrev_b32 v23, 7, v23
    v_min_u32 v23, L_text_end-recurrent_scan__sliding_block__glu_gated_bilinear__prompt_kernel-4, v23
    s_mov_b64 exec, 127
    global_load_dword v0, v23, s[44:45]
    s_mov_b64 exec, -1
    s_branch L_k2_w1_b3
L_k2_att:
    s_lshl_b32 s40, s3, 6
    s_add_u32 s40, s40, s41
    s_lshl_b32 s40, s40, 5
    s_add_u32 s40, s40, 4194304
    ds_read_b128 a[160:163], v10 offset:0
    ds_read_b128 a[164:167], v11 offset:0
    ds_read_b128 a[0:3], v8 offset:0
    ds_read_b128 a[4:7], v9 offset:0
    ds_read_b128 a[8:11], v8 offset:2048
    ds_read_b128 a[12:15], v9 offset:2048
    ds_read_b128 a[16:19], v8 offset:4096
    ds_read_b128 a[20:23], v9 offset:4096
    s_waitcnt lgkmcnt(5)
    v_mfma_f32_32x32x16_bf16 v[112:127], a[0:3], a[160:163], 0
    ds_read_b128 a[24:27], v8 offset:6144
    ds_read_b128 a[28:31], v9 offset:6144
    ds_read_b128 a[168:171], v10 offset:2048
    ds_read_b128 a[172:175], v11 offset:2048
    s_waitcnt lgkmcnt(8)
    v_mfma_f32_32x32x16_bf16 v[112:127], a[4:7], a[164:167], v[112:127]
    s_waitcnt lgkmcnt(7)
    v_mfma_f32_32x32x16_bf16 v[128:143], a[8:11], a[160:163], 0
    ds_read_b128 a[32:35], v8 offset:8192
    ds_read_b128 a[36:39], v9 offset:8192
    s_waitcnt lgkmcnt(8)
    v_mfma_f32_32x32x16_bf16 v[128:143], a[12:15], a[164:167], v[128:143]
    s_waitcnt lgkmcnt(7)
    v_mfma_f32_32x32x16_bf16 v[144:159], a[16:19], a[160:163], 0
    ds_read_b128 a[40:43], v8 offset:10240
    ds_read_b128 a[44:47], v9 offset:10240
    s_waitcnt lgkmcnt(8)
    v_mfma_f32_32x32x16_bf16 v[144:159], a[20:23], a[164:167], v[144:159]
    v_cndmask_b32 v112, v112, v18, s[44:45]
    v_cndmask_b32 v113, v113, v18, s[46:47]
    v_cndmask_b32 v114, v114, v18, s[48:49]
    v_cndmask_b32 v115, v115, v18, s[50:51]
    v_cndmask_b32 v116, v116, v18, s[52:53]
    v_cndmask_b32 v117, v117, v18, s[54:55]
    v_cndmask_b32 v118, v118, v18, s[56:57]
    v_cndmask_b32 v119, v119, v18, s[58:59]
    v_cndmask_b32 v120, v120, v18, s[60:61]
    v_cndmask_b32 v121, v121, v18, s[62:63]
    v_cndmask_b32 v122, v122, v18, s[64:65]
    v_cndmask_b32 v123, v123, v18, s[66:67]
    v_cndmask_b32 v124, v124, v18, s[68:69]
    v_cndmask_b32 v125, v125, v18, s[70:71]
    v_cndmask_b32 v126, v126, v18, s[72:73]
    v_cndmask_b32 v127, v127, v18, s[74:75]
    s_cmp_gt_u32 s100, 0
    s_cbranch_scc1 L_k2_fix0_0
L_k2_fixed0_0:
    v_max_f32 v80, v112, v113
    v_max_f32 v81, v114, v115
    v_max_f32 v82, v116, v117
    v_max_f32 v83, v118, v119
    v_max3_f32 v80, v80, v120, v121
    v_max3_f32 v81, v81, v122, v123
    v_max3_f32 v82, v82, v124, v125
    v_max3_f32 v83, v83, v126, v127
    s_waitcnt lgkmcnt(7)
    v_mfma_f32_32x32x16_bf16 v[160:175], a[24:27], a[160:163], 0
    ds_read_b128 a[48:51], v8 offset:12288
    ds_read_b128 a[52:55], v9 offset:12288
    s_waitcnt lgkmcnt(8)
    v_mfma_f32_32x32x16_bf16 v[160:175], a[28:31], a[164:167], v[160:175]
    s_cmp_gt_u32 s100, 1
    s_cbranch_scc1 L_k2_fix0_1
L_k2_fixed0_1:
    v_max3_f32 v80, v80, v128, v129
    v_max3_f32 v81, v81, v130, v131
    v_max3_f32 v82, v82, v132, v133
    v_max3_f32 v83, v83, v134, v135
    v_max3_f32 v80, v80, v136, v137
    v_max3_f32 v81, v81, v138, v139
    v_max3_f32 v82, v82, v140, v141
    v_max3_f32 v83, v83, v142, v143
    s_waitcnt lgkmcnt(5)
    v_mfma_f32_32x32x16_bf16 v[176:191], a[32:35], a[160:163], 0
    ds_read_b128 a[56:59], v8 offset:14336
    ds_read_b128 a[60:63], v9 offset:14336
    s_waitcnt lgkmcnt(6)
    v_mfma_f32_32x32x16_bf16 v[176:191], a[36:39], a[164:167], v[176:191]
    s_cmp_gt_u32 s100, 2
    s_cbranch_scc1 L_k2_fix0_2
L_k2_fixed0_2:
    v_max3_f32 v80, v80, v144, v145
    v_max3_f32 v81, v81, v146, v147
    v_max3_f32 v82, v82, v148, v149
    v_max3_f32 v83, v83, v150, v151
    v_max3_f32 v80, v80, v152, v153
    v_max3_f32 v81, v81, v154, v155
    v_max3_f32 v82, v82, v156, v157
    v_max3_f32 v83, v83, v158, v159
    s_waitcnt lgkmcnt(5)
    v_mfma_f32_32x32x16_bf16 v[192:207], a[40:43], a[160:163], 0
    ds_read_b128 a[64:67], v8 offset:16384
    ds_read_b128 a[68:71], v9 offset:16384
    s_waitcnt lgkmcnt(6)
    v_mfma_f32_32x32x16_bf16 v[192:207], a[44:47], a[164:167], v[192:207]
    s_cmp_gt_u32 s100, 3
    s_cbranch_scc1 L_k2_fix0_3
L_k2_fixed0_3:
    v_max3_f32 v80, v80, v160, v161
    v_max3_f32 v81, v81, v162, v163
    v_max3_f32 v82, v82, v164, v165
    v_max3_f32 v83, v83, v166, v167
    v_max3_f32 v80, v80, v168, v169
    v_max3_f32 v81, v81, v170, v171
    v_max3_f32 v82, v82, v172, v173
    v_max3_f32 v83, v83, v174, v175
    s_waitcnt lgkmcnt(5)
    v_mfma_f32_32x32x16_bf16 v[208:223], a[48:51], a[160:163], 0
    ds_read_b128 a[72:75], v8 offset:18432
    ds_read_b128 a[76:79], v9 offset:18432
    s_waitcnt lgkmcnt(6)
    v_mfma_f32_32x32x16_bf16 v[208:223], a[52:55], a[164:167], v[208:223]
    s_cmp_gt_u32 s100, 4
    s_cbranch_scc1 L_k2_fix0_4
L_k2_fixed0_4:
    v_max3_f32 v80, v80, v176, v177
    v_max3_f32 v81, v81, v178, v179
    v_max3_f32 v82, v82, v180, v181
    v_max3_f32 v83, v83, v182, v183
    v_max3_f32 v80, v80, v184, v185
    v_max3_f32 v81, v81, v186, v187
    v_max3_f32 v82, v82, v188, v189
    v_max3_f32 v83, v83, v190, v191
    s_waitcnt lgkmcnt(5)
    v_mfma_f32_32x32x16_bf16 v[224:239], a[56:59], a[160:163], 0
    s_waitcnt lgkmcnt(4)
    v_mfma_f32_32x32x16_bf16 v[224:239], a[60:63], a[164:167], v[224:239]
    s_cmp_gt_u32 s100, 5
    s_cbranch_scc1 L_k2_fix0_5
L_k2_fixed0_5:
    v_max3_f32 v80, v80, v192, v193
    v_max3_f32 v81, v81, v194, v195
    v_max3_f32 v82, v82, v196, v197
    v_max3_f32 v83, v83, v198, v199
    v_max3_f32 v80, v80, v200, v201
    v_max3_f32 v81, v81, v202, v203
    v_max3_f32 v82, v82, v204, v205
    v_max3_f32 v83, v83, v206, v207
    s_waitcnt lgkmcnt(3)
    v_mfma_f32_32x32x16_bf16 v[240:255], a[64:67], a[160:163], 0
    s_waitcnt lgkmcnt(2)
    v_mfma_f32_32x32x16_bf16 v[240:255], a[68:71], a[164:167], v[240:255]
    s_cmp_gt_u32 s100, 6
    s_cbranch_scc1 L_k2_fix0_6
L_k2_fixed0_6:
    v_max3_f32 v80, v80, v208, v209
    v_max3_f32 v81, v81, v210, v211
    v_max3_f32 v82, v82, v212, v213
    v_max3_f32 v83, v83, v214, v215
    v_max3_f32 v80, v80, v216, v217
    v_max3_f32 v81, v81, v218, v219
    v_max3_f32 v82, v82, v220, v221
    v_max3_f32 v83, v83, v222, v223
    s_cmp_gt_u32 s100, 7
    s_cbranch_scc1 L_k2_fix0_7
L_k2_fixed0_7:
    v_max3_f32 v80, v80, v224, v225
    v_max3_f32 v81, v81, v226, v227
    v_max3_f32 v82, v82, v228, v229
    v_max3_f32 v83, v83, v230, v231
    v_max3_f32 v80, v80, v232, v233
    v_max3_f32 v81, v81, v234, v235
    v_max3_f32 v82, v82, v236, v237
    v_max3_f32 v83, v83, v238, v239
    ds_read_b64_tr_b16 a[80:81], v12 offset:0
    ds_read_b64_tr_b16 a[82:83], v12 offset:512
    ds_read_b64_tr_b16 a[84:85], v12 offset:1024
    ds_read_b64_tr_b16 a[86:87], v12 offset:1536
    v_cndmask_b32 v240, v18, v240, s[44:45]
    v_cndmask_b32 v241, v18, v241, s[46:47]
    v_cndmask_b32 v242, v18, v242, s[48:49]
    v_cndmask_b32 v243, v18, v243, s[50:51]
    v_cndmask_b32 v244, v18, v244, s[52:53]
    v_cndmask_b32 v245, v18, v245, s[54:55]
    v_cndmask_b32 v246, v18, v246, s[56:57]
    v_cndmask_b32 v247, v18, v247, s[58:59]
    v_cndmask_b32 v248, v18, v248, s[60:61]
    v_cndmask_b32 v249, v18, v249, s[62:63]
    v_cndmask_b32 v250, v18, v250, s[64:65]
    v_cndmask_b32 v251, v18, v251, s[66:67]
    v_cndmask_b32 v252, v18, v252, s[68:69]
    v_cndmask_b32 v253, v18, v253, s[70:71]
    v_cndmask_b32 v254, v18, v254, s[72:73]
    v_cndmask_b32 v255, v18, v255, s[74:75]
    v_max3_f32 v80, v80, v240, v241
    v_max3_f32 v81, v81, v242, v243
    v_max3_f32 v82, v82, v244, v245
    v_max3_f32 v83, v83, v246, v247
    v_max3_f32 v80, v80, v248, v249
    v_max3_f32 v81, v81, v250, v251
    v_max3_f32 v82, v82, v252, v253
    v_max3_f32 v83, v83, v254, v255
    v_max3_f32 v80, v80, v81, v82
    v_max_f32 v80, v80, v83
    v_mov_b32 v81, v80
    s_nop 1
    v_permlane32_swap_b32 v80, v81
    v_max_f32 v80, v80, v81
    v_mul_f32 v88, v14, v80
    v_sub_f32 v88, 0, v88
    v_mov_b32 v89, v88
    v_mov_b32 v90, 0
    v_mov_b32 v91, 0
    v_mov_b32 v92, 0
    v_mov_b32 v93, 0
    v_pk_fma_f32 v[112:113], v[112:113], v[14:15], v[88:89]
    v_pk_fma_f32 v[114:115], v[114:115], v[14:15], v[88:89]
    v_pk_fma_f32 v[116:117], v[116:117], v[14:15], v[88:89]
    v_pk_fma_f32 v[118:119], v[118:119], v[14:15], v[88:89]
    v_pk_fma_f32 v[120:121], v[120:121], v[14:15], v[88:89]
    v_pk_fma_f32 v[122:123], v[122:123], v[14:15], v[88:89]
    v_pk_fma_f32 v[124:125], v[124:125], v[14:15], v[88:89]
    v_pk_fma_f32 v[126:127], v[126:127], v[14:15], v[88:89]
    v_exp_f32 v112, v112
    v_exp_f32 v113, v113
    ds_read_b64_tr_b16 a[88:89], v12 offset:2048
    v_exp_f32 v114, v114
    v_exp_f32 v115, v115
    v_exp_f32 v116, v116
    v_exp_f32 v117, v117
    v_exp_f32 v118, v118
    v_exp_f32 v119, v119
    ds_read_b64_tr_b16 a[90:91], v12 offset:2560
    v_exp_f32 v120, v120
    v_exp_f32 v121, v121
    v_exp_f32 v122, v122
    v_exp_f32 v123, v123
    v_exp_f32 v124, v124
    v_exp_f32 v125, v125
    ds_read_b64_tr_b16 a[92:93], v12 offset:3072
    v_exp_f32 v126, v126
    v_exp_f32 v127, v127
    v_pk_add_f32 v[90:91], v[90:91], v[112:113]
    v_cvt_pk_bf16_f32 v112, v112, v113
    v_pk_add_f32 v[92:93], v[92:93], v[114:115]
    v_cvt_pk_bf16_f32 v113, v114, v115
    ds_read_b64_tr_b16 a[94:95], v12 offset:3584
    v_pk_add_f32 v[90:91], v[90:91], v[116:117]
    v_cvt_pk_bf16_f32 v114, v116, v117
    v_pk_add_f32 v[92:93], v[92:93], v[118:119]
    v_cvt_pk_bf16_f32 v115, v118, v119
    v_pk_add_f32 v[90:91], v[90:91], v[120:121]
    v_cvt_pk_bf16_f32 v116, v120, v121
    v_pk_add_f32 v[92:93], v[92:93], v[122:123]
    v_cvt_pk_bf16_f32 v117, v122, v123
    v_pk_add_f32 v[90:91], v[90:91], v[124:125]
    v_cvt_pk_bf16_f32 v118, v124, v125
    v_pk_add_f32 v[92:93], v[92:93], v[126:127]
    v_cvt_pk_bf16_f32 v119, v126, v127
    v_pk_fma_f32 v[128:129], v[128:129], v[14:15], v[88:89]
    v_pk_fma_f32 v[130:131], v[130:131], v[14:15], v[88:89]
    s_waitcnt lgkmcnt(6)
    v_mfma_f32_32x32x16_bf16 v[64:79], a[80:83], v[112:115], 0
    v_pk_fma_f32 v[132:133], v[132:133], v[14:15], v[88:89]
    v_pk_fma_f32 v[134:135], v[134:135], v[14:15], v[88:89]
    v_pk_fma_f32 v[136:137], v[136:137], v[14:15], v[88:89]
    v_pk_fma_f32 v[138:139], v[138:139], v[14:15], v[88:89]
    v_pk_fma_f32 v[140:141], v[140:141], v[14:15], v[88:89]
    v_pk_fma_f32 v[142:143], v[142:143], v[14:15], v[88:89]
    s_waitcnt lgkmcnt(4)
    v_mfma_f32_32x32x16_bf16 v[64:79], a[84:87], v[116:119], v[64:79]
    v_exp_f32 v128, v128
    v_exp_f32 v129, v129
    ds_read_b64_tr_b16 a[96:97], v12 offset:4096
    v_exp_f32 v130, v130
    v_exp_f32 v131, v131
    v_exp_f32 v132, v132
    v_exp_f32 v133, v133
    v_mfma_f32_32x32x16_bf16 v[112:127], a[8:11], a[168:171], 0
    v_exp_f32 v134, v134
    v_exp_f32 v135, v135
    ds_read_b64_tr_b16 a[98:99], v12 offset:4608
    v_exp_f32 v136, v136
    v_exp_f32 v137, v137
    v_exp_f32 v138, v138
    v_exp_f32 v139, v139
    v_mfma_f32_32x32x16_bf16 v[112:127], a[12:15], a[172:175], v[112:127]
    v_exp_f32 v140, v140
    v_exp_f32 v141, v141
    ds_read_b64_tr_b16 a[100:101], v12 offset:5120
    v_exp_f32 v142, v142
    v_exp_f32 v143, v143
    v_pk_add_f32 v[90:91], v[90:91], v[128:129]
    v_cvt_pk_bf16_f32 v128, v128, v129
    v_pk_add_f32 v[92:93], v[92:93], v[130:131]
    v_cvt_pk_bf16_f32 v129, v130, v131
    ds_read_b64_tr_b16 a[102:103], v12 offset:5632
    v_pk_add_f32 v[90:91], v[90:91], v[132:133]
    v_cvt_pk_bf16_f32 v130, v132, v133
    v_pk_add_f32 v[92:93], v[92:93], v[134:135]
    v_cvt_pk_bf16_f32 v131, v134, v135
    v_pk_add_f32 v[90:91], v[90:91], v[136:137]
    v_cvt_pk_bf16_f32 v132, v136, v137
    v_pk_add_f32 v[92:93], v[92:93], v[138:139]
    v_cvt_pk_bf16_f32 v133, v138, v139
    v_pk_add_f32 v[90:91], v[90:91], v[140:141]
    v_cvt_pk_bf16_f32 v134, v140, v141
    v_pk_add_f32 v[92:93], v[92:93], v[142:143]
    v_cvt_pk_bf16_f32 v135, v142, v143
    v_pk_fma_f32 v[144:145], v[144:145], v[14:15], v[88:89]
    v_pk_fma_f32 v[146:147], v[146:147], v[14:15], v[88:89]
    s_waitcnt lgkmcnt(6)
    v_mfma_f32_32x32x16_bf16 v[64:79], a[88:91], v[128:131], v[64:79]
    v_pk_fma_f32 v[148:149], v[148:149], v[14:15], v[88:89]
    v_pk_fma_f32 v[150:151], v[150:151], v[14:15], v[88:89]
    v_pk_fma_f32 v[152:153], v[152:153], v[14:15], v[88:89]
    v_pk_fma_f32 v[154:155], v[154:155], v[14:15], v[88:89]
    v_pk_fma_f32 v[156:157], v[156:157], v[14:15], v[88:89]
    v_pk_fma_f32 v[158:159], v[158:159], v[14:15], v[88:89]
    s_waitcnt lgkmcnt(4)
    v_mfma_f32_32x32x16_bf16 v[64:79], a[92:95], v[132:135], v[64:79]
    v_exp_f32 v144, v144
    v_exp_f32 v145, v145
    ds_read_b64_tr_b16 a[104:105], v12 offset:6144
    v_exp_f32 v146, v146
    v_exp_f32 v147, v147
    v_exp_f32 v148, v148
    v_exp_f32 v149, v149
    v_mfma_f32_32x32x16_bf16 v[128:143], a[16:19], a[168:171], 0
    v_exp_f32 v150, v150
    v_exp_f32 v151, v151
    ds_read_b64_tr_b16 a[106:107], v12 offset:6656
    v_exp_f32 v152, v152
    v_exp_f32 v153, v153
    v_exp_f32 v154, v154
    v_exp_f32 v155, v155
    v_mfma_f32_32x32x16_bf16 v[128:143], a[20:23], a[172:175], v[128:143]
    v_exp_f32 v156, v156
    v_exp_f32 v157, v157
    ds_read_b64_tr_b16 a[108:109], v12 offset:7168
    v_exp_f32 v158, v158
    v_exp_f32 v159, v159
    v_pk_add_f32 v[90:91], v[90:91], v[144:145]
    v_cvt_pk_bf16_f32 v144, v144, v145
    v_pk_add_f32 v[92:93], v[92:93], v[146:147]
    v_cvt_pk_bf16_f32 v145, v146, v147
    ds_read_b64_tr_b16 a[110:111], v12 offset:7680
    v_pk_add_f32 v[90:91], v[90:91], v[148:149]
    v_cvt_pk_bf16_f32 v146, v148, v149
    v_pk_add_f32 v[92:93], v[92:93], v[150:151]
    v_cvt_pk_bf16_f32 v147, v150, v151
    v_pk_add_f32 v[90:91], v[90:91], v[152:153]
    v_cvt_pk_bf16_f32 v148, v152, v153
    v_pk_add_f32 v[92:93], v[92:93], v[154:155]
    v_cvt_pk_bf16_f32 v149, v154, v155
    v_pk_add_f32 v[90:91], v[90:91], v[156:157]
    v_cvt_pk_bf16_f32 v150, v156, v157
    v_pk_add_f32 v[92:93], v[92:93], v[158:159]
    v_cvt_pk_bf16_f32 v151, v158, v159
    v_pk_fma_f32 v[160:161], v[160:161], v[14:15], v[88:89]
    v_pk_fma_f32 v[162:163], v[162:163], v[14:15], v[88:89]
    s_waitcnt lgkmcnt(6)
    v_mfma_f32_32x32x16_bf16 v[64:79], a[96:99], v[144:147], v[64:79]
    v_pk_fma_f32 v[164:165], v[164:165], v[14:15], v[88:89]
    v_pk_fma_f32 v[166:167], v[166:167], v[14:15], v[88:89]
    v_pk_fma_f32 v[168:169], v[168:169], v[14:15], v[88:89]
    v_pk_fma_f32 v[170:171], v[170:171], v[14:15], v[88:89]
    v_pk_fma_f32 v[172:173], v[172:173], v[14:15], v[88:89]
    v_pk_fma_f32 v[174:175], v[174:175], v[14:15], v[88:89]
    s_waitcnt lgkmcnt(4)
    v_mfma_f32_32x32x16_bf16 v[64:79], a[100:103], v[148:151], v[64:79]
    v_exp_f32 v160, v160
    v_exp_f32 v161, v161
    ds_read_b64_tr_b16 a[112:113], v12 offset:8192
    v_exp_f32 v162, v162
    v_exp_f32 v163, v163
    v_exp_f32 v164, v164
    v_exp_f32 v165, v165
    v_mfma_f32_32x32x16_bf16 v[144:159], a[24:27], a[168:171], 0
    v_exp_f32 v166, v166
    v_exp_f32 v167, v167
    ds_read_b64_tr_b16 a[114:115], v12 offset:8704
    v_exp_f32 v168, v168
    v_exp_f32 v169, v169
    v_exp_f32 v170, v170
    v_exp_f32 v171, v171
    v_mfma_f32_32x32x16_bf16 v[144:159], a[28:31], a[172:175], v[144:159]
    v_exp_f32 v172, v172
    v_exp_f32 v173, v173
    ds_read_b64_tr_b16 a[116:117], v12 offset:9216
    v_exp_f32 v174, v174
    v_exp_f32 v175, v175
    v_pk_add_f32 v[90:91], v[90:91], v[160:161]
    v_cvt_pk_bf16_f32 v160, v160, v161
    v_pk_add_f32 v[92:93], v[92:93], v[162:163]
    v_cvt_pk_bf16_f32 v161, v162, v163
    ds_read_b64_tr_b16 a[118:119], v12 offset:9728
    v_pk_add_f32 v[90:91], v[90:91], v[164:165]
    v_cvt_pk_bf16_f32 v162, v164, v165
    v_pk_add_f32 v[92:93], v[92:93], v[166:167]
    v_cvt_pk_bf16_f32 v163, v166, v167
    v_pk_add_f32 v[90:91], v[90:91], v[168:169]
    v_cvt_pk_bf16_f32 v164, v168, v169
    v_pk_add_f32 v[92:93], v[92:93], v[170:171]
    v_cvt_pk_bf16_f32 v165, v170, v171
    v_pk_add_f32 v[90:91], v[90:91], v[172:173]
    v_cvt_pk_bf16_f32 v166, v172, v173
    v_pk_add_f32 v[92:93], v[92:93], v[174:175]
    v_cvt_pk_bf16_f32 v167, v174, v175
    v_cndmask_b32 v112, v112, v18, s[44:45]
    v_cndmask_b32 v113, v113, v18, s[46:47]
    v_cndmask_b32 v114, v114, v18, s[48:49]
    v_cndmask_b32 v115, v115, v18, s[50:51]
    v_cndmask_b32 v116, v116, v18, s[52:53]
    v_cndmask_b32 v117, v117, v18, s[54:55]
    v_cndmask_b32 v118, v118, v18, s[56:57]
    v_cndmask_b32 v119, v119, v18, s[58:59]
    v_cndmask_b32 v120, v120, v18, s[60:61]
    v_cndmask_b32 v121, v121, v18, s[62:63]
    v_cndmask_b32 v122, v122, v18, s[64:65]
    v_cndmask_b32 v123, v123, v18, s[66:67]
    v_cndmask_b32 v124, v124, v18, s[68:69]
    v_cndmask_b32 v125, v125, v18, s[70:71]
    v_cndmask_b32 v126, v126, v18, s[72:73]
    v_cndmask_b32 v127, v127, v18, s[74:75]
    s_cmp_gt_u32 s101, 0
    s_cbranch_scc1 L_k2_fix1_0
L_k2_fixed1_0:
    v_max_f32 v84, v112, v113
    v_max_f32 v85, v114, v115
    v_max_f32 v86, v116, v117
    v_max_f32 v87, v118, v119
    v_max3_f32 v84, v84, v120, v121
    v_max3_f32 v85, v85, v122, v123
    v_max3_f32 v86, v86, v124, v125
    v_max3_f32 v87, v87, v126, v127
    v_pk_fma_f32 v[176:177], v[176:177], v[14:15], v[88:89]
    v_pk_fma_f32 v[178:179], v[178:179], v[14:15], v[88:89]
    s_waitcnt lgkmcnt(6)
    v_mfma_f32_32x32x16_bf16 v[64:79], a[104:107], v[160:163], v[64:79]
    v_pk_fma_f32 v[180:181], v[180:181], v[14:15], v[88:89]
    v_pk_fma_f32 v[182:183], v[182:183], v[14:15], v[88:89]
    v_pk_fma_f32 v[184:185], v[184:185], v[14:15], v[88:89]
    v_pk_fma_f32 v[186:187], v[186:187], v[14:15], v[88:89]
    v_pk_fma_f32 v[188:189], v[188:189], v[14:15], v[88:89]
    v_pk_fma_f32 v[190:191], v[190:191], v[14:15], v[88:89]
    s_waitcnt lgkmcnt(4)
    v_mfma_f32_32x32x16_bf16 v[64:79], a[108:111], v[164:167], v[64:79]
    v_exp_f32 v176, v176
    v_exp_f32 v177, v177
    ds_read_b64_tr_b16 a[120:121], v12 offset:10240
    v_exp_f32 v178, v178
    v_exp_f32 v179, v179
    v_exp_f32 v180, v180
    v_exp_f32 v181, v181
    v_mfma_f32_32x32x16_bf16 v[160:175], a[32:35], a[168:171], 0
    v_exp_f32 v182, v182
    v_exp_f32 v183, v183
    ds_read_b64_tr_b16 a[122:123], v12 offset:10752
    v_exp_f32 v184, v184
    v_exp_f32 v185, v185
    v_exp_f32 v186, v186
    v_exp_f32 v187, v187
    v_mfma_f32_32x32x16_bf16 v[160:175], a[36:39], a[172:175], v[160:175]
    v_exp_f32 v188, v188
    v_exp_f32 v189, v189
    ds_read_b64_tr_b16 a[124:125], v12 offset:11264
    v_exp_f32 v190, v190
    v_exp_f32 v191, v191
    v_pk_add_f32 v[90:91], v[90:91], v[176:177]
    v_cvt_pk_bf16_f32 v176, v176, v177
    v_pk_add_f32 v[92:93], v[92:93], v[178:179]
    v_cvt_pk_bf16_f32 v177, v178, v179
    ds_read_b64_tr_b16 a[126:127], v12 offset:11776
    v_pk_add_f32 v[90:91], v[90:91], v[180:181]
    v_cvt_pk_bf16_f32 v178, v180, v181
    v_pk_add_f32 v[92:93], v[92:93], v[182:183]
    v_cvt_pk_bf16_f32 v179, v182, v183
    v_pk_add_f32 v[90:91], v[90:91], v[184:185]
    v_cvt_pk_bf16_f32 v180, v184, v185
    v_pk_add_f32 v[92:93], v[92:93], v[186:187]
    v_cvt_pk_bf16_f32 v181, v186, v187
    v_pk_add_f32 v[90:91], v[90:91], v[188:189]
    v_cvt_pk_bf16_f32 v182, v188, v189
    v_pk_add_f32 v[92:93], v[92:93], v[190:191]
    v_cvt_pk_bf16_f32 v183, v190, v191
    s_cmp_gt_u32 s101, 1
    s_cbranch_scc1 L_k2_fix1_1
L_k2_fixed1_1:
    v_max3_f32 v84, v84, v128, v129
    v_max3_f32 v85, v85, v130, v131
    v_max3_f32 v86, v86, v132, v133
    v_max3_f32 v87, v87, v134, v135
    v_max3_f32 v84, v84, v136, v137
    v_max3_f32 v85, v85, v138, v139
    v_max3_f32 v86, v86, v140, v141
    v_max3_f32 v87, v87, v142, v143
    v_pk_fma_f32 v[192:193], v[192:193], v[14:15], v[88:89]
    v_pk_fma_f32 v[194:195], v[194:195], v[14:15], v[88:89]
    s_waitcnt lgkmcnt(6)
    v_mfma_f32_32x32x16_bf16 v[64:79], a[112:115], v[176:179], v[64:79]
    v_pk_fma_f32 v[196:197], v[196:197], v[14:15], v[88:89]
    v_pk_fma_f32 v[198:199], v[198:199], v[14:15], v[88:89]
    v_pk_fma_f32 v[200:201], v[200:201], v[14:15], v[88:89]
    v_pk_fma_f32 v[202:203], v[202:203], v[14:15], v[88:89]
    v_pk_fma_f32 v[204:205], v[204:205], v[14:15], v[88:89]
    v_pk_fma_f32 v[206:207], v[206:207], v[14:15], v[88:89]
    s_waitcnt lgkmcnt(4)
    v_mfma_f32_32x32x16_bf16 v[64:79], a[116:119], v[180:183], v[64:79]
    v_exp_f32 v192, v192
    v_exp_f32 v193, v193
    ds_read_b64_tr_b16 a[128:129], v12 offset:12288
    v_exp_f32 v194, v194
    v_exp_f32 v195, v195
    v_exp_f32 v196, v196
    v_exp_f32 v197, v197
    v_mfma_f32_32x32x16_bf16 v[176:191], a[40:43], a[168:171], 0
    v_exp_f32 v198, v198
    v_exp_f32 v199, v199
    ds_read_b64_tr_b16 a[130:131], v12 offset:12800
    v_exp_f32 v200, v200
    v_exp_f32 v201, v201
    v_exp_f32 v202, v202
    v_exp_f32 v203, v203
    v_mfma_f32_32x32x16_bf16 v[176:191], a[44:47], a[172:175], v[176:191]
    v_exp_f32 v204, v204
    v_exp_f32 v205, v205
    ds_read_b64_tr_b16 a[132:133], v12 offset:13312
    v_exp_f32 v206, v206
    v_exp_f32 v207, v207
    v_pk_add_f32 v[90:91], v[90:91], v[192:193]
    v_cvt_pk_bf16_f32 v192, v192, v193
    v_pk_add_f32 v[92:93], v[92:93], v[194:195]
    v_cvt_pk_bf16_f32 v193, v194, v195
    ds_read_b64_tr_b16 a[134:135], v12 offset:13824
    v_pk_add_f32 v[90:91], v[90:91], v[196:197]
    v_cvt_pk_bf16_f32 v194, v196, v197
    v_pk_add_f32 v[92:93], v[92:93], v[198:199]
    v_cvt_pk_bf16_f32 v195, v198, v199
    v_pk_add_f32 v[90:91], v[90:91], v[200:201]
    v_cvt_pk_bf16_f32 v196, v200, v201
    v_pk_add_f32 v[92:93], v[92:93], v[202:203]
    v_cvt_pk_bf16_f32 v197, v202, v203
    v_pk_add_f32 v[90:91], v[90:91], v[204:205]
    v_cvt_pk_bf16_f32 v198, v204, v205
    v_pk_add_f32 v[92:93], v[92:93], v[206:207]
    v_cvt_pk_bf16_f32 v199, v206, v207
    s_cmp_gt_u32 s101, 2
    s_cbranch_scc1 L_k2_fix1_2
L_k2_fixed1_2:
    v_max3_f32 v84, v84, v144, v145
    v_max3_f32 v85, v85, v146, v147
    v_max3_f32 v86, v86, v148, v149
    v_max3_f32 v87, v87, v150, v151
    v_max3_f32 v84, v84, v152, v153
    v_max3_f32 v85, v85, v154, v155
    v_max3_f32 v86, v86, v156, v157
    v_max3_f32 v87, v87, v158, v159
    v_pk_fma_f32 v[208:209], v[208:209], v[14:15], v[88:89]
    v_pk_fma_f32 v[210:211], v[210:211], v[14:15], v[88:89]
    s_waitcnt lgkmcnt(6)
    v_mfma_f32_32x32x16_bf16 v[64:79], a[120:123], v[192:195], v[64:79]
    v_pk_fma_f32 v[212:213], v[212:213], v[14:15], v[88:89]
    v_pk_fma_f32 v[214:215], v[214:215], v[14:15], v[88:89]
    v_pk_fma_f32 v[216:217], v[216:217], v[14:15], v[88:89]
    v_pk_fma_f32 v[218:219], v[218:219], v[14:15], v[88:89]
    v_pk_fma_f32 v[220:221], v[220:221], v[14:15], v[88:89]
    v_pk_fma_f32 v[222:223], v[222:223], v[14:15], v[88:89]
    s_waitcnt lgkmcnt(4)
    v_mfma_f32_32x32x16_bf16 v[64:79], a[124:127], v[196:199], v[64:79]
    v_exp_f32 v208, v208
    v_exp_f32 v209, v209
    ds_read_b64_tr_b16 a[136:137], v12 offset:14336
    v_exp_f32 v210, v210
    v_exp_f32 v211, v211
    v_exp_f32 v212, v212
    v_exp_f32 v213, v213
    v_mfma_f32_32x32x16_bf16 v[192:207], a[48:51], a[168:171], 0
    v_exp_f32 v214, v214
    v_exp_f32 v215, v215
    ds_read_b64_tr_b16 a[138:139], v12 offset:14848
    v_exp_f32 v216, v216
    v_exp_f32 v217, v217
    v_exp_f32 v218, v218
    v_exp_f32 v219, v219
    v_mfma_f32_32x32x16_bf16 v[192:207], a[52:55], a[172:175], v[192:207]
    v_exp_f32 v220, v220
    v_exp_f32 v221, v221
    ds_read_b64_tr_b16 a[140:141], v12 offset:15360
    v_exp_f32 v222, v222
    v_exp_f32 v223, v223
    v_pk_add_f32 v[90:91], v[90:91], v[208:209]
    v_cvt_pk_bf16_f32 v208, v208, v209
    v_pk_add_f32 v[92:93], v[92:93], v[210:211]
    v_cvt_pk_bf16_f32 v209, v210, v211
    ds_read_b64_tr_b16 a[142:143], v12 offset:15872
    v_pk_add_f32 v[90:91], v[90:91], v[212:213]
    v_cvt_pk_bf16_f32 v210, v212, v213
    v_pk_add_f32 v[92:93], v[92:93], v[214:215]
    v_cvt_pk_bf16_f32 v211, v214, v215
    v_pk_add_f32 v[90:91], v[90:91], v[216:217]
    v_cvt_pk_bf16_f32 v212, v216, v217
    v_pk_add_f32 v[92:93], v[92:93], v[218:219]
    v_cvt_pk_bf16_f32 v213, v218, v219
    v_pk_add_f32 v[90:91], v[90:91], v[220:221]
    v_cvt_pk_bf16_f32 v214, v220, v221
    v_pk_add_f32 v[92:93], v[92:93], v[222:223]
    v_cvt_pk_bf16_f32 v215, v222, v223
    s_cmp_gt_u32 s101, 3
    s_cbranch_scc1 L_k2_fix1_3
L_k2_fixed1_3:
    v_max3_f32 v84, v84, v160, v161
    v_max3_f32 v85, v85, v162, v163
    v_max3_f32 v86, v86, v164, v165
    v_max3_f32 v87, v87, v166, v167
    v_max3_f32 v84, v84, v168, v169
    v_max3_f32 v85, v85, v170, v171
    v_max3_f32 v86, v86, v172, v173
    v_max3_f32 v87, v87, v174, v175
    v_pk_fma_f32 v[224:225], v[224:225], v[14:15], v[88:89]
    v_pk_fma_f32 v[226:227], v[226:227], v[14:15], v[88:89]
    s_waitcnt lgkmcnt(6)
    v_mfma_f32_32x32x16_bf16 v[64:79], a[128:131], v[208:211], v[64:79]
    v_pk_fma_f32 v[228:229], v[228:229], v[14:15], v[88:89]
    v_pk_fma_f32 v[230:231], v[230:231], v[14:15], v[88:89]
    v_pk_fma_f32 v[232:233], v[232:233], v[14:15], v[88:89]
    v_pk_fma_f32 v[234:235], v[234:235], v[14:15], v[88:89]
    v_pk_fma_f32 v[236:237], v[236:237], v[14:15], v[88:89]
    v_pk_fma_f32 v[238:239], v[238:239], v[14:15], v[88:89]
    s_waitcnt lgkmcnt(4)
    v_mfma_f32_32x32x16_bf16 v[64:79], a[132:135], v[212:215], v[64:79]
    v_exp_f32 v224, v224
    v_exp_f32 v225, v225
    ds_read_b64_tr_b16 a[144:145], v12 offset:16384
    v_exp_f32 v226, v226
    v_exp_f32 v227, v227
    v_exp_f32 v228, v228
    v_exp_f32 v229, v229
    v_mfma_f32_32x32x16_bf16 v[208:223], a[56:59], a[168:171], 0
    v_exp_f32 v230, v230
    v_exp_f32 v231, v231
    ds_read_b64_tr_b16 a[146:147], v12 offset:16896
    v_exp_f32 v232, v232
    v_exp_f32 v233, v233
    v_exp_f32 v234, v234
    v_exp_f32 v235, v235
    v_mfma_f32_32x32x16_bf16 v[208:223], a[60:63], a[172:175], v[208:223]
    v_exp_f32 v236, v236
    v_exp_f32 v237, v237
    ds_read_b64_tr_b16 a[148:149], v12 offset:17408
    v_exp_f32 v238, v238
    v_exp_f32 v239, v239
    v_pk_add_f32 v[90:91], v[90:91], v[224:225]
    v_cvt_pk_bf16_f32 v224, v224, v225
    v_pk_add_f32 v[92:93], v[92:93], v[226:227]
    v_cvt_pk_bf16_f32 v225, v226, v227
    ds_read_b64_tr_b16 a[150:151], v12 offset:17920
    v_pk_add_f32 v[90:91], v[90:91], v[228:229]
    v_cvt_pk_bf16_f32 v226, v228, v229
    v_pk_add_f32 v[92:93], v[92:93], v[230:231]
    v_cvt_pk_bf16_f32 v227, v230, v231
    v_pk_add_f32 v[90:91], v[90:91], v[232:233]
    v_cvt_pk_bf16_f32 v228, v232, v233
    v_pk_add_f32 v[92:93], v[92:93], v[234:235]
    v_cvt_pk_bf16_f32 v229, v234, v235
    v_pk_add_f32 v[90:91], v[90:91], v[236:237]
    v_cvt_pk_bf16_f32 v230, v236, v237
    v_pk_add_f32 v[92:93], v[92:93], v[238:239]
    v_cvt_pk_bf16_f32 v231, v238, v239
    s_cmp_gt_u32 s101, 4
    s_cbranch_scc1 L_k2_fix1_4
L_k2_fixed1_4:
    v_max3_f32 v84, v84, v176, v177
    v_max3_f32 v85, v85, v178, v179
    v_max3_f32 v86, v86, v180, v181
    v_max3_f32 v87, v87, v182, v183
    v_max3_f32 v84, v84, v184, v185
    v_max3_f32 v85, v85, v186, v187
    v_max3_f32 v86, v86, v188, v189
    v_max3_f32 v87, v87, v190, v191
    s_waitcnt vmcnt(0)
    s_barrier
    s_cmp_lg_u32 s3, 0
    s_cbranch_scc1 L_k2_nohflag
    s_lshl_b32 s33, s77, 7
    s_add_u32 s33, s33, 41091072
    s_add_u32 s34, s96, 1
    v_mov_b32 v23, s34
    v_mov_b32 v24, 0
    s_mov_b64 exec, 1
    buffer_store_dword v23, v24, s[36:39], s33 offen sc1
    s_mov_b64 exec, -1
L_k2_nohflag:
    v_pk_fma_f32 v[240:241], v[240:241], v[14:15], v[88:89]
    v_pk_fma_f32 v[242:243], v[242:243], v[14:15], v[88:89]
    s_waitcnt lgkmcnt(6)
    v_mfma_f32_32x32x16_bf16 v[64:79], a[136:139], v[224:227], v[64:79]
    v_pk_fma_f32 v[244:245], v[244:245], v[14:15], v[88:89]
    v_pk_fma_f32 v[246:247], v[246:247], v[14:15], v[88:89]
    v_pk_fma_f32 v[248:249], v[248:249], v[14:15], v[88:89]
    v_pk_fma_f32 v[250:251], v[250:251], v[14:15], v[88:89]
    v_pk_fma_f32 v[252:253], v[252:253], v[14:15], v[88:89]
    v_pk_fma_f32 v[254:255], v[254:255], v[14:15], v[88:89]
    s_waitcnt lgkmcnt(4)
    v_mfma_f32_32x32x16_bf16 v[64:79], a[140:143], v[228:231], v[64:79]
    v_exp_f32 v240, v240
    v_exp_f32 v241, v241
    ds_read_b64_tr_b16 a[152:153], v12 offset:18432
    v_exp_f32 v242, v242
    v_exp_f32 v243, v243
    v_exp_f32 v244, v244
    v_exp_f32 v245, v245
    v_mfma_f32_32x32x16_bf16 v[224:239], a[64:67], a[168:171], 0
    v_exp_f32 v246, v246
    v_exp_f32 v247, v247
    ds_read_b64_tr_b16 a[154:155], v12 offset:18944
    v_exp_f32 v248, v248
    v_exp_f32 v249, v249
    v_exp_f32 v250, v250
    v_exp_f32 v251, v251
    v_mfma_f32_32x32x16_bf16 v[224:239], a[68:71], a[172:175], v[224:239]
    v_exp_f32 v252, v252
    v_exp_f32 v253, v253
    ds_read_b64_tr_b16 a[156:157], v12 offset:19456
    v_exp_f32 v254, v254
    v_exp_f32 v255, v255
    v_pk_add_f32 v[90:91], v[90:91], v[240:241]
    v_cvt_pk_bf16_f32 v240, v240, v241
    v_pk_add_f32 v[92:93], v[92:93], v[242:243]
    v_cvt_pk_bf16_f32 v241, v242, v243
    ds_read_b64_tr_b16 a[158:159], v12 offset:19968
    v_pk_add_f32 v[90:91], v[90:91], v[244:245]
    v_cvt_pk_bf16_f32 v242, v244, v245
    v_pk_add_f32 v[92:93], v[92:93], v[246:247]
    v_cvt_pk_bf16_f32 v243, v246, v247
    v_pk_add_f32 v[90:91], v[90:91], v[248:249]
    v_cvt_pk_bf16_f32 v244, v248, v249
    v_pk_add_f32 v[92:93], v[92:93], v[250:251]
    v_cvt_pk_bf16_f32 v245, v250, v251
    v_pk_add_f32 v[90:91], v[90:91], v[252:253]
    v_cvt_pk_bf16_f32 v246, v252, v253
    v_pk_add_f32 v[92:93], v[92:93], v[254:255]
    v_cvt_pk_bf16_f32 v247, v254, v255
    s_cmp_gt_u32 s101, 5
    s_cbranch_scc1 L_k2_fix1_5
L_k2_fixed1_5:
    v_max3_f32 v84, v84, v192, v193
    v_max3_f32 v85, v85, v194, v195
    v_max3_f32 v86, v86, v196, v197
    v_max3_f32 v87, v87, v198, v199
    v_max3_f32 v84, v84, v200, v201
    v_max3_f32 v85, v85, v202, v203
    v_max3_f32 v86, v86, v204, v205
    v_max3_f32 v87, v87, v206, v207
    s_waitcnt lgkmcnt(6)
    v_mfma_f32_32x32x16_bf16 v[64:79], a[144:147], v[240:243], v[64:79]
    s_waitcnt lgkmcnt(4)
    v_mfma_f32_32x32x16_bf16 v[64:79], a[148:151], v[244:247], v[64:79]
    v_mfma_f32_32x32x16_bf16 v[240:255], a[72:75], a[168:171], 0
    v_mfma_f32_32x32x16_bf16 v[240:255], a[76:79], a[172:175], v[240:255]
    s_cmp_gt_u32 s101, 6
    s_cbranch_scc1 L_k2_fix1_6
L_k2_fixed1_6:
    v_max3_f32 v84, v84, v208, v209
    v_max3_f32 v85, v85, v210, v211
    v_max3_f32 v86, v86, v212, v213
    v_max3_f32 v87, v87, v214, v215
    v_max3_f32 v84, v84, v216, v217
    v_max3_f32 v85, v85, v218, v219
    v_max3_f32 v86, v86, v220, v221
    v_max3_f32 v87, v87, v222, v223
    s_cmp_gt_u32 s101, 7
    s_cbranch_scc1 L_k2_fix1_7
L_k2_fixed1_7:
    v_max3_f32 v84, v84, v224, v225
    v_max3_f32 v85, v85, v226, v227
    v_max3_f32 v86, v86, v228, v229
    v_max3_f32 v87, v87, v230, v231
    v_max3_f32 v84, v84, v232, v233
    v_max3_f32 v85, v85, v234, v235
    v_max3_f32 v86, v86, v236, v237
    v_max3_f32 v87, v87, v238, v239
    v_pk_add_f32 v[90:91], v[90:91], v[92:93]
    v_add_f32 v90, v90, v91
    v_mov_b32 v91, v90
    s_nop 1
    v_permlane32_swap_b32 v90, v91
    v_add_f32 v90, v90, v91
    v_rcp_f32 v90, v90
    s_nop 0
    v_pk_mul_f32 v[64:65], v[64:65], v[90:91] op_sel_hi:[1,0]
    v_pk_mul_f32 v[66:67], v[66:67], v[90:91] op_sel_hi:[1,0]
    v_pk_mul_f32 v[68:69], v[68:69], v[90:91] op_sel_hi:[1,0]
    v_pk_mul_f32 v[70:71], v[70:71], v[90:91] op_sel_hi:[1,0]
    v_pk_mul_f32 v[72:73], v[72:73], v[90:91] op_sel_hi:[1,0]
    v_pk_mul_f32 v[74:75], v[74:75], v[90:91] op_sel_hi:[1,0]
    v_pk_mul_f32 v[76:77], v[76:77], v[90:91] op_sel_hi:[1,0]
    v_pk_mul_f32 v[78:79], v[78:79], v[90:91] op_sel_hi:[1,0]
    v_cvt_pk_bf16_f32 v96, v64, v65
    v_cvt_pk_bf16_f32 v97, v66, v67
    v_cvt_pk_bf16_f32 v98, v68, v69
    v_cvt_pk_bf16_f32 v99, v70, v71
    v_cvt_pk_bf16_f32 v100, v72, v73
    v_cvt_pk_bf16_f32 v101, v74, v75
    v_cvt_pk_bf16_f32 v102, v76, v77
    v_cvt_pk_bf16_f32 v103, v78, v79
    s_lshl_b32 s33, s21, 1
    s_add_u32 s33, s33, 0
    s_lshl_b32 s33, s33, 16
    s_add_u32 s33, s33, s40
    v_permlane32_swap_b32 v96, v98
    v_permlane32_swap_b32 v97, v99
    buffer_store_dwordx4 v[96:99], v13, s[36:39], s33 offen offset:0 sc1
    s_lshl_b32 s33, s21, 1
    s_add_u32 s33, s33, 1
    s_lshl_b32 s33, s33, 16
    s_add_u32 s33, s33, s40
    v_permlane32_swap_b32 v100, v102
    v_permlane32_swap_b32 v101, v103
    buffer_store_dwordx4 v[100:103], v13, s[36:39], s33 offen offset:0 sc1
    v_cndmask_b32 v240, v18, v240, s[44:45]
    v_cndmask_b32 v241, v18, v241, s[46:47]
    v_cndmask_b32 v242, v18, v242, s[48:49]
    v_cndmask_b32 v243, v18, v243, s[50:51]
    v_cndmask_b32 v244, v18, v244, s[52:53]
    v_cndmask_b32 v245, v18, v245, s[54:55]
    v_cndmask_b32 v246, v18, v246, s[56:57]
    v_cndmask_b32 v247, v18, v247, s[58:59]
    v_cndmask_b32 v248, v18, v248, s[60:61]
    v_cndmask_b32 v249, v18, v249, s[62:63]
    v_cndmask_b32 v250, v18, v250, s[64:65]
    v_cndmask_b32 v251, v18, v251, s[66:67]
    v_cndmask_b32 v252, v18, v252, s[68:69]
    v_cndmask_b32 v253, v18, v253, s[70:71]
    v_cndmask_b32 v254, v18, v254, s[72:73]
    v_cndmask_b32 v255, v18, v255, s[74:75]
    v_max3_f32 v84, v84, v240, v241
    v_max3_f32 v85, v85, v242, v243
    v_max3_f32 v86, v86, v244, v245
    v_max3_f32 v87, v87, v246, v247
    v_max3_f32 v84, v84, v248, v249
    v_max3_f32 v85, v85, v250, v251
    v_max3_f32 v86, v86, v252, v253
    v_max3_f32 v87, v87, v254, v255
    v_max3_f32 v84, v84, v85, v86
    v_max_f32 v84, v84, v87
    v_mov_b32 v85, v84
    s_nop 1
    v_permlane32_swap_b32 v84, v85
    v_max_f32 v84, v84, v85
    v_mul_f32 v88, v16, v84
    v_sub_f32 v88, 0, v88
    v_mov_b32 v89, v88
    v_mov_b32 v90, 0
    v_mov_b32 v91, 0
    v_mov_b32 v92, 0
    v_mov_b32 v93, 0
    v_pk_fma_f32 v[112:113], v[112:113], v[16:17], v[88:89]
    v_pk_fma_f32 v[114:115], v[114:115], v[16:17], v[88:89]
    v_pk_fma_f32 v[116:117], v[116:117], v[16:17], v[88:89]
    v_pk_fma_f32 v[118:119], v[118:119], v[16:17], v[88:89]
    v_pk_fma_f32 v[120:121], v[120:121], v[16:17], v[88:89]
    v_pk_fma_f32 v[122:123], v[122:123], v[16:17], v[88:89]
    v_pk_fma_f32 v[124:125], v[124:125], v[16:17], v[88:89]
    v_pk_fma_f32 v[126:127], v[126:127], v[16:17], v[88:89]
    v_exp_f32 v112, v112
    v_exp_f32 v113, v113
    v_exp_f32 v114, v114
    v_exp_f32 v115, v115
    v_exp_f32 v116, v116
    v_exp_f32 v117, v117
    v_exp_f32 v118, v118
    v_exp_f32 v119, v119
    v_exp_f32 v120, v120
    v_exp_f32 v121, v121
    v_exp_f32 v122, v122
    v_exp_f32 v123, v123
    v_exp_f32 v124, v124
    v_exp_f32 v125, v125
    v_exp_f32 v126, v126
    v_exp_f32 v127, v127
    v_pk_add_f32 v[90:91], v[90:91], v[112:113]
    v_cvt_pk_bf16_f32 v112, v112, v113
    v_pk_add_f32 v[92:93], v[92:93], v[114:115]
    v_cvt_pk_bf16_f32 v113, v114, v115
    v_pk_add_f32 v[90:91], v[90:91], v[116:117]
    v_cvt_pk_bf16_f32 v114, v116, v117
    v_pk_add_f32 v[92:93], v[92:93], v[118:119]
    v_cvt_pk_bf16_f32 v115, v118, v119
    v_pk_add_f32 v[90:91], v[90:91], v[120:121]
    v_cvt_pk_bf16_f32 v116, v120, v121
    v_pk_add_f32 v[92:93], v[92:93], v[122:123]
    v_cvt_pk_bf16_f32 v117, v122, v123
    v_pk_add_f32 v[90:91], v[90:91], v[124:125]
    v_cvt_pk_bf16_f32 v118, v124, v125
    v_pk_add_f32 v[92:93], v[92:93], v[126:127]
    v_cvt_pk_bf16_f32 v119, v126, v127
    v_pk_fma_f32 v[128:129], v[128:129], v[16:17], v[88:89]
    v_pk_fma_f32 v[130:131], v[130:131], v[16:17], v[88:89]
    v_mfma_f32_32x32x16_bf16 v[64:79], a[88:91], v[112:115], 0
    v_pk_fma_f32 v[132:133], v[132:133], v[16:17], v[88:89]
    v_pk_fma_f32 v[134:135], v[134:135], v[16:17], v[88:89]
    v_pk_fma_f32 v[136:137], v[136:137], v[16:17], v[88:89]
    v_pk_fma_f32 v[138:139], v[138:139], v[16:17], v[88:89]
    v_pk_fma_f32 v[140:141], v[140:141], v[16:17], v[88:89]
    v_pk_fma_f32 v[142:143], v[142:143], v[16:17], v[88:89]
    v_exp_f32 v128, v128
    v_exp_f32 v129, v129
    v_exp_f32 v130, v130
    v_exp_f32 v131, v131
    v_mfma_f32_32x32x16_bf16 v[64:79], a[92:95], v[116:119], v[64:79]
    v_exp_f32 v132, v132
    v_exp_f32 v133, v133
    v_exp_f32 v134, v134
    v_exp_f32 v135, v135
    v_exp_f32 v136, v136
    v_exp_f32 v137, v137
    v_exp_f32 v138, v138
    v_exp_f32 v139, v139
    v_exp_f32 v140, v140
    v_exp_f32 v141, v141
    v_exp_f32 v142, v142
    v_exp_f32 v143, v143
    v_pk_add_f32 v[90:91], v[90:91], v[128:129]
    v_cvt_pk_bf16_f32 v128, v128, v129
    v_pk_add_f32 v[92:93], v[92:93], v[130:131]
    v_cvt_pk_bf16_f32 v129, v130, v131
    v_pk_add_f32 v[90:91], v[90:91], v[132:133]
    v_cvt_pk_bf16_f32 v130, v132, v133
    v_pk_add_f32 v[92:93], v[92:93], v[134:135]
    v_cvt_pk_bf16_f32 v131, v134, v135
    v_pk_add_f32 v[90:91], v[90:91], v[136:137]
    v_cvt_pk_bf16_f32 v132, v136, v137
    v_pk_add_f32 v[92:93], v[92:93], v[138:139]
    v_cvt_pk_bf16_f32 v133, v138, v139
    v_pk_add_f32 v[90:91], v[90:91], v[140:141]
    v_cvt_pk_bf16_f32 v134, v140, v141
    v_pk_add_f32 v[92:93], v[92:93], v[142:143]
    v_cvt_pk_bf16_f32 v135, v142, v143
    v_pk_fma_f32 v[144:145], v[144:145], v[16:17], v[88:89]
    v_pk_fma_f32 v[146:147], v[146:147], v[16:17], v[88:89]
    v_mfma_f32_32x32x16_bf16 v[64:79], a[96:99], v[128:131], v[64:79]
    v_pk_fma_f32 v[148:149], v[148:149], v[16:17], v[88:89]
    v_pk_fma_f32 v[150:151], v[150:151], v[16:17], v[88:89]
    v_pk_fma_f32 v[152:153], v[152:153], v[16:17], v[88:89]
    v_pk_fma_f32 v[154:155], v[154:155], v[16:17], v[88:89]
    v_pk_fma_f32 v[156:157], v[156:157], v[16:17], v[88:89]
    v_pk_fma_f32 v[158:159], v[158:159], v[16:17], v[88:89]
    v_exp_f32 v144, v144
    v_exp_f32 v145, v145
    v_exp_f32 v146, v146
    v_exp_f32 v147, v147
    v_mfma_f32_32x32x16_bf16 v[64:79], a[100:103], v[132:135], v[64:79]
    v_exp_f32 v148, v148
    v_exp_f32 v149, v149
    v_exp_f32 v150, v150
    v_exp_f32 v151, v151
    v_exp_f32 v152, v152
    v_exp_f32 v153, v153
    v_exp_f32 v154, v154
    v_exp_f32 v155, v155
    v_exp_f32 v156, v156
    v_exp_f32 v157, v157
    v_exp_f32 v158, v158
    v_exp_f32 v159, v159
    v_pk_add_f32 v[90:91], v[90:91], v[144:145]
    v_cvt_pk_bf16_f32 v144, v144, v145
    v_pk_add_f32 v[92:93], v[92:93], v[146:147]
    v_cvt_pk_bf16_f32 v145, v146, v147
    v_pk_add_f32 v[90:91], v[90:91], v[148:149]
    v_cvt_pk_bf16_f32 v146, v148, v149
    v_pk_add_f32 v[92:93], v[92:93], v[150:151]
    v_cvt_pk_bf16_f32 v147, v150, v151
    v_pk_add_f32 v[90:91], v[90:91], v[152:153]
    v_cvt_pk_bf16_f32 v148, v152, v153
    v_pk_add_f32 v[92:93], v[92:93], v[154:155]
    v_cvt_pk_bf16_f32 v149, v154, v155
    v_pk_add_f32 v[90:91], v[90:91], v[156:157]
    v_cvt_pk_bf16_f32 v150, v156, v157
    v_pk_add_f32 v[92:93], v[92:93], v[158:159]
    v_cvt_pk_bf16_f32 v151, v158, v159
    v_pk_fma_f32 v[160:161], v[160:161], v[16:17], v[88:89]
    v_pk_fma_f32 v[162:163], v[162:163], v[16:17], v[88:89]
    v_mfma_f32_32x32x16_bf16 v[64:79], a[104:107], v[144:147], v[64:79]
    v_pk_fma_f32 v[164:165], v[164:165], v[16:17], v[88:89]
    v_pk_fma_f32 v[166:167], v[166:167], v[16:17], v[88:89]
    v_pk_fma_f32 v[168:169], v[168:169], v[16:17], v[88:89]
    v_pk_fma_f32 v[170:171], v[170:171], v[16:17], v[88:89]
    v_pk_fma_f32 v[172:173], v[172:173], v[16:17], v[88:89]
    v_pk_fma_f32 v[174:175], v[174:175], v[16:17], v[88:89]
    v_exp_f32 v160, v160
    v_exp_f32 v161, v161
    v_exp_f32 v162, v162
    v_exp_f32 v163, v163
    v_mfma_f32_32x32x16_bf16 v[64:79], a[108:111], v[148:151], v[64:79]
    v_exp_f32 v164, v164
    v_exp_f32 v165, v165
    v_exp_f32 v166, v166
    v_exp_f32 v167, v167
    v_exp_f32 v168, v168
    v_exp_f32 v169, v169
    v_exp_f32 v170, v170
    v_exp_f32 v171, v171
    v_exp_f32 v172, v172
    v_exp_f32 v173, v173
    v_exp_f32 v174, v174
    v_exp_f32 v175, v175
    v_pk_add_f32 v[90:91], v[90:91], v[160:161]
    v_cvt_pk_bf16_f32 v160, v160, v161
    v_pk_add_f32 v[92:93], v[92:93], v[162:163]
    v_cvt_pk_bf16_f32 v161, v162, v163
    v_pk_add_f32 v[90:91], v[90:91], v[164:165]
    v_cvt_pk_bf16_f32 v162, v164, v165
    v_pk_add_f32 v[92:93], v[92:93], v[166:167]
    v_cvt_pk_bf16_f32 v163, v166, v167
    v_pk_add_f32 v[90:91], v[90:91], v[168:169]
    v_cvt_pk_bf16_f32 v164, v168, v169
    v_pk_add_f32 v[92:93], v[92:93], v[170:171]
    v_cvt_pk_bf16_f32 v165, v170, v171
    v_pk_add_f32 v[90:91], v[90:91], v[172:173]
    v_cvt_pk_bf16_f32 v166, v172, v173
    v_pk_add_f32 v[92:93], v[92:93], v[174:175]
    v_cvt_pk_bf16_f32 v167, v174, v175
    v_pk_fma_f32 v[176:177], v[176:177], v[16:17], v[88:89]
    v_pk_fma_f32 v[178:179], v[178:179], v[16:17], v[88:89]
    v_mfma_f32_32x32x16_bf16 v[64:79], a[112:115], v[160:163], v[64:79]
    v_pk_fma_f32 v[180:181], v[180:181], v[16:17], v[88:89]
    v_pk_fma_f32 v[182:183], v[182:183], v[16:17], v[88:89]
    v_pk_fma_f32 v[184:185], v[184:185], v[16:17], v[88:89]
    v_pk_fma_f32 v[186:187], v[186:187], v[16:17], v[88:89]
    v_pk_fma_f32 v[188:189], v[188:189], v[16:17], v[88:89]
    v_pk_fma_f32 v[190:191], v[190:191], v[16:17], v[88:89]
    v_exp_f32 v176, v176
    v_exp_f32 v177, v177
    v_exp_f32 v178, v178
    v_exp_f32 v179, v179
    v_mfma_f32_32x32x16_bf16 v[64:79], a[116:119], v[164:167], v[64:79]
    v_exp_f32 v180, v180
    v_exp_f32 v181, v181
    v_exp_f32 v182, v182
    v_exp_f32 v183, v183
    v_exp_f32 v184, v184
    v_exp_f32 v185, v185
    v_exp_f32 v186, v186
    v_exp_f32 v187, v187
    v_exp_f32 v188, v188
    v_exp_f32 v189, v189
    v_exp_f32 v190, v190
    v_exp_f32 v191, v191
    v_pk_add_f32 v[90:91], v[90:91], v[176:177]
    v_cvt_pk_bf16_f32 v176, v176, v177
    v_pk_add_f32 v[92:93], v[92:93], v[178:179]
    v_cvt_pk_bf16_f32 v177, v178, v179
    v_pk_add_f32 v[90:91], v[90:91], v[180:181]
    v_cvt_pk_bf16_f32 v178, v180, v181
    v_pk_add_f32 v[92:93], v[92:93], v[182:183]
    v_cvt_pk_bf16_f32 v179, v182, v183
    v_pk_add_f32 v[90:91], v[90:91], v[184:185]
    v_cvt_pk_bf16_f32 v180, v184, v185
    v_pk_add_f32 v[92:93], v[92:93], v[186:187]
    v_cvt_pk_bf16_f32 v181, v186, v187
    v_pk_add_f32 v[90:91], v[90:91], v[188:189]
    v_cvt_pk_bf16_f32 v182, v188, v189
    v_pk_add_f32 v[92:93], v[92:93], v[190:191]
    v_cvt_pk_bf16_f32 v183, v190, v191
    v_pk_fma_f32 v[192:193], v[192:193], v[16:17], v[88:89]
    v_pk_fma_f32 v[194:195], v[194:195], v[16:17], v[88:89]
    v_mfma_f32_32x32x16_bf16 v[64:79], a[120:123], v[176:179], v[64:79]
    v_pk_fma_f32 v[196:197], v[196:197], v[16:17], v[88:89]
    v_pk_fma_f32 v[198:199], v[198:199], v[16:17], v[88:89]
    v_pk_fma_f32 v[200:201], v[200:201], v[16:17], v[88:89]
    v_pk_fma_f32 v[202:203], v[202:203], v[16:17], v[88:89]
    v_pk_fma_f32 v[204:205], v[204:205], v[16:17], v[88:89]
    v_pk_fma_f32 v[206:207], v[206:207], v[16:17], v[88:89]
    v_exp_f32 v192, v192
    v_exp_f32 v193, v193
    v_exp_f32 v194, v194
    v_exp_f32 v195, v195
    v_mfma_f32_32x32x16_bf16 v[64:79], a[124:127], v[180:183], v[64:79]
    v_exp_f32 v196, v196
    v_exp_f32 v197, v197
    v_exp_f32 v198, v198
    v_exp_f32 v199, v199
    v_exp_f32 v200, v200
    v_exp_f32 v201, v201
    v_exp_f32 v202, v202
    v_exp_f32 v203, v203
    v_exp_f32 v204, v204
    v_exp_f32 v205, v205
    v_exp_f32 v206, v206
    v_exp_f32 v207, v207
    v_pk_add_f32 v[90:91], v[90:91], v[192:193]
    v_cvt_pk_bf16_f32 v192, v192, v193
    v_pk_add_f32 v[92:93], v[92:93], v[194:195]
    v_cvt_pk_bf16_f32 v193, v194, v195
    v_pk_add_f32 v[90:91], v[90:91], v[196:197]
    v_cvt_pk_bf16_f32 v194, v196, v197
    v_pk_add_f32 v[92:93], v[92:93], v[198:199]
    v_cvt_pk_bf16_f32 v195, v198, v199
    v_pk_add_f32 v[90:91], v[90:91], v[200:201]
    v_cvt_pk_bf16_f32 v196, v200, v201
    v_pk_add_f32 v[92:93], v[92:93], v[202:203]
    v_cvt_pk_bf16_f32 v197, v202, v203
    v_pk_add_f32 v[90:91], v[90:91], v[204:205]
    v_cvt_pk_bf16_f32 v198, v204, v205
    v_pk_add_f32 v[92:93], v[92:93], v[206:207]
    v_cvt_pk_bf16_f32 v199, v206, v207
    s_lshr_b32 s60, s2, 1
    s_and_b32 s60, s60, 3
    s_and_b32 s67, s2, 1
    s_xor_b32 s67, s67, 1
    s_lshl_b32 s67, s67, 2
    s_lshr_b32 s68, s2, 3
    s_lshr_b32 s62, s68, 2
    s_and_b32 s68, s68, 3
    s_add_u32 s61, s67, s68
    s_mov_b32 s63, 0
    s_mov_b32 s64, 11
    s_mov_b32 s65, 7
    s_cmp_eq_u32 s60, 2
    s_cselect_b32 s63, 10, s63
    s_cselect_b32 s64, 12, s64
    s_cselect_b32 s65, 15, s65
    s_cmp_eq_u32 s60, 3
    s_cselect_b32 s63, 21, s63
    s_cselect_b32 s65, 23, s65
    s_cmp_eq_u32 s60, 0
    s_cselect_b32 s64, 32, s64
    s_cselect_b32 s65, 0, s65
    s_mov_b32 s67, 41091072
    s_cselect_b32 s66, 41123840, s67
    v_add_u32 v27, s63, v22
    v_lshrrev_b32 v26, 2, v27
    v_lshlrev_b32 v26, 2, v26
    s_mov_b32 s67, 1983984928
    v_lshrrev_b32 v26, v26, s67
    v_and_b32 v26, 7, v26
    v_and_b32 v27, 3, v27
    v_lshl_add_u32 v27, v27, 6, v26
    s_lshl_b32 s67, s61, 3
    v_add_u32 v27, s67, v27
    v_lshlrev_b32 v27, 7, v27
    v_add_u32 v27, s66, v27
    v_subrev_u32 v26, s64, v22
    v_add_u32 v26, s65, v26
    v_lshlrev_b32 v26, 3, v26
    v_add_u32 v26, s62, v26
    v_lshlrev_b32 v26, 7, v26
    v_add_u32 v26, 41091072, v26
    v_cmp_gt_u32 vcc, s64, v22
    s_add_u32 s64, s64, 9
    s_lshl_b64 s[58:59], 1, s64
    v_cndmask_b32 v27, v26, v27, vcc
    s_sub_u32 s58, s58, 1
    s_subb_u32 s59, s59, 0
    s_mov_b64 exec, s[58:59]
    buffer_load_dword v26, v27, s[36:39], 0 offen sc1
    s_mov_b64 exec, -1
    v_pk_fma_f32 v[208:209], v[208:209], v[16:17], v[88:89]
    v_pk_fma_f32 v[210:211], v[210:211], v[16:17], v[88:89]
    v_mfma_f32_32x32x16_bf16 v[64:79], a[128:131], v[192:195], v[64:79]
    v_pk_fma_f32 v[212:213], v[212:213], v[16:17], v[88:89]
    v_pk_fma_f32 v[214:215], v[214:215], v[16:17], v[88:89]
    v_pk_fma_f32 v[216:217], v[216:217], v[16:17], v[88:89]
    v_pk_fma_f32 v[218:219], v[218:219], v[16:17], v[88:89]
    v_pk_fma_f32 v[220:221], v[220:221], v[16:17], v[88:89]
    v_pk_fma_f32 v[222:223], v[222:223], v[16:17], v[88:89]
    v_exp_f32 v208, v208
    v_exp_f32 v209, v209
    v_exp_f32 v210, v210
    v_exp_f32 v211, v211
    v_mfma_f32_32x32x16_bf16 v[64:79], a[132:135], v[196:199], v[64:79]
    v_exp_f32 v212, v212
    v_exp_f32 v213, v213
    v_exp_f32 v214, v214
    v_exp_f32 v215, v215
    v_exp_f32 v216, v216
    v_exp_f32 v217, v217
    v_exp_f32 v218, v218
    v_exp_f32 v219, v219
    v_exp_f32 v220, v220
    v_exp_f32 v221, v221
    v_exp_f32 v222, v222
    v_exp_f32 v223, v223
    v_pk_add_f32 v[90:91], v[90:91], v[208:209]
    v_cvt_pk_bf16_f32 v208, v208, v209
    v_pk_add_f32 v[92:93], v[92:93], v[210:211]
    v_cvt_pk_bf16_f32 v209, v210, v211
    v_pk_add_f32 v[90:91], v[90:91], v[212:213]
    v_cvt_pk_bf16_f32 v210, v212, v213
    v_pk_add_f32 v[92:93], v[92:93], v[214:215]
    v_cvt_pk_bf16_f32 v211, v214, v215
    v_pk_add_f32 v[90:91], v[90:91], v[216:217]
    v_cvt_pk_bf16_f32 v212, v216, v217
    v_pk_add_f32 v[92:93], v[92:93], v[218:219]
    v_cvt_pk_bf16_f32 v213, v218, v219
    v_pk_add_f32 v[90:91], v[90:91], v[220:221]
    v_cvt_pk_bf16_f32 v214, v220, v221
    v_pk_add_f32 v[92:93], v[92:93], v[222:223]
    v_cvt_pk_bf16_f32 v215, v222, v223
    v_pk_fma_f32 v[224:225], v[224:225], v[16:17], v[88:89]
    v_pk_fma_f32 v[226:227], v[226:227], v[16:17], v[88:89]
    v_mfma_f32_32x32x16_bf16 v[64:79], a[136:139], v[208:211], v[64:79]
    v_pk_fma_f32 v[228:229], v[228:229], v[16:17], v[88:89]
    v_pk_fma_f32 v[230:231], v[230:231], v[16:17], v[88:89]
    v_pk_fma_f32 v[232:233], v[232:233], v[16:17], v[88:89]
    v_pk_fma_f32 v[234:235], v[234:235], v[16:17], v[88:89]
    v_pk_fma_f32 v[236:237], v[236:237], v[16:17], v[88:89]
    v_pk_fma_f32 v[238:239], v[238:239], v[16:17], v[88:89]
    v_exp_f32 v224, v224
    v_exp_f32 v225, v225
    v_exp_f32 v226, v226
    v_exp_f32 v227, v227
    v_mfma_f32_32x32x16_bf16 v[64:79], a[140:143], v[212:215], v[64:79]
    v_exp_f32 v228, v228
    v_exp_f32 v229, v229
    v_exp_f32 v230, v230
    v_exp_f32 v231, v231
    v_exp_f32 v232, v232
    v_exp_f32 v233, v233
    v_exp_f32 v234, v234
    v_exp_f32 v235, v235
    v_exp_f32 v236, v236
    v_exp_f32 v237, v237
    v_exp_f32 v238, v238
    v_exp_f32 v239, v239
    v_pk_add_f32 v[90:91], v[90:91], v[224:225]
    v_cvt_pk_bf16_f32 v224, v224, v225
    v_pk_add_f32 v[92:93], v[92:93], v[226:227]
    v_cvt_pk_bf16_f32 v225, v226, v227
    v_pk_add_f32 v[90:91], v[90:91], v[228:229]
    v_cvt_pk_bf16_f32 v226, v228, v229
    v_pk_add_f32 v[92:93], v[92:93], v[230:231]
    v_cvt_pk_bf16_f32 v227, v230, v231
    v_pk_add_f32 v[90:91], v[90:91], v[232:233]
    v_cvt_pk_bf16_f32 v228, v232, v233
    v_pk_add_f32 v[92:93], v[92:93], v[234:235]
    v_cvt_pk_bf16_f32 v229, v234, v235
    v_pk_add_f32 v[90:91], v[90:91], v[236:237]
    v_cvt_pk_bf16_f32 v230, v236, v237
    v_pk_add_f32 v[92:93], v[92:93], v[238:239]
    v_cvt_pk_bf16_f32 v231, v238, v239
    v_pk_fma_f32 v[240:241], v[240:241], v[16:17], v[88:89]
    v_pk_fma_f32 v[242:243], v[242:243], v[16:17], v[88:89]
    v_mfma_f32_32x32x16_bf16 v[64:79], a[144:147], v[224:227], v[64:79]
    v_pk_fma_f32 v[244:245], v[244:245], v[16:17], v[88:89]
    v_pk_fma_f32 v[246:247], v[246:247], v[16:17], v[88:89]
    v_pk_fma_f32 v[248:249], v[248:249], v[16:17], v[88:89]
    v_pk_fma_f32 v[250:251], v[250:251], v[16:17], v[88:89]
    v_pk_fma_f32 v[252:253], v[252:253], v[16:17], v[88:89]
    v_pk_fma_f32 v[254:255], v[254:255], v[16:17], v[88:89]
    v_exp_f32 v240, v240
    v_exp_f32 v241, v241
    v_exp_f32 v242, v242
    v_exp_f32 v243, v243
    v_mfma_f32_32x32x16_bf16 v[64:79], a[148:151], v[228:231], v[64:79]
    v_exp_f32 v244, v244
    v_exp_f32 v245, v245
    v_exp_f32 v246, v246
    v_exp_f32 v247, v247
    v_exp_f32 v248, v248
    v_exp_f32 v249, v249
    v_exp_f32 v250, v250
    v_exp_f32 v251, v251
    v_exp_f32 v252, v252
    v_exp_f32 v253, v253
    v_exp_f32 v254, v254
    v_exp_f32 v255, v255
    v_pk_add_f32 v[90:91], v[90:91], v[240:241]
    v_cvt_pk_bf16_f32 v240, v240, v241
    v_pk_add_f32 v[92:93], v[92:93], v[242:243]
    v_cvt_pk_bf16_f32 v241, v242, v243
    v_pk_add_f32 v[90:91], v[90:91], v[244:245]
    v_cvt_pk_bf16_f32 v242, v244, v245
    v_pk_add_f32 v[92:93], v[92:93], v[246:247]
    v_cvt_pk_bf16_f32 v243, v246, v247
    v_pk_add_f32 v[90:91], v[90:91], v[248:249]
    v_cvt_pk_bf16_f32 v244, v248, v249
    v_pk_add_f32 v[92:93], v[92:93], v[250:251]
    v_cvt_pk_bf16_f32 v245, v250, v251
    v_pk_add_f32 v[90:91], v[90:91], v[252:253]
    v_cvt_pk_bf16_f32 v246, v252, v253
    v_pk_add_f32 v[92:93], v[92:93], v[254:255]
    v_cvt_pk_bf16_f32 v247, v254, v255
    s_waitcnt lgkmcnt(2)
    v_mfma_f32_32x32x16_bf16 v[64:79], a[152:155], v[240:243], v[64:79]
    s_waitcnt lgkmcnt(0)
    v_mfma_f32_32x32x16_bf16 v[64:79], a[156:159], v[244:247], v[64:79]
    v_pk_add_f32 v[90:91], v[90:91], v[92:93]
    v_add_f32 v90, v90, v91
    v_mov_b32 v91, v90
    s_nop 1
    v_permlane32_swap_b32 v90, v91
    v_add_f32 v90, v90, v91
    v_rcp_f32 v90, v90
    s_nop 5
    v_pk_mul_f32 v[64:65], v[64:65], v[90:91] op_sel_hi:[1,0]
    s_nop 4
    v_pk_mul_f32 v[66:67], v[66:67], v[90:91] op_sel_hi:[1,0]
    s_nop 3
    v_pk_mul_f32 v[68:69], v[68:69], v[90:91] op_sel_hi:[1,0]
    s_nop 2
    v_pk_mul_f32 v[70:71], v[70:71], v[90:91] op_sel_hi:[1,0]
    s_nop 1
    v_pk_mul_f32 v[72:73], v[72:73], v[90:91] op_sel_hi:[1,0]
    s_nop 0
    v_pk_mul_f32 v[74:75], v[74:75], v[90:91] op_sel_hi:[1,0]
    v_pk_mul_f32 v[76:77], v[76:77], v[90:91] op_sel_hi:[1,0]
    v_pk_mul_f32 v[78:79], v[78:79], v[90:91] op_sel_hi:[1,0]
    v_cvt_pk_bf16_f32 v96, v64, v65
    v_cvt_pk_bf16_f32 v97, v66, v67
    v_cvt_pk_bf16_f32 v98, v68, v69
    v_cvt_pk_bf16_f32 v99, v70, v71
    v_cvt_pk_bf16_f32 v100, v72, v73
    v_cvt_pk_bf16_f32 v101, v74, v75
    v_cvt_pk_bf16_f32 v102, v76, v77
    v_cvt_pk_bf16_f32 v103, v78, v79
    s_lshl_b32 s33, s21, 1
    s_add_u32 s33, s33, 0
    s_lshl_b32 s33, s33, 16
    s_add_u32 s33, s33, s40
    v_permlane32_swap_b32 v96, v98
    v_permlane32_swap_b32 v97, v99
    buffer_store_dwordx4 v[96:99], v13, s[36:39], s33 offen offset:1024 sc1
    s_lshl_b32 s33, s21, 1
    s_add_u32 s33, s33, 1
    s_lshl_b32 s33, s33, 16
    s_add_u32 s33, s33, s40
    v_permlane32_swap_b32 v100, v102
    v_permlane32_swap_b32 v101, v103
    buffer_store_dwordx4 v[100:103], v13, s[36:39], s33 offen offset:1024 sc1
    s_branch L_k3_entry
L_k2_done:
    s_endpgm
L_k2_fix0_0:
    v_mov_b32 v112, v18
    v_mov_b32 v113, v18
    v_mov_b32 v114, v18
    v_mov_b32 v115, v18
    v_mov_b32 v116, v18
    v_mov_b32 v117, v18
    v_mov_b32 v118, v18
    v_mov_b32 v119, v18
    v_mov_b32 v120, v18
    v_mov_b32 v121, v18
    v_mov_b32 v122, v18
    v_mov_b32 v123, v18
    v_mov_b32 v124, v18
    v_mov_b32 v125, v18
    v_mov_b32 v126, v18
    v_mov_b32 v127, v18
    s_branch L_k2_fixed0_0
L_k2_fix0_1:
    v_mov_b32 v128, v18
    v_mov_b32 v129, v18
    v_mov_b32 v130, v18
    v_mov_b32 v131, v18
    v_mov_b32 v132, v18
    v_mov_b32 v133, v18
    v_mov_b32 v134, v18
    v_mov_b32 v135, v18
    v_mov_b32 v136, v18
    v_mov_b32 v137, v18
    v_mov_b32 v138, v18
    v_mov_b32 v139, v18
    v_mov_b32 v140, v18
    v_mov_b32 v141, v18
    v_mov_b32 v142, v18
    v_mov_b32 v143, v18
    s_branch L_k2_fixed0_1
L_k2_fix0_2:
    v_mov_b32 v144, v18
    v_mov_b32 v145, v18
    v_mov_b32 v146, v18
    v_mov_b32 v147, v18
    v_mov_b32 v148, v18
    v_mov_b32 v149, v18
    v_mov_b32 v150, v18
    v_mov_b32 v151, v18
    v_mov_b32 v152, v18
    v_mov_b32 v153, v18
    v_mov_b32 v154, v18
    v_mov_b32 v155, v18
    v_mov_b32 v156, v18
    v_mov_b32 v157, v18
    v_mov_b32 v158, v18
    v_mov_b32 v159, v18
    s_branch L_k2_fixed0_2
L_k2_fix0_3:
    v_mov_b32 v160, v18
    v_mov_b32 v161, v18
    v_mov_b32 v162, v18
    v_mov_b32 v163, v18
    v_mov_b32 v164, v18
    v_mov_b32 v165, v18
    v_mov_b32 v166, v18
    v_mov_b32 v167, v18
    v_mov_b32 v168, v18
    v_mov_b32 v169, v18
    v_mov_b32 v170, v18
    v_mov_b32 v171, v18
    v_mov_b32 v172, v18
    v_mov_b32 v173, v18
    v_mov_b32 v174, v18
    v_mov_b32 v175, v18
    s_branch L_k2_fixed0_3
L_k2_fix0_4:
    v_mov_b32 v176, v18
    v_mov_b32 v177, v18
    v_mov_b32 v178, v18
    v_mov_b32 v179, v18
    v_mov_b32 v180, v18
    v_mov_b32 v181, v18
    v_mov_b32 v182, v18
    v_mov_b32 v183, v18
    v_mov_b32 v184, v18
    v_mov_b32 v185, v18
    v_mov_b32 v186, v18
    v_mov_b32 v187, v18
    v_mov_b32 v188, v18
    v_mov_b32 v189, v18
    v_mov_b32 v190, v18
    v_mov_b32 v191, v18
    s_branch L_k2_fixed0_4
L_k2_fix0_5:
    v_mov_b32 v192, v18
    v_mov_b32 v193, v18
    v_mov_b32 v194, v18
    v_mov_b32 v195, v18
    v_mov_b32 v196, v18
    v_mov_b32 v197, v18
    v_mov_b32 v198, v18
    v_mov_b32 v199, v18
    v_mov_b32 v200, v18
    v_mov_b32 v201, v18
    v_mov_b32 v202, v18
    v_mov_b32 v203, v18
    v_mov_b32 v204, v18
    v_mov_b32 v205, v18
    v_mov_b32 v206, v18
    v_mov_b32 v207, v18
    s_branch L_k2_fixed0_5
L_k2_fix0_6:
    v_mov_b32 v208, v18
    v_mov_b32 v209, v18
    v_mov_b32 v210, v18
    v_mov_b32 v211, v18
    v_mov_b32 v212, v18
    v_mov_b32 v213, v18
    v_mov_b32 v214, v18
    v_mov_b32 v215, v18
    v_mov_b32 v216, v18
    v_mov_b32 v217, v18
    v_mov_b32 v218, v18
    v_mov_b32 v219, v18
    v_mov_b32 v220, v18
    v_mov_b32 v221, v18
    v_mov_b32 v222, v18
    v_mov_b32 v223, v18
    s_branch L_k2_fixed0_6
L_k2_fix0_7:
    v_mov_b32 v224, v18
    v_mov_b32 v225, v18
    v_mov_b32 v226, v18
    v_mov_b32 v227, v18
    v_mov_b32 v228, v18
    v_mov_b32 v229, v18
    v_mov_b32 v230, v18
    v_mov_b32 v231, v18
    v_mov_b32 v232, v18
    v_mov_b32 v233, v18
    v_mov_b32 v234, v18
    v_mov_b32 v235, v18
    v_mov_b32 v236, v18
    v_mov_b32 v237, v18
    v_mov_b32 v238, v18
    v_mov_b32 v239, v18
    s_branch L_k2_fixed0_7
L_k2_fix1_0:
    v_mov_b32 v112, v18
    v_mov_b32 v113, v18
    v_mov_b32 v114, v18
    v_mov_b32 v115, v18
    v_mov_b32 v116, v18
    v_mov_b32 v117, v18
    v_mov_b32 v118, v18
    v_mov_b32 v119, v18
    v_mov_b32 v120, v18
    v_mov_b32 v121, v18
    v_mov_b32 v122, v18
    v_mov_b32 v123, v18
    v_mov_b32 v124, v18
    v_mov_b32 v125, v18
    v_mov_b32 v126, v18
    v_mov_b32 v127, v18
    s_branch L_k2_fixed1_0
L_k2_fix1_1:
    v_mov_b32 v128, v18
    v_mov_b32 v129, v18
    v_mov_b32 v130, v18
    v_mov_b32 v131, v18
    v_mov_b32 v132, v18
    v_mov_b32 v133, v18
    v_mov_b32 v134, v18
    v_mov_b32 v135, v18
    v_mov_b32 v136, v18
    v_mov_b32 v137, v18
    v_mov_b32 v138, v18
    v_mov_b32 v139, v18
    v_mov_b32 v140, v18
    v_mov_b32 v141, v18
    v_mov_b32 v142, v18
    v_mov_b32 v143, v18
    s_branch L_k2_fixed1_1
L_k2_fix1_2:
    v_mov_b32 v144, v18
    v_mov_b32 v145, v18
    v_mov_b32 v146, v18
    v_mov_b32 v147, v18
    v_mov_b32 v148, v18
    v_mov_b32 v149, v18
    v_mov_b32 v150, v18
    v_mov_b32 v151, v18
    v_mov_b32 v152, v18
    v_mov_b32 v153, v18
    v_mov_b32 v154, v18
    v_mov_b32 v155, v18
    v_mov_b32 v156, v18
    v_mov_b32 v157, v18
    v_mov_b32 v158, v18
    v_mov_b32 v159, v18
    s_branch L_k2_fixed1_2
L_k2_fix1_3:
    v_mov_b32 v160, v18
    v_mov_b32 v161, v18
    v_mov_b32 v162, v18
    v_mov_b32 v163, v18
    v_mov_b32 v164, v18
    v_mov_b32 v165, v18
    v_mov_b32 v166, v18
    v_mov_b32 v167, v18
    v_mov_b32 v168, v18
    v_mov_b32 v169, v18
    v_mov_b32 v170, v18
    v_mov_b32 v171, v18
    v_mov_b32 v172, v18
    v_mov_b32 v173, v18
    v_mov_b32 v174, v18
    v_mov_b32 v175, v18
    s_branch L_k2_fixed1_3
L_k2_fix1_4:
    v_mov_b32 v176, v18
    v_mov_b32 v177, v18
    v_mov_b32 v178, v18
    v_mov_b32 v179, v18
    v_mov_b32 v180, v18
    v_mov_b32 v181, v18
    v_mov_b32 v182, v18
    v_mov_b32 v183, v18
    v_mov_b32 v184, v18
    v_mov_b32 v185, v18
    v_mov_b32 v186, v18
    v_mov_b32 v187, v18
    v_mov_b32 v188, v18
    v_mov_b32 v189, v18
    v_mov_b32 v190, v18
    v_mov_b32 v191, v18
    s_branch L_k2_fixed1_4
L_k2_fix1_5:
    v_mov_b32 v192, v18
    v_mov_b32 v193, v18
    v_mov_b32 v194, v18
    v_mov_b32 v195, v18
    v_mov_b32 v196, v18
    v_mov_b32 v197, v18
    v_mov_b32 v198, v18
    v_mov_b32 v199, v18
    v_mov_b32 v200, v18
    v_mov_b32 v201, v18
    v_mov_b32 v202, v18
    v_mov_b32 v203, v18
    v_mov_b32 v204, v18
    v_mov_b32 v205, v18
    v_mov_b32 v206, v18
    v_mov_b32 v207, v18
    s_branch L_k2_fixed1_5
L_k2_fix1_6:
    v_mov_b32 v208, v18
    v_mov_b32 v209, v18
    v_mov_b32 v210, v18
    v_mov_b32 v211, v18
    v_mov_b32 v212, v18
    v_mov_b32 v213, v18
    v_mov_b32 v214, v18
    v_mov_b32 v215, v18
    v_mov_b32 v216, v18
    v_mov_b32 v217, v18
    v_mov_b32 v218, v18
    v_mov_b32 v219, v18
    v_mov_b32 v220, v18
    v_mov_b32 v221, v18
    v_mov_b32 v222, v18
    v_mov_b32 v223, v18
    s_branch L_k2_fixed1_6
L_k2_fix1_7:
    v_mov_b32 v224, v18
    v_mov_b32 v225, v18
    v_mov_b32 v226, v18
    v_mov_b32 v227, v18
    v_mov_b32 v228, v18
    v_mov_b32 v229, v18
    v_mov_b32 v230, v18
    v_mov_b32 v231, v18
    v_mov_b32 v232, v18
    v_mov_b32 v233, v18
    v_mov_b32 v234, v18
    v_mov_b32 v235, v18
    v_mov_b32 v236, v18
    v_mov_b32 v237, v18
    v_mov_b32 v238, v18
    v_mov_b32 v239, v18
    s_branch L_k2_fixed1_7
L_k3_entry:
    v_mov_b32 v0, v22
    s_add_u32 s97, s96, 1
    s_mov_b32 s49, s2
    s_load_dwordx2 s[4:5], s[0:1], 72
    s_load_dwordx2 s[42:43], s[0:1], 0
    s_load_dwordx2 s[44:45], s[0:1], 56
    v_and_b32 v20, 63, v0
    s_lshr_b32 s20, s2, 1
    s_and_b32 s20, s20, 3
    s_and_b32 s30, s2, 1
    s_lshr_b32 s31, s2, 3
    s_lshl_b32 s33, s31, 1
    s_or_b32 s33, s33, s30
    s_xor_b32 s30, s30, 1
    s_lshl_b32 s30, s30, 2
    s_and_b32 s32, s31, 3
    s_add_u32 s21, s30, s32
    s_lshr_b32 s22, s31, 2
    s_lshr_b32 s23, s3, 1
    s_and_b32 s24, s3, 1
    v_lshlrev_b32 v1, 4, v20
    s_lshl_b32 s28, s3, 13
    s_lshl_b32 s29, s3, 12
    s_mov_b32 s30, 0
    s_cmp_eq_u32 s20, 1
    s_cselect_b32 s30, 16, s30
    s_cmp_eq_u32 s20, 2
    s_cselect_b32 s30, 35, s30
    s_cmp_eq_u32 s20, 3
    s_cselect_b32 s30, 54, s30
    s_lshl_b32 s25, s30, 18
    s_lshl_b32 s31, s3, 16
    s_add_u32 s25, s25, s31
    s_lshl_b32 s31, s21, 13
    s_add_u32 s25, s25, s31
    s_add_u32 s25, s25, 4194304
    s_lshl_b32 s26, s30, 14
    s_mul_i32 s31, s22, 1179648
    s_add_u32 s26, s26, s31
    s_lshl_b32 s31, s3, 12
    s_add_u32 s26, s26, s31
    s_add_u32 s26, s26, 41943040
    s_waitcnt lgkmcnt(0)
    s_mov_b32 s8, s4
    s_mov_b32 s9, s5
    s_mov_b32 s10, 268435456
    s_mov_b32 s11, 0x00020000
    s_nop 0
    s_cmp_lg_u32 s20, 0
    s_cbranch_scc1 L_k3_noto
    s_waitcnt vmcnt(0)
    s_barrier
    s_cmp_lg_u32 s3, 0
    s_cbranch_scc1 L_k3_dwait
    s_lshl_b32 s32, s49, 7
    s_add_u32 s32, s32, 41123840
    v_mov_b32 v22, s97
    v_mov_b32 v23, 0
    s_mov_b64 exec, 1
    buffer_store_dword v22, v23, s[8:11], s32 offen sc1
    s_mov_b64 exec, -1
L_k3_noto:
    s_cmp_lg_u32 s3, 0
    s_cbranch_scc1 L_k3_dwait
    s_mov_b64 exec, s[58:59]
    s_mov_b32 s31, 0
    s_waitcnt vmcnt(2)
    v_cmp_eq_u32 vcc, s97, v26
    s_nop 1
    s_cmp_eq_u64 vcc, s[58:59]
    s_cbranch_scc1 L_k3_hgot
L_k3_hpoll:
    buffer_load_dword v26, v27, s[8:11], 0 offen sc1
    s_waitcnt vmcnt(0)
    v_cmp_eq_u32 vcc, s97, v26
    s_add_u32 s31, s31, 1
    s_cmp_gt_u32 s31, 0x40000
    s_cbranch_scc1 L_k3_hgot
    s_cmp_eq_u64 vcc, s[58:59]
    s_cbranch_scc1 L_k3_hgot
    s_sleep 4
    s_branch L_k3_hpoll
L_k3_hgot:
    s_mov_b64 exec, -1
L_k3_dwait:
    s_waitcnt vmcnt(0)
    s_barrier
    s_cmp_eq_u32 s20, 0
    s_cbranch_scc1 L_k3_oset2
    s_cmp_lg_u32 s3, 0
    s_cbranch_scc1 L_k3_oset2
    s_lshl_b32 s32, s49, 7
    s_add_u32 s32, s32, 41123840
    v_mov_b32 v22, s97
    v_mov_b32 v23, 0
    s_mov_b64 exec, 1
    buffer_store_dword v22, v23, s[8:11], s32 offen sc1
    s_mov_b64 exec, -1
L_k3_oset2:
    s_add_u32 m0, s29, 32768
    s_nop 0
    buffer_load_dwordx4 v1, s[8:11], s26 offen offset:0 lds
    buffer_load_dwordx4 v1, s[8:11], s26 offen offset:1024 lds
    buffer_load_dwordx4 v1, s[8:11], s26 offen offset:2048 lds
    buffer_load_dwordx4 v1, s[8:11], s26 offen offset:3072 lds
    s_add_u32 s26, s26, 16384
    s_add_u32 m0, s28, 0
    s_nop 0
    buffer_load_dwordx4 v1, s[8:11], s25 offen offset:0 lds
    buffer_load_dwordx4 v1, s[8:11], s25 offen offset:1024 lds
    buffer_load_dwordx4 v1, s[8:11], s25 offen offset:2048 lds
    buffer_load_dwordx4 v1, s[8:11], s25 offen offset:3072 lds
    s_add_u32 s25, s25, 4096
    s_add_u32 m0, s28, 4096
    s_nop 0
    buffer_load_dwordx4 v1, s[8:11], s25 offen offset:0 lds
    buffer_load_dwordx4 v1, s[8:11], s25 offen offset:1024 lds
    buffer_load_dwordx4 v1, s[8:11], s25 offen offset:2048 lds
    buffer_load_dwordx4 v1, s[8:11], s25 offen offset:3072 lds
    s_add_u32 s25, s25, 258048
    v_and_b32 v21, 15, v20
    v_lshrrev_b32 v22, 4, v20
    v_lshrrev_b32 v23, 1, v22
    v_lshlrev_b32 v23, 13, v23
    v_and_b32 v24, 1, v22
    v_lshl_add_u32 v23, v24, 4, v23
    s_lshl_b32 s30, s23, 7
    v_add_u32 v25, s30, v21
    v_lshl_add_u32 v4, v25, 5, v23
    v_add_u32 v5, 49152, v4
    v_add_u32 v6, 98304, v4
    v_lshrrev_b32 v23, 2, v21
    v_lshl_or_b32 v25, v24, 2, v23
    v_lshl_add_u32 v23, v22, 3, v23
    v_lshlrev_b32 v23, 8, v23
    v_and_b32 v26, 3, v21
    v_lshl_add_u32 v23, v26, 3, v23
    v_add_u32 v23, 32768, v23
    s_lshl_b32 s30, s24, 2
    s_add_u32 s31, s30, 0
    v_xor_b32 v26, s31, v25
    v_lshl_add_u32 v8, v26, 5, v23
    v_add_u32 v12, 49152, v8
    v_add_u32 v16, 98304, v8
    s_add_u32 s31, s30, 1
    v_xor_b32 v26, s31, v25
    v_lshl_add_u32 v9, v26, 5, v23
    v_add_u32 v13, 49152, v9
    v_add_u32 v17, 98304, v9
    s_add_u32 s31, s30, 2
    v_xor_b32 v26, s31, v25
    v_lshl_add_u32 v10, v26, 5, v23
    v_add_u32 v14, 49152, v10
    v_add_u32 v18, 98304, v10
    s_add_u32 s31, s30, 3
    v_xor_b32 v26, s31, v25
    v_lshl_add_u32 v11, v26, 5, v23
    v_add_u32 v15, 49152, v11
    v_add_u32 v19, 98304, v11
    s_add_u32 m0, s29, 81920
    s_nop 0
    buffer_load_dwordx4 v1, s[8:11], s26 offen offset:0 lds
    buffer_load_dwordx4 v1, s[8:11], s26 offen offset:1024 lds
    buffer_load_dwordx4 v1, s[8:11], s26 offen offset:2048 lds
    buffer_load_dwordx4 v1, s[8:11], s26 offen offset:3072 lds
    s_add_u32 s26, s26, 16384
    s_add_u32 m0, s28, 49152
    s_nop 0
    buffer_load_dwordx4 v1, s[8:11], s25 offen offset:0 lds
    buffer_load_dwordx4 v1, s[8:11], s25 offen offset:1024 lds
    buffer_load_dwordx4 v1, s[8:11], s25 offen offset:2048 lds
    buffer_load_dwordx4 v1, s[8:11], s25 offen offset:3072 lds
    s_add_u32 s25, s25, 4096
    s_add_u32 m0, s28, 53248
    s_nop 0
    buffer_load_dwordx4 v1, s[8:11], s25 offen offset:0 lds
    buffer_load_dwordx4 v1, s[8:11], s25 offen offset:1024 lds
    buffer_load_dwordx4 v1, s[8:11], s25 offen offset:2048 lds
    buffer_load_dwordx4 v1, s[8:11], s25 offen offset:3072 lds
    s_add_u32 s25, s25, 258048
    s_mov_b32 s16, s42
    s_mov_b32 s17, s43
    s_mov_b32 s18, 4194304
    s_mov_b32 s19, 0x00020000
    s_mov_b32 s36, s44
    s_mov_b32 s37, s45
    s_mov_b32 s38, 4194304
    s_mov_b32 s39, 0x00020000
    s_lshl_b32 s30, s21, 8
    s_lshl_b32 s31, s23, 7
    s_add_u32 s30, s30, s31
    s_lshl_b32 s41, s30, 3
    s_add_u32 s41, s41, 39911428
    s_lshl_b32 s40, s30, 11
    v_lshlrev_b32 v28, 11, v21
    v_lshlrev_b32 v24, 5, v24
    v_lshrrev_b32 v25, 1, v22
    v_lshl_add_u32 v24, v25, 4, v24
    v_add_u32 v28, v28, v24
    s_lshl_b32 s30, s22, 8
    s_lshl_b32 s31, s24, 7
    s_add_u32 s30, s30, s31
    v_add_u32 v28, s30, v28
    v_lshlrev_b32 v29, 3, v21
    s_mul_i32 s30, s33, 327680
    s_lshl_b32 s31, s3, 12
    s_add_u32 s30, s30, s31
    s_add_u32 s34, s30, 83886080
    s_lshl_b32 s32, s33, 11
    s_lshl_b32 s31, s3, 7
    s_add_u32 s32, s32, s31
    s_add_u32 s35, s32, 40894464
    v_mov_b32 v48, 0
    v_mov_b32 v49, 0
    v_mov_b32 v50, 0
    v_mov_b32 v51, 0
    s_nop 1
    v_mfma_f32_32x32x16_bf16 v[128:143], v[48:51], v[48:51], 0
    v_mfma_f32_32x32x16_bf16 v[144:159], v[48:51], v[48:51], 0
    v_mfma_f32_32x32x16_bf16 v[160:175], v[48:51], v[48:51], 0
    v_mfma_f32_32x32x16_bf16 v[176:191], v[48:51], v[48:51], 0
    v_mfma_f32_32x32x16_bf16 v[192:207], v[48:51], v[48:51], 0
    v_mfma_f32_32x32x16_bf16 v[208:223], v[48:51], v[48:51], 0
    v_mfma_f32_32x32x16_bf16 v[224:239], v[48:51], v[48:51], 0
    v_mfma_f32_32x32x16_bf16 v[240:255], v[48:51], v[48:51], 0
    s_waitcnt vmcnt(12)
    s_barrier
    ds_read_b64_tr_b16 a[32:33], v8 offset:0
    ds_read_b64_tr_b16 a[34:35], v8 offset:1024
    ds_read_b128 a[0:3], v4 offset:0
    ds_read_b128 a[4:7], v4 offset:512
    ds_read_b128 a[8:11], v4 offset:1024
    ds_read_b128 a[12:15], v4 offset:1536
    ds_read_b128 a[16:19], v4 offset:2048
    ds_read_b128 a[20:23], v4 offset:2560
    ds_read_b128 a[24:27], v4 offset:3072
    ds_read_b128 a[28:31], v4 offset:3584
    ds_read_b64_tr_b16 a[36:37], v9 offset:0
    ds_read_b64_tr_b16 a[38:39], v9 offset:1024
    ds_read_b64_tr_b16 a[40:41], v10 offset:0
    ds_read_b64_tr_b16 a[42:43], v10 offset:1024
    ds_read_b64_tr_b16 a[44:45], v11 offset:0
    ds_read_b64_tr_b16 a[46:47], v11 offset:1024
    s_add_u32 m0, s29, 131072
    s_nop 0
    buffer_load_dwordx4 v1, s[8:11], s26 offen offset:0 lds
    buffer_load_dwordx4 v1, s[8:11], s26 offen offset:1024 lds
    buffer_load_dwordx4 v1, s[8:11], s26 offen offset:2048 lds
    buffer_load_dwordx4 v1, s[8:11], s26 offen offset:3072 lds
    s_add_u32 s26, s26, 16384
    s_add_u32 m0, s28, 98304
    s_nop 0
    buffer_load_dwordx4 v1, s[8:11], s25 offen offset:0 lds
    buffer_load_dwordx4 v1, s[8:11], s25 offen offset:1024 lds
    s_cmp_eq_u32 s20, 0
    s_cselect_b32 s27, 4, 5
L_k3_loop:
    s_waitcnt lgkmcnt(13)
    v_mfma_f32_16x16x32_bf16 v[128:131], a[32:35], a[0:3], v[128:131]
    ds_read_b64_tr_b16 a[80:81], v8 offset:8192
    s_waitcnt lgkmcnt(13)
    v_mfma_f32_16x16x32_bf16 v[132:135], a[32:35], a[4:7], v[132:135]
    ds_read_b64_tr_b16 a[82:83], v8 offset:9216
    s_waitcnt lgkmcnt(13)
    v_mfma_f32_16x16x32_bf16 v[136:139], a[32:35], a[8:11], v[136:139]
    ds_read_b128 a[48:51], v4 offset:16384
    buffer_load_dwordx4 v1, s[8:11], s25 offen offset:2048 lds
    s_waitcnt lgkmcnt(13)
    v_mfma_f32_16x16x32_bf16 v[140:143], a[32:35], a[12:15], v[140:143]
    ds_read_b128 a[52:55], v4 offset:16896
    s_waitcnt lgkmcnt(13)
    v_mfma_f32_16x16x32_bf16 v[144:147], a[32:35], a[16:19], v[144:147]
    ds_read_b128 a[56:59], v4 offset:17408
    s_waitcnt lgkmcnt(13)
    v_mfma_f32_16x16x32_bf16 v[148:151], a[32:35], a[20:23], v[148:151]
    ds_read_b128 a[60:63], v4 offset:17920
    s_waitcnt lgkmcnt(13)
    v_mfma_f32_16x16x32_bf16 v[152:155], a[32:35], a[24:27], v[152:155]
    ds_read_b128 a[64:67], v4 offset:18432
    s_waitcnt lgkmcnt(13)
    v_mfma_f32_16x16x32_bf16 v[156:159], a[32:35], a[28:31], v[156:159]
    ds_read_b128 a[68:71], v4 offset:18944
    buffer_load_dwordx4 v1, s[8:11], s25 offen offset:3072 lds
    s_waitcnt lgkmcnt(12)
    v_mfma_f32_16x16x32_bf16 v[160:163], a[36:39], a[0:3], v[160:163]
    s_add_u32 s25, s25, 4096
    ds_read_b128 a[72:75], v4 offset:19456
    v_mfma_f32_16x16x32_bf16 v[164:167], a[36:39], a[4:7], v[164:167]
    ds_read_b128 a[76:79], v4 offset:19968
    v_mfma_f32_16x16x32_bf16 v[168:171], a[36:39], a[8:11], v[168:171]
    ds_read_b64_tr_b16 a[84:85], v9 offset:8192
    v_mfma_f32_16x16x32_bf16 v[172:175], a[36:39], a[12:15], v[172:175]
    s_add_u32 m0, s28, 102400
    ds_read_b64_tr_b16 a[86:87], v9 offset:9216
    v_mfma_f32_16x16x32_bf16 v[176:179], a[36:39], a[16:19], v[176:179]
    ds_read_b64_tr_b16 a[88:89], v10 offset:8192
    buffer_load_dwordx4 v1, s[8:11], s25 offen offset:0 lds
    v_mfma_f32_16x16x32_bf16 v[180:183], a[36:39], a[20:23], v[180:183]
    ds_read_b64_tr_b16 a[90:91], v10 offset:9216
    v_mfma_f32_16x16x32_bf16 v[184:187], a[36:39], a[24:27], v[184:187]
    ds_read_b64_tr_b16 a[92:93], v11 offset:8192
    v_mfma_f32_16x16x32_bf16 v[188:191], a[36:39], a[28:31], v[188:191]
    ds_read_b64_tr_b16 a[94:95], v11 offset:9216
    s_waitcnt lgkmcnt(15)
    v_mfma_f32_16x16x32_bf16 v[192:195], a[40:43], a[0:3], v[192:195]
    v_mfma_f32_16x16x32_bf16 v[196:199], a[40:43], a[4:7], v[196:199]
    buffer_load_dwordx4 v1, s[8:11], s25 offen offset:1024 lds
    v_mfma_f32_16x16x32_bf16 v[200:203], a[40:43], a[8:11], v[200:203]
    v_mfma_f32_16x16x32_bf16 v[204:207], a[40:43], a[12:15], v[204:207]
    v_mfma_f32_16x16x32_bf16 v[208:211], a[40:43], a[16:19], v[208:211]
    v_mfma_f32_16x16x32_bf16 v[212:215], a[40:43], a[20:23], v[212:215]
    v_mfma_f32_16x16x32_bf16 v[216:219], a[40:43], a[24:27], v[216:219]
    buffer_load_dwordx4 v1, s[8:11], s25 offen offset:2048 lds
    v_mfma_f32_16x16x32_bf16 v[220:223], a[40:43], a[28:31], v[220:223]
    s_waitcnt lgkmcnt(15)
    v_mfma_f32_16x16x32_bf16 v[224:227], a[44:47], a[0:3], v[224:227]
    v_mfma_f32_16x16x32_bf16 v[228:231], a[44:47], a[4:7], v[228:231]
    v_mfma_f32_16x16x32_bf16 v[232:235], a[44:47], a[8:11], v[232:235]
    v_mfma_f32_16x16x32_bf16 v[236:239], a[44:47], a[12:15], v[236:239]
    buffer_load_dwordx4 v1, s[8:11], s25 offen offset:3072 lds
    v_mfma_f32_16x16x32_bf16 v[240:243], a[44:47], a[16:19], v[240:243]
    s_add_u32 s25, s25, 258048
    v_mfma_f32_16x16x32_bf16 v[244:247], a[44:47], a[20:23], v[244:247]
    v_mfma_f32_16x16x32_bf16 v[248:251], a[44:47], a[24:27], v[248:251]
    v_mfma_f32_16x16x32_bf16 v[252:255], a[44:47], a[28:31], v[252:255]
    s_waitcnt vmcnt(12) lgkmcnt(0)
    s_barrier
    v_mfma_f32_16x16x32_bf16 v[128:131], a[80:83], a[48:51], v[128:131]
    ds_read_b64_tr_b16 a[32:33], v12 offset:0
    v_mfma_f32_16x16x32_bf16 v[132:135], a[80:83], a[52:55], v[132:135]
    s_add_u32 m0, s29, 32768
    ds_read_b64_tr_b16 a[34:35], v12 offset:1024
    v_mfma_f32_16x16x32_bf16 v[136:139], a[80:83], a[56:59], v[136:139]
    ds_read_b128 a[0:3], v5 offset:0
    buffer_load_dwordx4 v1, s[8:11], s26 offen offset:0 lds
    v_mfma_f32_16x16x32_bf16 v[140:143], a[80:83], a[60:63], v[140:143]
    ds_read_b128 a[4:7], v5 offset:512
    v_mfma_f32_16x16x32_bf16 v[144:147], a[80:83], a[64:67], v[144:147]
    ds_read_b128 a[8:11], v5 offset:1024
    v_mfma_f32_16x16x32_bf16 v[148:151], a[80:83], a[68:71], v[148:151]
    ds_read_b128 a[12:15], v5 offset:1536
    v_mfma_f32_16x16x32_bf16 v[152:155], a[80:83], a[72:75], v[152:155]
    ds_read_b128 a[16:19], v5 offset:2048
    v_mfma_f32_16x16x32_bf16 v[156:159], a[80:83], a[76:79], v[156:159]
    ds_read_b128 a[20:23], v5 offset:2560
    buffer_load_dwordx4 v1, s[8:11], s26 offen offset:1024 lds
    v_mfma_f32_16x16x32_bf16 v[160:163], a[84:87], a[48:51], v[160:163]
    ds_read_b128 a[24:27], v5 offset:3072
    v_mfma_f32_16x16x32_bf16 v[164:167], a[84:87], a[52:55], v[164:167]
    ds_read_b128 a[28:31], v5 offset:3584
    v_mfma_f32_16x16x32_bf16 v[168:171], a[84:87], a[56:59], v[168:171]
    ds_read_b64_tr_b16 a[36:37], v13 offset:0
    v_mfma_f32_16x16x32_bf16 v[172:175], a[84:87], a[60:63], v[172:175]
    ds_read_b64_tr_b16 a[38:39], v13 offset:1024
    v_mfma_f32_16x16x32_bf16 v[176:179], a[84:87], a[64:67], v[176:179]
    ds_read_b64_tr_b16 a[40:41], v14 offset:0
    buffer_load_dwordx4 v1, s[8:11], s26 offen offset:2048 lds
    v_mfma_f32_16x16x32_bf16 v[180:183], a[84:87], a[68:71], v[180:183]
    ds_read_b64_tr_b16 a[42:43], v14 offset:1024
    v_mfma_f32_16x16x32_bf16 v[184:187], a[84:87], a[72:75], v[184:187]
    ds_read_b64_tr_b16 a[44:45], v15 offset:0
    v_mfma_f32_16x16x32_bf16 v[188:191], a[84:87], a[76:79], v[188:191]
    ds_read_b64_tr_b16 a[46:47], v15 offset:1024
    v_mfma_f32_16x16x32_bf16 v[192:195], a[88:91], a[48:51], v[192:195]
    v_mfma_f32_16x16x32_bf16 v[196:199], a[88:91], a[52:55], v[196:199]
    buffer_load_dwordx4 v1, s[8:11], s26 offen offset:3072 lds
    v_mfma_f32_16x16x32_bf16 v[200:203], a[88:91], a[56:59], v[200:203]
    s_add_u32 s26, s26, 16384
    v_mfma_f32_16x16x32_bf16 v[204:207], a[88:91], a[60:63], v[204:207]
    v_mfma_f32_16x16x32_bf16 v[208:211], a[88:91], a[64:67], v[208:211]
    v_mfma_f32_16x16x32_bf16 v[212:215], a[88:91], a[68:71], v[212:215]
    s_add_u32 m0, s28, 0
    v_mfma_f32_16x16x32_bf16 v[216:219], a[88:91], a[72:75], v[216:219]
    buffer_load_dwordx4 v1, s[8:11], s25 offen offset:0 lds
    v_mfma_f32_16x16x32_bf16 v[220:223], a[88:91], a[76:79], v[220:223]
    v_mfma_f32_16x16x32_bf16 v[224:227], a[92:95], a[48:51], v[224:227]
    v_mfma_f32_16x16x32_bf16 v[228:231], a[92:95], a[52:55], v[228:231]
    v_mfma_f32_16x16x32_bf16 v[232:235], a[92:95], a[56:59], v[232:235]
    v_mfma_f32_16x16x32_bf16 v[236:239], a[92:95], a[60:63], v[236:239]
    buffer_load_dwordx4 v1, s[8:11], s25 offen offset:1024 lds
    v_mfma_f32_16x16x32_bf16 v[240:243], a[92:95], a[64:67], v[240:243]
    v_mfma_f32_16x16x32_bf16 v[244:247], a[92:95], a[68:71], v[244:247]
    v_mfma_f32_16x16x32_bf16 v[248:251], a[92:95], a[72:75], v[248:251]
    v_mfma_f32_16x16x32_bf16 v[252:255], a[92:95], a[76:79], v[252:255]
    s_waitcnt lgkmcnt(13)
    v_mfma_f32_16x16x32_bf16 v[128:131], a[32:35], a[0:3], v[128:131]
    ds_read_b64_tr_b16 a[80:81], v12 offset:8192
    s_waitcnt lgkmcnt(13)
    v_mfma_f32_16x16x32_bf16 v[132:135], a[32:35], a[4:7], v[132:135]
    ds_read_b64_tr_b16 a[82:83], v12 offset:9216
    s_waitcnt lgkmcnt(13)
    v_mfma_f32_16x16x32_bf16 v[136:139], a[32:35], a[8:11], v[136:139]
    ds_read_b128 a[48:51], v5 offset:16384
    buffer_load_dwordx4 v1, s[8:11], s25 offen offset:2048 lds
    s_waitcnt lgkmcnt(13)
    v_mfma_f32_16x16x32_bf16 v[140:143], a[32:35], a[12:15], v[140:143]
    ds_read_b128 a[52:55], v5 offset:16896
    s_waitcnt lgkmcnt(13)
    v_mfma_f32_16x16x32_bf16 v[144:147], a[32:35], a[16:19], v[144:147]
    ds_read_b128 a[56:59], v5 offset:17408
    s_waitcnt lgkmcnt(13)
    v_mfma_f32_16x16x32_bf16 v[148:151], a[32:35], a[20:23], v[148:151]
    ds_read_b128 a[60:63], v5 offset:17920
    s_waitcnt lgkmcnt(13)
    v_mfma_f32_16x16x32_bf16 v[152:155], a[32:35], a[24:27], v[152:155]
    ds_read_b128 a[64:67], v5 offset:18432
    s_waitcnt lgkmcnt(13)
    v_mfma_f32_16x16x32_bf16 v[156:159], a[32:35], a[28:31], v[156:159]
    ds_read_b128 a[68:71], v5 offset:18944
    buffer_load_dwordx4 v1, s[8:11], s25 offen offset:3072 lds
    s_waitcnt lgkmcnt(12)
    v_mfma_f32_16x16x32_bf16 v[160:163], a[36:39], a[0:3], v[160:163]
    s_add_u32 s25, s25, 4096
    ds_read_b128 a[72:75], v5 offset:19456
    v_mfma_f32_16x16x32_bf16 v[164:167], a[36:39], a[4:7], v[164:167]
    ds_read_b128 a[76:79], v5 offset:19968
    v_mfma_f32_16x16x32_bf16 v[168:171], a[36:39], a[8:11], v[168:171]
    ds_read_b64_tr_b16 a[84:85], v13 offset:8192
    v_mfma_f32_16x16x32_bf16 v[172:175], a[36:39], a[12:15], v[172:175]
    s_add_u32 m0, s28, 4096
    ds_read_b64_tr_b16 a[86:87], v13 offset:9216
    v_mfma_f32_16x16x32_bf16 v[176:179], a[36:39], a[16:19], v[176:179]
    ds_read_b64_tr_b16 a[88:89], v14 offset:8192
    buffer_load_dwordx4 v1, s[8:11], s25 offen offset:0 lds
    v_mfma_f32_16x16x32_bf16 v[180:183], a[36:39], a[20:23], v[180:183]
    ds_read_b64_tr_b16 a[90:91], v14 offset:9216
    v_mfma_f32_16x16x32_bf16 v[184:187], a[36:39], a[24:27], v[184:187]
    ds_read_b64_tr_b16 a[92:93], v15 offset:8192
    v_mfma_f32_16x16x32_bf16 v[188:191], a[36:39], a[28:31], v[188:191]
    ds_read_b64_tr_b16 a[94:95], v15 offset:9216
    s_waitcnt lgkmcnt(15)
    v_mfma_f32_16x16x32_bf16 v[192:195], a[40:43], a[0:3], v[192:195]
    v_mfma_f32_16x16x32_bf16 v[196:199], a[40:43], a[4:7], v[196:199]
    buffer_load_dwordx4 v1, s[8:11], s25 offen offset:1024 lds
    v_mfma_f32_16x16x32_bf16 v[200:203], a[40:43], a[8:11], v[200:203]
    v_mfma_f32_16x16x32_bf16 v[204:207], a[40:43], a[12:15], v[204:207]
    v_mfma_f32_16x16x32_bf16 v[208:211], a[40:43], a[16:19], v[208:211]
    v_mfma_f32_16x16x32_bf16 v[212:215], a[40:43], a[20:23], v[212:215]
    v_mfma_f32_16x16x32_bf16 v[216:219], a[40:43], a[24:27], v[216:219]
    buffer_load_dwordx4 v1, s[8:11], s25 offen offset:2048 lds
    v_mfma_f32_16x16x32_bf16 v[220:223], a[40:43], a[28:31], v[220:223]
    s_waitcnt lgkmcnt(15)
    v_mfma_f32_16x16x32_bf16 v[224:227], a[44:47], a[0:3], v[224:227]
    v_mfma_f32_16x16x32_bf16 v[228:231], a[44:47], a[4:7], v[228:231]
    v_mfma_f32_16x16x32_bf16 v[232:235], a[44:47], a[8:11], v[232:235]
    v_mfma_f32_16x16x32_bf16 v[236:239], a[44:47], a[12:15], v[236:239]
    buffer_load_dwordx4 v1, s[8:11], s25 offen offset:3072 lds
    v_mfma_f32_16x16x32_bf16 v[240:243], a[44:47], a[16:19], v[240:243]
    s_add_u32 s25, s25, 258048
    v_mfma_f32_16x16x32_bf16 v[244:247], a[44:47], a[20:23], v[244:247]
    v_mfma_f32_16x16x32_bf16 v[248:251], a[44:47], a[24:27], v[248:251]
    v_mfma_f32_16x16x32_bf16 v[252:255], a[44:47], a[28:31], v[252:255]
    s_waitcnt vmcnt(12) lgkmcnt(0)
    s_barrier
    v_mfma_f32_16x16x32_bf16 v[128:131], a[80:83], a[48:51], v[128:131]
    ds_read_b64_tr_b16 a[32:33], v16 offset:0
    v_mfma_f32_16x16x32_bf16 v[132:135], a[80:83], a[52:55], v[132:135]
    s_add_u32 m0, s29, 81920
    ds_read_b64_tr_b16 a[34:35], v16 offset:1024
    v_mfma_f32_16x16x32_bf16 v[136:139], a[80:83], a[56:59], v[136:139]
    ds_read_b128 a[0:3], v6 offset:0
    buffer_load_dwordx4 v1, s[8:11], s26 offen offset:0 lds
    v_mfma_f32_16x16x32_bf16 v[140:143], a[80:83], a[60:63], v[140:143]
    ds_read_b128 a[4:7], v6 offset:512
    v_mfma_f32_16x16x32_bf16 v[144:147], a[80:83], a[64:67], v[144:147]
    ds_read_b128 a[8:11], v6 offset:1024
    v_mfma_f32_16x16x32_bf16 v[148:151], a[80:83], a[68:71], v[148:151]
    ds_read_b128 a[12:15], v6 offset:1536
    v_mfma_f32_16x16x32_bf16 v[152:155], a[80:83], a[72:75], v[152:155]
    ds_read_b128 a[16:19], v6 offset:2048
    v_mfma_f32_16x16x32_bf16 v[156:159], a[80:83], a[76:79], v[156:159]
    ds_read_b128 a[20:23], v6 offset:2560
    buffer_load_dwordx4 v1, s[8:11], s26 offen offset:1024 lds
    v_mfma_f32_16x16x32_bf16 v[160:163], a[84:87], a[48:51], v[160:163]
    ds_read_b128 a[24:27], v6 offset:3072
    v_mfma_f32_16x16x32_bf16 v[164:167], a[84:87], a[52:55], v[164:167]
    ds_read_b128 a[28:31], v6 offset:3584
    v_mfma_f32_16x16x32_bf16 v[168:171], a[84:87], a[56:59], v[168:171]
    ds_read_b64_tr_b16 a[36:37], v17 offset:0
    v_mfma_f32_16x16x32_bf16 v[172:175], a[84:87], a[60:63], v[172:175]
    ds_read_b64_tr_b16 a[38:39], v17 offset:1024
    v_mfma_f32_16x16x32_bf16 v[176:179], a[84:87], a[64:67], v[176:179]
    ds_read_b64_tr_b16 a[40:41], v18 offset:0
    buffer_load_dwordx4 v1, s[8:11], s26 offen offset:2048 lds
    v_mfma_f32_16x16x32_bf16 v[180:183], a[84:87], a[68:71], v[180:183]
    ds_read_b64_tr_b16 a[42:43], v18 offset:1024
    v_mfma_f32_16x16x32_bf16 v[184:187], a[84:87], a[72:75], v[184:187]
    ds_read_b64_tr_b16 a[44:45], v19 offset:0
    v_mfma_f32_16x16x32_bf16 v[188:191], a[84:87], a[76:79], v[188:191]
    ds_read_b64_tr_b16 a[46:47], v19 offset:1024
    v_mfma_f32_16x16x32_bf16 v[192:195], a[88:91], a[48:51], v[192:195]
    v_mfma_f32_16x16x32_bf16 v[196:199], a[88:91], a[52:55], v[196:199]
    buffer_load_dwordx4 v1, s[8:11], s26 offen offset:3072 lds
    v_mfma_f32_16x16x32_bf16 v[200:203], a[88:91], a[56:59], v[200:203]
    s_add_u32 s26, s26, 16384
    v_mfma_f32_16x16x32_bf16 v[204:207], a[88:91], a[60:63], v[204:207]
    v_mfma_f32_16x16x32_bf16 v[208:211], a[88:91], a[64:67], v[208:211]
    v_mfma_f32_16x16x32_bf16 v[212:215], a[88:91], a[68:71], v[212:215]
    s_add_u32 m0, s28, 49152
    v_mfma_f32_16x16x32_bf16 v[216:219], a[88:91], a[72:75], v[216:219]
    buffer_load_dwordx4 v1, s[8:11], s25 offen offset:0 lds
    v_mfma_f32_16x16x32_bf16 v[220:223], a[88:91], a[76:79], v[220:223]
    v_mfma_f32_16x16x32_bf16 v[224:227], a[92:95], a[48:51], v[224:227]
    v_mfma_f32_16x16x32_bf16 v[228:231], a[92:95], a[52:55], v[228:231]
    v_mfma_f32_16x16x32_bf16 v[232:235], a[92:95], a[56:59], v[232:235]
    v_mfma_f32_16x16x32_bf16 v[236:239], a[92:95], a[60:63], v[236:239]
    buffer_load_dwordx4 v1, s[8:11], s25 offen offset:1024 lds
    v_mfma_f32_16x16x32_bf16 v[240:243], a[92:95], a[64:67], v[240:243]
    v_mfma_f32_16x16x32_bf16 v[244:247], a[92:95], a[68:71], v[244:247]
    v_mfma_f32_16x16x32_bf16 v[248:251], a[92:95], a[72:75], v[248:251]
    v_mfma_f32_16x16x32_bf16 v[252:255], a[92:95], a[76:79], v[252:255]
    s_waitcnt lgkmcnt(13)
    v_mfma_f32_16x16x32_bf16 v[128:131], a[32:35], a[0:3], v[128:131]
    ds_read_b64_tr_b16 a[80:81], v16 offset:8192
    s_waitcnt lgkmcnt(13)
    v_mfma_f32_16x16x32_bf16 v[132:135], a[32:35], a[4:7], v[132:135]
    ds_read_b64_tr_b16 a[82:83], v16 offset:9216
    s_waitcnt lgkmcnt(13)
    v_mfma_f32_16x16x32_bf16 v[136:139], a[32:35], a[8:11], v[136:139]
    ds_read_b128 a[48:51], v6 offset:16384
    buffer_load_dwordx4 v1, s[8:11], s25 offen offset:2048 lds
    s_waitcnt lgkmcnt(13)
    v_mfma_f32_16x16x32_bf16 v[140:143], a[32:35], a[12:15], v[140:143]
    ds_read_b128 a[52:55], v6 offset:16896
    s_waitcnt lgkmcnt(13)
    v_mfma_f32_16x16x32_bf16 v[144:147], a[32:35], a[16:19], v[144:147]
    ds_read_b128 a[56:59], v6 offset:17408
    s_waitcnt lgkmcnt(13)
    v_mfma_f32_16x16x32_bf16 v[148:151], a[32:35], a[20:23], v[148:151]
    ds_read_b128 a[60:63], v6 offset:17920
    s_waitcnt lgkmcnt(13)
    v_mfma_f32_16x16x32_bf16 v[152:155], a[32:35], a[24:27], v[152:155]
    ds_read_b128 a[64:67], v6 offset:18432
    s_waitcnt lgkmcnt(13)
    v_mfma_f32_16x16x32_bf16 v[156:159], a[32:35], a[28:31], v[156:159]
    ds_read_b128 a[68:71], v6 offset:18944
    buffer_load_dwordx4 v1, s[8:11], s25 offen offset:3072 lds
    s_waitcnt lgkmcnt(12)
    v_mfma_f32_16x16x32_bf16 v[160:163], a[36:39], a[0:3], v[160:163]
    s_add_u32 s25, s25, 4096
    ds_read_b128 a[72:75], v6 offset:19456
    v_mfma_f32_16x16x32_bf16 v[164:167], a[36:39], a[4:7], v[164:167]
    ds_read_b128 a[76:79], v6 offset:19968
    v_mfma_f32_16x16x32_bf16 v[168:171], a[36:39], a[8:11], v[168:171]
    ds_read_b64_tr_b16 a[84:85], v17 offset:8192
    v_mfma_f32_16x16x32_bf16 v[172:175], a[36:39], a[12:15], v[172:175]
    s_add_u32 m0, s28, 53248
    ds_read_b64_tr_b16 a[86:87], v17 offset:9216
    v_mfma_f32_16x16x32_bf16 v[176:179], a[36:39], a[16:19], v[176:179]
    ds_read_b64_tr_b16 a[88:89], v18 offset:8192
    buffer_load_dwordx4 v1, s[8:11], s25 offen offset:0 lds
    v_mfma_f32_16x16x32_bf16 v[180:183], a[36:39], a[20:23], v[180:183]
    ds_read_b64_tr_b16 a[90:91], v18 offset:9216
    v_mfma_f32_16x16x32_bf16 v[184:187], a[36:39], a[24:27], v[184:187]
    ds_read_b64_tr_b16 a[92:93], v19 offset:8192
    v_mfma_f32_16x16x32_bf16 v[188:191], a[36:39], a[28:31], v[188:191]
    ds_read_b64_tr_b16 a[94:95], v19 offset:9216
    s_waitcnt lgkmcnt(15)
    v_mfma_f32_16x16x32_bf16 v[192:195], a[40:43], a[0:3], v[192:195]
    v_mfma_f32_16x16x32_bf16 v[196:199], a[40:43], a[4:7], v[196:199]
    buffer_load_dwordx4 v1, s[8:11], s25 offen offset:1024 lds
    v_mfma_f32_16x16x32_bf16 v[200:203], a[40:43], a[8:11], v[200:203]
    v_mfma_f32_16x16x32_bf16 v[204:207], a[40:43], a[12:15], v[204:207]
    v_mfma_f32_16x16x32_bf16 v[208:211], a[40:43], a[16:19], v[208:211]
    v_mfma_f32_16x16x32_bf16 v[212:215], a[40:43], a[20:23], v[212:215]
    v_mfma_f32_16x16x32_bf16 v[216:219], a[40:43], a[24:27], v[216:219]
    buffer_load_dwordx4 v1, s[8:11], s25 offen offset:2048 lds
    v_mfma_f32_16x16x32_bf16 v[220:223], a[40:43], a[28:31], v[220:223]
    s_waitcnt lgkmcnt(15)
    v_mfma_f32_16x16x32_bf16 v[224:227], a[44:47], a[0:3], v[224:227]
    v_mfma_f32_16x16x32_bf16 v[228:231], a[44:47], a[4:7], v[228:231]
    v_mfma_f32_16x16x32_bf16 v[232:235], a[44:47], a[8:11], v[232:235]
    v_mfma_f32_16x16x32_bf16 v[236:239], a[44:47], a[12:15], v[236:239]
    buffer_load_dwordx4 v1, s[8:11], s25 offen offset:3072 lds
    v_mfma_f32_16x16x32_bf16 v[240:243], a[44:47], a[16:19], v[240:243]
    s_add_u32 s25, s25, 258048
    v_mfma_f32_16x16x32_bf16 v[244:247], a[44:47], a[20:23], v[244:247]
    v_mfma_f32_16x16x32_bf16 v[248:251], a[44:47], a[24:27], v[248:251]
    v_mfma_f32_16x16x32_bf16 v[252:255], a[44:47], a[28:31], v[252:255]
    s_waitcnt vmcnt(12) lgkmcnt(0)
    s_barrier
    v_mfma_f32_16x16x32_bf16 v[128:131], a[80:83], a[48:51], v[128:131]
    ds_read_b64_tr_b16 a[32:33], v8 offset:0
    v_mfma_f32_16x16x32_bf16 v[132:135], a[80:83], a[52:55], v[132:135]
    s_add_u32 m0, s29, 131072
    ds_read_b64_tr_b16 a[34:35], v8 offset:1024
    v_mfma_f32_16x16x32_bf16 v[136:139], a[80:83], a[56:59], v[136:139]
    ds_read_b128 a[0:3], v4 offset:0
    buffer_load_dwordx4 v1, s[8:11], s26 offen offset:0 lds
    v_mfma_f32_16x16x32_bf16 v[140:143], a[80:83], a[60:63], v[140:143]
    ds_read_b128 a[4:7], v4 offset:512
    v_mfma_f32_16x16x32_bf16 v[144:147], a[80:83], a[64:67], v[144:147]
    ds_read_b128 a[8:11], v4 offset:1024
    v_mfma_f32_16x16x32_bf16 v[148:151], a[80:83], a[68:71], v[148:151]
    ds_read_b128 a[12:15], v4 offset:1536
    v_mfma_f32_16x16x32_bf16 v[152:155], a[80:83], a[72:75], v[152:155]
    ds_read_b128 a[16:19], v4 offset:2048
    v_mfma_f32_16x16x32_bf16 v[156:159], a[80:83], a[76:79], v[156:159]
    ds_read_b128 a[20:23], v4 offset:2560
    buffer_load_dwordx4 v1, s[8:11], s26 offen offset:1024 lds
    v_mfma_f32_16x16x32_bf16 v[160:163], a[84:87], a[48:51], v[160:163]
    ds_read_b128 a[24:27], v4 offset:3072
    v_mfma_f32_16x16x32_bf16 v[164:167], a[84:87], a[52:55], v[164:167]
    ds_read_b128 a[28:31], v4 offset:3584
    v_mfma_f32_16x16x32_bf16 v[168:171], a[84:87], a[56:59], v[168:171]
    ds_read_b64_tr_b16 a[36:37], v9 offset:0
    v_mfma_f32_16x16x32_bf16 v[172:175], a[84:87], a[60:63], v[172:175]
    ds_read_b64_tr_b16 a[38:39], v9 offset:1024
    v_mfma_f32_16x16x32_bf16 v[176:179], a[84:87], a[64:67], v[176:179]
    ds_read_b64_tr_b16 a[40:41], v10 offset:0
    buffer_load_dwordx4 v1, s[8:11], s26 offen offset:2048 lds
    v_mfma_f32_16x16x32_bf16 v[180:183], a[84:87], a[68:71], v[180:183]
    ds_read_b64_tr_b16 a[42:43], v10 offset:1024
    v_mfma_f32_16x16x32_bf16 v[184:187], a[84:87], a[72:75], v[184:187]
    ds_read_b64_tr_b16 a[44:45], v11 offset:0
    v_mfma_f32_16x16x32_bf16 v[188:191], a[84:87], a[76:79], v[188:191]
    ds_read_b64_tr_b16 a[46:47], v11 offset:1024
    v_mfma_f32_16x16x32_bf16 v[192:195], a[88:91], a[48:51], v[192:195]
    v_mfma_f32_16x16x32_bf16 v[196:199], a[88:91], a[52:55], v[196:199]
    buffer_load_dwordx4 v1, s[8:11], s26 offen offset:3072 lds
    v_mfma_f32_16x16x32_bf16 v[200:203], a[88:91], a[56:59], v[200:203]
    s_add_u32 s26, s26, 16384
    v_mfma_f32_16x16x32_bf16 v[204:207], a[88:91], a[60:63], v[204:207]
    v_mfma_f32_16x16x32_bf16 v[208:211], a[88:91], a[64:67], v[208:211]
    v_mfma_f32_16x16x32_bf16 v[212:215], a[88:91], a[68:71], v[212:215]
    s_add_u32 m0, s28, 98304
    v_mfma_f32_16x16x32_bf16 v[216:219], a[88:91], a[72:75], v[216:219]
    buffer_load_dwordx4 v1, s[8:11], s25 offen offset:0 lds
    v_mfma_f32_16x16x32_bf16 v[220:223], a[88:91], a[76:79], v[220:223]
    v_mfma_f32_16x16x32_bf16 v[224:227], a[92:95], a[48:51], v[224:227]
    v_mfma_f32_16x16x32_bf16 v[228:231], a[92:95], a[52:55], v[228:231]
    v_mfma_f32_16x16x32_bf16 v[232:235], a[92:95], a[56:59], v[232:235]
    v_mfma_f32_16x16x32_bf16 v[236:239], a[92:95], a[60:63], v[236:239]
    buffer_load_dwordx4 v1, s[8:11], s25 offen offset:1024 lds
    v_mfma_f32_16x16x32_bf16 v[240:243], a[92:95], a[64:67], v[240:243]
    v_mfma_f32_16x16x32_bf16 v[244:247], a[92:95], a[68:71], v[244:247]
    v_mfma_f32_16x16x32_bf16 v[248:251], a[92:95], a[72:75], v[248:251]
    v_mfma_f32_16x16x32_bf16 v[252:255], a[92:95], a[76:79], v[252:255]
    s_sub_u32 s27, s27, 1
    s_cmp_lg_u32 s27, 0
    s_cbranch_scc1 L_k3_loop
    s_cmp_eq_u32 s20, 3
    s_cbranch_scc1 L_k3_last3
L_k3_last1:
    s_waitcnt lgkmcnt(13)
    v_mfma_f32_16x16x32_bf16 v[128:131], a[32:35], a[0:3], v[128:131]
    ds_read_b64_tr_b16 a[80:81], v8 offset:8192
    s_waitcnt lgkmcnt(13)
    v_mfma_f32_16x16x32_bf16 v[132:135], a[32:35], a[4:7], v[132:135]
    ds_read_b64_tr_b16 a[82:83], v8 offset:9216
    s_waitcnt lgkmcnt(13)
    v_mfma_f32_16x16x32_bf16 v[136:139], a[32:35], a[8:11], v[136:139]
    ds_read_b128 a[48:51], v4 offset:16384
    buffer_load_dwordx4 v1, s[8:11], s25 offen offset:2048 lds
    s_waitcnt lgkmcnt(13)
    v_mfma_f32_16x16x32_bf16 v[140:143], a[32:35], a[12:15], v[140:143]
    ds_read_b128 a[52:55], v4 offset:16896
    s_waitcnt lgkmcnt(13)
    v_mfma_f32_16x16x32_bf16 v[144:147], a[32:35], a[16:19], v[144:147]
    ds_read_b128 a[56:59], v4 offset:17408
    s_waitcnt lgkmcnt(13)
    v_mfma_f32_16x16x32_bf16 v[148:151], a[32:35], a[20:23], v[148:151]
    ds_read_b128 a[60:63], v4 offset:17920
    s_waitcnt lgkmcnt(13)
    v_mfma_f32_16x16x32_bf16 v[152:155], a[32:35], a[24:27], v[152:155]
    ds_read_b128 a[64:67], v4 offset:18432
    s_waitcnt lgkmcnt(13)
    v_mfma_f32_16x16x32_bf16 v[156:159], a[32:35], a[28:31], v[156:159]
    ds_read_b128 a[68:71], v4 offset:18944
    buffer_load_dwordx4 v1, s[8:11], s25 offen offset:3072 lds
    s_waitcnt lgkmcnt(12)
    v_mfma_f32_16x16x32_bf16 v[160:163], a[36:39], a[0:3], v[160:163]
    s_add_u32 s25, s25, 4096
    ds_read_b128 a[72:75], v4 offset:19456
    v_mfma_f32_16x16x32_bf16 v[164:167], a[36:39], a[4:7], v[164:167]
    ds_read_b128 a[76:79], v4 offset:19968
    v_mfma_f32_16x16x32_bf16 v[168:171], a[36:39], a[8:11], v[168:171]
    ds_read_b64_tr_b16 a[84:85], v9 offset:8192
    v_mfma_f32_16x16x32_bf16 v[172:175], a[36:39], a[12:15], v[172:175]
    s_add_u32 m0, s28, 102400
    ds_read_b64_tr_b16 a[86:87], v9 offset:9216
    v_mfma_f32_16x16x32_bf16 v[176:179], a[36:39], a[16:19], v[176:179]
    ds_read_b64_tr_b16 a[88:89], v10 offset:8192
    buffer_load_dwordx4 v1, s[8:11], s25 offen offset:0 lds
    v_mfma_f32_16x16x32_bf16 v[180:183], a[36:39], a[20:23], v[180:183]
    ds_read_b64_tr_b16 a[90:91], v10 offset:9216
    v_mfma_f32_16x16x32_bf16 v[184:187], a[36:39], a[24:27], v[184:187]
    ds_read_b64_tr_b16 a[92:93], v11 offset:8192
    v_mfma_f32_16x16x32_bf16 v[188:191], a[36:39], a[28:31], v[188:191]
    ds_read_b64_tr_b16 a[94:95], v11 offset:9216
    s_waitcnt lgkmcnt(15)
    v_mfma_f32_16x16x32_bf16 v[192:195], a[40:43], a[0:3], v[192:195]
    v_mfma_f32_16x16x32_bf16 v[196:199], a[40:43], a[4:7], v[196:199]
    buffer_load_dwordx4 v1, s[8:11], s25 offen offset:1024 lds
    v_mfma_f32_16x16x32_bf16 v[200:203], a[40:43], a[8:11], v[200:203]
    v_mfma_f32_16x16x32_bf16 v[204:207], a[40:43], a[12:15], v[204:207]
    v_mfma_f32_16x16x32_bf16 v[208:211], a[40:43], a[16:19], v[208:211]
    v_mfma_f32_16x16x32_bf16 v[212:215], a[40:43], a[20:23], v[212:215]
    v_mfma_f32_16x16x32_bf16 v[216:219], a[40:43], a[24:27], v[216:219]
    buffer_load_dwordx4 v1, s[8:11], s25 offen offset:2048 lds
    v_mfma_f32_16x16x32_bf16 v[220:223], a[40:43], a[28:31], v[220:223]
    s_waitcnt lgkmcnt(15)
    v_mfma_f32_16x16x32_bf16 v[224:227], a[44:47], a[0:3], v[224:227]
    v_mfma_f32_16x16x32_bf16 v[228:231], a[44:47], a[4:7], v[228:231]
    v_mfma_f32_16x16x32_bf16 v[232:235], a[44:47], a[8:11], v[232:235]
    v_mfma_f32_16x16x32_bf16 v[236:239], a[44:47], a[12:15], v[236:239]
    buffer_load_dwordx4 v1, s[8:11], s25 offen offset:3072 lds
    v_mfma_f32_16x16x32_bf16 v[240:243], a[44:47], a[16:19], v[240:243]
    s_add_u32 s25, s25, 258048
    v_mfma_f32_16x16x32_bf16 v[244:247], a[44:47], a[20:23], v[244:247]
    v_mfma_f32_16x16x32_bf16 v[248:251], a[44:47], a[24:27], v[248:251]
    v_mfma_f32_16x16x32_bf16 v[252:255], a[44:47], a[28:31], v[252:255]
    s_waitcnt vmcnt(12) lgkmcnt(0)
    s_barrier
    v_mfma_f32_16x16x32_bf16 v[128:131], a[80:83], a[48:51], v[128:131]
    ds_read_b64_tr_b16 a[32:33], v12 offset:0
    v_mfma_f32_16x16x32_bf16 v[132:135], a[80:83], a[52:55], v[132:135]
    s_add_u32 m0, s29, 32768
    ds_read_b64_tr_b16 a[34:35], v12 offset:1024
    v_mfma_f32_16x16x32_bf16 v[136:139], a[80:83], a[56:59], v[136:139]
    ds_read_b128 a[0:3], v5 offset:0
    buffer_load_dwordx4 v1, s[8:11], s26 offen offset:0 lds
    v_mfma_f32_16x16x32_bf16 v[140:143], a[80:83], a[60:63], v[140:143]
    ds_read_b128 a[4:7], v5 offset:512
    v_mfma_f32_16x16x32_bf16 v[144:147], a[80:83], a[64:67], v[144:147]
    ds_read_b128 a[8:11], v5 offset:1024
    v_mfma_f32_16x16x32_bf16 v[148:151], a[80:83], a[68:71], v[148:151]
    ds_read_b128 a[12:15], v5 offset:1536
    v_mfma_f32_16x16x32_bf16 v[152:155], a[80:83], a[72:75], v[152:155]
    ds_read_b128 a[16:19], v5 offset:2048
    v_mfma_f32_16x16x32_bf16 v[156:159], a[80:83], a[76:79], v[156:159]
    ds_read_b128 a[20:23], v5 offset:2560
    buffer_load_dwordx4 v1, s[8:11], s26 offen offset:1024 lds
    v_mfma_f32_16x16x32_bf16 v[160:163], a[84:87], a[48:51], v[160:163]
    ds_read_b128 a[24:27], v5 offset:3072
    v_mfma_f32_16x16x32_bf16 v[164:167], a[84:87], a[52:55], v[164:167]
    ds_read_b128 a[28:31], v5 offset:3584
    v_mfma_f32_16x16x32_bf16 v[168:171], a[84:87], a[56:59], v[168:171]
    ds_read_b64_tr_b16 a[36:37], v13 offset:0
    v_mfma_f32_16x16x32_bf16 v[172:175], a[84:87], a[60:63], v[172:175]
    ds_read_b64_tr_b16 a[38:39], v13 offset:1024
    v_mfma_f32_16x16x32_bf16 v[176:179], a[84:87], a[64:67], v[176:179]
    ds_read_b64_tr_b16 a[40:41], v14 offset:0
    buffer_load_dwordx4 v1, s[8:11], s26 offen offset:2048 lds
    v_mfma_f32_16x16x32_bf16 v[180:183], a[84:87], a[68:71], v[180:183]
    ds_read_b64_tr_b16 a[42:43], v14 offset:1024
    v_mfma_f32_16x16x32_bf16 v[184:187], a[84:87], a[72:75], v[184:187]
    ds_read_b64_tr_b16 a[44:45], v15 offset:0
    v_mfma_f32_16x16x32_bf16 v[188:191], a[84:87], a[76:79], v[188:191]
    ds_read_b64_tr_b16 a[46:47], v15 offset:1024
    v_mfma_f32_16x16x32_bf16 v[192:195], a[88:91], a[48:51], v[192:195]
    v_mfma_f32_16x16x32_bf16 v[196:199], a[88:91], a[52:55], v[196:199]
    buffer_load_dwordx4 v1, s[8:11], s26 offen offset:3072 lds
    v_mfma_f32_16x16x32_bf16 v[200:203], a[88:91], a[56:59], v[200:203]
    s_add_u32 s26, s26, 16384
    v_mfma_f32_16x16x32_bf16 v[204:207], a[88:91], a[60:63], v[204:207]
    v_mfma_f32_16x16x32_bf16 v[208:211], a[88:91], a[64:67], v[208:211]
    v_mfma_f32_16x16x32_bf16 v[212:215], a[88:91], a[68:71], v[212:215]
    s_add_u32 m0, s28, 0
    v_mfma_f32_16x16x32_bf16 v[216:219], a[88:91], a[72:75], v[216:219]
    buffer_load_dwordx4 v1, s[8:11], s25 offen offset:0 lds
    v_mfma_f32_16x16x32_bf16 v[220:223], a[88:91], a[76:79], v[220:223]
    v_mfma_f32_16x16x32_bf16 v[224:227], a[92:95], a[48:51], v[224:227]
    v_mfma_f32_16x16x32_bf16 v[228:231], a[92:95], a[52:55], v[228:231]
    v_mfma_f32_16x16x32_bf16 v[232:235], a[92:95], a[56:59], v[232:235]
    v_mfma_f32_16x16x32_bf16 v[236:239], a[92:95], a[60:63], v[236:239]
    buffer_load_dwordx4 v1, s[8:11], s25 offen offset:1024 lds
    v_mfma_f32_16x16x32_bf16 v[240:243], a[92:95], a[64:67], v[240:243]
    v_mfma_f32_16x16x32_bf16 v[244:247], a[92:95], a[68:71], v[244:247]
    v_mfma_f32_16x16x32_bf16 v[248:251], a[92:95], a[72:75], v[248:251]
    v_mfma_f32_16x16x32_bf16 v[252:255], a[92:95], a[76:79], v[252:255]
    s_waitcnt lgkmcnt(13)
    v_mfma_f32_16x16x32_bf16 v[128:131], a[32:35], a[0:3], v[128:131]
    ds_read_b64_tr_b16 a[80:81], v12 offset:8192
    s_waitcnt lgkmcnt(13)
    v_mfma_f32_16x16x32_bf16 v[132:135], a[32:35], a[4:7], v[132:135]
    ds_read_b64_tr_b16 a[82:83], v12 offset:9216
    s_waitcnt lgkmcnt(13)
    v_mfma_f32_16x16x32_bf16 v[136:139], a[32:35], a[8:11], v[136:139]
    ds_read_b128 a[48:51], v5 offset:16384
    buffer_load_dwordx4 v1, s[8:11], s25 offen offset:2048 lds
    s_waitcnt lgkmcnt(13)
    v_mfma_f32_16x16x32_bf16 v[140:143], a[32:35], a[12:15], v[140:143]
    ds_read_b128 a[52:55], v5 offset:16896
    s_waitcnt lgkmcnt(13)
    v_mfma_f32_16x16x32_bf16 v[144:147], a[32:35], a[16:19], v[144:147]
    ds_read_b128 a[56:59], v5 offset:17408
    s_waitcnt lgkmcnt(13)
    v_mfma_f32_16x16x32_bf16 v[148:151], a[32:35], a[20:23], v[148:151]
    ds_read_b128 a[60:63], v5 offset:17920
    s_waitcnt lgkmcnt(13)
    v_mfma_f32_16x16x32_bf16 v[152:155], a[32:35], a[24:27], v[152:155]
    ds_read_b128 a[64:67], v5 offset:18432
    s_waitcnt lgkmcnt(13)
    v_mfma_f32_16x16x32_bf16 v[156:159], a[32:35], a[28:31], v[156:159]
    ds_read_b128 a[68:71], v5 offset:18944
    buffer_load_dwordx4 v1, s[8:11], s25 offen offset:3072 lds
    s_waitcnt lgkmcnt(12)
    v_mfma_f32_16x16x32_bf16 v[160:163], a[36:39], a[0:3], v[160:163]
    s_add_u32 s25, s25, 4096
    ds_read_b128 a[72:75], v5 offset:19456
    v_mfma_f32_16x16x32_bf16 v[164:167], a[36:39], a[4:7], v[164:167]
    ds_read_b128 a[76:79], v5 offset:19968
    v_mfma_f32_16x16x32_bf16 v[168:171], a[36:39], a[8:11], v[168:171]
    ds_read_b64_tr_b16 a[84:85], v13 offset:8192
    v_mfma_f32_16x16x32_bf16 v[172:175], a[36:39], a[12:15], v[172:175]
    s_add_u32 m0, s28, 4096
    ds_read_b64_tr_b16 a[86:87], v13 offset:9216
    v_mfma_f32_16x16x32_bf16 v[176:179], a[36:39], a[16:19], v[176:179]
    ds_read_b64_tr_b16 a[88:89], v14 offset:8192
    buffer_load_dwordx4 v1, s[8:11], s25 offen offset:0 lds
    v_mfma_f32_16x16x32_bf16 v[180:183], a[36:39], a[20:23], v[180:183]
    ds_read_b64_tr_b16 a[90:91], v14 offset:9216
    v_mfma_f32_16x16x32_bf16 v[184:187], a[36:39], a[24:27], v[184:187]
    ds_read_b64_tr_b16 a[92:93], v15 offset:8192
    v_mfma_f32_16x16x32_bf16 v[188:191], a[36:39], a[28:31], v[188:191]
    ds_read_b64_tr_b16 a[94:95], v15 offset:9216
    s_waitcnt lgkmcnt(15)
    v_mfma_f32_16x16x32_bf16 v[192:195], a[40:43], a[0:3], v[192:195]
    v_mfma_f32_16x16x32_bf16 v[196:199], a[40:43], a[4:7], v[196:199]
    buffer_load_dwordx4 v1, s[8:11], s25 offen offset:1024 lds
    v_mfma_f32_16x16x32_bf16 v[200:203], a[40:43], a[8:11], v[200:203]
    v_mfma_f32_16x16x32_bf16 v[204:207], a[40:43], a[12:15], v[204:207]
    v_mfma_f32_16x16x32_bf16 v[208:211], a[40:43], a[16:19], v[208:211]
    v_mfma_f32_16x16x32_bf16 v[212:215], a[40:43], a[20:23], v[212:215]
    v_mfma_f32_16x16x32_bf16 v[216:219], a[40:43], a[24:27], v[216:219]
    buffer_load_dwordx4 v1, s[8:11], s25 offen offset:2048 lds
    v_mfma_f32_16x16x32_bf16 v[220:223], a[40:43], a[28:31], v[220:223]
    s_waitcnt lgkmcnt(15)
    v_mfma_f32_16x16x32_bf16 v[224:227], a[44:47], a[0:3], v[224:227]
    v_mfma_f32_16x16x32_bf16 v[228:231], a[44:47], a[4:7], v[228:231]
    v_mfma_f32_16x16x32_bf16 v[232:235], a[44:47], a[8:11], v[232:235]
    v_mfma_f32_16x16x32_bf16 v[236:239], a[44:47], a[12:15], v[236:239]
    buffer_load_dwordx4 v1, s[8:11], s25 offen offset:3072 lds
    v_mfma_f32_16x16x32_bf16 v[240:243], a[44:47], a[16:19], v[240:243]
    s_add_u32 s25, s25, 258048
    v_mfma_f32_16x16x32_bf16 v[244:247], a[44:47], a[20:23], v[244:247]
    v_mfma_f32_16x16x32_bf16 v[248:251], a[44:47], a[24:27], v[248:251]
    v_mfma_f32_16x16x32_bf16 v[252:255], a[44:47], a[28:31], v[252:255]
    s_waitcnt vmcnt(12) lgkmcnt(0)
    s_barrier
    v_mfma_f32_16x16x32_bf16 v[128:131], a[80:83], a[48:51], v[128:131]
    ds_read_b64_tr_b16 a[32:33], v16 offset:0
    v_mfma_f32_16x16x32_bf16 v[132:135], a[80:83], a[52:55], v[132:135]
    ds_read_b64_tr_b16 a[34:35], v16 offset:1024
    v_mfma_f32_16x16x32_bf16 v[136:139], a[80:83], a[56:59], v[136:139]
    ds_read_b128 a[0:3], v6 offset:0
    v_mfma_f32_16x16x32_bf16 v[140:143], a[80:83], a[60:63], v[140:143]
    ds_read_b128 a[4:7], v6 offset:512
    v_mfma_f32_16x16x32_bf16 v[144:147], a[80:83], a[64:67], v[144:147]
    ds_read_b128 a[8:11], v6 offset:1024
    v_mfma_f32_16x16x32_bf16 v[148:151], a[80:83], a[68:71], v[148:151]
    ds_read_b128 a[12:15], v6 offset:1536
    v_mfma_f32_16x16x32_bf16 v[152:155], a[80:83], a[72:75], v[152:155]
    ds_read_b128 a[16:19], v6 offset:2048
    v_mfma_f32_16x16x32_bf16 v[156:159], a[80:83], a[76:79], v[156:159]
    ds_read_b128 a[20:23], v6 offset:2560
    v_mfma_f32_16x16x32_bf16 v[160:163], a[84:87], a[48:51], v[160:163]
    ds_read_b128 a[24:27], v6 offset:3072
    v_mfma_f32_16x16x32_bf16 v[164:167], a[84:87], a[52:55], v[164:167]
    ds_read_b128 a[28:31], v6 offset:3584
    v_mfma_f32_16x16x32_bf16 v[168:171], a[84:87], a[56:59], v[168:171]
    ds_read_b64_tr_b16 a[36:37], v17 offset:0
    v_mfma_f32_16x16x32_bf16 v[172:175], a[84:87], a[60:63], v[172:175]
    ds_read_b64_tr_b16 a[38:39], v17 offset:1024
    v_mfma_f32_16x16x32_bf16 v[176:179], a[84:87], a[64:67], v[176:179]
    ds_read_b64_tr_b16 a[40:41], v18 offset:0
    v_mfma_f32_16x16x32_bf16 v[180:183], a[84:87], a[68:71], v[180:183]
    ds_read_b64_tr_b16 a[42:43], v18 offset:1024
    v_mfma_f32_16x16x32_bf16 v[184:187], a[84:87], a[72:75], v[184:187]
    ds_read_b64_tr_b16 a[44:45], v19 offset:0
    v_mfma_f32_16x16x32_bf16 v[188:191], a[84:87], a[76:79], v[188:191]
    ds_read_b64_tr_b16 a[46:47], v19 offset:1024
    v_mfma_f32_16x16x32_bf16 v[192:195], a[88:91], a[48:51], v[192:195]
    v_mfma_f32_16x16x32_bf16 v[196:199], a[88:91], a[52:55], v[196:199]
    v_mfma_f32_16x16x32_bf16 v[200:203], a[88:91], a[56:59], v[200:203]
    v_mfma_f32_16x16x32_bf16 v[204:207], a[88:91], a[60:63], v[204:207]
    v_mfma_f32_16x16x32_bf16 v[208:211], a[88:91], a[64:67], v[208:211]
    v_mfma_f32_16x16x32_bf16 v[212:215], a[88:91], a[68:71], v[212:215]
    v_mfma_f32_16x16x32_bf16 v[216:219], a[88:91], a[72:75], v[216:219]
    v_mfma_f32_16x16x32_bf16 v[220:223], a[88:91], a[76:79], v[220:223]
    v_mfma_f32_16x16x32_bf16 v[224:227], a[92:95], a[48:51], v[224:227]
    v_mfma_f32_16x16x32_bf16 v[228:231], a[92:95], a[52:55], v[228:231]
    v_mfma_f32_16x16x32_bf16 v[232:235], a[92:95], a[56:59], v[232:235]
    v_mfma_f32_16x16x32_bf16 v[236:239], a[92:95], a[60:63], v[236:239]
    v_mfma_f32_16x16x32_bf16 v[240:243], a[92:95], a[64:67], v[240:243]
    v_mfma_f32_16x16x32_bf16 v[244:247], a[92:95], a[68:71], v[244:247]
    v_mfma_f32_16x16x32_bf16 v[248:251], a[92:95], a[72:75], v[248:251]
    v_mfma_f32_16x16x32_bf16 v[252:255], a[92:95], a[76:79], v[252:255]
    s_waitcnt lgkmcnt(13)
    v_mfma_f32_16x16x32_bf16 v[128:131], a[32:35], a[0:3], v[128:131]
    ds_read_b64_tr_b16 a[80:81], v16 offset:8192
    s_waitcnt lgkmcnt(13)
    v_mfma_f32_16x16x32_bf16 v[132:135], a[32:35], a[4:7], v[132:135]
    ds_read_b64_tr_b16 a[82:83], v16 offset:9216
    s_waitcnt lgkmcnt(13)
    v_mfma_f32_16x16x32_bf16 v[136:139], a[32:35], a[8:11], v[136:139]
    ds_read_b128 a[48:51], v6 offset:16384
    s_waitcnt lgkmcnt(13)
    v_mfma_f32_16x16x32_bf16 v[140:143], a[32:35], a[12:15], v[140:143]
    ds_read_b128 a[52:55], v6 offset:16896
    s_waitcnt lgkmcnt(13)
    v_mfma_f32_16x16x32_bf16 v[144:147], a[32:35], a[16:19], v[144:147]
    ds_read_b128 a[56:59], v6 offset:17408
    s_waitcnt lgkmcnt(13)
    v_mfma_f32_16x16x32_bf16 v[148:151], a[32:35], a[20:23], v[148:151]
    ds_read_b128 a[60:63], v6 offset:17920
    s_waitcnt lgkmcnt(13)
    v_mfma_f32_16x16x32_bf16 v[152:155], a[32:35], a[24:27], v[152:155]
    ds_read_b128 a[64:67], v6 offset:18432
    s_waitcnt lgkmcnt(13)
    v_mfma_f32_16x16x32_bf16 v[156:159], a[32:35], a[28:31], v[156:159]
    ds_read_b128 a[68:71], v6 offset:18944
    s_waitcnt lgkmcnt(12)
    v_mfma_f32_16x16x32_bf16 v[160:163], a[36:39], a[0:3], v[160:163]
    ds_read_b128 a[72:75], v6 offset:19456
    v_mfma_f32_16x16x32_bf16 v[164:167], a[36:39], a[4:7], v[164:167]
    ds_read_b128 a[76:79], v6 offset:19968
    v_mfma_f32_16x16x32_bf16 v[168:171], a[36:39], a[8:11], v[168:171]
    ds_read_b64_tr_b16 a[84:85], v17 offset:8192
    v_mfma_f32_16x16x32_bf16 v[172:175], a[36:39], a[12:15], v[172:175]
    ds_read_b64_tr_b16 a[86:87], v17 offset:9216
    v_mfma_f32_16x16x32_bf16 v[176:179], a[36:39], a[16:19], v[176:179]
    ds_read_b64_tr_b16 a[88:89], v18 offset:8192
    v_mfma_f32_16x16x32_bf16 v[180:183], a[36:39], a[20:23], v[180:183]
    ds_read_b64_tr_b16 a[90:91], v18 offset:9216
    v_mfma_f32_16x16x32_bf16 v[184:187], a[36:39], a[24:27], v[184:187]
    ds_read_b64_tr_b16 a[92:93], v19 offset:8192
    v_mfma_f32_16x16x32_bf16 v[188:191], a[36:39], a[28:31], v[188:191]
    ds_read_b64_tr_b16 a[94:95], v19 offset:9216
    s_waitcnt lgkmcnt(15)
    v_mfma_f32_16x16x32_bf16 v[192:195], a[40:43], a[0:3], v[192:195]
    v_mfma_f32_16x16x32_bf16 v[196:199], a[40:43], a[4:7], v[196:199]
    v_mfma_f32_16x16x32_bf16 v[200:203], a[40:43], a[8:11], v[200:203]
    v_mfma_f32_16x16x32_bf16 v[204:207], a[40:43], a[12:15], v[204:207]
    v_mfma_f32_16x16x32_bf16 v[208:211], a[40:43], a[16:19], v[208:211]
    v_mfma_f32_16x16x32_bf16 v[212:215], a[40:43], a[20:23], v[212:215]
    v_mfma_f32_16x16x32_bf16 v[216:219], a[40:43], a[24:27], v[216:219]
    v_mfma_f32_16x16x32_bf16 v[220:223], a[40:43], a[28:31], v[220:223]
    s_waitcnt lgkmcnt(15)
    v_mfma_f32_16x16x32_bf16 v[224:227], a[44:47], a[0:3], v[224:227]
    v_mfma_f32_16x16x32_bf16 v[228:231], a[44:47], a[4:7], v[228:231]
    v_mfma_f32_16x16x32_bf16 v[232:235], a[44:47], a[8:11], v[232:235]
    v_mfma_f32_16x16x32_bf16 v[236:239], a[44:47], a[12:15], v[236:239]
    v_mfma_f32_16x16x32_bf16 v[240:243], a[44:47], a[16:19], v[240:243]
    v_mfma_f32_16x16x32_bf16 v[244:247], a[44:47], a[20:23], v[244:247]
    v_mfma_f32_16x16x32_bf16 v[248:251], a[44:47], a[24:27], v[248:251]
    v_mfma_f32_16x16x32_bf16 v[252:255], a[44:47], a[28:31], v[252:255]
    s_waitcnt vmcnt(0) lgkmcnt(0)
    s_barrier
    s_cmp_eq_u32 s20, 1
    s_cbranch_scc1 L_k3_fin1
    s_cmp_eq_u32 s20, 2
    s_cbranch_scc1 L_k3_fin2
L_k3_fin0:
    v_mfma_f32_16x16x32_bf16 v[136:139], a[80:83], a[56:59], v[136:139]
    ds_read_b64_tr_b16 a[128:129], v8 offset:0
    v_mfma_f32_16x16x32_bf16 v[140:143], a[80:83], a[60:63], v[140:143]
    ds_read_b64_tr_b16 a[130:131], v8 offset:1024
    s_add_u32 s31, s40, 0
    buffer_load_dwordx4 v[32:35], v28, s[16:19], s31 offen offset:0
    v_mfma_f32_16x16x32_bf16 v[168:171], a[84:87], a[56:59], v[168:171]
    ds_read_b64_tr_b16 a[132:133], v9 offset:0
    v_mfma_f32_16x16x32_bf16 v[172:175], a[84:87], a[60:63], v[172:175]
    ds_read_b64_tr_b16 a[134:135], v9 offset:1024
    s_add_u32 s31, s40, 0
    buffer_load_dwordx4 v[36:39], v28, s[16:19], s31 offen offset:64
    v_mfma_f32_16x16x32_bf16 v[200:203], a[88:91], a[56:59], v[200:203]
    ds_read_b64_tr_b16 a[136:137], v10 offset:0
    v_mfma_f32_16x16x32_bf16 v[204:207], a[88:91], a[60:63], v[204:207]
    ds_read_b64_tr_b16 a[138:139], v10 offset:1024
    s_add_u32 s31, s40, 32768
    buffer_load_dwordx4 v[40:43], v28, s[16:19], s31 offen offset:0
    v_mfma_f32_16x16x32_bf16 v[232:235], a[92:95], a[56:59], v[232:235]
    ds_read_b64_tr_b16 a[140:141], v11 offset:0
    v_mfma_f32_16x16x32_bf16 v[236:239], a[92:95], a[60:63], v[236:239]
    ds_read_b64_tr_b16 a[142:143], v11 offset:1024
    s_add_u32 s31, s40, 32768
    buffer_load_dwordx4 v[44:47], v28, s[16:19], s31 offen offset:64
    v_mfma_f32_16x16x32_bf16 v[144:147], a[80:83], a[64:67], v[144:147]
    ds_read_b128 a[104:107], v4 offset:1024
    v_mfma_f32_16x16x32_bf16 v[148:151], a[80:83], a[68:71], v[148:151]
    ds_read_b128 a[108:111], v4 offset:1536
    s_add_u32 s31, s41, 0
    buffer_load_dword v30, v29, s[8:11], s31 offen offset:0
    v_mfma_f32_16x16x32_bf16 v[176:179], a[84:87], a[64:67], v[176:179]
    ds_read_b64_tr_b16 a[176:177], v8 offset:8192
    v_mfma_f32_16x16x32_bf16 v[180:183], a[84:87], a[68:71], v[180:183]
    ds_read_b64_tr_b16 a[178:179], v8 offset:9216
    s_add_u32 s31, s41, 0
    buffer_load_dword v31, v29, s[8:11], s31 offen offset:128
    v_mfma_f32_16x16x32_bf16 v[208:211], a[88:91], a[64:67], v[208:211]
    ds_read_b64_tr_b16 a[180:181], v9 offset:8192
    v_mfma_f32_16x16x32_bf16 v[212:215], a[88:91], a[68:71], v[212:215]
    ds_read_b64_tr_b16 a[182:183], v9 offset:9216
    v_mfma_f32_16x16x32_bf16 v[240:243], a[92:95], a[64:67], v[240:243]
    ds_read_b64_tr_b16 a[184:185], v10 offset:8192
    v_mfma_f32_16x16x32_bf16 v[244:247], a[92:95], a[68:71], v[244:247]
    ds_read_b64_tr_b16 a[186:187], v10 offset:9216
    s_waitcnt lgkmcnt(7)
    v_mfma_f32_16x16x32_bf16 v[136:139], a[128:131], a[104:107], v[136:139]
    ds_read_b64_tr_b16 a[188:189], v11 offset:8192
    s_waitcnt lgkmcnt(7)
    v_mfma_f32_16x16x32_bf16 v[140:143], a[128:131], a[108:111], v[140:143]
    ds_read_b64_tr_b16 a[190:191], v11 offset:9216
    v_mfma_f32_16x16x32_bf16 v[168:171], a[132:135], a[104:107], v[168:171]
    ds_read_b128 a[152:155], v4 offset:17408
    v_mfma_f32_16x16x32_bf16 v[172:175], a[132:135], a[108:111], v[172:175]
    ds_read_b128 a[156:159], v4 offset:17920
    v_mfma_f32_16x16x32_bf16 v[200:203], a[136:139], a[104:107], v[200:203]
    ds_read_b128 a[112:115], v4 offset:2048
    v_mfma_f32_16x16x32_bf16 v[204:207], a[136:139], a[108:111], v[204:207]
    ds_read_b128 a[116:119], v4 offset:2560
    v_mfma_f32_16x16x32_bf16 v[232:235], a[140:143], a[104:107], v[232:235]
    ds_read_b128 a[160:163], v4 offset:18432
    v_mfma_f32_16x16x32_bf16 v[236:239], a[140:143], a[108:111], v[236:239]
    ds_read_b128 a[164:167], v4 offset:18944
    s_waitcnt lgkmcnt(5)
    v_mfma_f32_16x16x32_bf16 v[136:139], a[176:179], a[152:155], v[136:139]
    ds_read_b128 a[120:123], v4 offset:3072
    s_waitcnt lgkmcnt(5)
    v_mfma_f32_16x16x32_bf16 v[140:143], a[176:179], a[156:159], v[140:143]
    ds_read_b128 a[124:127], v4 offset:3584
    v_mfma_f32_16x16x32_bf16 v[168:171], a[180:183], a[152:155], v[168:171]
    ds_read_b128 a[168:171], v4 offset:19456
    v_mfma_f32_16x16x32_bf16 v[172:175], a[180:183], a[156:159], v[172:175]
    ds_read_b128 a[172:175], v4 offset:19968
    v_mfma_f32_16x16x32_bf16 v[200:203], a[184:187], a[152:155], v[200:203]
    ds_read_b128 a[96:99], v4 offset:0
    v_mfma_f32_16x16x32_bf16 v[204:207], a[184:187], a[156:159], v[204:207]
    ds_read_b128 a[100:103], v4 offset:512
    v_mfma_f32_16x16x32_bf16 v[232:235], a[188:191], a[152:155], v[232:235]
    ds_read_b128 a[144:147], v4 offset:16384
    v_mfma_f32_16x16x32_bf16 v[236:239], a[188:191], a[156:159], v[236:239]
    ds_read_b128 a[148:151], v4 offset:16896
    s_waitcnt lgkmcnt(11)
    v_mfma_f32_16x16x32_bf16 v[144:147], a[128:131], a[112:115], v[144:147]
    s_waitcnt lgkmcnt(10)
    v_mfma_f32_16x16x32_bf16 v[148:151], a[128:131], a[116:119], v[148:151]
    v_mfma_f32_16x16x32_bf16 v[176:179], a[132:135], a[112:115], v[176:179]
    v_mfma_f32_16x16x32_bf16 v[180:183], a[132:135], a[116:119], v[180:183]
    v_mfma_f32_16x16x32_bf16 v[208:211], a[136:139], a[112:115], v[208:211]
    v_mfma_f32_16x16x32_bf16 v[212:215], a[136:139], a[116:119], v[212:215]
    s_add_u32 s30, s34, 278528
    v_cvt_pk_bf16_f32 v48, v136, v137
    v_cvt_pk_bf16_f32 v49, v138, v139
    v_mfma_f32_16x16x32_bf16 v[240:243], a[140:143], a[112:115], v[240:243]
    v_cvt_pk_bf16_f32 v50, v168, v169
    v_cvt_pk_bf16_f32 v51, v170, v171
    v_mfma_f32_16x16x32_bf16 v[244:247], a[140:143], a[116:119], v[244:247]
    buffer_store_dwordx4 v[48:51], v1, s[8:11], s30 offen offset:0 sc1
    v_cvt_pk_bf16_f32 v52, v200, v201
    s_waitcnt lgkmcnt(9)
    v_mfma_f32_16x16x32_bf16 v[144:147], a[176:179], a[160:163], v[144:147]
    v_cvt_pk_bf16_f32 v53, v202, v203
    v_cvt_pk_bf16_f32 v54, v232, v233
    s_waitcnt lgkmcnt(8)
    v_mfma_f32_16x16x32_bf16 v[148:151], a[176:179], a[164:167], v[148:151]
    v_cvt_pk_bf16_f32 v55, v234, v235
    buffer_store_dwordx4 v[52:55], v1, s[8:11], s30 offen offset:1024 sc1
    v_mfma_f32_16x16x32_bf16 v[176:179], a[180:183], a[160:163], v[176:179]
    v_cvt_pk_bf16_f32 v56, v140, v141
    v_cvt_pk_bf16_f32 v57, v142, v143
    v_mfma_f32_16x16x32_bf16 v[180:183], a[180:183], a[164:167], v[180:183]
    v_cvt_pk_bf16_f32 v58, v172, v173
    v_cvt_pk_bf16_f32 v59, v174, v175
    v_mfma_f32_16x16x32_bf16 v[208:211], a[184:187], a[160:163], v[208:211]
    buffer_store_dwordx4 v[56:59], v1, s[8:11], s30 offen offset:2048 sc1
    v_cvt_pk_bf16_f32 v60, v204, v205
    v_mfma_f32_16x16x32_bf16 v[212:215], a[184:187], a[164:167], v[212:215]
    v_cvt_pk_bf16_f32 v61, v206, v207
    v_cvt_pk_bf16_f32 v62, v236, v237
    v_mfma_f32_16x16x32_bf16 v[240:243], a[188:191], a[160:163], v[240:243]
    v_cvt_pk_bf16_f32 v63, v238, v239
    buffer_store_dwordx4 v[60:63], v1, s[8:11], s30 offen offset:3072 sc1
    v_mfma_f32_16x16x32_bf16 v[244:247], a[188:191], a[164:167], v[244:247]
    v_mfma_f32_16x16x32_bf16 v[152:155], a[80:83], a[72:75], v[152:155]
    v_mfma_f32_16x16x32_bf16 v[156:159], a[80:83], a[76:79], v[156:159]
    v_mfma_f32_16x16x32_bf16 v[184:187], a[84:87], a[72:75], v[184:187]
    v_mfma_f32_16x16x32_bf16 v[188:191], a[84:87], a[76:79], v[188:191]
    v_mfma_f32_16x16x32_bf16 v[216:219], a[88:91], a[72:75], v[216:219]
    v_mfma_f32_16x16x32_bf16 v[220:223], a[88:91], a[76:79], v[220:223]
    s_add_u32 s30, s34, 294912
    v_cvt_pk_bf16_f32 v48, v144, v145
    v_cvt_pk_bf16_f32 v49, v146, v147
    v_mfma_f32_16x16x32_bf16 v[248:251], a[92:95], a[72:75], v[248:251]
    v_cvt_pk_bf16_f32 v50, v176, v177
    v_cvt_pk_bf16_f32 v51, v178, v179
    v_mfma_f32_16x16x32_bf16 v[252:255], a[92:95], a[76:79], v[252:255]
    buffer_store_dwordx4 v[48:51], v1, s[8:11], s30 offen offset:0 sc1
    v_cvt_pk_bf16_f32 v52, v208, v209
    s_waitcnt lgkmcnt(7)
    v_mfma_f32_16x16x32_bf16 v[152:155], a[128:131], a[120:123], v[152:155]
    v_cvt_pk_bf16_f32 v53, v210, v211
    v_cvt_pk_bf16_f32 v54, v240, v241
    s_waitcnt lgkmcnt(6)
    v_mfma_f32_16x16x32_bf16 v[156:159], a[128:131], a[124:127], v[156:159]
    v_cvt_pk_bf16_f32 v55, v242, v243
    buffer_store_dwordx4 v[52:55], v1, s[8:11], s30 offen offset:1024 sc1
    v_mfma_f32_16x16x32_bf16 v[184:187], a[132:135], a[120:123], v[184:187]
    v_cvt_pk_bf16_f32 v56, v148, v149
    v_cvt_pk_bf16_f32 v57, v150, v151
    v_mfma_f32_16x16x32_bf16 v[188:191], a[132:135], a[124:127], v[188:191]
    v_cvt_pk_bf16_f32 v58, v180, v181
    v_cvt_pk_bf16_f32 v59, v182, v183
    v_mfma_f32_16x16x32_bf16 v[216:219], a[136:139], a[120:123], v[216:219]
    buffer_store_dwordx4 v[56:59], v1, s[8:11], s30 offen offset:2048 sc1
    v_cvt_pk_bf16_f32 v60, v212, v213
    v_mfma_f32_16x16x32_bf16 v[220:223], a[136:139], a[124:127], v[220:223]
    v_cvt_pk_bf16_f32 v61, v214, v215
    v_cvt_pk_bf16_f32 v62, v244, v245
    v_mfma_f32_16x16x32_bf16 v[248:251], a[140:143], a[120:123], v[248:251]
    v_cvt_pk_bf16_f32 v63, v246, v247
    buffer_store_dwordx4 v[60:63], v1, s[8:11], s30 offen offset:3072 sc1
    v_mfma_f32_16x16x32_bf16 v[252:255], a[140:143], a[124:127], v[252:255]
    s_waitcnt lgkmcnt(5)
    v_mfma_f32_16x16x32_bf16 v[152:155], a[176:179], a[168:171], v[152:155]
    s_waitcnt lgkmcnt(4)
    v_mfma_f32_16x16x32_bf16 v[156:159], a[176:179], a[172:175], v[156:159]
    v_mfma_f32_16x16x32_bf16 v[184:187], a[180:183], a[168:171], v[184:187]
    v_mfma_f32_16x16x32_bf16 v[188:191], a[180:183], a[172:175], v[188:191]
    v_mfma_f32_16x16x32_bf16 v[216:219], a[184:187], a[168:171], v[216:219]
    v_mfma_f32_16x16x32_bf16 v[220:223], a[184:187], a[172:175], v[220:223]
    v_mfma_f32_16x16x32_bf16 v[248:251], a[188:191], a[168:171], v[248:251]
    v_mfma_f32_16x16x32_bf16 v[252:255], a[188:191], a[172:175], v[252:255]
    v_mfma_f32_16x16x32_bf16 v[128:131], a[80:83], a[48:51], v[128:131]
    v_mfma_f32_16x16x32_bf16 v[132:135], a[80:83], a[52:55], v[132:135]
    v_mfma_f32_16x16x32_bf16 v[160:163], a[84:87], a[48:51], v[160:163]
    v_mfma_f32_16x16x32_bf16 v[164:167], a[84:87], a[52:55], v[164:167]
    v_mfma_f32_16x16x32_bf16 v[192:195], a[88:91], a[48:51], v[192:195]
    v_mfma_f32_16x16x32_bf16 v[196:199], a[88:91], a[52:55], v[196:199]
    s_add_u32 s30, s34, 311296
    v_cvt_pk_bf16_f32 v48, v152, v153
    v_cvt_pk_bf16_f32 v49, v154, v155
    v_mfma_f32_16x16x32_bf16 v[224:227], a[92:95], a[48:51], v[224:227]
    v_cvt_pk_bf16_f32 v50, v184, v185
    v_cvt_pk_bf16_f32 v51, v186, v187
    v_mfma_f32_16x16x32_bf16 v[228:231], a[92:95], a[52:55], v[228:231]
    buffer_store_dwordx4 v[48:51], v1, s[8:11], s30 offen offset:0 sc1
    v_cvt_pk_bf16_f32 v52, v216, v217
    s_waitcnt lgkmcnt(3)
    v_mfma_f32_16x16x32_bf16 v[128:131], a[128:131], a[96:99], v[128:131]
    v_cvt_pk_bf16_f32 v53, v218, v219
    v_cvt_pk_bf16_f32 v54, v248, v249
    s_waitcnt lgkmcnt(2)
    v_mfma_f32_16x16x32_bf16 v[132:135], a[128:131], a[100:103], v[132:135]
    v_cvt_pk_bf16_f32 v55, v250, v251
    buffer_store_dwordx4 v[52:55], v1, s[8:11], s30 offen offset:1024 sc1
    v_mfma_f32_16x16x32_bf16 v[160:163], a[132:135], a[96:99], v[160:163]
    v_cvt_pk_bf16_f32 v56, v156, v157
    v_cvt_pk_bf16_f32 v57, v158, v159
    v_mfma_f32_16x16x32_bf16 v[164:167], a[132:135], a[100:103], v[164:167]
    v_cvt_pk_bf16_f32 v58, v188, v189
    v_cvt_pk_bf16_f32 v59, v190, v191
    v_mfma_f32_16x16x32_bf16 v[192:195], a[136:139], a[96:99], v[192:195]
    buffer_store_dwordx4 v[56:59], v1, s[8:11], s30 offen offset:2048 sc1
    v_cvt_pk_bf16_f32 v60, v220, v221
    v_mfma_f32_16x16x32_bf16 v[196:199], a[136:139], a[100:103], v[196:199]
    v_cvt_pk_bf16_f32 v61, v222, v223
    v_cvt_pk_bf16_f32 v62, v252, v253
    v_mfma_f32_16x16x32_bf16 v[224:227], a[140:143], a[96:99], v[224:227]
    v_cvt_pk_bf16_f32 v63, v254, v255
    buffer_store_dwordx4 v[60:63], v1, s[8:11], s30 offen offset:3072 sc1
    v_mfma_f32_16x16x32_bf16 v[228:231], a[140:143], a[100:103], v[228:231]
    s_waitcnt lgkmcnt(1)
    v_mfma_f32_16x16x32_bf16 v[128:131], a[176:179], a[144:147], v[128:131]
    s_waitcnt lgkmcnt(0)
    v_mfma_f32_16x16x32_bf16 v[132:135], a[176:179], a[148:151], v[132:135]
    v_mfma_f32_16x16x32_bf16 v[160:163], a[180:183], a[144:147], v[160:163]
    v_mfma_f32_16x16x32_bf16 v[164:167], a[180:183], a[148:151], v[164:167]
    v_mfma_f32_16x16x32_bf16 v[192:195], a[184:187], a[144:147], v[192:195]
    v_mfma_f32_16x16x32_bf16 v[196:199], a[184:187], a[148:151], v[196:199]
    v_mfma_f32_16x16x32_bf16 v[224:227], a[188:191], a[144:147], v[224:227]
    v_mfma_f32_16x16x32_bf16 v[228:231], a[188:191], a[148:151], v[228:231]
    s_waitcnt vmcnt(0)
    v_mov_b32 v22, s97
    v_mov_b32 v23, 0
    v_lshlrev_b32 v24, 9, v20
    s_add_u32 s31, s35, 0
    s_mov_b64 exec, 1
    buffer_store_dword v22, v23, s[8:11], s31 offen sc1
    s_mov_b64 exec, -1
    s_mov_b64 exec, 14
    s_mov_b32 s31, 0
L_k3_q0_poll:
    buffer_load_dword v25, v24, s[8:11], s35 offen sc1
    s_waitcnt vmcnt(0)
    v_cmp_eq_u32 vcc, s97, v25
    s_add_u32 s31, s31, 1
    s_cmp_gt_u32 s31, 0x40000
    s_cbranch_scc1 L_k3_q0_got
    s_cmp_eq_u32 vcc_lo, 14
    s_cbranch_scc0 L_k3_q0_poll
L_k3_q0_got:
    s_mov_b64 exec, -1
    s_add_u32 s30, s34, 65536
    buffer_load_dwordx4 v[64:67], v1, s[8:11], s30 offen offset:0 sc1
    buffer_load_dwordx4 v[68:71], v1, s[8:11], s30 offen offset:1024 sc1
    buffer_load_dwordx4 v[72:75], v1, s[8:11], s30 offen offset:2048 sc1
    buffer_load_dwordx4 v[76:79], v1, s[8:11], s30 offen offset:3072 sc1
    s_add_u32 s30, s34, 131072
    buffer_load_dwordx4 v[80:83], v1, s[8:11], s30 offen offset:0 sc1
    buffer_load_dwordx4 v[84:87], v1, s[8:11], s30 offen offset:1024 sc1
    buffer_load_dwordx4 v[88:91], v1, s[8:11], s30 offen offset:2048 sc1
    buffer_load_dwordx4 v[92:95], v1, s[8:11], s30 offen offset:3072 sc1
    s_add_u32 s30, s34, 196608
    buffer_load_dwordx4 v[96:99], v1, s[8:11], s30 offen offset:0 sc1
    buffer_load_dwordx4 v[100:103], v1, s[8:11], s30 offen offset:1024 sc1
    buffer_load_dwordx4 v[104:107], v1, s[8:11], s30 offen offset:2048 sc1
    buffer_load_dwordx4 v[108:111], v1, s[8:11], s30 offen offset:3072 sc1
    s_mov_b32 s47, 0xbfb8aa3b
    s_mov_b32 s48, 0xffff0000
    v_mul_f32 v30, v30, v30
    v_mul_f32 v2, s47, v30
    v_rcp_f32 v30, v30
    v_mul_f32 v31, v31, v31
    v_mul_f32 v3, s47, v31
    v_rcp_f32 v31, v31
    v_permlane16_swap_b32 v32, v34
    v_permlane16_swap_b32 v33, v35
    v_permlane16_swap_b32 v36, v38
    v_permlane16_swap_b32 v37, v39
    v_permlane16_swap_b32 v40, v42
    v_permlane16_swap_b32 v41, v43
    v_permlane16_swap_b32 v44, v46
    v_permlane16_swap_b32 v45, v47
    s_waitcnt vmcnt(11)
    v_lshlrev_b32 v136, 16, v64
    v_and_b32 v137, s48, v64
    v_lshlrev_b32 v138, 16, v65
    v_and_b32 v139, s48, v65
    s_waitcnt vmcnt(7)
    v_lshlrev_b32 v48, 16, v80
    v_and_b32 v49, s48, v80
    v_lshlrev_b32 v50, 16, v81
    v_and_b32 v51, s48, v81
    v_pk_add_f32 v[136:137], v[136:137], v[48:49]
    v_pk_add_f32 v[138:139], v[138:139], v[50:51]
    s_waitcnt vmcnt(3)
    v_lshlrev_b32 v48, 16, v96
    v_and_b32 v49, s48, v96
    v_lshlrev_b32 v50, 16, v97
    v_and_b32 v51, s48, v97
    v_pk_add_f32 v[136:137], v[136:137], v[48:49]
    v_pk_add_f32 v[138:139], v[138:139], v[50:51]
    v_mul_f32 v52, v2, v136
    v_mul_f32 v53, v2, v137
    v_mul_f32 v54, v2, v138
    v_mul_f32 v55, v2, v139
    v_exp_f32 v52, v52
    v_exp_f32 v53, v53
    v_exp_f32 v54, v54
    v_exp_f32 v55, v55
    v_pk_mul_f32 v[136:137], v[136:137], v[128:129]
    v_pk_mul_f32 v[138:139], v[138:139], v[130:131]
    v_fma_f32 v52, v52, v30, v30
    v_fma_f32 v53, v53, v30, v30
    v_fma_f32 v54, v54, v30, v30
    v_fma_f32 v55, v55, v30, v30
    v_lshlrev_b32 v48, 16, v32
    v_and_b32 v49, s48, v32
    v_rcp_f32 v52, v52
    v_rcp_f32 v53, v53
    v_rcp_f32 v54, v54
    v_rcp_f32 v55, v55
    v_lshlrev_b32 v50, 16, v33
    v_and_b32 v51, s48, v33
    v_pk_fma_f32 v[136:137], v[136:137], v[52:53], v[48:49]
    v_pk_fma_f32 v[138:139], v[138:139], v[54:55], v[50:51]
    v_cvt_pk_bf16_f32 v32, v136, v137
    v_cvt_pk_bf16_f32 v33, v138, v139
    v_lshlrev_b32 v168, 16, v66
    v_and_b32 v169, s48, v66
    v_lshlrev_b32 v170, 16, v67
    v_and_b32 v171, s48, v67
    v_lshlrev_b32 v56, 16, v82
    v_and_b32 v57, s48, v82
    v_lshlrev_b32 v58, 16, v83
    v_and_b32 v59, s48, v83
    v_pk_add_f32 v[168:169], v[168:169], v[56:57]
    v_pk_add_f32 v[170:171], v[170:171], v[58:59]
    v_lshlrev_b32 v56, 16, v98
    v_and_b32 v57, s48, v98
    v_lshlrev_b32 v58, 16, v99
    v_and_b32 v59, s48, v99
    v_pk_add_f32 v[168:169], v[168:169], v[56:57]
    v_pk_add_f32 v[170:171], v[170:171], v[58:59]
    v_mul_f32 v60, v2, v168
    v_mul_f32 v61, v2, v169
    v_mul_f32 v62, v2, v170
    v_mul_f32 v63, v2, v171
    v_exp_f32 v60, v60
    v_exp_f32 v61, v61
    v_exp_f32 v62, v62
    v_exp_f32 v63, v63
    v_pk_mul_f32 v[168:169], v[168:169], v[160:161]
    v_pk_mul_f32 v[170:171], v[170:171], v[162:163]
    v_fma_f32 v60, v60, v30, v30
    v_fma_f32 v61, v61, v30, v30
    v_fma_f32 v62, v62, v30, v30
    v_fma_f32 v63, v63, v30, v30
    v_lshlrev_b32 v56, 16, v34
    v_and_b32 v57, s48, v34
    v_rcp_f32 v60, v60
    v_rcp_f32 v61, v61
    v_rcp_f32 v62, v62
    v_rcp_f32 v63, v63
    v_lshlrev_b32 v58, 16, v35
    v_and_b32 v59, s48, v35
    v_pk_fma_f32 v[168:169], v[168:169], v[60:61], v[56:57]
    v_pk_fma_f32 v[170:171], v[170:171], v[62:63], v[58:59]
    v_cvt_pk_bf16_f32 v34, v168, v169
    v_cvt_pk_bf16_f32 v35, v170, v171
    s_add_u32 s31, s40, 0
    s_nop 0
    v_permlane16_swap_b32 v32, v34
    v_permlane16_swap_b32 v33, v35
    buffer_store_dwordx4 v[32:35], v28, s[36:39], s31 offen offset:0 sc1
    v_lshlrev_b32 v200, 16, v68
    v_and_b32 v201, s48, v68
    v_lshlrev_b32 v202, 16, v69
    v_and_b32 v203, s48, v69
    v_lshlrev_b32 v48, 16, v84
    v_and_b32 v49, s48, v84
    v_lshlrev_b32 v50, 16, v85
    v_and_b32 v51, s48, v85
    v_pk_add_f32 v[200:201], v[200:201], v[48:49]
    v_pk_add_f32 v[202:203], v[202:203], v[50:51]
    s_waitcnt vmcnt(3)
    v_lshlrev_b32 v48, 16, v100
    v_and_b32 v49, s48, v100
    v_lshlrev_b32 v50, 16, v101
    v_and_b32 v51, s48, v101
    v_pk_add_f32 v[200:201], v[200:201], v[48:49]
    v_pk_add_f32 v[202:203], v[202:203], v[50:51]
    v_mul_f32 v52, v2, v200
    v_mul_f32 v53, v2, v201
    v_mul_f32 v54, v2, v202
    v_mul_f32 v55, v2, v203
    v_exp_f32 v52, v52
    v_exp_f32 v53, v53
    v_exp_f32 v54, v54
    v_exp_f32 v55, v55
    v_pk_mul_f32 v[200:201], v[200:201], v[192:193]
    v_pk_mul_f32 v[202:203], v[202:203], v[194:195]
    v_fma_f32 v52, v52, v30, v30
    v_fma_f32 v53, v53, v30, v30
    v_fma_f32 v54, v54, v30, v30
    v_fma_f32 v55, v55, v30, v30
    v_lshlrev_b32 v48, 16, v36
    v_and_b32 v49, s48, v36
    v_rcp_f32 v52, v52
    v_rcp_f32 v53, v53
    v_rcp_f32 v54, v54
    v_rcp_f32 v55, v55
    v_lshlrev_b32 v50, 16, v37
    v_and_b32 v51, s48, v37
    v_pk_fma_f32 v[200:201], v[200:201], v[52:53], v[48:49]
    v_pk_fma_f32 v[202:203], v[202:203], v[54:55], v[50:51]
    v_cvt_pk_bf16_f32 v36, v200, v201
    v_cvt_pk_bf16_f32 v37, v202, v203
    v_lshlrev_b32 v232, 16, v70
    v_and_b32 v233, s48, v70
    v_lshlrev_b32 v234, 16, v71
    v_and_b32 v235, s48, v71
    v_lshlrev_b32 v56, 16, v86
    v_and_b32 v57, s48, v86
    v_lshlrev_b32 v58, 16, v87
    v_and_b32 v59, s48, v87
    v_pk_add_f32 v[232:233], v[232:233], v[56:57]
    v_pk_add_f32 v[234:235], v[234:235], v[58:59]
    v_lshlrev_b32 v56, 16, v102
    v_and_b32 v57, s48, v102
    v_lshlrev_b32 v58, 16, v103
    v_and_b32 v59, s48, v103
    v_pk_add_f32 v[232:233], v[232:233], v[56:57]
    v_pk_add_f32 v[234:235], v[234:235], v[58:59]
    v_mul_f32 v60, v2, v232
    v_mul_f32 v61, v2, v233
    v_mul_f32 v62, v2, v234
    v_mul_f32 v63, v2, v235
    v_exp_f32 v60, v60
    v_exp_f32 v61, v61
    v_exp_f32 v62, v62
    v_exp_f32 v63, v63
    v_pk_mul_f32 v[232:233], v[232:233], v[224:225]
    v_pk_mul_f32 v[234:235], v[234:235], v[226:227]
    v_fma_f32 v60, v60, v30, v30
    v_fma_f32 v61, v61, v30, v30
    v_fma_f32 v62, v62, v30, v30
    v_fma_f32 v63, v63, v30, v30
    v_lshlrev_b32 v56, 16, v38
    v_and_b32 v57, s48, v38
    v_rcp_f32 v60, v60
    v_rcp_f32 v61, v61
    v_rcp_f32 v62, v62
    v_rcp_f32 v63, v63
    v_lshlrev_b32 v58, 16, v39
    v_and_b32 v59, s48, v39
    v_pk_fma_f32 v[232:233], v[232:233], v[60:61], v[56:57]
    v_pk_fma_f32 v[234:235], v[234:235], v[62:63], v[58:59]
    v_cvt_pk_bf16_f32 v38, v232, v233
    v_cvt_pk_bf16_f32 v39, v234, v235
    s_add_u32 s31, s40, 0
    s_nop 0
    v_permlane16_swap_b32 v36, v38
    v_permlane16_swap_b32 v37, v39
    buffer_store_dwordx4 v[36:39], v28, s[36:39], s31 offen offset:64 sc1
    v_lshlrev_b32 v140, 16, v72
    v_and_b32 v141, s48, v72
    v_lshlrev_b32 v142, 16, v73
    v_and_b32 v143, s48, v73
    v_lshlrev_b32 v48, 16, v88
    v_and_b32 v49, s48, v88
    v_lshlrev_b32 v50, 16, v89
    v_and_b32 v51, s48, v89
    v_pk_add_f32 v[140:141], v[140:141], v[48:49]
    v_pk_add_f32 v[142:143], v[142:143], v[50:51]
    s_waitcnt vmcnt(3)
    v_lshlrev_b32 v48, 16, v104
    v_and_b32 v49, s48, v104
    v_lshlrev_b32 v50, 16, v105
    v_and_b32 v51, s48, v105
    v_pk_add_f32 v[140:141], v[140:141], v[48:49]
    v_pk_add_f32 v[142:143], v[142:143], v[50:51]
    v_mul_f32 v52, v3, v140
    v_mul_f32 v53, v3, v141
    v_mul_f32 v54, v3, v142
    v_mul_f32 v55, v3, v143
    v_exp_f32 v52, v52
    v_exp_f32 v53, v53
    v_exp_f32 v54, v54
    v_exp_f32 v55, v55
    v_pk_mul_f32 v[140:141], v[140:141], v[132:133]
    v_pk_mul_f32 v[142:143], v[142:143], v[134:135]
    v_fma_f32 v52, v52, v31, v31
    v_fma_f32 v53, v53, v31, v31
    v_fma_f32 v54, v54, v31, v31
    v_fma_f32 v55, v55, v31, v31
    v_lshlrev_b32 v48, 16, v40
    v_and_b32 v49, s48, v40
    v_rcp_f32 v52, v52
    v_rcp_f32 v53, v53
    v_rcp_f32 v54, v54
    v_rcp_f32 v55, v55
    v_lshlrev_b32 v50, 16, v41
    v_and_b32 v51, s48, v41
    v_pk_fma_f32 v[140:141], v[140:141], v[52:53], v[48:49]
    v_pk_fma_f32 v[142:143], v[142:143], v[54:55], v[50:51]
    v_cvt_pk_bf16_f32 v40, v140, v141
    v_cvt_pk_bf16_f32 v41, v142, v143
    v_lshlrev_b32 v172, 16, v74
    v_and_b32 v173, s48, v74
    v_lshlrev_b32 v174, 16, v75
    v_and_b32 v175, s48, v75
    v_lshlrev_b32 v56, 16, v90
    v_and_b32 v57, s48, v90
    v_lshlrev_b32 v58, 16, v91
    v_and_b32 v59, s48, v91
    v_pk_add_f32 v[172:173], v[172:173], v[56:57]
    v_pk_add_f32 v[174:175], v[174:175], v[58:59]
    v_lshlrev_b32 v56, 16, v106
    v_and_b32 v57, s48, v106
    v_lshlrev_b32 v58, 16, v107
    v_and_b32 v59, s48, v107
    v_pk_add_f32 v[172:173], v[172:173], v[56:57]
    v_pk_add_f32 v[174:175], v[174:175], v[58:59]
    v_mul_f32 v60, v3, v172
    v_mul_f32 v61, v3, v173
    v_mul_f32 v62, v3, v174
    v_mul_f32 v63, v3, v175
    v_exp_f32 v60, v60
    v_exp_f32 v61, v61
    v_exp_f32 v62, v62
    v_exp_f32 v63, v63
    v_pk_mul_f32 v[172:173], v[172:173], v[164:165]
    v_pk_mul_f32 v[174:175], v[174:175], v[166:167]
    v_fma_f32 v60, v60, v31, v31
    v_fma_f32 v61, v61, v31, v31
    v_fma_f32 v62, v62, v31, v31
    v_fma_f32 v63, v63, v31, v31
    v_lshlrev_b32 v56, 16, v42
    v_and_b32 v57, s48, v42
    v_rcp_f32 v60, v60
    v_rcp_f32 v61, v61
    v_rcp_f32 v62, v62
    v_rcp_f32 v63, v63
    v_lshlrev_b32 v58, 16, v43
    v_and_b32 v59, s48, v43
    v_pk_fma_f32 v[172:173], v[172:173], v[60:61], v[56:57]
    v_pk_fma_f32 v[174:175], v[174:175], v[62:63], v[58:59]
    v_cvt_pk_bf16_f32 v42, v172, v173
    v_cvt_pk_bf16_f32 v43, v174, v175
    s_add_u32 s31, s40, 32768
    s_nop 0
    v_permlane16_swap_b32 v40, v42
    v_permlane16_swap_b32 v41, v43
    buffer_store_dwordx4 v[40:43], v28, s[36:39], s31 offen offset:0 sc1
    v_lshlrev_b32 v204, 16, v76
    v_and_b32 v205, s48, v76
    v_lshlrev_b32 v206, 16, v77
    v_and_b32 v207, s48, v77
    v_lshlrev_b32 v48, 16, v92
    v_and_b32 v49, s48, v92
    v_lshlrev_b32 v50, 16, v93
    v_and_b32 v51, s48, v93
    v_pk_add_f32 v[204:205], v[204:205], v[48:49]
    v_pk_add_f32 v[206:207], v[206:207], v[50:51]
    s_waitcnt vmcnt(3)
    v_lshlrev_b32 v48, 16, v108
    v_and_b32 v49, s48, v108
    v_lshlrev_b32 v50, 16, v109
    v_and_b32 v51, s48, v109
    v_pk_add_f32 v[204:205], v[204:205], v[48:49]
    v_pk_add_f32 v[206:207], v[206:207], v[50:51]
    v_mul_f32 v52, v3, v204
    v_mul_f32 v53, v3, v205
    v_mul_f32 v54, v3, v206
    v_mul_f32 v55, v3, v207
    v_exp_f32 v52, v52
    v_exp_f32 v53, v53
    v_exp_f32 v54, v54
    v_exp_f32 v55, v55
    v_pk_mul_f32 v[204:205], v[204:205], v[196:197]
    v_pk_mul_f32 v[206:207], v[206:207], v[198:199]
    v_fma_f32 v52, v52, v31, v31
    v_fma_f32 v53, v53, v31, v31
    v_fma_f32 v54, v54, v31, v31
    v_fma_f32 v55, v55, v31, v31
    v_lshlrev_b32 v48, 16, v44
    v_and_b32 v49, s48, v44
    v_rcp_f32 v52, v52
    v_rcp_f32 v53, v53
    v_rcp_f32 v54, v54
    v_rcp_f32 v55, v55
    v_lshlrev_b32 v50, 16, v45
    v_and_b32 v51, s48, v45
    v_pk_fma_f32 v[204:205], v[204:205], v[52:53], v[48:49]
    v_pk_fma_f32 v[206:207], v[206:207], v[54:55], v[50:51]
    v_cvt_pk_bf16_f32 v44, v204, v205
    v_cvt_pk_bf16_f32 v45, v206, v207
    v_lshlrev_b32 v236, 16, v78
    v_and_b32 v237, s48, v78
    v_lshlrev_b32 v238, 16, v79
    v_and_b32 v239, s48, v79
    v_lshlrev_b32 v56, 16, v94
    v_and_b32 v57, s48, v94
    v_lshlrev_b32 v58, 16, v95
    v_and_b32 v59, s48, v95
    v_pk_add_f32 v[236:237], v[236:237], v[56:57]
    v_pk_add_f32 v[238:239], v[238:239], v[58:59]
    v_lshlrev_b32 v56, 16, v110
    v_and_b32 v57, s48, v110
    v_lshlrev_b32 v58, 16, v111
    v_and_b32 v59, s48, v111
    v_pk_add_f32 v[236:237], v[236:237], v[56:57]
    v_pk_add_f32 v[238:239], v[238:239], v[58:59]
    v_mul_f32 v60, v3, v236
    v_mul_f32 v61, v3, v237
    v_mul_f32 v62, v3, v238
    v_mul_f32 v63, v3, v239
    v_exp_f32 v60, v60
    v_exp_f32 v61, v61
    v_exp_f32 v62, v62
    v_exp_f32 v63, v63
    v_pk_mul_f32 v[236:237], v[236:237], v[228:229]
    v_pk_mul_f32 v[238:239], v[238:239], v[230:231]
    v_fma_f32 v60, v60, v31, v31
    v_fma_f32 v61, v61, v31, v31
    v_fma_f32 v62, v62, v31, v31
    v_fma_f32 v63, v63, v31, v31
    v_lshlrev_b32 v56, 16, v46
    v_and_b32 v57, s48, v46
    v_rcp_f32 v60, v60
    v_rcp_f32 v61, v61
    v_rcp_f32 v62, v62
    v_rcp_f32 v63, v63
    v_lshlrev_b32 v58, 16, v47
    v_and_b32 v59, s48, v47
    v_pk_fma_f32 v[236:237], v[236:237], v[60:61], v[56:57]
    v_pk_fma_f32 v[238:239], v[238:239], v[62:63], v[58:59]
    v_cvt_pk_bf16_f32 v46, v236, v237
    v_cvt_pk_bf16_f32 v47, v238, v239
    s_add_u32 s31, s40, 32768
    s_nop 0
    v_permlane16_swap_b32 v44, v46
    v_permlane16_swap_b32 v45, v47
    buffer_store_dwordx4 v[44:47], v28, s[36:39], s31 offen offset:64 sc1
    s_endpgm
L_k3_fin1:
    v_mfma_f32_16x16x32_bf16 v[144:147], a[80:83], a[64:67], v[144:147]
    ds_read_b64_tr_b16 a[128:129], v8 offset:0
    v_mfma_f32_16x16x32_bf16 v[148:151], a[80:83], a[68:71], v[148:151]
    ds_read_b64_tr_b16 a[130:131], v8 offset:1024
    s_add_u32 s31, s40, 65536
    buffer_load_dwordx4 v[32:35], v28, s[16:19], s31 offen offset:0
    v_mfma_f32_16x16x32_bf16 v[176:179], a[84:87], a[64:67], v[176:179]
    ds_read_b64_tr_b16 a[132:133], v9 offset:0
    v_mfma_f32_16x16x32_bf16 v[180:183], a[84:87], a[68:71], v[180:183]
    ds_read_b64_tr_b16 a[134:135], v9 offset:1024
    s_add_u32 s31, s40, 65536
    buffer_load_dwordx4 v[36:39], v28, s[16:19], s31 offen offset:64
    v_mfma_f32_16x16x32_bf16 v[208:211], a[88:91], a[64:67], v[208:211]
    ds_read_b64_tr_b16 a[136:137], v10 offset:0
    v_mfma_f32_16x16x32_bf16 v[212:215], a[88:91], a[68:71], v[212:215]
    ds_read_b64_tr_b16 a[138:139], v10 offset:1024
    s_add_u32 s31, s40, 98304
    buffer_load_dwordx4 v[40:43], v28, s[16:19], s31 offen offset:0
    v_mfma_f32_16x16x32_bf16 v[240:243], a[92:95], a[64:67], v[240:243]
    ds_read_b64_tr_b16 a[140:141], v11 offset:0
    v_mfma_f32_16x16x32_bf16 v[244:247], a[92:95], a[68:71], v[244:247]
    ds_read_b64_tr_b16 a[142:143], v11 offset:1024
    s_add_u32 s31, s40, 98304
    buffer_load_dwordx4 v[44:47], v28, s[16:19], s31 offen offset:64
    v_mfma_f32_16x16x32_bf16 v[152:155], a[80:83], a[72:75], v[152:155]
    ds_read_b128 a[112:115], v4 offset:2048
    v_mfma_f32_16x16x32_bf16 v[156:159], a[80:83], a[76:79], v[156:159]
    ds_read_b128 a[116:119], v4 offset:2560
    s_add_u32 s31, s41, 256
    buffer_load_dword v30, v29, s[8:11], s31 offen offset:0
    v_mfma_f32_16x16x32_bf16 v[184:187], a[84:87], a[72:75], v[184:187]
    ds_read_b64_tr_b16 a[176:177], v8 offset:8192
    v_mfma_f32_16x16x32_bf16 v[188:191], a[84:87], a[76:79], v[188:191]
    ds_read_b64_tr_b16 a[178:179], v8 offset:9216
    s_add_u32 s31, s41, 256
    buffer_load_dword v31, v29, s[8:11], s31 offen offset:128
    v_mfma_f32_16x16x32_bf16 v[216:219], a[88:91], a[72:75], v[216:219]
    ds_read_b64_tr_b16 a[180:181], v9 offset:8192
    v_mfma_f32_16x16x32_bf16 v[220:223], a[88:91], a[76:79], v[220:223]
    ds_read_b64_tr_b16 a[182:183], v9 offset:9216
    v_mfma_f32_16x16x32_bf16 v[248:251], a[92:95], a[72:75], v[248:251]
    ds_read_b64_tr_b16 a[184:185], v10 offset:8192
    v_mfma_f32_16x16x32_bf16 v[252:255], a[92:95], a[76:79], v[252:255]
    ds_read_b64_tr_b16 a[186:187], v10 offset:9216
    s_waitcnt lgkmcnt(7)
    v_mfma_f32_16x16x32_bf16 v[144:147], a[128:131], a[112:115], v[144:147]
    ds_read_b64_tr_b16 a[188:189], v11 offset:8192
    s_waitcnt lgkmcnt(7)
    v_mfma_f32_16x16x32_bf16 v[148:151], a[128:131], a[116:119], v[148:151]
    ds_read_b64_tr_b16 a[190:191], v11 offset:9216
    v_mfma_f32_16x16x32_bf16 v[176:179], a[132:135], a[112:115], v[176:179]
    ds_read_b128 a[160:163], v4 offset:18432
    v_mfma_f32_16x16x32_bf16 v[180:183], a[132:135], a[116:119], v[180:183]
    ds_read_b128 a[164:167], v4 offset:18944
    v_mfma_f32_16x16x32_bf16 v[208:211], a[136:139], a[112:115], v[208:211]
    ds_read_b128 a[120:123], v4 offset:3072
    v_mfma_f32_16x16x32_bf16 v[212:215], a[136:139], a[116:119], v[212:215]
    ds_read_b128 a[124:127], v4 offset:3584
    v_mfma_f32_16x16x32_bf16 v[240:243], a[140:143], a[112:115], v[240:243]
    ds_read_b128 a[168:171], v4 offset:19456
    v_mfma_f32_16x16x32_bf16 v[244:247], a[140:143], a[116:119], v[244:247]
    ds_read_b128 a[172:175], v4 offset:19968
    s_waitcnt lgkmcnt(5)
    v_mfma_f32_16x16x32_bf16 v[144:147], a[176:179], a[160:163], v[144:147]
    ds_read_b128 a[96:99], v4 offset:0
    s_waitcnt lgkmcnt(5)
    v_mfma_f32_16x16x32_bf16 v[148:151], a[176:179], a[164:167], v[148:151]
    ds_read_b128 a[100:103], v4 offset:512
    v_mfma_f32_16x16x32_bf16 v[176:179], a[180:183], a[160:163], v[176:179]
    ds_read_b128 a[144:147], v4 offset:16384
    v_mfma_f32_16x16x32_bf16 v[180:183], a[180:183], a[164:167], v[180:183]
    ds_read_b128 a[148:151], v4 offset:16896
    v_mfma_f32_16x16x32_bf16 v[208:211], a[184:187], a[160:163], v[208:211]
    ds_read_b128 a[104:107], v4 offset:1024
    v_mfma_f32_16x16x32_bf16 v[212:215], a[184:187], a[164:167], v[212:215]
    ds_read_b128 a[108:111], v4 offset:1536
    v_mfma_f32_16x16x32_bf16 v[240:243], a[188:191], a[160:163], v[240:243]
    ds_read_b128 a[152:155], v4 offset:17408
    v_mfma_f32_16x16x32_bf16 v[244:247], a[188:191], a[164:167], v[244:247]
    ds_read_b128 a[156:159], v4 offset:17920
    s_waitcnt lgkmcnt(11)
    v_mfma_f32_16x16x32_bf16 v[152:155], a[128:131], a[120:123], v[152:155]
    s_waitcnt lgkmcnt(10)
    v_mfma_f32_16x16x32_bf16 v[156:159], a[128:131], a[124:127], v[156:159]
    v_mfma_f32_16x16x32_bf16 v[184:187], a[132:135], a[120:123], v[184:187]
    v_mfma_f32_16x16x32_bf16 v[188:191], a[132:135], a[124:127], v[188:191]
    v_mfma_f32_16x16x32_bf16 v[216:219], a[136:139], a[120:123], v[216:219]
    v_mfma_f32_16x16x32_bf16 v[220:223], a[136:139], a[124:127], v[220:223]
    s_add_u32 s30, s34, 98304
    v_cvt_pk_bf16_f32 v48, v144, v145
    v_cvt_pk_bf16_f32 v49, v146, v147
    v_mfma_f32_16x16x32_bf16 v[248:251], a[140:143], a[120:123], v[248:251]
    v_cvt_pk_bf16_f32 v50, v176, v177
    v_cvt_pk_bf16_f32 v51, v178, v179
    v_mfma_f32_16x16x32_bf16 v[252:255], a[140:143], a[124:127], v[252:255]
    buffer_store_dwordx4 v[48:51], v1, s[8:11], s30 offen offset:0 sc1
    v_cvt_pk_bf16_f32 v52, v208, v209
    s_waitcnt lgkmcnt(9)
    v_mfma_f32_16x16x32_bf16 v[152:155], a[176:179], a[168:171], v[152:155]
    v_cvt_pk_bf16_f32 v53, v210, v211
    v_cvt_pk_bf16_f32 v54, v240, v241
    s_waitcnt lgkmcnt(8)
    v_mfma_f32_16x16x32_bf16 v[156:159], a[176:179], a[172:175], v[156:159]
    v_cvt_pk_bf16_f32 v55, v242, v243
    buffer_store_dwordx4 v[52:55], v1, s[8:11], s30 offen offset:1024 sc1
    v_mfma_f32_16x16x32_bf16 v[184:187], a[180:183], a[168:171], v[184:187]
    v_cvt_pk_bf16_f32 v56, v148, v149
    v_cvt_pk_bf16_f32 v57, v150, v151
    v_mfma_f32_16x16x32_bf16 v[188:191], a[180:183], a[172:175], v[188:191]
    v_cvt_pk_bf16_f32 v58, v180, v181
    v_cvt_pk_bf16_f32 v59, v182, v183
    v_mfma_f32_16x16x32_bf16 v[216:219], a[184:187], a[168:171], v[216:219]
    buffer_store_dwordx4 v[56:59], v1, s[8:11], s30 offen offset:2048 sc1
    v_cvt_pk_bf16_f32 v60, v212, v213
    v_mfma_f32_16x16x32_bf16 v[220:223], a[184:187], a[172:175], v[220:223]
    v_cvt_pk_bf16_f32 v61, v214, v215
    v_cvt_pk_bf16_f32 v62, v244, v245
    v_mfma_f32_16x16x32_bf16 v[248:251], a[188:191], a[168:171], v[248:251]
    v_cvt_pk_bf16_f32 v63, v246, v247
    buffer_store_dwordx4 v[60:63], v1, s[8:11], s30 offen offset:3072 sc1
    v_mfma_f32_16x16x32_bf16 v[252:255], a[188:191], a[172:175], v[252:255]
    v_mfma_f32_16x16x32_bf16 v[128:131], a[80:83], a[48:51], v[128:131]
    v_mfma_f32_16x16x32_bf16 v[132:135], a[80:83], a[52:55], v[132:135]
    v_mfma_f32_16x16x32_bf16 v[160:163], a[84:87], a[48:51], v[160:163]
    v_mfma_f32_16x16x32_bf16 v[164:167], a[84:87], a[52:55], v[164:167]
    v_mfma_f32_16x16x32_bf16 v[192:195], a[88:91], a[48:51], v[192:195]
    v_mfma_f32_16x16x32_bf16 v[196:199], a[88:91], a[52:55], v[196:199]
    s_add_u32 s30, s34, 114688
    v_cvt_pk_bf16_f32 v48, v152, v153
    v_cvt_pk_bf16_f32 v49, v154, v155
    v_mfma_f32_16x16x32_bf16 v[224:227], a[92:95], a[48:51], v[224:227]
    v_cvt_pk_bf16_f32 v50, v184, v185
    v_cvt_pk_bf16_f32 v51, v186, v187
    v_mfma_f32_16x16x32_bf16 v[228:231], a[92:95], a[52:55], v[228:231]
    buffer_store_dwordx4 v[48:51], v1, s[8:11], s30 offen offset:0 sc1
    v_cvt_pk_bf16_f32 v52, v216, v217
    s_waitcnt lgkmcnt(7)
    v_mfma_f32_16x16x32_bf16 v[128:131], a[128:131], a[96:99], v[128:131]
    v_cvt_pk_bf16_f32 v53, v218, v219
    v_cvt_pk_bf16_f32 v54, v248, v249
    s_waitcnt lgkmcnt(6)
    v_mfma_f32_16x16x32_bf16 v[132:135], a[128:131], a[100:103], v[132:135]
    v_cvt_pk_bf16_f32 v55, v250, v251
    buffer_store_dwordx4 v[52:55], v1, s[8:11], s30 offen offset:1024 sc1
    v_mfma_f32_16x16x32_bf16 v[160:163], a[132:135], a[96:99], v[160:163]
    v_cvt_pk_bf16_f32 v56, v156, v157
    v_cvt_pk_bf16_f32 v57, v158, v159
    v_mfma_f32_16x16x32_bf16 v[164:167], a[132:135], a[100:103], v[164:167]
    v_cvt_pk_bf16_f32 v58, v188, v189
    v_cvt_pk_bf16_f32 v59, v190, v191
    v_mfma_f32_16x16x32_bf16 v[192:195], a[136:139], a[96:99], v[192:195]
    buffer_store_dwordx4 v[56:59], v1, s[8:11], s30 offen offset:2048 sc1
    v_cvt_pk_bf16_f32 v60, v220, v221
    v_mfma_f32_16x16x32_bf16 v[196:199], a[136:139], a[100:103], v[196:199]
    v_cvt_pk_bf16_f32 v61, v222, v223
    v_cvt_pk_bf16_f32 v62, v252, v253
    v_mfma_f32_16x16x32_bf16 v[224:227], a[140:143], a[96:99], v[224:227]
    v_cvt_pk_bf16_f32 v63, v254, v255
    buffer_store_dwordx4 v[60:63], v1, s[8:11], s30 offen offset:3072 sc1
    v_mfma_f32_16x16x32_bf16 v[228:231], a[140:143], a[100:103], v[228:231]
    s_waitcnt lgkmcnt(5)
    v_mfma_f32_16x16x32_bf16 v[128:131], a[176:179], a[144:147], v[128:131]
    s_waitcnt lgkmcnt(4)
    v_mfma_f32_16x16x32_bf16 v[132:135], a[176:179], a[148:151], v[132:135]
    v_mfma_f32_16x16x32_bf16 v[160:163], a[180:183], a[144:147], v[160:163]
    v_mfma_f32_16x16x32_bf16 v[164:167], a[180:183], a[148:151], v[164:167]
    v_mfma_f32_16x16x32_bf16 v[192:195], a[184:187], a[144:147], v[192:195]
    v_mfma_f32_16x16x32_bf16 v[196:199], a[184:187], a[148:151], v[196:199]
    v_mfma_f32_16x16x32_bf16 v[224:227], a[188:191], a[144:147], v[224:227]
    v_mfma_f32_16x16x32_bf16 v[228:231], a[188:191], a[148:151], v[228:231]
    v_mfma_f32_16x16x32_bf16 v[136:139], a[80:83], a[56:59], v[136:139]
    v_mfma_f32_16x16x32_bf16 v[140:143], a[80:83], a[60:63], v[140:143]
    v_mfma_f32_16x16x32_bf16 v[168:171], a[84:87], a[56:59], v[168:171]
    v_mfma_f32_16x16x32_bf16 v[172:175], a[84:87], a[60:63], v[172:175]
    v_mfma_f32_16x16x32_bf16 v[200:203], a[88:91], a[56:59], v[200:203]
    v_mfma_f32_16x16x32_bf16 v[204:207], a[88:91], a[60:63], v[204:207]
    s_add_u32 s30, s34, 65536
    v_cvt_pk_bf16_f32 v48, v128, v129
    v_cvt_pk_bf16_f32 v49, v130, v131
    v_mfma_f32_16x16x32_bf16 v[232:235], a[92:95], a[56:59], v[232:235]
    v_cvt_pk_bf16_f32 v50, v160, v161
    v_cvt_pk_bf16_f32 v51, v162, v163
    v_mfma_f32_16x16x32_bf16 v[236:239], a[92:95], a[60:63], v[236:239]
    buffer_store_dwordx4 v[48:51], v1, s[8:11], s30 offen offset:0 sc1
    v_cvt_pk_bf16_f32 v52, v192, v193
    s_waitcnt lgkmcnt(3)
    v_mfma_f32_16x16x32_bf16 v[136:139], a[128:131], a[104:107], v[136:139]
    v_cvt_pk_bf16_f32 v53, v194, v195
    v_cvt_pk_bf16_f32 v54, v224, v225
    s_waitcnt lgkmcnt(2)
    v_mfma_f32_16x16x32_bf16 v[140:143], a[128:131], a[108:111], v[140:143]
    v_cvt_pk_bf16_f32 v55, v226, v227
    buffer_store_dwordx4 v[52:55], v1, s[8:11], s30 offen offset:1024 sc1
    v_mfma_f32_16x16x32_bf16 v[168:171], a[132:135], a[104:107], v[168:171]
    v_cvt_pk_bf16_f32 v56, v132, v133
    v_cvt_pk_bf16_f32 v57, v134, v135
    v_mfma_f32_16x16x32_bf16 v[172:175], a[132:135], a[108:111], v[172:175]
    v_cvt_pk_bf16_f32 v58, v164, v165
    v_cvt_pk_bf16_f32 v59, v166, v167
    v_mfma_f32_16x16x32_bf16 v[200:203], a[136:139], a[104:107], v[200:203]
    buffer_store_dwordx4 v[56:59], v1, s[8:11], s30 offen offset:2048 sc1
    v_cvt_pk_bf16_f32 v60, v196, v197
    v_mfma_f32_16x16x32_bf16 v[204:207], a[136:139], a[108:111], v[204:207]
    v_cvt_pk_bf16_f32 v61, v198, v199
    v_cvt_pk_bf16_f32 v62, v228, v229
    v_mfma_f32_16x16x32_bf16 v[232:235], a[140:143], a[104:107], v[232:235]
    v_cvt_pk_bf16_f32 v63, v230, v231
    buffer_store_dwordx4 v[60:63], v1, s[8:11], s30 offen offset:3072 sc1
    v_mfma_f32_16x16x32_bf16 v[236:239], a[140:143], a[108:111], v[236:239]
    s_waitcnt lgkmcnt(1)
    v_mfma_f32_16x16x32_bf16 v[136:139], a[176:179], a[152:155], v[136:139]
    s_waitcnt lgkmcnt(0)
    v_mfma_f32_16x16x32_bf16 v[140:143], a[176:179], a[156:159], v[140:143]
    v_mfma_f32_16x16x32_bf16 v[168:171], a[180:183], a[152:155], v[168:171]
    v_mfma_f32_16x16x32_bf16 v[172:175], a[180:183], a[156:159], v[172:175]
    v_mfma_f32_16x16x32_bf16 v[200:203], a[184:187], a[152:155], v[200:203]
    v_mfma_f32_16x16x32_bf16 v[204:207], a[184:187], a[156:159], v[204:207]
    v_mfma_f32_16x16x32_bf16 v[232:235], a[188:191], a[152:155], v[232:235]
    v_mfma_f32_16x16x32_bf16 v[236:239], a[188:191], a[156:159], v[236:239]
    v_mov_b32 v23, 0
    buffer_load_dword v26, v23, s[8:11], s35 offen sc1
    s_waitcnt vmcnt(1)
    v_mov_b32 v22, s97
    v_mov_b32 v23, 0
    v_lshlrev_b32 v24, 9, v20
    s_add_u32 s31, s35, 512
    s_mov_b64 exec, 1
    buffer_store_dword v22, v23, s[8:11], s31 offen sc1
    s_mov_b64 exec, -1
    s_waitcnt vmcnt(1)
    v_readfirstlane_b32 s46, v26
    s_nop 0
    s_cmp_eq_u32 s46, s97
    s_cselect_b32 s46, 1, 0
    s_cbranch_scc0 L_k3_q1_nos
    s_add_u32 s30, s34, 278528
    buffer_load_dwordx4 v[96:99], v1, s[8:11], s30 offen offset:0 sc1
    buffer_load_dwordx4 v[100:103], v1, s[8:11], s30 offen offset:1024 sc1
    buffer_load_dwordx4 v[104:107], v1, s[8:11], s30 offen offset:2048 sc1
    buffer_load_dwordx4 v[108:111], v1, s[8:11], s30 offen offset:3072 sc1
L_k3_q1_nos:
    s_mov_b64 exec, 13
    s_mov_b32 s31, 0
L_k3_q1_poll:
    buffer_load_dword v25, v24, s[8:11], s35 offen sc1
    s_waitcnt vmcnt(0)
    v_cmp_eq_u32 vcc, s97, v25
    s_add_u32 s31, s31, 1
    s_cmp_gt_u32 s31, 0x40000
    s_cbranch_scc1 L_k3_q1_got
    s_cmp_eq_u32 vcc_lo, 13
    s_cbranch_scc0 L_k3_q1_poll
L_k3_q1_got:
    s_mov_b64 exec, -1
    s_add_u32 s30, s34, 147456
    buffer_load_dwordx4 v[64:67], v1, s[8:11], s30 offen offset:0 sc1
    buffer_load_dwordx4 v[68:71], v1, s[8:11], s30 offen offset:1024 sc1
    buffer_load_dwordx4 v[72:75], v1, s[8:11], s30 offen offset:2048 sc1
    buffer_load_dwordx4 v[76:79], v1, s[8:11], s30 offen offset:3072 sc1
    s_add_u32 s30, s34, 212992
    buffer_load_dwordx4 v[80:83], v1, s[8:11], s30 offen offset:0 sc1
    buffer_load_dwordx4 v[84:87], v1, s[8:11], s30 offen offset:1024 sc1
    buffer_load_dwordx4 v[88:91], v1, s[8:11], s30 offen offset:2048 sc1
    buffer_load_dwordx4 v[92:95], v1, s[8:11], s30 offen offset:3072 sc1
    s_cmp_eq_u32 s46, 1
    s_cbranch_scc1 L_k3_q1_haves
    s_add_u32 s30, s34, 278528
    buffer_load_dwordx4 v[96:99], v1, s[8:11], s30 offen offset:0 sc1
    buffer_load_dwordx4 v[100:103], v1, s[8:11], s30 offen offset:1024 sc1
    buffer_load_dwordx4 v[104:107], v1, s[8:11], s30 offen offset:2048 sc1
    buffer_load_dwordx4 v[108:111], v1, s[8:11], s30 offen offset:3072 sc1
L_k3_q1_haves:
    s_mov_b32 s47, 0xbfb8aa3b
    s_mov_b32 s48, 0xffff0000
    v_mul_f32 v30, v30, v30
    v_mul_f32 v2, s47, v30
    v_rcp_f32 v30, v30
    v_mul_f32 v31, v31, v31
    v_mul_f32 v3, s47, v31
    v_rcp_f32 v31, v31
    v_permlane16_swap_b32 v32, v34
    v_permlane16_swap_b32 v33, v35
    v_permlane16_swap_b32 v36, v38
    v_permlane16_swap_b32 v37, v39
    v_permlane16_swap_b32 v40, v42
    v_permlane16_swap_b32 v41, v43
    v_permlane16_swap_b32 v44, v46
    v_permlane16_swap_b32 v45, v47
    s_waitcnt vmcnt(7)
    v_lshlrev_b32 v48, 16, v64
    v_and_b32 v49, s48, v64
    v_lshlrev_b32 v50, 16, v65
    v_and_b32 v51, s48, v65
    v_pk_add_f32 v[136:137], v[136:137], v[48:49]
    v_pk_add_f32 v[138:139], v[138:139], v[50:51]
    s_waitcnt vmcnt(3)
    v_lshlrev_b32 v48, 16, v80
    v_and_b32 v49, s48, v80
    v_lshlrev_b32 v50, 16, v81
    v_and_b32 v51, s48, v81
    v_pk_add_f32 v[136:137], v[136:137], v[48:49]
    v_pk_add_f32 v[138:139], v[138:139], v[50:51]
    v_mul_f32 v52, v2, v136
    v_mul_f32 v53, v2, v137
    v_mul_f32 v54, v2, v138
    v_mul_f32 v55, v2, v139
    s_waitcnt vmcnt(3)
    v_lshlrev_b32 v144, 16, v96
    v_and_b32 v145, s48, v96
    v_lshlrev_b32 v146, 16, v97
    v_and_b32 v147, s48, v97
    v_exp_f32 v52, v52
    v_exp_f32 v53, v53
    v_exp_f32 v54, v54
    v_exp_f32 v55, v55
    v_pk_mul_f32 v[136:137], v[136:137], v[144:145]
    v_pk_mul_f32 v[138:139], v[138:139], v[146:147]
    v_fma_f32 v52, v52, v30, v30
    v_fma_f32 v53, v53, v30, v30
    v_fma_f32 v54, v54, v30, v30
    v_fma_f32 v55, v55, v30, v30
    v_lshlrev_b32 v48, 16, v32
    v_and_b32 v49, s48, v32
    v_rcp_f32 v52, v52
    v_rcp_f32 v53, v53
    v_rcp_f32 v54, v54
    v_rcp_f32 v55, v55
    v_lshlrev_b32 v50, 16, v33
    v_and_b32 v51, s48, v33
    v_pk_fma_f32 v[136:137], v[136:137], v[52:53], v[48:49]
    v_pk_fma_f32 v[138:139], v[138:139], v[54:55], v[50:51]
    v_cvt_pk_bf16_f32 v32, v136, v137
    v_cvt_pk_bf16_f32 v33, v138, v139
    v_lshlrev_b32 v56, 16, v66
    v_and_b32 v57, s48, v66
    v_lshlrev_b32 v58, 16, v67
    v_and_b32 v59, s48, v67
    v_pk_add_f32 v[168:169], v[168:169], v[56:57]
    v_pk_add_f32 v[170:171], v[170:171], v[58:59]
    v_lshlrev_b32 v56, 16, v82
    v_and_b32 v57, s48, v82
    v_lshlrev_b32 v58, 16, v83
    v_and_b32 v59, s48, v83
    v_pk_add_f32 v[168:169], v[168:169], v[56:57]
    v_pk_add_f32 v[170:171], v[170:171], v[58:59]
    v_mul_f32 v60, v2, v168
    v_mul_f32 v61, v2, v169
    v_mul_f32 v62, v2, v170
    v_mul_f32 v63, v2, v171
    v_lshlrev_b32 v176, 16, v98
    v_and_b32 v177, s48, v98
    v_lshlrev_b32 v178, 16, v99
    v_and_b32 v179, s48, v99
    v_exp_f32 v60, v60
    v_exp_f32 v61, v61
    v_exp_f32 v62, v62
    v_exp_f32 v63, v63
    v_pk_mul_f32 v[168:169], v[168:169], v[176:177]
    v_pk_mul_f32 v[170:171], v[170:171], v[178:179]
    v_fma_f32 v60, v60, v30, v30
    v_fma_f32 v61, v61, v30, v30
    v_fma_f32 v62, v62, v30, v30
    v_fma_f32 v63, v63, v30, v30
    v_lshlrev_b32 v56, 16, v34
    v_and_b32 v57, s48, v34
    v_rcp_f32 v60, v60
    v_rcp_f32 v61, v61
    v_rcp_f32 v62, v62
    v_rcp_f32 v63, v63
    v_lshlrev_b32 v58, 16, v35
    v_and_b32 v59, s48, v35
    v_pk_fma_f32 v[168:169], v[168:169], v[60:61], v[56:57]
    v_pk_fma_f32 v[170:171], v[170:171], v[62:63], v[58:59]
    v_cvt_pk_bf16_f32 v34, v168, v169
    v_cvt_pk_bf16_f32 v35, v170, v171
    s_add_u32 s31, s40, 65536
    s_nop 0
    v_permlane16_swap_b32 v32, v34
    v_permlane16_swap_b32 v33, v35
    buffer_store_dwordx4 v[32:35], v28, s[36:39], s31 offen offset:0 sc1
    v_lshlrev_b32 v48, 16, v68
    v_and_b32 v49, s48, v68
    v_lshlrev_b32 v50, 16, v69
    v_and_b32 v51, s48, v69
    v_pk_add_f32 v[200:201], v[200:201], v[48:49]
    v_pk_add_f32 v[202:203], v[202:203], v[50:51]
    s_waitcnt vmcnt(3)
    v_lshlrev_b32 v48, 16, v84
    v_and_b32 v49, s48, v84
    v_lshlrev_b32 v50, 16, v85
    v_and_b32 v51, s48, v85
    v_pk_add_f32 v[200:201], v[200:201], v[48:49]
    v_pk_add_f32 v[202:203], v[202:203], v[50:51]
    v_mul_f32 v52, v2, v200
    v_mul_f32 v53, v2, v201
    v_mul_f32 v54, v2, v202
    v_mul_f32 v55, v2, v203
    s_waitcnt vmcnt(3)
    v_lshlrev_b32 v208, 16, v100
    v_and_b32 v209, s48, v100
    v_lshlrev_b32 v210, 16, v101
    v_and_b32 v211, s48, v101
    v_exp_f32 v52, v52
    v_exp_f32 v53, v53
    v_exp_f32 v54, v54
    v_exp_f32 v55, v55
    v_pk_mul_f32 v[200:201], v[200:201], v[208:209]
    v_pk_mul_f32 v[202:203], v[202:203], v[210:211]
    v_fma_f32 v52, v52, v30, v30
    v_fma_f32 v53, v53, v30, v30
    v_fma_f32 v54, v54, v30, v30
    v_fma_f32 v55, v55, v30, v30
    v_lshlrev_b32 v48, 16, v36
    v_and_b32 v49, s48, v36
    v_rcp_f32 v52, v52
    v_rcp_f32 v53, v53
    v_rcp_f32 v54, v54
    v_rcp_f32 v55, v55
    v_lshlrev_b32 v50, 16, v37
    v_and_b32 v51, s48, v37
    v_pk_fma_f32 v[200:201], v[200:201], v[52:53], v[48:49]
    v_pk_fma_f32 v[202:203], v[202:203], v[54:55], v[50:51]
    v_cvt_pk_bf16_f32 v36, v200, v201
    v_cvt_pk_bf16_f32 v37, v202, v203
    v_lshlrev_b32 v56, 16, v70
    v_and_b32 v57, s48, v70
    v_lshlrev_b32 v58, 16, v71
    v_and_b32 v59, s48, v71
    v_pk_add_f32 v[232:233], v[232:233], v[56:57]
    v_pk_add_f32 v[234:235], v[234:235], v[58:59]
    v_lshlrev_b32 v56, 16, v86
    v_and_b32 v57, s48, v86
    v_lshlrev_b32 v58, 16, v87
    v_and_b32 v59, s48, v87
    v_pk_add_f32 v[232:233], v[232:233], v[56:57]
    v_pk_add_f32 v[234:235], v[234:235], v[58:59]
    v_mul_f32 v60, v2, v232
    v_mul_f32 v61, v2, v233
    v_mul_f32 v62, v2, v234
    v_mul_f32 v63, v2, v235
    v_lshlrev_b32 v240, 16, v102
    v_and_b32 v241, s48, v102
    v_lshlrev_b32 v242, 16, v103
    v_and_b32 v243, s48, v103
    v_exp_f32 v60, v60
    v_exp_f32 v61, v61
    v_exp_f32 v62, v62
    v_exp_f32 v63, v63
    v_pk_mul_f32 v[232:233], v[232:233], v[240:241]
    v_pk_mul_f32 v[234:235], v[234:235], v[242:243]
    v_fma_f32 v60, v60, v30, v30
    v_fma_f32 v61, v61, v30, v30
    v_fma_f32 v62, v62, v30, v30
    v_fma_f32 v63, v63, v30, v30
    v_lshlrev_b32 v56, 16, v38
    v_and_b32 v57, s48, v38
    v_rcp_f32 v60, v60
    v_rcp_f32 v61, v61
    v_rcp_f32 v62, v62
    v_rcp_f32 v63, v63
    v_lshlrev_b32 v58, 16, v39
    v_and_b32 v59, s48, v39
    v_pk_fma_f32 v[232:233], v[232:233], v[60:61], v[56:57]
    v_pk_fma_f32 v[234:235], v[234:235], v[62:63], v[58:59]
    v_cvt_pk_bf16_f32 v38, v232, v233
    v_cvt_pk_bf16_f32 v39, v234, v235
    s_add_u32 s31, s40, 65536
    s_nop 0
    v_permlane16_swap_b32 v36, v38
    v_permlane16_swap_b32 v37, v39
    buffer_store_dwordx4 v[36:39], v28, s[36:39], s31 offen offset:64 sc1
    v_lshlrev_b32 v48, 16, v72
    v_and_b32 v49, s48, v72
    v_lshlrev_b32 v50, 16, v73
    v_and_b32 v51, s48, v73
    v_pk_add_f32 v[140:141], v[140:141], v[48:49]
    v_pk_add_f32 v[142:143], v[142:143], v[50:51]
    s_waitcnt vmcnt(3)
    v_lshlrev_b32 v48, 16, v88
    v_and_b32 v49, s48, v88
    v_lshlrev_b32 v50, 16, v89
    v_and_b32 v51, s48, v89
    v_pk_add_f32 v[140:141], v[140:141], v[48:49]
    v_pk_add_f32 v[142:143], v[142:143], v[50:51]
    v_mul_f32 v52, v3, v140
    v_mul_f32 v53, v3, v141
    v_mul_f32 v54, v3, v142
    v_mul_f32 v55, v3, v143
    s_waitcnt vmcnt(3)
    v_lshlrev_b32 v148, 16, v104
    v_and_b32 v149, s48, v104
    v_lshlrev_b32 v150, 16, v105
    v_and_b32 v151, s48, v105
    v_exp_f32 v52, v52
    v_exp_f32 v53, v53
    v_exp_f32 v54, v54
    v_exp_f32 v55, v55
    v_pk_mul_f32 v[140:141], v[140:141], v[148:149]
    v_pk_mul_f32 v[142:143], v[142:143], v[150:151]
    v_fma_f32 v52, v52, v31, v31
    v_fma_f32 v53, v53, v31, v31
    v_fma_f32 v54, v54, v31, v31
    v_fma_f32 v55, v55, v31, v31
    v_lshlrev_b32 v48, 16, v40
    v_and_b32 v49, s48, v40
    v_rcp_f32 v52, v52
    v_rcp_f32 v53, v53
    v_rcp_f32 v54, v54
    v_rcp_f32 v55, v55
    v_lshlrev_b32 v50, 16, v41
    v_and_b32 v51, s48, v41
    v_pk_fma_f32 v[140:141], v[140:141], v[52:53], v[48:49]
    v_pk_fma_f32 v[142:143], v[142:143], v[54:55], v[50:51]
    v_cvt_pk_bf16_f32 v40, v140, v141
    v_cvt_pk_bf16_f32 v41, v142, v143
    v_lshlrev_b32 v56, 16, v74
    v_and_b32 v57, s48, v74
    v_lshlrev_b32 v58, 16, v75
    v_and_b32 v59, s48, v75
    v_pk_add_f32 v[172:173], v[172:173], v[56:57]
    v_pk_add_f32 v[174:175], v[174:175], v[58:59]
    v_lshlrev_b32 v56, 16, v90
    v_and_b32 v57, s48, v90
    v_lshlrev_b32 v58, 16, v91
    v_and_b32 v59, s48, v91
    v_pk_add_f32 v[172:173], v[172:173], v[56:57]
    v_pk_add_f32 v[174:175], v[174:175], v[58:59]
    v_mul_f32 v60, v3, v172
    v_mul_f32 v61, v3, v173
    v_mul_f32 v62, v3, v174
    v_mul_f32 v63, v3, v175
    v_lshlrev_b32 v180, 16, v106
    v_and_b32 v181, s48, v106
    v_lshlrev_b32 v182, 16, v107
    v_and_b32 v183, s48, v107
    v_exp_f32 v60, v60
    v_exp_f32 v61, v61
    v_exp_f32 v62, v62
    v_exp_f32 v63, v63
    v_pk_mul_f32 v[172:173], v[172:173], v[180:181]
    v_pk_mul_f32 v[174:175], v[174:175], v[182:183]
    v_fma_f32 v60, v60, v31, v31
    v_fma_f32 v61, v61, v31, v31
    v_fma_f32 v62, v62, v31, v31
    v_fma_f32 v63, v63, v31, v31
    v_lshlrev_b32 v56, 16, v42
    v_and_b32 v57, s48, v42
    v_rcp_f32 v60, v60
    v_rcp_f32 v61, v61
    v_rcp_f32 v62, v62
    v_rcp_f32 v63, v63
    v_lshlrev_b32 v58, 16, v43
    v_and_b32 v59, s48, v43
    v_pk_fma_f32 v[172:173], v[172:173], v[60:61], v[56:57]
    v_pk_fma_f32 v[174:175], v[174:175], v[62:63], v[58:59]
    v_cvt_pk_bf16_f32 v42, v172, v173
    v_cvt_pk_bf16_f32 v43, v174, v175
    s_add_u32 s31, s40, 98304
    s_nop 0
    v_permlane16_swap_b32 v40, v42
    v_permlane16_swap_b32 v41, v43
    buffer_store_dwordx4 v[40:43], v28, s[36:39], s31 offen offset:0 sc1
    v_lshlrev_b32 v48, 16, v76
    v_and_b32 v49, s48, v76
    v_lshlrev_b32 v50, 16, v77
    v_and_b32 v51, s48, v77
    v_pk_add_f32 v[204:205], v[204:205], v[48:49]
    v_pk_add_f32 v[206:207], v[206:207], v[50:51]
    s_waitcnt vmcnt(3)
    v_lshlrev_b32 v48, 16, v92
    v_and_b32 v49, s48, v92
    v_lshlrev_b32 v50, 16, v93
    v_and_b32 v51, s48, v93
    v_pk_add_f32 v[204:205], v[204:205], v[48:49]
    v_pk_add_f32 v[206:207], v[206:207], v[50:51]
    v_mul_f32 v52, v3, v204
    v_mul_f32 v53, v3, v205
    v_mul_f32 v54, v3, v206
    v_mul_f32 v55, v3, v207
    s_waitcnt vmcnt(3)
    v_lshlrev_b32 v212, 16, v108
    v_and_b32 v213, s48, v108
    v_lshlrev_b32 v214, 16, v109
    v_and_b32 v215, s48, v109
    v_exp_f32 v52, v52
    v_exp_f32 v53, v53
    v_exp_f32 v54, v54
    v_exp_f32 v55, v55
    v_pk_mul_f32 v[204:205], v[204:205], v[212:213]
    v_pk_mul_f32 v[206:207], v[206:207], v[214:215]
    v_fma_f32 v52, v52, v31, v31
    v_fma_f32 v53, v53, v31, v31
    v_fma_f32 v54, v54, v31, v31
    v_fma_f32 v55, v55, v31, v31
    v_lshlrev_b32 v48, 16, v44
    v_and_b32 v49, s48, v44
    v_rcp_f32 v52, v52
    v_rcp_f32 v53, v53
    v_rcp_f32 v54, v54
    v_rcp_f32 v55, v55
    v_lshlrev_b32 v50, 16, v45
    v_and_b32 v51, s48, v45
    v_pk_fma_f32 v[204:205], v[204:205], v[52:53], v[48:49]
    v_pk_fma_f32 v[206:207], v[206:207], v[54:55], v[50:51]
    v_cvt_pk_bf16_f32 v44, v204, v205
    v_cvt_pk_bf16_f32 v45, v206, v207
    v_lshlrev_b32 v56, 16, v78
    v_and_b32 v57, s48, v78
    v_lshlrev_b32 v58, 16, v79
    v_and_b32 v59, s48, v79
    v_pk_add_f32 v[236:237], v[236:237], v[56:57]
    v_pk_add_f32 v[238:239], v[238:239], v[58:59]
    v_lshlrev_b32 v56, 16, v94
    v_and_b32 v57, s48, v94
    v_lshlrev_b32 v58, 16, v95
    v_and_b32 v59, s48, v95
    v_pk_add_f32 v[236:237], v[236:237], v[56:57]
    v_pk_add_f32 v[238:239], v[238:239], v[58:59]
    v_mul_f32 v60, v3, v236
    v_mul_f32 v61, v3, v237
    v_mul_f32 v62, v3, v238
    v_mul_f32 v63, v3, v239
    v_lshlrev_b32 v244, 16, v110
    v_and_b32 v245, s48, v110
    v_lshlrev_b32 v246, 16, v111
    v_and_b32 v247, s48, v111
    v_exp_f32 v60, v60
    v_exp_f32 v61, v61
    v_exp_f32 v62, v62
    v_exp_f32 v63, v63
    v_pk_mul_f32 v[236:237], v[236:237], v[244:245]
    v_pk_mul_f32 v[238:239], v[238:239], v[246:247]
    v_fma_f32 v60, v60, v31, v31
    v_fma_f32 v61, v61, v31, v31
    v_fma_f32 v62, v62, v31, v31
    v_fma_f32 v63, v63, v31, v31
    v_lshlrev_b32 v56, 16, v46
    v_and_b32 v57, s48, v46
    v_rcp_f32 v60, v60
    v_rcp_f32 v61, v61
    v_rcp_f32 v62, v62
    v_rcp_f32 v63, v63
    v_lshlrev_b32 v58, 16, v47
    v_and_b32 v59, s48, v47
    v_pk_fma_f32 v[236:237], v[236:237], v[60:61], v[56:57]
    v_pk_fma_f32 v[238:239], v[238:239], v[62:63], v[58:59]
    v_cvt_pk_bf16_f32 v46, v236, v237
    v_cvt_pk_bf16_f32 v47, v238, v239
    s_add_u32 s31, s40, 98304
    s_nop 0
    v_permlane16_swap_b32 v44, v46
    v_permlane16_swap_b32 v45, v47
    buffer_store_dwordx4 v[44:47], v28, s[36:39], s31 offen offset:64 sc1
    s_endpgm
L_k3_fin2:
    v_mfma_f32_16x16x32_bf16 v[152:155], a[80:83], a[72:75], v[152:155]
    ds_read_b64_tr_b16 a[128:129], v8 offset:0
    v_mfma_f32_16x16x32_bf16 v[156:159], a[80:83], a[76:79], v[156:159]
    ds_read_b64_tr_b16 a[130:131], v8 offset:1024
    s_add_u32 s31, s40, 131072
    buffer_load_dwordx4 v[32:35], v28, s[16:19], s31 offen offset:0
    v_mfma_f32_16x16x32_bf16 v[184:187], a[84:87], a[72:75], v[184:187]
    ds_read_b64_tr_b16 a[132:133], v9 offset:0
    v_mfma_f32_16x16x32_bf16 v[188:191], a[84:87], a[76:79], v[188:191]
    ds_read_b64_tr_b16 a[134:135], v9 offset:1024
    s_add_u32 s31, s40, 131072
    buffer_load_dwordx4 v[36:39], v28, s[16:19], s31 offen offset:64
    v_mfma_f32_16x16x32_bf16 v[216:219], a[88:91], a[72:75], v[216:219]
    ds_read_b64_tr_b16 a[136:137], v10 offset:0
    v_mfma_f32_16x16x32_bf16 v[220:223], a[88:91], a[76:79], v[220:223]
    ds_read_b64_tr_b16 a[138:139], v10 offset:1024
    s_add_u32 s31, s40, 163840
    buffer_load_dwordx4 v[40:43], v28, s[16:19], s31 offen offset:0
    v_mfma_f32_16x16x32_bf16 v[248:251], a[92:95], a[72:75], v[248:251]
    ds_read_b64_tr_b16 a[140:141], v11 offset:0
    v_mfma_f32_16x16x32_bf16 v[252:255], a[92:95], a[76:79], v[252:255]
    ds_read_b64_tr_b16 a[142:143], v11 offset:1024
    s_add_u32 s31, s40, 163840
    buffer_load_dwordx4 v[44:47], v28, s[16:19], s31 offen offset:64
    v_mfma_f32_16x16x32_bf16 v[128:131], a[80:83], a[48:51], v[128:131]
    ds_read_b128 a[120:123], v4 offset:3072
    v_mfma_f32_16x16x32_bf16 v[132:135], a[80:83], a[52:55], v[132:135]
    ds_read_b128 a[124:127], v4 offset:3584
    s_add_u32 s31, s41, 512
    buffer_load_dword v30, v29, s[8:11], s31 offen offset:0
    v_mfma_f32_16x16x32_bf16 v[160:163], a[84:87], a[48:51], v[160:163]
    ds_read_b64_tr_b16 a[176:177], v8 offset:8192
    v_mfma_f32_16x16x32_bf16 v[164:167], a[84:87], a[52:55], v[164:167]
    ds_read_b64_tr_b16 a[178:179], v8 offset:9216
    s_add_u32 s31, s41, 512
    buffer_load_dword v31, v29, s[8:11], s31 offen offset:128
    v_mfma_f32_16x16x32_bf16 v[192:195], a[88:91], a[48:51], v[192:195]
    ds_read_b64_tr_b16 a[180:181], v9 offset:8192
    v_mfma_f32_16x16x32_bf16 v[196:199], a[88:91], a[52:55], v[196:199]
    ds_read_b64_tr_b16 a[182:183], v9 offset:9216
    v_mfma_f32_16x16x32_bf16 v[224:227], a[92:95], a[48:51], v[224:227]
    ds_read_b64_tr_b16 a[184:185], v10 offset:8192
    v_mfma_f32_16x16x32_bf16 v[228:231], a[92:95], a[52:55], v[228:231]
    ds_read_b64_tr_b16 a[186:187], v10 offset:9216
    s_waitcnt lgkmcnt(7)
    v_mfma_f32_16x16x32_bf16 v[152:155], a[128:131], a[120:123], v[152:155]
    ds_read_b64_tr_b16 a[188:189], v11 offset:8192
    s_waitcnt lgkmcnt(7)
    v_mfma_f32_16x16x32_bf16 v[156:159], a[128:131], a[124:127], v[156:159]
    ds_read_b64_tr_b16 a[190:191], v11 offset:9216
    v_mfma_f32_16x16x32_bf16 v[184:187], a[132:135], a[120:123], v[184:187]
    ds_read_b128 a[168:171], v4 offset:19456
    v_mfma_f32_16x16x32_bf16 v[188:191], a[132:135], a[124:127], v[188:191]
    ds_read_b128 a[172:175], v4 offset:19968
    v_mfma_f32_16x16x32_bf16 v[216:219], a[136:139], a[120:123], v[216:219]
    ds_read_b128 a[96:99], v4 offset:0
    v_mfma_f32_16x16x32_bf16 v[220:223], a[136:139], a[124:127], v[220:223]
    ds_read_b128 a[100:103], v4 offset:512
    v_mfma_f32_16x16x32_bf16 v[248:251], a[140:143], a[120:123], v[248:251]
    ds_read_b128 a[144:147], v4 offset:16384
    v_mfma_f32_16x16x32_bf16 v[252:255], a[140:143], a[124:127], v[252:255]
    ds_read_b128 a[148:151], v4 offset:16896
    s_waitcnt lgkmcnt(5)
    v_mfma_f32_16x16x32_bf16 v[152:155], a[176:179], a[168:171], v[152:155]
    ds_read_b128 a[104:107], v4 offset:1024
    s_waitcnt lgkmcnt(5)
    v_mfma_f32_16x16x32_bf16 v[156:159], a[176:179], a[172:175], v[156:159]
    ds_read_b128 a[108:111], v4 offset:1536
    v_mfma_f32_16x16x32_bf16 v[184:187], a[180:183], a[168:171], v[184:187]
    ds_read_b128 a[152:155], v4 offset:17408
    v_mfma_f32_16x16x32_bf16 v[188:191], a[180:183], a[172:175], v[188:191]
    ds_read_b128 a[156:159], v4 offset:17920
    v_mfma_f32_16x16x32_bf16 v[216:219], a[184:187], a[168:171], v[216:219]
    ds_read_b128 a[112:115], v4 offset:2048
    v_mfma_f32_16x16x32_bf16 v[220:223], a[184:187], a[172:175], v[220:223]
    ds_read_b128 a[116:119], v4 offset:2560
    v_mfma_f32_16x16x32_bf16 v[248:251], a[188:191], a[168:171], v[248:251]
    ds_read_b128 a[160:163], v4 offset:18432
    v_mfma_f32_16x16x32_bf16 v[252:255], a[188:191], a[172:175], v[252:255]
    ds_read_b128 a[164:167], v4 offset:18944
    s_waitcnt lgkmcnt(11)
    v_mfma_f32_16x16x32_bf16 v[128:131], a[128:131], a[96:99], v[128:131]
    s_waitcnt lgkmcnt(10)
    v_mfma_f32_16x16x32_bf16 v[132:135], a[128:131], a[100:103], v[132:135]
    v_mfma_f32_16x16x32_bf16 v[160:163], a[132:135], a[96:99], v[160:163]
    v_mfma_f32_16x16x32_bf16 v[164:167], a[132:135], a[100:103], v[164:167]
    v_mfma_f32_16x16x32_bf16 v[192:195], a[136:139], a[96:99], v[192:195]
    v_mfma_f32_16x16x32_bf16 v[196:199], a[136:139], a[100:103], v[196:199]
    s_add_u32 s30, s34, 180224
    v_cvt_pk_bf16_f32 v48, v152, v153
    v_cvt_pk_bf16_f32 v49, v154, v155
    v_mfma_f32_16x16x32_bf16 v[224:227], a[140:143], a[96:99], v[224:227]
    v_cvt_pk_bf16_f32 v50, v184, v185
    v_cvt_pk_bf16_f32 v51, v186, v187
    v_mfma_f32_16x16x32_bf16 v[228:231], a[140:143], a[100:103], v[228:231]
    buffer_store_dwordx4 v[48:51], v1, s[8:11], s30 offen offset:0 sc1
    v_cvt_pk_bf16_f32 v52, v216, v217
    s_waitcnt lgkmcnt(9)
    v_mfma_f32_16x16x32_bf16 v[128:131], a[176:179], a[144:147], v[128:131]
    v_cvt_pk_bf16_f32 v53, v218, v219
    v_cvt_pk_bf16_f32 v54, v248, v249
    s_waitcnt lgkmcnt(8)
    v_mfma_f32_16x16x32_bf16 v[132:135], a[176:179], a[148:151], v[132:135]
    v_cvt_pk_bf16_f32 v55, v250, v251
    buffer_store_dwordx4 v[52:55], v1, s[8:11], s30 offen offset:1024 sc1
    v_mfma_f32_16x16x32_bf16 v[160:163], a[180:183], a[144:147], v[160:163]
    v_cvt_pk_bf16_f32 v56, v156, v157
    v_cvt_pk_bf16_f32 v57, v158, v159
    v_mfma_f32_16x16x32_bf16 v[164:167], a[180:183], a[148:151], v[164:167]
    v_cvt_pk_bf16_f32 v58, v188, v189
    v_cvt_pk_bf16_f32 v59, v190, v191
    v_mfma_f32_16x16x32_bf16 v[192:195], a[184:187], a[144:147], v[192:195]
    buffer_store_dwordx4 v[56:59], v1, s[8:11], s30 offen offset:2048 sc1
    v_cvt_pk_bf16_f32 v60, v220, v221
    v_mfma_f32_16x16x32_bf16 v[196:199], a[184:187], a[148:151], v[196:199]
    v_cvt_pk_bf16_f32 v61, v222, v223
    v_cvt_pk_bf16_f32 v62, v252, v253
    v_mfma_f32_16x16x32_bf16 v[224:227], a[188:191], a[144:147], v[224:227]
    v_cvt_pk_bf16_f32 v63, v254, v255
    buffer_store_dwordx4 v[60:63], v1, s[8:11], s30 offen offset:3072 sc1
    v_mfma_f32_16x16x32_bf16 v[228:231], a[188:191], a[148:151], v[228:231]
    v_mfma_f32_16x16x32_bf16 v[136:139], a[80:83], a[56:59], v[136:139]
    v_mfma_f32_16x16x32_bf16 v[140:143], a[80:83], a[60:63], v[140:143]
    v_mfma_f32_16x16x32_bf16 v[168:171], a[84:87], a[56:59], v[168:171]
    v_mfma_f32_16x16x32_bf16 v[172:175], a[84:87], a[60:63], v[172:175]
    v_mfma_f32_16x16x32_bf16 v[200:203], a[88:91], a[56:59], v[200:203]
    v_mfma_f32_16x16x32_bf16 v[204:207], a[88:91], a[60:63], v[204:207]
    s_add_u32 s30, s34, 131072
    v_cvt_pk_bf16_f32 v48, v128, v129
    v_cvt_pk_bf16_f32 v49, v130, v131
    v_mfma_f32_16x16x32_bf16 v[232:235], a[92:95], a[56:59], v[232:235]
    v_cvt_pk_bf16_f32 v50, v160, v161
    v_cvt_pk_bf16_f32 v51, v162, v163
    v_mfma_f32_16x16x32_bf16 v[236:239], a[92:95], a[60:63], v[236:239]
    buffer_store_dwordx4 v[48:51], v1, s[8:11], s30 offen offset:0 sc1
    v_cvt_pk_bf16_f32 v52, v192, v193
    s_waitcnt lgkmcnt(7)
    v_mfma_f32_16x16x32_bf16 v[136:139], a[128:131], a[104:107], v[136:139]
    v_cvt_pk_bf16_f32 v53, v194, v195
    v_cvt_pk_bf16_f32 v54, v224, v225
    s_waitcnt lgkmcnt(6)
    v_mfma_f32_16x16x32_bf16 v[140:143], a[128:131], a[108:111], v[140:143]
    v_cvt_pk_bf16_f32 v55, v226, v227
    buffer_store_dwordx4 v[52:55], v1, s[8:11], s30 offen offset:1024 sc1
    v_mfma_f32_16x16x32_bf16 v[168:171], a[132:135], a[104:107], v[168:171]
    v_cvt_pk_bf16_f32 v56, v132, v133
    v_cvt_pk_bf16_f32 v57, v134, v135
    v_mfma_f32_16x16x32_bf16 v[172:175], a[132:135], a[108:111], v[172:175]
    v_cvt_pk_bf16_f32 v58, v164, v165
    v_cvt_pk_bf16_f32 v59, v166, v167
    v_mfma_f32_16x16x32_bf16 v[200:203], a[136:139], a[104:107], v[200:203]
    buffer_store_dwordx4 v[56:59], v1, s[8:11], s30 offen offset:2048 sc1
    v_cvt_pk_bf16_f32 v60, v196, v197
    v_mfma_f32_16x16x32_bf16 v[204:207], a[136:139], a[108:111], v[204:207]
    v_cvt_pk_bf16_f32 v61, v198, v199
    v_cvt_pk_bf16_f32 v62, v228, v229
    v_mfma_f32_16x16x32_bf16 v[232:235], a[140:143], a[104:107], v[232:235]
    v_cvt_pk_bf16_f32 v63, v230, v231
    buffer_store_dwordx4 v[60:63], v1, s[8:11], s30 offen offset:3072 sc1
    v_mfma_f32_16x16x32_bf16 v[236:239], a[140:143], a[108:111], v[236:239]
    s_waitcnt lgkmcnt(5)
    v_mfma_f32_16x16x32_bf16 v[136:139], a[176:179], a[152:155], v[136:139]
    s_waitcnt lgkmcnt(4)
    v_mfma_f32_16x16x32_bf16 v[140:143], a[176:179], a[156:159], v[140:143]
    v_mfma_f32_16x16x32_bf16 v[168:171], a[180:183], a[152:155], v[168:171]
    v_mfma_f32_16x16x32_bf16 v[172:175], a[180:183], a[156:159], v[172:175]
    v_mfma_f32_16x16x32_bf16 v[200:203], a[184:187], a[152:155], v[200:203]
    v_mfma_f32_16x16x32_bf16 v[204:207], a[184:187], a[156:159], v[204:207]
    v_mfma_f32_16x16x32_bf16 v[232:235], a[188:191], a[152:155], v[232:235]
    v_mfma_f32_16x16x32_bf16 v[236:239], a[188:191], a[156:159], v[236:239]
    v_mfma_f32_16x16x32_bf16 v[144:147], a[80:83], a[64:67], v[144:147]
    v_mfma_f32_16x16x32_bf16 v[148:151], a[80:83], a[68:71], v[148:151]
    v_mfma_f32_16x16x32_bf16 v[176:179], a[84:87], a[64:67], v[176:179]
    v_mfma_f32_16x16x32_bf16 v[180:183], a[84:87], a[68:71], v[180:183]
    v_mfma_f32_16x16x32_bf16 v[208:211], a[88:91], a[64:67], v[208:211]
    v_mfma_f32_16x16x32_bf16 v[212:215], a[88:91], a[68:71], v[212:215]
    s_add_u32 s30, s34, 147456
    v_cvt_pk_bf16_f32 v48, v136, v137
    v_cvt_pk_bf16_f32 v49, v138, v139
    v_mfma_f32_16x16x32_bf16 v[240:243], a[92:95], a[64:67], v[240:243]
    v_cvt_pk_bf16_f32 v50, v168, v169
    v_cvt_pk_bf16_f32 v51, v170, v171
    v_mfma_f32_16x16x32_bf16 v[244:247], a[92:95], a[68:71], v[244:247]
    buffer_store_dwordx4 v[48:51], v1, s[8:11], s30 offen offset:0 sc1
    v_cvt_pk_bf16_f32 v52, v200, v201
    s_waitcnt lgkmcnt(3)
    v_mfma_f32_16x16x32_bf16 v[144:147], a[128:131], a[112:115], v[144:147]
    v_cvt_pk_bf16_f32 v53, v202, v203
    v_cvt_pk_bf16_f32 v54, v232, v233
    s_waitcnt lgkmcnt(2)
    v_mfma_f32_16x16x32_bf16 v[148:151], a[128:131], a[116:119], v[148:151]
    v_cvt_pk_bf16_f32 v55, v234, v235
    buffer_store_dwordx4 v[52:55], v1, s[8:11], s30 offen offset:1024 sc1
    v_mfma_f32_16x16x32_bf16 v[176:179], a[132:135], a[112:115], v[176:179]
    v_cvt_pk_bf16_f32 v56, v140, v141
    v_cvt_pk_bf16_f32 v57, v142, v143
    v_mfma_f32_16x16x32_bf16 v[180:183], a[132:135], a[116:119], v[180:183]
    v_cvt_pk_bf16_f32 v58, v172, v173
    v_cvt_pk_bf16_f32 v59, v174, v175
    v_mfma_f32_16x16x32_bf16 v[208:211], a[136:139], a[112:115], v[208:211]
    buffer_store_dwordx4 v[56:59], v1, s[8:11], s30 offen offset:2048 sc1
    v_cvt_pk_bf16_f32 v60, v204, v205
    v_mfma_f32_16x16x32_bf16 v[212:215], a[136:139], a[116:119], v[212:215]
    v_cvt_pk_bf16_f32 v61, v206, v207
    v_cvt_pk_bf16_f32 v62, v236, v237
    v_mfma_f32_16x16x32_bf16 v[240:243], a[140:143], a[112:115], v[240:243]
    v_cvt_pk_bf16_f32 v63, v238, v239
    buffer_store_dwordx4 v[60:63], v1, s[8:11], s30 offen offset:3072 sc1
    v_mfma_f32_16x16x32_bf16 v[244:247], a[140:143], a[116:119], v[244:247]
    s_waitcnt lgkmcnt(1)
    v_mfma_f32_16x16x32_bf16 v[144:147], a[176:179], a[160:163], v[144:147]
    s_waitcnt lgkmcnt(0)
    v_mfma_f32_16x16x32_bf16 v[148:151], a[176:179], a[164:167], v[148:151]
    v_mfma_f32_16x16x32_bf16 v[176:179], a[180:183], a[160:163], v[176:179]
    v_mfma_f32_16x16x32_bf16 v[180:183], a[180:183], a[164:167], v[180:183]
    v_mfma_f32_16x16x32_bf16 v[208:211], a[184:187], a[160:163], v[208:211]
    v_mfma_f32_16x16x32_bf16 v[212:215], a[184:187], a[164:167], v[212:215]
    v_mfma_f32_16x16x32_bf16 v[240:243], a[188:191], a[160:163], v[240:243]
    v_mfma_f32_16x16x32_bf16 v[244:247], a[188:191], a[164:167], v[244:247]
    v_mov_b32 v23, 0
    buffer_load_dword v26, v23, s[8:11], s35 offen sc1
    s_waitcnt vmcnt(1)
    v_mov_b32 v22, s97
    v_mov_b32 v23, 0
    v_lshlrev_b32 v24, 9, v20
    s_add_u32 s31, s35, 1024
    s_mov_b64 exec, 1
    buffer_store_dword v22, v23, s[8:11], s31 offen sc1
    s_mov_b64 exec, -1
    s_waitcnt vmcnt(1)
    v_readfirstlane_b32 s46, v26
    s_nop 0
    s_cmp_eq_u32 s46, s97
    s_cselect_b32 s46, 1, 0
    s_cbranch_scc0 L_k3_q2_nos
    s_add_u32 s30, s34, 294912
    buffer_load_dwordx4 v[96:99], v1, s[8:11], s30 offen offset:0 sc1
    buffer_load_dwordx4 v[100:103], v1, s[8:11], s30 offen offset:1024 sc1
    buffer_load_dwordx4 v[104:107], v1, s[8:11], s30 offen offset:2048 sc1
    buffer_load_dwordx4 v[108:111], v1, s[8:11], s30 offen offset:3072 sc1
L_k3_q2_nos:
    s_mov_b64 exec, 11
    s_mov_b32 s31, 0
L_k3_q2_poll:
    buffer_load_dword v25, v24, s[8:11], s35 offen sc1
    s_waitcnt vmcnt(0)
    v_cmp_eq_u32 vcc, s97, v25
    s_add_u32 s31, s31, 1
    s_cmp_gt_u32 s31, 0x40000
    s_cbranch_scc1 L_k3_q2_got
    s_cmp_eq_u32 vcc_lo, 11
    s_cbranch_scc0 L_k3_q2_poll
L_k3_q2_got:
    s_mov_b64 exec, -1
    s_add_u32 s30, s34, 98304
    buffer_load_dwordx4 v[64:67], v1, s[8:11], s30 offen offset:0 sc1
    buffer_load_dwordx4 v[68:71], v1, s[8:11], s30 offen offset:1024 sc1
    buffer_load_dwordx4 v[72:75], v1, s[8:11], s30 offen offset:2048 sc1
    buffer_load_dwordx4 v[76:79], v1, s[8:11], s30 offen offset:3072 sc1
    s_add_u32 s30, s34, 229376
    buffer_load_dwordx4 v[80:83], v1, s[8:11], s30 offen offset:0 sc1
    buffer_load_dwordx4 v[84:87], v1, s[8:11], s30 offen offset:1024 sc1
    buffer_load_dwordx4 v[88:91], v1, s[8:11], s30 offen offset:2048 sc1
    buffer_load_dwordx4 v[92:95], v1, s[8:11], s30 offen offset:3072 sc1
    s_cmp_eq_u32 s46, 1
    s_cbranch_scc1 L_k3_q2_haves
    s_add_u32 s30, s34, 294912
    buffer_load_dwordx4 v[96:99], v1, s[8:11], s30 offen offset:0 sc1
    buffer_load_dwordx4 v[100:103], v1, s[8:11], s30 offen offset:1024 sc1
    buffer_load_dwordx4 v[104:107], v1, s[8:11], s30 offen offset:2048 sc1
    buffer_load_dwordx4 v[108:111], v1, s[8:11], s30 offen offset:3072 sc1
L_k3_q2_haves:
    s_mov_b32 s47, 0xbfb8aa3b
    s_mov_b32 s48, 0xffff0000
    v_mul_f32 v30, v30, v30
    v_mul_f32 v2, s47, v30
    v_rcp_f32 v30, v30
    v_mul_f32 v31, v31, v31
    v_mul_f32 v3, s47, v31
    v_rcp_f32 v31, v31
    v_permlane16_swap_b32 v32, v34
    v_permlane16_swap_b32 v33, v35
    v_permlane16_swap_b32 v36, v38
    v_permlane16_swap_b32 v37, v39
    v_permlane16_swap_b32 v40, v42
    v_permlane16_swap_b32 v41, v43
    v_permlane16_swap_b32 v44, v46
    v_permlane16_swap_b32 v45, v47
    s_waitcnt vmcnt(7)
    v_lshlrev_b32 v48, 16, v64
    v_and_b32 v49, s48, v64
    v_lshlrev_b32 v50, 16, v65
    v_and_b32 v51, s48, v65
    v_pk_add_f32 v[144:145], v[144:145], v[48:49]
    v_pk_add_f32 v[146:147], v[146:147], v[50:51]
    s_waitcnt vmcnt(3)
    v_lshlrev_b32 v48, 16, v80
    v_and_b32 v49, s48, v80
    v_lshlrev_b32 v50, 16, v81
    v_and_b32 v51, s48, v81
    v_pk_add_f32 v[144:145], v[144:145], v[48:49]
    v_pk_add_f32 v[146:147], v[146:147], v[50:51]
    v_mul_f32 v52, v2, v144
    v_mul_f32 v53, v2, v145
    v_mul_f32 v54, v2, v146
    v_mul_f32 v55, v2, v147
    s_waitcnt vmcnt(3)
    v_lshlrev_b32 v152, 16, v96
    v_and_b32 v153, s48, v96
    v_lshlrev_b32 v154, 16, v97
    v_and_b32 v155, s48, v97
    v_exp_f32 v52, v52
    v_exp_f32 v53, v53
    v_exp_f32 v54, v54
    v_exp_f32 v55, v55
    v_pk_mul_f32 v[144:145], v[144:145], v[152:153]
    v_pk_mul_f32 v[146:147], v[146:147], v[154:155]
    v_fma_f32 v52, v52, v30, v30
    v_fma_f32 v53, v53, v30, v30
    v_fma_f32 v54, v54, v30, v30
    v_fma_f32 v55, v55, v30, v30
    v_lshlrev_b32 v48, 16, v32
    v_and_b32 v49, s48, v32
    v_rcp_f32 v52, v52
    v_rcp_f32 v53, v53
    v_rcp_f32 v54, v54
    v_rcp_f32 v55, v55
    v_lshlrev_b32 v50, 16, v33
    v_and_b32 v51, s48, v33
    v_pk_fma_f32 v[144:145], v[144:145], v[52:53], v[48:49]
    v_pk_fma_f32 v[146:147], v[146:147], v[54:55], v[50:51]
    v_cvt_pk_bf16_f32 v32, v144, v145
    v_cvt_pk_bf16_f32 v33, v146, v147
    v_lshlrev_b32 v56, 16, v66
    v_and_b32 v57, s48, v66
    v_lshlrev_b32 v58, 16, v67
    v_and_b32 v59, s48, v67
    v_pk_add_f32 v[176:177], v[176:177], v[56:57]
    v_pk_add_f32 v[178:179], v[178:179], v[58:59]
    v_lshlrev_b32 v56, 16, v82
    v_and_b32 v57, s48, v82
    v_lshlrev_b32 v58, 16, v83
    v_and_b32 v59, s48, v83
    v_pk_add_f32 v[176:177], v[176:177], v[56:57]
    v_pk_add_f32 v[178:179], v[178:179], v[58:59]
    v_mul_f32 v60, v2, v176
    v_mul_f32 v61, v2, v177
    v_mul_f32 v62, v2, v178
    v_mul_f32 v63, v2, v179
    v_lshlrev_b32 v184, 16, v98
    v_and_b32 v185, s48, v98
    v_lshlrev_b32 v186, 16, v99
    v_and_b32 v187, s48, v99
    v_exp_f32 v60, v60
    v_exp_f32 v61, v61
    v_exp_f32 v62, v62
    v_exp_f32 v63, v63
    v_pk_mul_f32 v[176:177], v[176:177], v[184:185]
    v_pk_mul_f32 v[178:179], v[178:179], v[186:187]
    v_fma_f32 v60, v60, v30, v30
    v_fma_f32 v61, v61, v30, v30
    v_fma_f32 v62, v62, v30, v30
    v_fma_f32 v63, v63, v30, v30
    v_lshlrev_b32 v56, 16, v34
    v_and_b32 v57, s48, v34
    v_rcp_f32 v60, v60
    v_rcp_f32 v61, v61
    v_rcp_f32 v62, v62
    v_rcp_f32 v63, v63
    v_lshlrev_b32 v58, 16, v35
    v_and_b32 v59, s48, v35
    v_pk_fma_f32 v[176:177], v[176:177], v[60:61], v[56:57]
    v_pk_fma_f32 v[178:179], v[178:179], v[62:63], v[58:59]
    v_cvt_pk_bf16_f32 v34, v176, v177
    v_cvt_pk_bf16_f32 v35, v178, v179
    s_add_u32 s31, s40, 131072
    s_nop 0
    v_permlane16_swap_b32 v32, v34
    v_permlane16_swap_b32 v33, v35
    buffer_store_dwordx4 v[32:35], v28, s[36:39], s31 offen offset:0 sc1
    v_lshlrev_b32 v48, 16, v68
    v_and_b32 v49, s48, v68
    v_lshlrev_b32 v50, 16, v69
    v_and_b32 v51, s48, v69
    v_pk_add_f32 v[208:209], v[208:209], v[48:49]
    v_pk_add_f32 v[210:211], v[210:211], v[50:51]
    s_waitcnt vmcnt(3)
    v_lshlrev_b32 v48, 16, v84
    v_and_b32 v49, s48, v84
    v_lshlrev_b32 v50, 16, v85
    v_and_b32 v51, s48, v85
    v_pk_add_f32 v[208:209], v[208:209], v[48:49]
    v_pk_add_f32 v[210:211], v[210:211], v[50:51]
    v_mul_f32 v52, v2, v208
    v_mul_f32 v53, v2, v209
    v_mul_f32 v54, v2, v210
    v_mul_f32 v55, v2, v211
    s_waitcnt vmcnt(3)
    v_lshlrev_b32 v216, 16, v100
    v_and_b32 v217, s48, v100
    v_lshlrev_b32 v218, 16, v101
    v_and_b32 v219, s48, v101
    v_exp_f32 v52, v52
    v_exp_f32 v53, v53
    v_exp_f32 v54, v54
    v_exp_f32 v55, v55
    v_pk_mul_f32 v[208:209], v[208:209], v[216:217]
    v_pk_mul_f32 v[210:211], v[210:211], v[218:219]
    v_fma_f32 v52, v52, v30, v30
    v_fma_f32 v53, v53, v30, v30
    v_fma_f32 v54, v54, v30, v30
    v_fma_f32 v55, v55, v30, v30
    v_lshlrev_b32 v48, 16, v36
    v_and_b32 v49, s48, v36
    v_rcp_f32 v52, v52
    v_rcp_f32 v53, v53
    v_rcp_f32 v54, v54
    v_rcp_f32 v55, v55
    v_lshlrev_b32 v50, 16, v37
    v_and_b32 v51, s48, v37
    v_pk_fma_f32 v[208:209], v[208:209], v[52:53], v[48:49]
    v_pk_fma_f32 v[210:211], v[210:211], v[54:55], v[50:51]
    v_cvt_pk_bf16_f32 v36, v208, v209
    v_cvt_pk_bf16_f32 v37, v210, v211
    v_lshlrev_b32 v56, 16, v70
    v_and_b32 v57, s48, v70
    v_lshlrev_b32 v58, 16, v71
    v_and_b32 v59, s48, v71
    v_pk_add_f32 v[240:241], v[240:241], v[56:57]
    v_pk_add_f32 v[242:243], v[242:243], v[58:59]
    v_lshlrev_b32 v56, 16, v86
    v_and_b32 v57, s48, v86
    v_lshlrev_b32 v58, 16, v87
    v_and_b32 v59, s48, v87
    v_pk_add_f32 v[240:241], v[240:241], v[56:57]
    v_pk_add_f32 v[242:243], v[242:243], v[58:59]
    v_mul_f32 v60, v2, v240
    v_mul_f32 v61, v2, v241
    v_mul_f32 v62, v2, v242
    v_mul_f32 v63, v2, v243
    v_lshlrev_b32 v248, 16, v102
    v_and_b32 v249, s48, v102
    v_lshlrev_b32 v250, 16, v103
    v_and_b32 v251, s48, v103
    v_exp_f32 v60, v60
    v_exp_f32 v61, v61
    v_exp_f32 v62, v62
    v_exp_f32 v63, v63
    v_pk_mul_f32 v[240:241], v[240:241], v[248:249]
    v_pk_mul_f32 v[242:243], v[242:243], v[250:251]
    v_fma_f32 v60, v60, v30, v30
    v_fma_f32 v61, v61, v30, v30
    v_fma_f32 v62, v62, v30, v30
    v_fma_f32 v63, v63, v30, v30
    v_lshlrev_b32 v56, 16, v38
    v_and_b32 v57, s48, v38
    v_rcp_f32 v60, v60
    v_rcp_f32 v61, v61
    v_rcp_f32 v62, v62
    v_rcp_f32 v63, v63
    v_lshlrev_b32 v58, 16, v39
    v_and_b32 v59, s48, v39
    v_pk_fma_f32 v[240:241], v[240:241], v[60:61], v[56:57]
    v_pk_fma_f32 v[242:243], v[242:243], v[62:63], v[58:59]
    v_cvt_pk_bf16_f32 v38, v240, v241
    v_cvt_pk_bf16_f32 v39, v242, v243
    s_add_u32 s31, s40, 131072
    s_nop 0
    v_permlane16_swap_b32 v36, v38
    v_permlane16_swap_b32 v37, v39
    buffer_store_dwordx4 v[36:39], v28, s[36:39], s31 offen offset:64 sc1
    v_lshlrev_b32 v48, 16, v72
    v_and_b32 v49, s48, v72
    v_lshlrev_b32 v50, 16, v73
    v_and_b32 v51, s48, v73
    v_pk_add_f32 v[148:149], v[148:149], v[48:49]
    v_pk_add_f32 v[150:151], v[150:151], v[50:51]
    s_waitcnt vmcnt(3)
    v_lshlrev_b32 v48, 16, v88
    v_and_b32 v49, s48, v88
    v_lshlrev_b32 v50, 16, v89
    v_and_b32 v51, s48, v89
    v_pk_add_f32 v[148:149], v[148:149], v[48:49]
    v_pk_add_f32 v[150:151], v[150:151], v[50:51]
    v_mul_f32 v52, v3, v148
    v_mul_f32 v53, v3, v149
    v_mul_f32 v54, v3, v150
    v_mul_f32 v55, v3, v151
    s_waitcnt vmcnt(3)
    v_lshlrev_b32 v156, 16, v104
    v_and_b32 v157, s48, v104
    v_lshlrev_b32 v158, 16, v105
    v_and_b32 v159, s48, v105
    v_exp_f32 v52, v52
    v_exp_f32 v53, v53
    v_exp_f32 v54, v54
    v_exp_f32 v55, v55
    v_pk_mul_f32 v[148:149], v[148:149], v[156:157]
    v_pk_mul_f32 v[150:151], v[150:151], v[158:159]
    v_fma_f32 v52, v52, v31, v31
    v_fma_f32 v53, v53, v31, v31
    v_fma_f32 v54, v54, v31, v31
    v_fma_f32 v55, v55, v31, v31
    v_lshlrev_b32 v48, 16, v40
    v_and_b32 v49, s48, v40
    v_rcp_f32 v52, v52
    v_rcp_f32 v53, v53
    v_rcp_f32 v54, v54
    v_rcp_f32 v55, v55
    v_lshlrev_b32 v50, 16, v41
    v_and_b32 v51, s48, v41
    v_pk_fma_f32 v[148:149], v[148:149], v[52:53], v[48:49]
    v_pk_fma_f32 v[150:151], v[150:151], v[54:55], v[50:51]
    v_cvt_pk_bf16_f32 v40, v148, v149
    v_cvt_pk_bf16_f32 v41, v150, v151
    v_lshlrev_b32 v56, 16, v74
    v_and_b32 v57, s48, v74
    v_lshlrev_b32 v58, 16, v75
    v_and_b32 v59, s48, v75
    v_pk_add_f32 v[180:181], v[180:181], v[56:57]
    v_pk_add_f32 v[182:183], v[182:183], v[58:59]
    v_lshlrev_b32 v56, 16, v90
    v_and_b32 v57, s48, v90
    v_lshlrev_b32 v58, 16, v91
    v_and_b32 v59, s48, v91
    v_pk_add_f32 v[180:181], v[180:181], v[56:57]
    v_pk_add_f32 v[182:183], v[182:183], v[58:59]
    v_mul_f32 v60, v3, v180
    v_mul_f32 v61, v3, v181
    v_mul_f32 v62, v3, v182
    v_mul_f32 v63, v3, v183
    v_lshlrev_b32 v188, 16, v106
    v_and_b32 v189, s48, v106
    v_lshlrev_b32 v190, 16, v107
    v_and_b32 v191, s48, v107
    v_exp_f32 v60, v60
    v_exp_f32 v61, v61
    v_exp_f32 v62, v62
    v_exp_f32 v63, v63
    v_pk_mul_f32 v[180:181], v[180:181], v[188:189]
    v_pk_mul_f32 v[182:183], v[182:183], v[190:191]
    v_fma_f32 v60, v60, v31, v31
    v_fma_f32 v61, v61, v31, v31
    v_fma_f32 v62, v62, v31, v31
    v_fma_f32 v63, v63, v31, v31
    v_lshlrev_b32 v56, 16, v42
    v_and_b32 v57, s48, v42
    v_rcp_f32 v60, v60
    v_rcp_f32 v61, v61
    v_rcp_f32 v62, v62
    v_rcp_f32 v63, v63
    v_lshlrev_b32 v58, 16, v43
    v_and_b32 v59, s48, v43
    v_pk_fma_f32 v[180:181], v[180:181], v[60:61], v[56:57]
    v_pk_fma_f32 v[182:183], v[182:183], v[62:63], v[58:59]
    v_cvt_pk_bf16_f32 v42, v180, v181
    v_cvt_pk_bf16_f32 v43, v182, v183
    s_add_u32 s31, s40, 163840
    s_nop 0
    v_permlane16_swap_b32 v40, v42
    v_permlane16_swap_b32 v41, v43
    buffer_store_dwordx4 v[40:43], v28, s[36:39], s31 offen offset:0 sc1
    v_lshlrev_b32 v48, 16, v76
    v_and_b32 v49, s48, v76
    v_lshlrev_b32 v50, 16, v77
    v_and_b32 v51, s48, v77
    v_pk_add_f32 v[212:213], v[212:213], v[48:49]
    v_pk_add_f32 v[214:215], v[214:215], v[50:51]
    s_waitcnt vmcnt(3)
    v_lshlrev_b32 v48, 16, v92
    v_and_b32 v49, s48, v92
    v_lshlrev_b32 v50, 16, v93
    v_and_b32 v51, s48, v93
    v_pk_add_f32 v[212:213], v[212:213], v[48:49]
    v_pk_add_f32 v[214:215], v[214:215], v[50:51]
    v_mul_f32 v52, v3, v212
    v_mul_f32 v53, v3, v213
    v_mul_f32 v54, v3, v214
    v_mul_f32 v55, v3, v215
    s_waitcnt vmcnt(3)
    v_lshlrev_b32 v220, 16, v108
    v_and_b32 v221, s48, v108
    v_lshlrev_b32 v222, 16, v109
    v_and_b32 v223, s48, v109
    v_exp_f32 v52, v52
    v_exp_f32 v53, v53
    v_exp_f32 v54, v54
    v_exp_f32 v55, v55
    v_pk_mul_f32 v[212:213], v[212:213], v[220:221]
    v_pk_mul_f32 v[214:215], v[214:215], v[222:223]
    v_fma_f32 v52, v52, v31, v31
    v_fma_f32 v53, v53, v31, v31
    v_fma_f32 v54, v54, v31, v31
    v_fma_f32 v55, v55, v31, v31
    v_lshlrev_b32 v48, 16, v44
    v_and_b32 v49, s48, v44
    v_rcp_f32 v52, v52
    v_rcp_f32 v53, v53
    v_rcp_f32 v54, v54
    v_rcp_f32 v55, v55
    v_lshlrev_b32 v50, 16, v45
    v_and_b32 v51, s48, v45
    v_pk_fma_f32 v[212:213], v[212:213], v[52:53], v[48:49]
    v_pk_fma_f32 v[214:215], v[214:215], v[54:55], v[50:51]
    v_cvt_pk_bf16_f32 v44, v212, v213
    v_cvt_pk_bf16_f32 v45, v214, v215
    v_lshlrev_b32 v56, 16, v78
    v_and_b32 v57, s48, v78
    v_lshlrev_b32 v58, 16, v79
    v_and_b32 v59, s48, v79
    v_pk_add_f32 v[244:245], v[244:245], v[56:57]
    v_pk_add_f32 v[246:247], v[246:247], v[58:59]
    v_lshlrev_b32 v56, 16, v94
    v_and_b32 v57, s48, v94
    v_lshlrev_b32 v58, 16, v95
    v_and_b32 v59, s48, v95
    v_pk_add_f32 v[244:245], v[244:245], v[56:57]
    v_pk_add_f32 v[246:247], v[246:247], v[58:59]
    v_mul_f32 v60, v3, v244
    v_mul_f32 v61, v3, v245
    v_mul_f32 v62, v3, v246
    v_mul_f32 v63, v3, v247
    v_lshlrev_b32 v252, 16, v110
    v_and_b32 v253, s48, v110
    v_lshlrev_b32 v254, 16, v111
    v_and_b32 v255, s48, v111
    v_exp_f32 v60, v60
    v_exp_f32 v61, v61
    v_exp_f32 v62, v62
    v_exp_f32 v63, v63
    v_pk_mul_f32 v[244:245], v[244:245], v[252:253]
    v_pk_mul_f32 v[246:247], v[246:247], v[254:255]
    v_fma_f32 v60, v60, v31, v31
    v_fma_f32 v61, v61, v31, v31
    v_fma_f32 v62, v62, v31, v31
    v_fma_f32 v63, v63, v31, v31
    v_lshlrev_b32 v56, 16, v46
    v_and_b32 v57, s48, v46
    v_rcp_f32 v60, v60
    v_rcp_f32 v61, v61
    v_rcp_f32 v62, v62
    v_rcp_f32 v63, v63
    v_lshlrev_b32 v58, 16, v47
    v_and_b32 v59, s48, v47
    v_pk_fma_f32 v[244:245], v[244:245], v[60:61], v[56:57]
    v_pk_fma_f32 v[246:247], v[246:247], v[62:63], v[58:59]
    v_cvt_pk_bf16_f32 v46, v244, v245
    v_cvt_pk_bf16_f32 v47, v246, v247
    s_add_u32 s31, s40, 163840
    s_nop 0
    v_permlane16_swap_b32 v44, v46
    v_permlane16_swap_b32 v45, v47
    buffer_store_dwordx4 v[44:47], v28, s[36:39], s31 offen offset:64 sc1
    s_endpgm
L_k3_last3:
    s_waitcnt lgkmcnt(13)
    v_mfma_f32_16x16x32_bf16 v[128:131], a[32:35], a[0:3], v[128:131]
    ds_read_b64_tr_b16 a[80:81], v8 offset:8192
    s_waitcnt lgkmcnt(13)
    v_mfma_f32_16x16x32_bf16 v[132:135], a[32:35], a[4:7], v[132:135]
    ds_read_b64_tr_b16 a[82:83], v8 offset:9216
    s_waitcnt lgkmcnt(13)
    v_mfma_f32_16x16x32_bf16 v[136:139], a[32:35], a[8:11], v[136:139]
    ds_read_b128 a[48:51], v4 offset:16384
    buffer_load_dwordx4 v1, s[8:11], s25 offen offset:2048 lds
    s_waitcnt lgkmcnt(13)
    v_mfma_f32_16x16x32_bf16 v[140:143], a[32:35], a[12:15], v[140:143]
    ds_read_b128 a[52:55], v4 offset:16896
    s_waitcnt lgkmcnt(13)
    v_mfma_f32_16x16x32_bf16 v[144:147], a[32:35], a[16:19], v[144:147]
    ds_read_b128 a[56:59], v4 offset:17408
    s_waitcnt lgkmcnt(13)
    v_mfma_f32_16x16x32_bf16 v[148:151], a[32:35], a[20:23], v[148:151]
    ds_read_b128 a[60:63], v4 offset:17920
    s_waitcnt lgkmcnt(13)
    v_mfma_f32_16x16x32_bf16 v[152:155], a[32:35], a[24:27], v[152:155]
    ds_read_b128 a[64:67], v4 offset:18432
    s_waitcnt lgkmcnt(13)
    v_mfma_f32_16x16x32_bf16 v[156:159], a[32:35], a[28:31], v[156:159]
    ds_read_b128 a[68:71], v4 offset:18944
    buffer_load_dwordx4 v1, s[8:11], s25 offen offset:3072 lds
    s_waitcnt lgkmcnt(12)
    v_mfma_f32_16x16x32_bf16 v[160:163], a[36:39], a[0:3], v[160:163]
    s_add_u32 s25, s25, 4096
    ds_read_b128 a[72:75], v4 offset:19456
    v_mfma_f32_16x16x32_bf16 v[164:167], a[36:39], a[4:7], v[164:167]
    ds_read_b128 a[76:79], v4 offset:19968
    v_mfma_f32_16x16x32_bf16 v[168:171], a[36:39], a[8:11], v[168:171]
    ds_read_b64_tr_b16 a[84:85], v9 offset:8192
    v_mfma_f32_16x16x32_bf16 v[172:175], a[36:39], a[12:15], v[172:175]
    s_add_u32 m0, s28, 102400
    ds_read_b64_tr_b16 a[86:87], v9 offset:9216
    v_mfma_f32_16x16x32_bf16 v[176:179], a[36:39], a[16:19], v[176:179]
    ds_read_b64_tr_b16 a[88:89], v10 offset:8192
    buffer_load_dwordx4 v1, s[8:11], s25 offen offset:0 lds
    v_mfma_f32_16x16x32_bf16 v[180:183], a[36:39], a[20:23], v[180:183]
    ds_read_b64_tr_b16 a[90:91], v10 offset:9216
    v_mfma_f32_16x16x32_bf16 v[184:187], a[36:39], a[24:27], v[184:187]
    ds_read_b64_tr_b16 a[92:93], v11 offset:8192
    v_mfma_f32_16x16x32_bf16 v[188:191], a[36:39], a[28:31], v[188:191]
    ds_read_b64_tr_b16 a[94:95], v11 offset:9216
    s_waitcnt lgkmcnt(15)
    v_mfma_f32_16x16x32_bf16 v[192:195], a[40:43], a[0:3], v[192:195]
    v_mfma_f32_16x16x32_bf16 v[196:199], a[40:43], a[4:7], v[196:199]
    buffer_load_dwordx4 v1, s[8:11], s25 offen offset:1024 lds
    v_mfma_f32_16x16x32_bf16 v[200:203], a[40:43], a[8:11], v[200:203]
    v_mfma_f32_16x16x32_bf16 v[204:207], a[40:43], a[12:15], v[204:207]
    v_mfma_f32_16x16x32_bf16 v[208:211], a[40:43], a[16:19], v[208:211]
    v_mfma_f32_16x16x32_bf16 v[212:215], a[40:43], a[20:23], v[212:215]
    v_mfma_f32_16x16x32_bf16 v[216:219], a[40:43], a[24:27], v[216:219]
    buffer_load_dwordx4 v1, s[8:11], s25 offen offset:2048 lds
    v_mfma_f32_16x16x32_bf16 v[220:223], a[40:43], a[28:31], v[220:223]
    s_waitcnt lgkmcnt(15)
    v_mfma_f32_16x16x32_bf16 v[224:227], a[44:47], a[0:3], v[224:227]
    v_mfma_f32_16x16x32_bf16 v[228:231], a[44:47], a[4:7], v[228:231]
    v_mfma_f32_16x16x32_bf16 v[232:235], a[44:47], a[8:11], v[232:235]
    v_mfma_f32_16x16x32_bf16 v[236:239], a[44:47], a[12:15], v[236:239]
    buffer_load_dwordx4 v1, s[8:11], s25 offen offset:3072 lds
    v_mfma_f32_16x16x32_bf16 v[240:243], a[44:47], a[16:19], v[240:243]
    s_add_u32 s25, s25, 258048
    v_mfma_f32_16x16x32_bf16 v[244:247], a[44:47], a[20:23], v[244:247]
    v_mfma_f32_16x16x32_bf16 v[248:251], a[44:47], a[24:27], v[248:251]
    v_mfma_f32_16x16x32_bf16 v[252:255], a[44:47], a[28:31], v[252:255]
    s_waitcnt vmcnt(12) lgkmcnt(0)
    s_barrier
    v_mfma_f32_16x16x32_bf16 v[128:131], a[80:83], a[48:51], v[128:131]
    ds_read_b64_tr_b16 a[32:33], v12 offset:0
    v_mfma_f32_16x16x32_bf16 v[132:135], a[80:83], a[52:55], v[132:135]
    ds_read_b64_tr_b16 a[34:35], v12 offset:1024
    v_mfma_f32_16x16x32_bf16 v[136:139], a[80:83], a[56:59], v[136:139]
    ds_read_b128 a[0:3], v5 offset:0
    v_mfma_f32_16x16x32_bf16 v[140:143], a[80:83], a[60:63], v[140:143]
    ds_read_b128 a[4:7], v5 offset:512
    v_mfma_f32_16x16x32_bf16 v[144:147], a[80:83], a[64:67], v[144:147]
    ds_read_b128 a[8:11], v5 offset:1024
    v_mfma_f32_16x16x32_bf16 v[148:151], a[80:83], a[68:71], v[148:151]
    ds_read_b128 a[12:15], v5 offset:1536
    v_mfma_f32_16x16x32_bf16 v[152:155], a[80:83], a[72:75], v[152:155]
    ds_read_b128 a[16:19], v5 offset:2048
    v_mfma_f32_16x16x32_bf16 v[156:159], a[80:83], a[76:79], v[156:159]
    ds_read_b128 a[20:23], v5 offset:2560
    v_mfma_f32_16x16x32_bf16 v[160:163], a[84:87], a[48:51], v[160:163]
    ds_read_b128 a[24:27], v5 offset:3072
    v_mfma_f32_16x16x32_bf16 v[164:167], a[84:87], a[52:55], v[164:167]
    ds_read_b128 a[28:31], v5 offset:3584
    v_mfma_f32_16x16x32_bf16 v[168:171], a[84:87], a[56:59], v[168:171]
    ds_read_b64_tr_b16 a[36:37], v13 offset:0
    v_mfma_f32_16x16x32_bf16 v[172:175], a[84:87], a[60:63], v[172:175]
    ds_read_b64_tr_b16 a[38:39], v13 offset:1024
    v_mfma_f32_16x16x32_bf16 v[176:179], a[84:87], a[64:67], v[176:179]
    ds_read_b64_tr_b16 a[40:41], v14 offset:0
    v_mfma_f32_16x16x32_bf16 v[180:183], a[84:87], a[68:71], v[180:183]
    ds_read_b64_tr_b16 a[42:43], v14 offset:1024
    v_mfma_f32_16x16x32_bf16 v[184:187], a[84:87], a[72:75], v[184:187]
    ds_read_b64_tr_b16 a[44:45], v15 offset:0
    v_mfma_f32_16x16x32_bf16 v[188:191], a[84:87], a[76:79], v[188:191]
    ds_read_b64_tr_b16 a[46:47], v15 offset:1024
    v_mfma_f32_16x16x32_bf16 v[192:195], a[88:91], a[48:51], v[192:195]
    v_mfma_f32_16x16x32_bf16 v[196:199], a[88:91], a[52:55], v[196:199]
    v_mfma_f32_16x16x32_bf16 v[200:203], a[88:91], a[56:59], v[200:203]
    v_mfma_f32_16x16x32_bf16 v[204:207], a[88:91], a[60:63], v[204:207]
    v_mfma_f32_16x16x32_bf16 v[208:211], a[88:91], a[64:67], v[208:211]
    v_mfma_f32_16x16x32_bf16 v[212:215], a[88:91], a[68:71], v[212:215]
    v_mfma_f32_16x16x32_bf16 v[216:219], a[88:91], a[72:75], v[216:219]
    v_mfma_f32_16x16x32_bf16 v[220:223], a[88:91], a[76:79], v[220:223]
    v_mfma_f32_16x16x32_bf16 v[224:227], a[92:95], a[48:51], v[224:227]
    v_mfma_f32_16x16x32_bf16 v[228:231], a[92:95], a[52:55], v[228:231]
    v_mfma_f32_16x16x32_bf16 v[232:235], a[92:95], a[56:59], v[232:235]
    v_mfma_f32_16x16x32_bf16 v[236:239], a[92:95], a[60:63], v[236:239]
    v_mfma_f32_16x16x32_bf16 v[240:243], a[92:95], a[64:67], v[240:243]
    v_mfma_f32_16x16x32_bf16 v[244:247], a[92:95], a[68:71], v[244:247]
    v_mfma_f32_16x16x32_bf16 v[248:251], a[92:95], a[72:75], v[248:251]
    v_mfma_f32_16x16x32_bf16 v[252:255], a[92:95], a[76:79], v[252:255]
    s_waitcnt lgkmcnt(13)
    v_mfma_f32_16x16x32_bf16 v[128:131], a[32:35], a[0:3], v[128:131]
    ds_read_b64_tr_b16 a[80:81], v12 offset:8192
    s_waitcnt lgkmcnt(13)
    v_mfma_f32_16x16x32_bf16 v[132:135], a[32:35], a[4:7], v[132:135]
    ds_read_b64_tr_b16 a[82:83], v12 offset:9216
    s_waitcnt lgkmcnt(13)
    v_mfma_f32_16x16x32_bf16 v[136:139], a[32:35], a[8:11], v[136:139]
    ds_read_b128 a[48:51], v5 offset:16384
    s_waitcnt lgkmcnt(13)
    v_mfma_f32_16x16x32_bf16 v[140:143], a[32:35], a[12:15], v[140:143]
    ds_read_b128 a[52:55], v5 offset:16896
    s_waitcnt lgkmcnt(13)
    v_mfma_f32_16x16x32_bf16 v[144:147], a[32:35], a[16:19], v[144:147]
    ds_read_b128 a[56:59], v5 offset:17408
    s_waitcnt lgkmcnt(13)
    v_mfma_f32_16x16x32_bf16 v[148:151], a[32:35], a[20:23], v[148:151]
    ds_read_b128 a[60:63], v5 offset:17920
    s_waitcnt lgkmcnt(13)
    v_mfma_f32_16x16x32_bf16 v[152:155], a[32:35], a[24:27], v[152:155]
    ds_read_b128 a[64:67], v5 offset:18432
    s_waitcnt lgkmcnt(13)
    v_mfma_f32_16x16x32_bf16 v[156:159], a[32:35], a[28:31], v[156:159]
    ds_read_b128 a[68:71], v5 offset:18944
    s_waitcnt lgkmcnt(12)
    v_mfma_f32_16x16x32_bf16 v[160:163], a[36:39], a[0:3], v[160:163]
    ds_read_b128 a[72:75], v5 offset:19456
    v_mfma_f32_16x16x32_bf16 v[164:167], a[36:39], a[4:7], v[164:167]
    ds_read_b128 a[76:79], v5 offset:19968
    v_mfma_f32_16x16x32_bf16 v[168:171], a[36:39], a[8:11], v[168:171]
    ds_read_b64_tr_b16 a[84:85], v13 offset:8192
    v_mfma_f32_16x16x32_bf16 v[172:175], a[36:39], a[12:15], v[172:175]
    ds_read_b64_tr_b16 a[86:87], v13 offset:9216
    v_mfma_f32_16x16x32_bf16 v[176:179], a[36:39], a[16:19], v[176:179]
    ds_read_b64_tr_b16 a[88:89], v14 offset:8192
    v_mfma_f32_16x16x32_bf16 v[180:183], a[36:39], a[20:23], v[180:183]
    ds_read_b64_tr_b16 a[90:91], v14 offset:9216
    v_mfma_f32_16x16x32_bf16 v[184:187], a[36:39], a[24:27], v[184:187]
    ds_read_b64_tr_b16 a[92:93], v15 offset:8192
    v_mfma_f32_16x16x32_bf16 v[188:191], a[36:39], a[28:31], v[188:191]
    ds_read_b64_tr_b16 a[94:95], v15 offset:9216
    s_waitcnt lgkmcnt(15)
    v_mfma_f32_16x16x32_bf16 v[192:195], a[40:43], a[0:3], v[192:195]
    v_mfma_f32_16x16x32_bf16 v[196:199], a[40:43], a[4:7], v[196:199]
    v_mfma_f32_16x16x32_bf16 v[200:203], a[40:43], a[8:11], v[200:203]
    v_mfma_f32_16x16x32_bf16 v[204:207], a[40:43], a[12:15], v[204:207]
    v_mfma_f32_16x16x32_bf16 v[208:211], a[40:43], a[16:19], v[208:211]
    v_mfma_f32_16x16x32_bf16 v[212:215], a[40:43], a[20:23], v[212:215]
    v_mfma_f32_16x16x32_bf16 v[216:219], a[40:43], a[24:27], v[216:219]
    v_mfma_f32_16x16x32_bf16 v[220:223], a[40:43], a[28:31], v[220:223]
    s_waitcnt lgkmcnt(15)
    v_mfma_f32_16x16x32_bf16 v[224:227], a[44:47], a[0:3], v[224:227]
    v_mfma_f32_16x16x32_bf16 v[228:231], a[44:47], a[4:7], v[228:231]
    v_mfma_f32_16x16x32_bf16 v[232:235], a[44:47], a[8:11], v[232:235]
    v_mfma_f32_16x16x32_bf16 v[236:239], a[44:47], a[12:15], v[236:239]
    v_mfma_f32_16x16x32_bf16 v[240:243], a[44:47], a[16:19], v[240:243]
    v_mfma_f32_16x16x32_bf16 v[244:247], a[44:47], a[20:23], v[244:247]
    v_mfma_f32_16x16x32_bf16 v[248:251], a[44:47], a[24:27], v[248:251]
    v_mfma_f32_16x16x32_bf16 v[252:255], a[44:47], a[28:31], v[252:255]
    s_waitcnt vmcnt(0) lgkmcnt(0)
    s_barrier
L_k3_fin3:
    v_mfma_f32_16x16x32_bf16 v[128:131], a[80:83], a[48:51], v[128:131]
    ds_read_b64_tr_b16 a[128:129], v16 offset:0
    v_mfma_f32_16x16x32_bf16 v[132:135], a[80:83], a[52:55], v[132:135]
    ds_read_b64_tr_b16 a[130:131], v16 offset:1024
    s_add_u32 s31, s40, 196608
    buffer_load_dwordx4 v[32:35], v28, s[16:19], s31 offen offset:0
    v_mfma_f32_16x16x32_bf16 v[160:163], a[84:87], a[48:51], v[160:163]
    ds_read_b64_tr_b16 a[132:133], v17 offset:0
    v_mfma_f32_16x16x32_bf16 v[164:167], a[84:87], a[52:55], v[164:167]
    ds_read_b64_tr_b16 a[134:135], v17 offset:1024
    s_add_u32 s31, s40, 196608
    buffer_load_dwordx4 v[36:39], v28, s[16:19], s31 offen offset:64
    v_mfma_f32_16x16x32_bf16 v[192:195], a[88:91], a[48:51], v[192:195]
    ds_read_b64_tr_b16 a[136:137], v18 offset:0
    v_mfma_f32_16x16x32_bf16 v[196:199], a[88:91], a[52:55], v[196:199]
    ds_read_b64_tr_b16 a[138:139], v18 offset:1024
    s_add_u32 s31, s40, 229376
    buffer_load_dwordx4 v[40:43], v28, s[16:19], s31 offen offset:0
    v_mfma_f32_16x16x32_bf16 v[224:227], a[92:95], a[48:51], v[224:227]
    ds_read_b64_tr_b16 a[140:141], v19 offset:0
    v_mfma_f32_16x16x32_bf16 v[228:231], a[92:95], a[52:55], v[228:231]
    ds_read_b64_tr_b16 a[142:143], v19 offset:1024
    s_add_u32 s31, s40, 229376
    buffer_load_dwordx4 v[44:47], v28, s[16:19], s31 offen offset:64
    v_mfma_f32_16x16x32_bf16 v[136:139], a[80:83], a[56:59], v[136:139]
    ds_read_b128 a[96:99], v6 offset:0
    v_mfma_f32_16x16x32_bf16 v[140:143], a[80:83], a[60:63], v[140:143]
    ds_read_b128 a[100:103], v6 offset:512
    s_add_u32 s31, s41, 768
    buffer_load_dword v30, v29, s[8:11], s31 offen offset:0
    v_mfma_f32_16x16x32_bf16 v[168:171], a[84:87], a[56:59], v[168:171]
    ds_read_b64_tr_b16 a[176:177], v16 offset:8192
    v_mfma_f32_16x16x32_bf16 v[172:175], a[84:87], a[60:63], v[172:175]
    ds_read_b64_tr_b16 a[178:179], v16 offset:9216
    s_add_u32 s31, s41, 768
    buffer_load_dword v31, v29, s[8:11], s31 offen offset:128
    v_mfma_f32_16x16x32_bf16 v[200:203], a[88:91], a[56:59], v[200:203]
    ds_read_b64_tr_b16 a[180:181], v17 offset:8192
    v_mfma_f32_16x16x32_bf16 v[204:207], a[88:91], a[60:63], v[204:207]
    ds_read_b64_tr_b16 a[182:183], v17 offset:9216
    v_mfma_f32_16x16x32_bf16 v[232:235], a[92:95], a[56:59], v[232:235]
    ds_read_b64_tr_b16 a[184:185], v18 offset:8192
    v_mfma_f32_16x16x32_bf16 v[236:239], a[92:95], a[60:63], v[236:239]
    ds_read_b64_tr_b16 a[186:187], v18 offset:9216
    s_waitcnt lgkmcnt(7)
    v_mfma_f32_16x16x32_bf16 v[128:131], a[128:131], a[96:99], v[128:131]
    ds_read_b64_tr_b16 a[188:189], v19 offset:8192
    s_waitcnt lgkmcnt(7)
    v_mfma_f32_16x16x32_bf16 v[132:135], a[128:131], a[100:103], v[132:135]
    ds_read_b64_tr_b16 a[190:191], v19 offset:9216
    v_mfma_f32_16x16x32_bf16 v[160:163], a[132:135], a[96:99], v[160:163]
    ds_read_b128 a[144:147], v6 offset:16384
    v_mfma_f32_16x16x32_bf16 v[164:167], a[132:135], a[100:103], v[164:167]
    ds_read_b128 a[148:151], v6 offset:16896
    v_mfma_f32_16x16x32_bf16 v[192:195], a[136:139], a[96:99], v[192:195]
    ds_read_b128 a[104:107], v6 offset:1024
    v_mfma_f32_16x16x32_bf16 v[196:199], a[136:139], a[100:103], v[196:199]
    ds_read_b128 a[108:111], v6 offset:1536
    v_mfma_f32_16x16x32_bf16 v[224:227], a[140:143], a[96:99], v[224:227]
    ds_read_b128 a[152:155], v6 offset:17408
    v_mfma_f32_16x16x32_bf16 v[228:231], a[140:143], a[100:103], v[228:231]
    ds_read_b128 a[156:159], v6 offset:17920
    s_waitcnt lgkmcnt(5)
    v_mfma_f32_16x16x32_bf16 v[128:131], a[176:179], a[144:147], v[128:131]
    ds_read_b128 a[112:115], v6 offset:2048
    s_waitcnt lgkmcnt(5)
    v_mfma_f32_16x16x32_bf16 v[132:135], a[176:179], a[148:151], v[132:135]
    ds_read_b128 a[116:119], v6 offset:2560
    v_mfma_f32_16x16x32_bf16 v[160:163], a[180:183], a[144:147], v[160:163]
    ds_read_b128 a[160:163], v6 offset:18432
    v_mfma_f32_16x16x32_bf16 v[164:167], a[180:183], a[148:151], v[164:167]
    ds_read_b128 a[164:167], v6 offset:18944
    v_mfma_f32_16x16x32_bf16 v[192:195], a[184:187], a[144:147], v[192:195]
    ds_read_b128 a[120:123], v6 offset:3072
    v_mfma_f32_16x16x32_bf16 v[196:199], a[184:187], a[148:151], v[196:199]
    ds_read_b128 a[124:127], v6 offset:3584
    v_mfma_f32_16x16x32_bf16 v[224:227], a[188:191], a[144:147], v[224:227]
    ds_read_b128 a[168:171], v6 offset:19456
    v_mfma_f32_16x16x32_bf16 v[228:231], a[188:191], a[148:151], v[228:231]
    ds_read_b128 a[172:175], v6 offset:19968
    s_waitcnt lgkmcnt(11)
    v_mfma_f32_16x16x32_bf16 v[136:139], a[128:131], a[104:107], v[136:139]
    s_waitcnt lgkmcnt(10)
    v_mfma_f32_16x16x32_bf16 v[140:143], a[128:131], a[108:111], v[140:143]
    v_mfma_f32_16x16x32_bf16 v[168:171], a[132:135], a[104:107], v[168:171]
    v_mfma_f32_16x16x32_bf16 v[172:175], a[132:135], a[108:111], v[172:175]
    v_mfma_f32_16x16x32_bf16 v[200:203], a[136:139], a[104:107], v[200:203]
    v_mfma_f32_16x16x32_bf16 v[204:207], a[136:139], a[108:111], v[204:207]
    s_add_u32 s30, s34, 196608
    v_cvt_pk_bf16_f32 v48, v128, v129
    v_cvt_pk_bf16_f32 v49, v130, v131
    v_mfma_f32_16x16x32_bf16 v[232:235], a[140:143], a[104:107], v[232:235]
    v_cvt_pk_bf16_f32 v50, v160, v161
    v_cvt_pk_bf16_f32 v51, v162, v163
    v_mfma_f32_16x16x32_bf16 v[236:239], a[140:143], a[108:111], v[236:239]
    buffer_store_dwordx4 v[48:51], v1, s[8:11], s30 offen offset:0 sc1
    v_cvt_pk_bf16_f32 v52, v192, v193
    s_waitcnt lgkmcnt(9)
    v_mfma_f32_16x16x32_bf16 v[136:139], a[176:179], a[152:155], v[136:139]
    v_cvt_pk_bf16_f32 v53, v194, v195
    v_cvt_pk_bf16_f32 v54, v224, v225
    s_waitcnt lgkmcnt(8)
    v_mfma_f32_16x16x32_bf16 v[140:143], a[176:179], a[156:159], v[140:143]
    v_cvt_pk_bf16_f32 v55, v226, v227
    buffer_store_dwordx4 v[52:55], v1, s[8:11], s30 offen offset:1024 sc1
    v_mfma_f32_16x16x32_bf16 v[168:171], a[180:183], a[152:155], v[168:171]
    v_cvt_pk_bf16_f32 v56, v132, v133
    v_cvt_pk_bf16_f32 v57, v134, v135
    v_mfma_f32_16x16x32_bf16 v[172:175], a[180:183], a[156:159], v[172:175]
    v_cvt_pk_bf16_f32 v58, v164, v165
    v_cvt_pk_bf16_f32 v59, v166, v167
    v_mfma_f32_16x16x32_bf16 v[200:203], a[184:187], a[152:155], v[200:203]
    buffer_store_dwordx4 v[56:59], v1, s[8:11], s30 offen offset:2048 sc1
    v_cvt_pk_bf16_f32 v60, v196, v197
    v_mfma_f32_16x16x32_bf16 v[204:207], a[184:187], a[156:159], v[204:207]
    v_cvt_pk_bf16_f32 v61, v198, v199
    v_cvt_pk_bf16_f32 v62, v228, v229
    v_mfma_f32_16x16x32_bf16 v[232:235], a[188:191], a[152:155], v[232:235]
    v_cvt_pk_bf16_f32 v63, v230, v231
    buffer_store_dwordx4 v[60:63], v1, s[8:11], s30 offen offset:3072 sc1
    v_mfma_f32_16x16x32_bf16 v[236:239], a[188:191], a[156:159], v[236:239]
    v_mfma_f32_16x16x32_bf16 v[144:147], a[80:83], a[64:67], v[144:147]
    v_mfma_f32_16x16x32_bf16 v[148:151], a[80:83], a[68:71], v[148:151]
    v_mfma_f32_16x16x32_bf16 v[176:179], a[84:87], a[64:67], v[176:179]
    v_mfma_f32_16x16x32_bf16 v[180:183], a[84:87], a[68:71], v[180:183]
    v_mfma_f32_16x16x32_bf16 v[208:211], a[88:91], a[64:67], v[208:211]
    v_mfma_f32_16x16x32_bf16 v[212:215], a[88:91], a[68:71], v[212:215]
    s_add_u32 s30, s34, 212992
    v_cvt_pk_bf16_f32 v48, v136, v137
    v_cvt_pk_bf16_f32 v49, v138, v139
    v_mfma_f32_16x16x32_bf16 v[240:243], a[92:95], a[64:67], v[240:243]
    v_cvt_pk_bf16_f32 v50, v168, v169
    v_cvt_pk_bf16_f32 v51, v170, v171
    v_mfma_f32_16x16x32_bf16 v[244:247], a[92:95], a[68:71], v[244:247]
    buffer_store_dwordx4 v[48:51], v1, s[8:11], s30 offen offset:0 sc1
    v_cvt_pk_bf16_f32 v52, v200, v201
    s_waitcnt lgkmcnt(7)
    v_mfma_f32_16x16x32_bf16 v[144:147], a[128:131], a[112:115], v[144:147]
    v_cvt_pk_bf16_f32 v53, v202, v203
    v_cvt_pk_bf16_f32 v54, v232, v233
    s_waitcnt lgkmcnt(6)
    v_mfma_f32_16x16x32_bf16 v[148:151], a[128:131], a[116:119], v[148:151]
    v_cvt_pk_bf16_f32 v55, v234, v235
    buffer_store_dwordx4 v[52:55], v1, s[8:11], s30 offen offset:1024 sc1
    v_mfma_f32_16x16x32_bf16 v[176:179], a[132:135], a[112:115], v[176:179]
    v_cvt_pk_bf16_f32 v56, v140, v141
    v_cvt_pk_bf16_f32 v57, v142, v143
    v_mfma_f32_16x16x32_bf16 v[180:183], a[132:135], a[116:119], v[180:183]
    v_cvt_pk_bf16_f32 v58, v172, v173
    v_cvt_pk_bf16_f32 v59, v174, v175
    v_mfma_f32_16x16x32_bf16 v[208:211], a[136:139], a[112:115], v[208:211]
    buffer_store_dwordx4 v[56:59], v1, s[8:11], s30 offen offset:2048 sc1
    v_cvt_pk_bf16_f32 v60, v204, v205
    v_mfma_f32_16x16x32_bf16 v[212:215], a[136:139], a[116:119], v[212:215]
    v_cvt_pk_bf16_f32 v61, v206, v207
    v_cvt_pk_bf16_f32 v62, v236, v237
    v_mfma_f32_16x16x32_bf16 v[240:243], a[140:143], a[112:115], v[240:243]
    v_cvt_pk_bf16_f32 v63, v238, v239
    buffer_store_dwordx4 v[60:63], v1, s[8:11], s30 offen offset:3072 sc1
    v_mfma_f32_16x16x32_bf16 v[244:247], a[140:143], a[116:119], v[244:247]
    s_waitcnt lgkmcnt(5)
    v_mfma_f32_16x16x32_bf16 v[144:147], a[176:179], a[160:163], v[144:147]
    s_waitcnt lgkmcnt(4)
    v_mfma_f32_16x16x32_bf16 v[148:151], a[176:179], a[164:167], v[148:151]
    v_mfma_f32_16x16x32_bf16 v[176:179], a[180:183], a[160:163], v[176:179]
    v_mfma_f32_16x16x32_bf16 v[180:183], a[180:183], a[164:167], v[180:183]
    v_mfma_f32_16x16x32_bf16 v[208:211], a[184:187], a[160:163], v[208:211]
    v_mfma_f32_16x16x32_bf16 v[212:215], a[184:187], a[164:167], v[212:215]
    v_mfma_f32_16x16x32_bf16 v[240:243], a[188:191], a[160:163], v[240:243]
    v_mfma_f32_16x16x32_bf16 v[244:247], a[188:191], a[164:167], v[244:247]
    v_mfma_f32_16x16x32_bf16 v[152:155], a[80:83], a[72:75], v[152:155]
    v_mfma_f32_16x16x32_bf16 v[156:159], a[80:83], a[76:79], v[156:159]
    v_mfma_f32_16x16x32_bf16 v[184:187], a[84:87], a[72:75], v[184:187]
    v_mfma_f32_16x16x32_bf16 v[188:191], a[84:87], a[76:79], v[188:191]
    v_mfma_f32_16x16x32_bf16 v[216:219], a[88:91], a[72:75], v[216:219]
    v_mfma_f32_16x16x32_bf16 v[220:223], a[88:91], a[76:79], v[220:223]
    s_add_u32 s30, s34, 229376
    v_cvt_pk_bf16_f32 v48, v144, v145
    v_cvt_pk_bf16_f32 v49, v146, v147
    v_mfma_f32_16x16x32_bf16 v[248:251], a[92:95], a[72:75], v[248:251]
    v_cvt_pk_bf16_f32 v50, v176, v177
    v_cvt_pk_bf16_f32 v51, v178, v179
    v_mfma_f32_16x16x32_bf16 v[252:255], a[92:95], a[76:79], v[252:255]
    buffer_store_dwordx4 v[48:51], v1, s[8:11], s30 offen offset:0 sc1
    v_cvt_pk_bf16_f32 v52, v208, v209
    s_waitcnt lgkmcnt(3)
    v_mfma_f32_16x16x32_bf16 v[152:155], a[128:131], a[120:123], v[152:155]
    v_cvt_pk_bf16_f32 v53, v210, v211
    v_cvt_pk_bf16_f32 v54, v240, v241
    s_waitcnt lgkmcnt(2)
    v_mfma_f32_16x16x32_bf16 v[156:159], a[128:131], a[124:127], v[156:159]
    v_cvt_pk_bf16_f32 v55, v242, v243
    buffer_store_dwordx4 v[52:55], v1, s[8:11], s30 offen offset:1024 sc1
    v_mfma_f32_16x16x32_bf16 v[184:187], a[132:135], a[120:123], v[184:187]
    v_cvt_pk_bf16_f32 v56, v148, v149
    v_cvt_pk_bf16_f32 v57, v150, v151
    v_mfma_f32_16x16x32_bf16 v[188:191], a[132:135], a[124:127], v[188:191]
    v_cvt_pk_bf16_f32 v58, v180, v181
    v_cvt_pk_bf16_f32 v59, v182, v183
    v_mfma_f32_16x16x32_bf16 v[216:219], a[136:139], a[120:123], v[216:219]
    buffer_store_dwordx4 v[56:59], v1, s[8:11], s30 offen offset:2048 sc1
    v_cvt_pk_bf16_f32 v60, v212, v213
    v_mfma_f32_16x16x32_bf16 v[220:223], a[136:139], a[124:127], v[220:223]
    v_cvt_pk_bf16_f32 v61, v214, v215
    v_cvt_pk_bf16_f32 v62, v244, v245
    v_mfma_f32_16x16x32_bf16 v[248:251], a[140:143], a[120:123], v[248:251]
    v_cvt_pk_bf16_f32 v63, v246, v247
    buffer_store_dwordx4 v[60:63], v1, s[8:11], s30 offen offset:3072 sc1
    v_mfma_f32_16x16x32_bf16 v[252:255], a[140:143], a[124:127], v[252:255]
    s_waitcnt lgkmcnt(1)
    v_mfma_f32_16x16x32_bf16 v[152:155], a[176:179], a[168:171], v[152:155]
    s_waitcnt lgkmcnt(0)
    v_mfma_f32_16x16x32_bf16 v[156:159], a[176:179], a[172:175], v[156:159]
    v_mfma_f32_16x16x32_bf16 v[184:187], a[180:183], a[168:171], v[184:187]
    v_mfma_f32_16x16x32_bf16 v[188:191], a[180:183], a[172:175], v[188:191]
    v_mfma_f32_16x16x32_bf16 v[216:219], a[184:187], a[168:171], v[216:219]
    v_mfma_f32_16x16x32_bf16 v[220:223], a[184:187], a[172:175], v[220:223]
    v_mfma_f32_16x16x32_bf16 v[248:251], a[188:191], a[168:171], v[248:251]
    v_mfma_f32_16x16x32_bf16 v[252:255], a[188:191], a[172:175], v[252:255]
    v_mov_b32 v23, 0
    buffer_load_dword v26, v23, s[8:11], s35 offen sc1
    s_waitcnt vmcnt(1)
    v_mov_b32 v22, s97
    v_mov_b32 v23, 0
    v_lshlrev_b32 v24, 9, v20
    s_add_u32 s31, s35, 1536
    s_mov_b64 exec, 1
    buffer_store_dword v22, v23, s[8:11], s31 offen sc1
    s_mov_b64 exec, -1
    s_waitcnt vmcnt(1)
    v_readfirstlane_b32 s46, v26
    s_nop 0
    s_cmp_eq_u32 s46, s97
    s_cselect_b32 s46, 1, 0
    s_cbranch_scc0 L_k3_q3_nos
    s_add_u32 s30, s34, 311296
    buffer_load_dwordx4 v[96:99], v1, s[8:11], s30 offen offset:0 sc1
    buffer_load_dwordx4 v[100:103], v1, s[8:11], s30 offen offset:1024 sc1
    buffer_load_dwordx4 v[104:107], v1, s[8:11], s30 offen offset:2048 sc1
    buffer_load_dwordx4 v[108:111], v1, s[8:11], s30 offen offset:3072 sc1
L_k3_q3_nos:
    s_mov_b64 exec, 7
    s_mov_b32 s31, 0
L_k3_q3_poll:
    buffer_load_dword v25, v24, s[8:11], s35 offen sc1
    s_waitcnt vmcnt(0)
    v_cmp_eq_u32 vcc, s97, v25
    s_add_u32 s31, s31, 1
    s_cmp_gt_u32 s31, 0x40000
    s_cbranch_scc1 L_k3_q3_got
    s_cmp_eq_u32 vcc_lo, 7
    s_cbranch_scc0 L_k3_q3_poll
L_k3_q3_got:
    s_mov_b64 exec, -1
    s_add_u32 s30, s34, 114688
    buffer_load_dwordx4 v[64:67], v1, s[8:11], s30 offen offset:0 sc1
    buffer_load_dwordx4 v[68:71], v1, s[8:11], s30 offen offset:1024 sc1
    buffer_load_dwordx4 v[72:75], v1, s[8:11], s30 offen offset:2048 sc1
    buffer_load_dwordx4 v[76:79], v1, s[8:11], s30 offen offset:3072 sc1
    s_add_u32 s30, s34, 180224
    buffer_load_dwordx4 v[80:83], v1, s[8:11], s30 offen offset:0 sc1
    buffer_load_dwordx4 v[84:87], v1, s[8:11], s30 offen offset:1024 sc1
    buffer_load_dwordx4 v[88:91], v1, s[8:11], s30 offen offset:2048 sc1
    buffer_load_dwordx4 v[92:95], v1, s[8:11], s30 offen offset:3072 sc1
    s_cmp_eq_u32 s46, 1
    s_cbranch_scc1 L_k3_q3_haves
    s_add_u32 s30, s34, 311296
    buffer_load_dwordx4 v[96:99], v1, s[8:11], s30 offen offset:0 sc1
    buffer_load_dwordx4 v[100:103], v1, s[8:11], s30 offen offset:1024 sc1
    buffer_load_dwordx4 v[104:107], v1, s[8:11], s30 offen offset:2048 sc1
    buffer_load_dwordx4 v[108:111], v1, s[8:11], s30 offen offset:3072 sc1
L_k3_q3_haves:
    s_mov_b32 s47, 0xbfb8aa3b
    s_mov_b32 s48, 0xffff0000
    v_mul_f32 v30, v30, v30
    v_mul_f32 v2, s47, v30
    v_rcp_f32 v30, v30
    v_mul_f32 v31, v31, v31
    v_mul_f32 v3, s47, v31
    v_rcp_f32 v31, v31
    v_permlane16_swap_b32 v32, v34
    v_permlane16_swap_b32 v33, v35
    v_permlane16_swap_b32 v36, v38
    v_permlane16_swap_b32 v37, v39
    v_permlane16_swap_b32 v40, v42
    v_permlane16_swap_b32 v41, v43
    v_permlane16_swap_b32 v44, v46
    v_permlane16_swap_b32 v45, v47
    s_waitcnt vmcnt(7)
    v_lshlrev_b32 v48, 16, v64
    v_and_b32 v49, s48, v64
    v_lshlrev_b32 v50, 16, v65
    v_and_b32 v51, s48, v65
    v_pk_add_f32 v[152:153], v[152:153], v[48:49]
    v_pk_add_f32 v[154:155], v[154:155], v[50:51]
    s_waitcnt vmcnt(3)
    v_lshlrev_b32 v48, 16, v80
    v_and_b32 v49, s48, v80
    v_lshlrev_b32 v50, 16, v81
    v_and_b32 v51, s48, v81
    v_pk_add_f32 v[152:153], v[152:153], v[48:49]
    v_pk_add_f32 v[154:155], v[154:155], v[50:51]
    v_mul_f32 v52, v2, v152
    v_mul_f32 v53, v2, v153
    v_mul_f32 v54, v2, v154
    v_mul_f32 v55, v2, v155
    s_waitcnt vmcnt(3)
    v_lshlrev_b32 v128, 16, v96
    v_and_b32 v129, s48, v96
    v_lshlrev_b32 v130, 16, v97
    v_and_b32 v131, s48, v97
    v_exp_f32 v52, v52
    v_exp_f32 v53, v53
    v_exp_f32 v54, v54
    v_exp_f32 v55, v55
    v_pk_mul_f32 v[152:153], v[152:153], v[128:129]
    v_pk_mul_f32 v[154:155], v[154:155], v[130:131]
    v_fma_f32 v52, v52, v30, v30
    v_fma_f32 v53, v53, v30, v30
    v_fma_f32 v54, v54, v30, v30
    v_fma_f32 v55, v55, v30, v30
    v_lshlrev_b32 v48, 16, v32
    v_and_b32 v49, s48, v32
    v_rcp_f32 v52, v52
    v_rcp_f32 v53, v53
    v_rcp_f32 v54, v54
    v_rcp_f32 v55, v55
    v_lshlrev_b32 v50, 16, v33
    v_and_b32 v51, s48, v33
    v_pk_fma_f32 v[152:153], v[152:153], v[52:53], v[48:49]
    v_pk_fma_f32 v[154:155], v[154:155], v[54:55], v[50:51]
    v_cvt_pk_bf16_f32 v32, v152, v153
    v_cvt_pk_bf16_f32 v33, v154, v155
    v_lshlrev_b32 v56, 16, v66
    v_and_b32 v57, s48, v66
    v_lshlrev_b32 v58, 16, v67
    v_and_b32 v59, s48, v67
    v_pk_add_f32 v[184:185], v[184:185], v[56:57]
    v_pk_add_f32 v[186:187], v[186:187], v[58:59]
    v_lshlrev_b32 v56, 16, v82
    v_and_b32 v57, s48, v82
    v_lshlrev_b32 v58, 16, v83
    v_and_b32 v59, s48, v83
    v_pk_add_f32 v[184:185], v[184:185], v[56:57]
    v_pk_add_f32 v[186:187], v[186:187], v[58:59]
    v_mul_f32 v60, v2, v184
    v_mul_f32 v61, v2, v185
    v_mul_f32 v62, v2, v186
    v_mul_f32 v63, v2, v187
    v_lshlrev_b32 v160, 16, v98
    v_and_b32 v161, s48, v98
    v_lshlrev_b32 v162, 16, v99
    v_and_b32 v163, s48, v99
    v_exp_f32 v60, v60
    v_exp_f32 v61, v61
    v_exp_f32 v62, v62
    v_exp_f32 v63, v63
    v_pk_mul_f32 v[184:185], v[184:185], v[160:161]
    v_pk_mul_f32 v[186:187], v[186:187], v[162:163]
    v_fma_f32 v60, v60, v30, v30
    v_fma_f32 v61, v61, v30, v30
    v_fma_f32 v62, v62, v30, v30
    v_fma_f32 v63, v63, v30, v30
    v_lshlrev_b32 v56, 16, v34
    v_and_b32 v57, s48, v34
    v_rcp_f32 v60, v60
    v_rcp_f32 v61, v61
    v_rcp_f32 v62, v62
    v_rcp_f32 v63, v63
    v_lshlrev_b32 v58, 16, v35
    v_and_b32 v59, s48, v35
    v_pk_fma_f32 v[184:185], v[184:185], v[60:61], v[56:57]
    v_pk_fma_f32 v[186:187], v[186:187], v[62:63], v[58:59]
    v_cvt_pk_bf16_f32 v34, v184, v185
    v_cvt_pk_bf16_f32 v35, v186, v187
    s_add_u32 s31, s40, 196608
    s_nop 0
    v_permlane16_swap_b32 v32, v34
    v_permlane16_swap_b32 v33, v35
    buffer_store_dwordx4 v[32:35], v28, s[36:39], s31 offen offset:0 sc1
    v_lshlrev_b32 v48, 16, v68
    v_and_b32 v49, s48, v68
    v_lshlrev_b32 v50, 16, v69
    v_and_b32 v51, s48, v69
    v_pk_add_f32 v[216:217], v[216:217], v[48:49]
    v_pk_add_f32 v[218:219], v[218:219], v[50:51]
    s_waitcnt vmcnt(3)
    v_lshlrev_b32 v48, 16, v84
    v_and_b32 v49, s48, v84
    v_lshlrev_b32 v50, 16, v85
    v_and_b32 v51, s48, v85
    v_pk_add_f32 v[216:217], v[216:217], v[48:49]
    v_pk_add_f32 v[218:219], v[218:219], v[50:51]
    v_mul_f32 v52, v2, v216
    v_mul_f32 v53, v2, v217
    v_mul_f32 v54, v2, v218
    v_mul_f32 v55, v2, v219
    s_waitcnt vmcnt(3)
    v_lshlrev_b32 v192, 16, v100
    v_and_b32 v193, s48, v100
    v_lshlrev_b32 v194, 16, v101
    v_and_b32 v195, s48, v101
    v_exp_f32 v52, v52
    v_exp_f32 v53, v53
    v_exp_f32 v54, v54
    v_exp_f32 v55, v55
    v_pk_mul_f32 v[216:217], v[216:217], v[192:193]
    v_pk_mul_f32 v[218:219], v[218:219], v[194:195]
    v_fma_f32 v52, v52, v30, v30
    v_fma_f32 v53, v53, v30, v30
    v_fma_f32 v54, v54, v30, v30
    v_fma_f32 v55, v55, v30, v30
    v_lshlrev_b32 v48, 16, v36
    v_and_b32 v49, s48, v36
    v_rcp_f32 v52, v52
    v_rcp_f32 v53, v53
    v_rcp_f32 v54, v54
    v_rcp_f32 v55, v55
    v_lshlrev_b32 v50, 16, v37
    v_and_b32 v51, s48, v37
    v_pk_fma_f32 v[216:217], v[216:217], v[52:53], v[48:49]
    v_pk_fma_f32 v[218:219], v[218:219], v[54:55], v[50:51]
    v_cvt_pk_bf16_f32 v36, v216, v217
    v_cvt_pk_bf16_f32 v37, v218, v219
    v_lshlrev_b32 v56, 16, v70
    v_and_b32 v57, s48, v70
    v_lshlrev_b32 v58, 16, v71
    v_and_b32 v59, s48, v71
    v_pk_add_f32 v[248:249], v[248:249], v[56:57]
    v_pk_add_f32 v[250:251], v[250:251], v[58:59]
    v_lshlrev_b32 v56, 16, v86
    v_and_b32 v57, s48, v86
    v_lshlrev_b32 v58, 16, v87
    v_and_b32 v59, s48, v87
    v_pk_add_f32 v[248:249], v[248:249], v[56:57]
    v_pk_add_f32 v[250:251], v[250:251], v[58:59]
    v_mul_f32 v60, v2, v248
    v_mul_f32 v61, v2, v249
    v_mul_f32 v62, v2, v250
    v_mul_f32 v63, v2, v251
    v_lshlrev_b32 v224, 16, v102
    v_and_b32 v225, s48, v102
    v_lshlrev_b32 v226, 16, v103
    v_and_b32 v227, s48, v103
    v_exp_f32 v60, v60
    v_exp_f32 v61, v61
    v_exp_f32 v62, v62
    v_exp_f32 v63, v63
    v_pk_mul_f32 v[248:249], v[248:249], v[224:225]
    v_pk_mul_f32 v[250:251], v[250:251], v[226:227]
    v_fma_f32 v60, v60, v30, v30
    v_fma_f32 v61, v61, v30, v30
    v_fma_f32 v62, v62, v30, v30
    v_fma_f32 v63, v63, v30, v30
    v_lshlrev_b32 v56, 16, v38
    v_and_b32 v57, s48, v38
    v_rcp_f32 v60, v60
    v_rcp_f32 v61, v61
    v_rcp_f32 v62, v62
    v_rcp_f32 v63, v63
    v_lshlrev_b32 v58, 16, v39
    v_and_b32 v59, s48, v39
    v_pk_fma_f32 v[248:249], v[248:249], v[60:61], v[56:57]
    v_pk_fma_f32 v[250:251], v[250:251], v[62:63], v[58:59]
    v_cvt_pk_bf16_f32 v38, v248, v249
    v_cvt_pk_bf16_f32 v39, v250, v251
    s_add_u32 s31, s40, 196608
    s_nop 0
    v_permlane16_swap_b32 v36, v38
    v_permlane16_swap_b32 v37, v39
    buffer_store_dwordx4 v[36:39], v28, s[36:39], s31 offen offset:64 sc1
    v_lshlrev_b32 v48, 16, v72
    v_and_b32 v49, s48, v72
    v_lshlrev_b32 v50, 16, v73
    v_and_b32 v51, s48, v73
    v_pk_add_f32 v[156:157], v[156:157], v[48:49]
    v_pk_add_f32 v[158:159], v[158:159], v[50:51]
    s_waitcnt vmcnt(3)
    v_lshlrev_b32 v48, 16, v88
    v_and_b32 v49, s48, v88
    v_lshlrev_b32 v50, 16, v89
    v_and_b32 v51, s48, v89
    v_pk_add_f32 v[156:157], v[156:157], v[48:49]
    v_pk_add_f32 v[158:159], v[158:159], v[50:51]
    v_mul_f32 v52, v3, v156
    v_mul_f32 v53, v3, v157
    v_mul_f32 v54, v3, v158
    v_mul_f32 v55, v3, v159
    s_waitcnt vmcnt(3)
    v_lshlrev_b32 v132, 16, v104
    v_and_b32 v133, s48, v104
    v_lshlrev_b32 v134, 16, v105
    v_and_b32 v135, s48, v105
    v_exp_f32 v52, v52
    v_exp_f32 v53, v53
    v_exp_f32 v54, v54
    v_exp_f32 v55, v55
    v_pk_mul_f32 v[156:157], v[156:157], v[132:133]
    v_pk_mul_f32 v[158:159], v[158:159], v[134:135]
    v_fma_f32 v52, v52, v31, v31
    v_fma_f32 v53, v53, v31, v31
    v_fma_f32 v54, v54, v31, v31
    v_fma_f32 v55, v55, v31, v31
    v_lshlrev_b32 v48, 16, v40
    v_and_b32 v49, s48, v40
    v_rcp_f32 v52, v52
    v_rcp_f32 v53, v53
    v_rcp_f32 v54, v54
    v_rcp_f32 v55, v55
    v_lshlrev_b32 v50, 16, v41
    v_and_b32 v51, s48, v41
    v_pk_fma_f32 v[156:157], v[156:157], v[52:53], v[48:49]
    v_pk_fma_f32 v[158:159], v[158:159], v[54:55], v[50:51]
    v_cvt_pk_bf16_f32 v40, v156, v157
    v_cvt_pk_bf16_f32 v41, v158, v159
    v_lshlrev_b32 v56, 16, v74
    v_and_b32 v57, s48, v74
    v_lshlrev_b32 v58, 16, v75
    v_and_b32 v59, s48, v75
    v_pk_add_f32 v[188:189], v[188:189], v[56:57]
    v_pk_add_f32 v[190:191], v[190:191], v[58:59]
    v_lshlrev_b32 v56, 16, v90
    v_and_b32 v57, s48, v90
    v_lshlrev_b32 v58, 16, v91
    v_and_b32 v59, s48, v91
    v_pk_add_f32 v[188:189], v[188:189], v[56:57]
    v_pk_add_f32 v[190:191], v[190:191], v[58:59]
    v_mul_f32 v60, v3, v188
    v_mul_f32 v61, v3, v189
    v_mul_f32 v62, v3, v190
    v_mul_f32 v63, v3, v191
    v_lshlrev_b32 v164, 16, v106
    v_and_b32 v165, s48, v106
    v_lshlrev_b32 v166, 16, v107
    v_and_b32 v167, s48, v107
    v_exp_f32 v60, v60
    v_exp_f32 v61, v61
    v_exp_f32 v62, v62
    v_exp_f32 v63, v63
    v_pk_mul_f32 v[188:189], v[188:189], v[164:165]
    v_pk_mul_f32 v[190:191], v[190:191], v[166:167]
    v_fma_f32 v60, v60, v31, v31
    v_fma_f32 v61, v61, v31, v31
    v_fma_f32 v62, v62, v31, v31
    v_fma_f32 v63, v63, v31, v31
    v_lshlrev_b32 v56, 16, v42
    v_and_b32 v57, s48, v42
    v_rcp_f32 v60, v60
    v_rcp_f32 v61, v61
    v_rcp_f32 v62, v62
    v_rcp_f32 v63, v63
    v_lshlrev_b32 v58, 16, v43
    v_and_b32 v59, s48, v43
    v_pk_fma_f32 v[188:189], v[188:189], v[60:61], v[56:57]
    v_pk_fma_f32 v[190:191], v[190:191], v[62:63], v[58:59]
    v_cvt_pk_bf16_f32 v42, v188, v189
    v_cvt_pk_bf16_f32 v43, v190, v191
    s_add_u32 s31, s40, 229376
    s_nop 0
    v_permlane16_swap_b32 v40, v42
    v_permlane16_swap_b32 v41, v43
    buffer_store_dwordx4 v[40:43], v28, s[36:39], s31 offen offset:0 sc1
    v_lshlrev_b32 v48, 16, v76
    v_and_b32 v49, s48, v76
    v_lshlrev_b32 v50, 16, v77
    v_and_b32 v51, s48, v77
    v_pk_add_f32 v[220:221], v[220:221], v[48:49]
    v_pk_add_f32 v[222:223], v[222:223], v[50:51]
    s_waitcnt vmcnt(3)
    v_lshlrev_b32 v48, 16, v92
    v_and_b32 v49, s48, v92
    v_lshlrev_b32 v50, 16, v93
    v_and_b32 v51, s48, v93
    v_pk_add_f32 v[220:221], v[220:221], v[48:49]
    v_pk_add_f32 v[222:223], v[222:223], v[50:51]
    v_mul_f32 v52, v3, v220
    v_mul_f32 v53, v3, v221
    v_mul_f32 v54, v3, v222
    v_mul_f32 v55, v3, v223
    s_waitcnt vmcnt(3)
    v_lshlrev_b32 v196, 16, v108
    v_and_b32 v197, s48, v108
    v_lshlrev_b32 v198, 16, v109
    v_and_b32 v199, s48, v109
    v_exp_f32 v52, v52
    v_exp_f32 v53, v53
    v_exp_f32 v54, v54
    v_exp_f32 v55, v55
    v_pk_mul_f32 v[220:221], v[220:221], v[196:197]
    v_pk_mul_f32 v[222:223], v[222:223], v[198:199]
    v_fma_f32 v52, v52, v31, v31
    v_fma_f32 v53, v53, v31, v31
    v_fma_f32 v54, v54, v31, v31
    v_fma_f32 v55, v55, v31, v31
    v_lshlrev_b32 v48, 16, v44
    v_and_b32 v49, s48, v44
    v_rcp_f32 v52, v52
    v_rcp_f32 v53, v53
    v_rcp_f32 v54, v54
    v_rcp_f32 v55, v55
    v_lshlrev_b32 v50, 16, v45
    v_and_b32 v51, s48, v45
    v_pk_fma_f32 v[220:221], v[220:221], v[52:53], v[48:49]
    v_pk_fma_f32 v[222:223], v[222:223], v[54:55], v[50:51]
    v_cvt_pk_bf16_f32 v44, v220, v221
    v_cvt_pk_bf16_f32 v45, v222, v223
    v_lshlrev_b32 v56, 16, v78
    v_and_b32 v57, s48, v78
    v_lshlrev_b32 v58, 16, v79
    v_and_b32 v59, s48, v79
    v_pk_add_f32 v[252:253], v[252:253], v[56:57]
    v_pk_add_f32 v[254:255], v[254:255], v[58:59]
    v_lshlrev_b32 v56, 16, v94
    v_and_b32 v57, s48, v94
    v_lshlrev_b32 v58, 16, v95
    v_and_b32 v59, s48, v95
    v_pk_add_f32 v[252:253], v[252:253], v[56:57]
    v_pk_add_f32 v[254:255], v[254:255], v[58:59]
    v_mul_f32 v60, v3, v252
    v_mul_f32 v61, v3, v253
    v_mul_f32 v62, v3, v254
    v_mul_f32 v63, v3, v255
    v_lshlrev_b32 v228, 16, v110
    v_and_b32 v229, s48, v110
    v_lshlrev_b32 v230, 16, v111
    v_and_b32 v231, s48, v111
    v_exp_f32 v60, v60
    v_exp_f32 v61, v61
    v_exp_f32 v62, v62
    v_exp_f32 v63, v63
    v_pk_mul_f32 v[252:253], v[252:253], v[228:229]
    v_pk_mul_f32 v[254:255], v[254:255], v[230:231]
    v_fma_f32 v60, v60, v31, v31
    v_fma_f32 v61, v61, v31, v31
    v_fma_f32 v62, v62, v31, v31
    v_fma_f32 v63, v63, v31, v31
    v_lshlrev_b32 v56, 16, v46
    v_and_b32 v57, s48, v46
    v_rcp_f32 v60, v60
    v_rcp_f32 v61, v61
    v_rcp_f32 v62, v62
    v_rcp_f32 v63, v63
    v_lshlrev_b32 v58, 16, v47
    v_and_b32 v59, s48, v47
    v_pk_fma_f32 v[252:253], v[252:253], v[60:61], v[56:57]
    v_pk_fma_f32 v[254:255], v[254:255], v[62:63], v[58:59]
    v_cvt_pk_bf16_f32 v46, v252, v253
    v_cvt_pk_bf16_f32 v47, v254, v255
    s_add_u32 s31, s40, 229376
    s_nop 0
    v_permlane16_swap_b32 v44, v46
    v_permlane16_swap_b32 v45, v47
    buffer_store_dwordx4 v[44:47], v28, s[36:39], s31 offen offset:64 sc1
    s_endpgm
    s_endpgm
L_text_end:
    s_endpgm
.section .rodata,"a"
.p2align 6
.amdhsa_kernel recurrent_scan__sliding_block__glu_gated_bilinear__prompt_kernel
  .amdhsa_next_free_vgpr 512
  .amdhsa_next_free_sgpr 102
  .amdhsa_accum_offset 256
  .amdhsa_group_segment_fixed_size 0
  .amdhsa_kernarg_size 80
  .amdhsa_user_sgpr_count 2
  .amdhsa_user_sgpr_kernarg_segment_ptr 1
  .amdhsa_system_sgpr_workgroup_id_x 1
  .amdhsa_float_denorm_mode_32 3
.end_amdhsa_kernel
```
